```python
import torch

def _softmax(x, axis=-1):
    return torch.softmax(x, dim=axis)

def _gelu(x):
    return torch.nn.functional.gelu(x, approximate='tanh')

def _silu(x):
    return torch.nn.functional.silu(x)

def _sigmoid(x):
    return torch.sigmoid(x)

def _layernorm(x, axis=-1, eps=1e-05):
    m = x.mean(dim=axis, keepdim=True)
    v = x.var(dim=axis, keepdim=True, unbiased=False)
    return (x - m) / torch.sqrt(v + eps)

def _scatter_add(tgt, idx, src, axis=0):
    return tgt.clone().index_add_(axis, idx, src)

def _segment_sum(src, seg, n):
    out = torch.zeros((n,) + src.shape[1:], dtype=src.dtype)
    return out.index_add_(0, seg, src)

def _pad(x, pw):
    flat = tuple((v for pair in reversed(pw) for v in pair))
    return torch.nn.functional.pad(x, flat)
kernel_name = 'adaLN_cond__sliding_block_cached__dense_activation_relu__prompt'

def setup_inputs():

    _w = lambda a: (lambda t: t.to(torch.bfloat16) if t.is_floating_point() else t)(torch.as_tensor(a))

    def _A_setup():
        B, Sq, D = (1, 2048, 448)
        Hq, Hkv, Sk, Dh = (16, 8, 2048, 256)
        assert Hq % Hkv == 0, (Hq, Hkv)
        return {'x': _w((lambda *s: torch.randn(*s, dtype=torch.bfloat16) * 0.05)(B, Sq, D)), 'k_cache': _w((lambda *s: torch.randn(*s, dtype=torch.bfloat16) * 3.2)(B, Hkv, Sk, Dh)), 'v_cache': _w((lambda *s: torch.randn(*s, dtype=torch.bfloat16) * 0.4)(B, Hkv, Sk, Dh)), 'wq': _w((lambda *s: torch.randn(*s, dtype=torch.bfloat16) * 3.2)(D, Hq * Dh) * D ** (-0.5)), 'wo': _w((lambda *s: torch.randn(*s, dtype=torch.bfloat16) * 0.4)(Hq * Dh, D) * (Hq * Dh) ** (-0.5))}
    _A_in = _A_setup()

    def _B_setup():
        B, S, D, Dff = (1, 2048, 448, 1792)
        return {'x': _w((lambda *s: torch.randn(*s, dtype=torch.bfloat16) * 0.05)(B, S, D)), 'w1': _w((lambda *s: torch.randn(*s, dtype=torch.bfloat16) * 0.05)(D, Dff)), 'w2': _w((lambda *s: torch.randn(*s, dtype=torch.bfloat16) * 0.05)(Dff, D))}
    _B_in = _B_setup()
    return {'A_x': _A_in['x'], 'A_k_cache': _A_in['k_cache'], 'A_v_cache': _A_in['v_cache'], 'A_wq': _A_in['wq'], 'A_wo': _A_in['wo'], 'B_x': _B_in['x'], 'B_w1': _B_in['w1'], 'B_w2': _B_in['w2'], 'c': _w((lambda *s: torch.randn(*s, dtype=torch.bfloat16) * 0.1)(1, 448) * 8.0), 'w_mod': _w((lambda *s: torch.randn(*s, dtype=torch.bfloat16) * 0.1)(448, 6 * 448) * 448 ** (-0.5) * 8.0)}

def reference(A_x, A_k_cache, A_v_cache, A_wq, A_wo, B_x, B_w1, B_w2, c, w_mod):

    def _A_ref(x, k_cache, v_cache, wq, wo):
        B, Sq, D = x.shape
        Hq, Dh = (16, 256)
        Hkv, Sk = (k_cache.shape[1], k_cache.shape[2])
        W = min(4096, max(256, Sk // 4))
        rep = Hq // Hkv
        q = (lambda x, *d: x.permute(*d))((x @ wq).reshape(B, Sq, Hq, Dh), 0, 2, 1, 3)
        k = (lambda x, n, axis: torch.repeat_interleave(x, n, dim=axis))(k_cache[:, :, Sk - W:, :], rep, axis=1)
        v = (lambda x, n, axis: torch.repeat_interleave(x, n, dim=axis))(v_cache[:, :, Sk - W:, :], rep, axis=1)
        scores = torch.einsum('bhqd,bhkd->bhqk', q, k) * Dh ** (-0.5)
        p = _softmax(scores, axis=-1)
        o = torch.einsum('bhqk,bhkd->bhqd', p, v)
        return (lambda x, *d: x.permute(*d))(o, 0, 2, 1, 3).reshape(B, Sq, Hq * Dh) @ wo

    def _B_ref(x, w1, w2):
        h = torch.einsum('bsd,df->bsf', x, w1)
        zero = torch.zeros_like(h)
        h = torch.maximum(h, zero)
        return torch.einsum('bsf,fd->bsd', h, w2)
    x = A_x
    mod = (_silu(c) @ w_mod).reshape(c.shape[0], 6, 1, -1)
    sa, ca, ga, sb, cb, gb = (mod[:, 0].clone(), mod[:, 1].clone(), mod[:, 2].clone(), mod[:, 3].clone(), mod[:, 4].clone(), mod[:, 5].clone())
    h = _layernorm(x, axis=-1) * (1 + ca) + sa
    x = x + ga * _A_ref(h, A_k_cache, A_v_cache, A_wq, A_wo)
    h = _layernorm(x, axis=-1) * (1 + cb) + sb
    x = x + gb * _B_ref(h, B_w1, B_w2)
    return x
```

```asm
; @launch grid=(256,1,1) block=(256,1,1) lds=163840
.amdgcn_target "amdgcn-amd-amdhsa--gfx950"
.text
.globl adaLN_cond__sliding_block_cached__dense_activation_relu__prompt_kernel
.p2align 8
.type adaLN_cond__sliding_block_cached__dense_activation_relu__prompt_kernel,@function
adaLN_cond__sliding_block_cached__dense_activation_relu__prompt_kernel:
    s_cmp_ge_u32 s2, 256
    s_cbranch_scc1 L_end
    s_load_dwordx16 s[36:51], s[0:1], 0
    s_load_dwordx8 s[52:59], s[0:1], 64
    s_load_dwordx2 s[60:61], s[0:1], 96
    s_getpc_b64 s[4:5]
L_pc:
    s_add_u32 s4, s4, L_page0-L_pc
    s_addc_u32 s5, s5, 0
    s_mov_b32 s6, L_fast_end-L_page0
    s_mov_b32 s7, 0x20000
    s_lshr_b32 s69, s2, 3
    s_and_b32 s70, s2, 7
    v_lshrrev_b32 v1, 6, v0
    v_lshlrev_b32 v2, 7, v0
    v_readfirstlane_b32 s88, v1
    s_mul_i32 s3, s69, 2560
    v_cmp_gt_u32 vcc, 64, v0
    v_add_u32 v3, s3, v2
    s_nop 0
    v_cndmask_b32 v3, v3, v2, vcc
    v_mov_b32 v63, 1073741824
    v_cmp_gt_u32 vcc, 0x54, v0
    s_nop 1
    v_cndmask_b32 v3, v63, v3, vcc
    buffer_load_dword v62, v3, s[4:7], 0 offen
    v_lshrrev_b32 v3, 2, v0
    v_mul_u32_u24 v4, 5376, v3
    v_and_b32 v5, 3, v0
    v_lshl_add_u32 v4, v5, 4, v4
    v_lshlrev_b32 v6, 1, v3
    s_lshr_b32 s99, s69, 1
    s_lshr_b32 s4, s99, 1
    s_sub_u32 s6, s70, s4
    s_and_b32 s6, s6, 3
    s_lshl_b32 s4, s4, 1
    s_lshr_b32 s5, s70, 2
    s_add_u32 s4, s4, s5
    s_mul_i32 s4, s4, 3
    s_add_u32 s4, s4, s6
    s_lshl_b32 s4, s4, 1
    s_and_b32 s5, s99, 1
    s_add_u32 s71, s4, s5
    s_cmp_eq_u32 s6, 3
    s_cselect_b32 s71, 0x82, s71
    s_and_b32 s5, s69, 1
    s_cselect_b32 s71, 0x80, s71
    s_lshl_b32 s3, s71, 6
    s_bitcmp1_b32 s71, 0
    s_cselect_b32 s62, 2064384, 0
    s_cselect_b32 s63, 0x300, 0
    s_mov_b32 s64, 344064
    s_cselect_b32 s64, 4294623232, s64
    s_mov_b32 s65, 0x80
    s_cselect_b32 s65, 0xffffff80, s65
    s_add_u32 s3, s3, s62
    v_mov_b32 v61, v0
    v_and_b32 v0, 63, v0
    s_and_b32 s4, s70, 3
    s_lshl_b32 s4, s4, 1
    s_add_u32 s86, s4, s5
    s_lshr_b32 s4, s70, 2
    s_lshl_b32 s4, s4, 4
    s_add_u32 s87, s4, s99
    v_lshlrev_b32 v27, 4, v0
    v_cmp_gt_u32 vcc, 56, v0
    s_mov_b32 s68, 0xffff0000
    s_nop 0
    v_cndmask_b32 v57, v63, v27, vcc
    s_lshl_b32 s4, s87, 2
    s_add_u32 s4, s4, s88
    s_mul_i32 s69, s4, 14336
    v_mov_b32 v59, 0
    s_waitcnt lgkmcnt(0)
    s_cmp_lt_u32 s71, 84
    s_cbranch_scc0 L_x
    s_mov_b32 s12, s52
    s_mov_b32 s13, s53
    s_mov_b32 s14, 896
    s_mov_b32 s15, 0x20000
    s_mov_b32 s8, s54
    s_mov_b32 s9, s55
    s_mov_b32 s10, 2408448
    s_mov_b32 s11, 0x20000
    buffer_load_ushort v160, v6, s[12:15], s63 offen
    s_add_u32 s63, s63, s65
    buffer_load_ushort v161, v6, s[12:15], s63 offen
    s_add_u32 s63, s63, s65
    buffer_load_ushort v162, v6, s[12:15], s63 offen
    s_add_u32 s63, s63, s65
    buffer_load_ushort v163, v6, s[12:15], s63 offen
    s_add_u32 s63, s63, s65
    buffer_load_ushort v164, v6, s[12:15], s63 offen
    s_add_u32 s63, s63, s65
    buffer_load_ushort v165, v6, s[12:15], s63 offen
    s_add_u32 s63, s63, s65
    buffer_load_ushort v166, v6, s[12:15], s63 offen
    buffer_load_dwordx4 v[128:131], v4, s[8:11], s3 offen
    s_add_u32 s3, s3, s64
    buffer_load_dwordx4 v[132:135], v4, s[8:11], s3 offen
    s_add_u32 s3, s3, s64
    buffer_load_dwordx4 v[136:139], v4, s[8:11], s3 offen
    s_add_u32 s3, s3, s64
    buffer_load_dwordx4 v[140:143], v4, s[8:11], s3 offen
    s_add_u32 s3, s3, s64
    buffer_load_dwordx4 v[144:147], v4, s[8:11], s3 offen
    s_add_u32 s3, s3, s64
    buffer_load_dwordx4 v[148:151], v4, s[8:11], s3 offen
    s_add_u32 s3, s3, s64
    buffer_load_dwordx4 v[152:155], v4, s[8:11], s3 offen
    s_mov_b32 s24, s36
    s_mov_b32 s25, s37
    s_mov_b32 s26, 1835008
    s_mov_b32 s27, 0x20000
    s_mov_b32 s32, s58
    s_mov_b32 s33, s59
    s_mov_b32 s34, 256
    s_mov_b32 s35, 0x20000
    s_branch L_setup
L_x:
    s_mov_b32 s24, s36
    s_mov_b32 s25, s37
    s_mov_b32 s26, 1835008
    s_mov_b32 s27, 0x20000
    s_mov_b32 s32, s58
    s_mov_b32 s33, s59
    s_mov_b32 s34, 256
    s_mov_b32 s35, 0x20000
    s_lshl_b32 s3, s88, 8
    s_add_u32 s3, s3, s2
    s_cmp_lg_u32 s3, 8
    s_cbranch_scc1 L_notag
    s_memrealtime s[4:5]
    v_cmp_eq_u32 vcc, 0, v0
    s_waitcnt lgkmcnt(0)
    s_or_b32 s3, s4, 1
    v_mov_b32 v8, s3
    s_xor_b32 s3, s5, 0x5bd1e995
    v_mov_b32 v9, s3
    v_cndmask_b32 v10, v63, v59, vcc
    buffer_store_dwordx2 v[8:9], v10, s[32:35], 0 offen sc1
L_notag:
    buffer_load_dwordx4 v[64:67], v57, s[24:27], s69 offen
    buffer_load_dwordx4 v[68:71], v57, s[24:27], s69 offen offset:896
    buffer_load_dwordx4 v[72:75], v57, s[24:27], s69 offen offset:1792
    buffer_load_dwordx4 v[76:79], v57, s[24:27], s69 offen offset:2688
    s_add_u32 s69, s69, 3584
    buffer_load_dwordx4 v[80:83], v57, s[24:27], s69 offen
    buffer_load_dwordx4 v[84:87], v57, s[24:27], s69 offen offset:896
    buffer_load_dwordx4 v[88:91], v57, s[24:27], s69 offen offset:1792
    buffer_load_dwordx4 v[92:95], v57, s[24:27], s69 offen offset:2688
    s_add_u32 s69, s69, 3584
    buffer_load_dwordx4 v[96:99], v57, s[24:27], s69 offen
    buffer_load_dwordx4 v[100:103], v57, s[24:27], s69 offen offset:896
    buffer_load_dwordx4 v[104:107], v57, s[24:27], s69 offen offset:1792
    buffer_load_dwordx4 v[108:111], v57, s[24:27], s69 offen offset:2688
    s_add_u32 s69, s69, 3584
    buffer_load_dwordx4 v[112:115], v57, s[24:27], s69 offen
    buffer_load_dwordx4 v[116:119], v57, s[24:27], s69 offen offset:896
    buffer_load_dwordx4 v[120:123], v57, s[24:27], s69 offen offset:1792
    buffer_load_dwordx4 v[124:127], v57, s[24:27], s69 offen offset:2688
    s_branch L_setup
.p2align 12
L_page0:
L_setup:
    s_mov_b32 s28, s60
    s_mov_b32 s29, s61
    s_mov_b32 s30, 69206016
    s_mov_b32 s31, 0x20000
    s_bfe_u32 s3, s86, 0x10001
    s_xor_b32 s91, s88, s3
    s_lshr_b32 s89, s88, 1
    s_and_b32 s90, s88, 1
    s_lshl_b32 s4, s86, 10
    s_lshl_b32 s5, s86, 20
    s_mul_i32 s6, s86, 458752
    s_add_u32 s8, s42, s4
    s_addc_u32 s9, s43, 0
    s_mov_b32 s10, 3662848
    s_mov_b32 s11, 0x20000
    s_add_u32 s12, s38, s5
    s_addc_u32 s13, s39, 0
    s_add_u32 s12, s12, 784384
    s_addc_u32 s13, s13, 0
    s_mov_b32 s14, 264192
    s_mov_b32 s15, 0x20000
    s_add_u32 s16, s40, s5
    s_addc_u32 s17, s41, 0
    s_add_u32 s16, s16, 784384
    s_addc_u32 s17, s17, 0
    s_mov_b32 s18, 264192
    s_mov_b32 s19, 0x20000
    s_add_u32 s20, s44, s6
    s_addc_u32 s21, s45, 0
    s_sub_u32 s20, s20, 512
    s_subb_u32 s21, s21, 0
    s_mov_b32 s22, 459264
    s_mov_b32 s23, 0x20000
    v_lshrrev_b32 v55, 3, v61
    v_lshlrev_b32 v55, 13, v55
    v_bfe_u32 v35, v0, 1, 2
    v_lshl_add_u32 v55, v35, 9, v55
    v_and_b32 v35, 1, v0
    v_lshl_add_u32 v55, v35, 7, v55
    v_and_b32 v35, 15, v0
    s_and_b32 s3, s86, 1
    s_cselect_b32 s7, 0xe0, 0
    v_cmp_gt_u32 vcc, s7, v61
    s_mul_i32 s101, s99, 229376
    s_add_u32 s101, s101, s4
    v_cndmask_b32 v29, v63, v55, vcc
    s_max_u32 s101, s101, 1024
    s_sub_u32 s101, s101, 1024
    s_mov_b32 s4, s42
    s_mov_b32 s5, s43
    s_mov_b32 s6, 3670016
    s_mov_b32 s7, 0x20000
    buffer_load_dword v28, v29, s[4:7], s101 offen
    v_cmp_gt_u32 vcc, 32, v61
    v_lshlrev_b32 v31, 7, v61
    s_lshl_b32 s100, s99, 12
    v_cndmask_b32 v31, v63, v31, vcc
    s_add_u32 s100, s100, 2048
    v_and_b32 v39, 7, v0
    v_lshrrev_b32 v38, 5, v0
    v_lshlrev_b32 v38, 5, v38
    v_bfe_u32 v37, v0, 3, 1
    v_lshl_add_u32 v38, v37, 4, v38
    v_bfe_u32 v37, v0, 4, 1
    v_lshl_add_u32 v38, v37, 2, v38
    v_lshlrev_b32 v38, 13, v38
    v_lshl_add_u32 v38, v39, 4, v38
    v_add_u32 v15, 0, v38
    v_add_u32 v16, 7160, v38
    v_add_u32 v17, 14272, v38
    v_add_u32 v18, 21432, v38
    s_mul_i32 s72, s88, 8448
    s_mul_i32 s73, s88, 4224
    s_lshl_b32 s3, s90, 19
    s_lshl_b32 s70, s89, 9
    s_add_u32 s74, s3, s70
    s_mul_i32 s3, s90, 4291821696
    s_add_u32 s92, s3, s70
    s_lshl_b32 s75, s88, 11
    s_lshl_b32 s3, s89, 2
    s_add_u32 s3, s3, s90
    s_mul_i32 s76, s3, 57344
    v_lshrrev_b32 v1, 3, v0
    v_lshlrev_b32 v1, 8, v1
    v_lshl_add_u32 v1, v39, 4, v1
    v_bfe_u32 v33, v0, 2, 3
    v_lshlrev_b32 v32, 10, v33
    v_lshrrev_b32 v34, 1, v33
    v_lshl_add_u32 v32, v34, 6, v32
    v_and_b32 v34, 1, v33
    v_lshl_add_u32 v32, v34, 3, v32
    v_and_b32 v33, 3, v0
    v_lshl_add_u32 v32, v33, 4, v32
    v_lshrrev_b32 v34, 5, v0
    v_lshl_add_u32 v8, v34, 7, v32
    s_mul_i32 s3, s89, 16896
    v_add_u32 v2, s3, v8
    s_mul_i32 s3, s89, 16832
    s_add_u32 s3, s3, 64
    v_add_u32 v12, s3, v8
    s_mul_i32 s3, s89, 16960
    v_add_u32 v8, s3, v8
    v_lshrrev_b32 v36, 4, v0
    v_mul_u32_u24 v4, 1056, v35
    v_lshl_add_u32 v4, v36, 4, v4
    v_lshrrev_b32 v37, 2, v0
    v_mul_u32_u24 v6, 1056, v37
    v_lshl_add_u32 v6, v33, 3, v6
    v_add_u32 v3, 67584, v2
    v_add_u32 v5, 67584, v4
    v_add_u32 v7, 67584, v6
    v_add_u32 v9, 67584, v8
    v_add_u32 v13, 67584, v12
    v_mul_u32_u24 v42, 3584, v37
    v_lshl_add_u32 v42, v33, 7, v42
    v_xor_b32 v37, v35, v36
    v_lshlrev_b32 v10, 8, v36
    v_lshl_add_u32 v10, v37, 4, v10
    s_mul_i32 s3, s90, 28672
    s_add_u32 s3, s3, 101376
    v_add_u32 v10, s3, v10
    v_and_b32 v38, 31, v0
    v_lshlrev_b32 v38, 4, v38
    v_lshl_add_u32 v38, v34, 13, v38
    v_add_u32 v19, 2048, v38
    v_add_u32 v20, 1504, v38
    v_add_u32 v21, 960, v38
    v_add_u32 v22, 416, v38
    v_lshrrev_b32 v38, 3, v0
    v_mul_u32_u24 v38, 7168, v38
    v_lshl_add_u32 v38, v39, 4, v38
    v_add_u32 v23, 512, v38
    v_add_u32 v24, 376, v38
    v_add_u32 v25, 192, v38
    v_add_u32 v26, 56, v38
    v_mov_b32 v14, v1
    s_lshl_b32 s79, s90, 19
    s_and_b32 s3, s86, 4
    s_add_u32 s3, s3, s86
    s_lshl_b32 s3, s3, 11
    s_add_u32 s79, s79, s3
    s_lshl_b32 s3, s89, 10
    s_add_u32 s79, s79, s3
    s_bitcmp1_b32 s86, 1
    s_cselect_b32 s3, 0, 0x40000
    s_cselect_b32 s70, 0x40000, 0
    s_add_u32 s81, s79, s3
    s_add_u32 s79, s79, s70
    v_lshlrev_b32 v58, 8, v0
    v_lshl_add_u32 v58, v39, 4, v58
    s_mul_i32 s3, s91, 14336
    s_add_u32 s3, s3, 101376
    v_add_u32 v58, s3, v58
    v_cmp_gt_u32 vcc, 56, v0
    v_lshlrev_b32 v38, 4, v39
    v_add_u32 v38, 162304, v38
    v_cndmask_b32 v58, v38, v58, vcc
    v_xor_b32 v44, 16, v58
    v_xor_b32 v45, 32, v58
    v_xor_b32 v46, 48, v58
    v_xor_b32 v47, 64, v58
    v_xor_b32 v48, 80, v58
    v_xor_b32 v49, 96, v58
    v_xor_b32 v50, 112, v58
    v_mov_b32 v38, 0x3f803f80
    v_cmp_eq_u32 vcc, 0, v33
    s_nop 1
    v_cndmask_b32 v38, v59, v38, vcc
    v_accvgpr_write_b32 a248, v38
    v_accvgpr_write_b32 a249, v38
    v_accvgpr_write_b32 a250, v38
    v_accvgpr_write_b32 a251, v38
    v_accvgpr_write_b32 a252, -1
    v_accvgpr_write_b32 a253, -1
    v_accvgpr_write_b32 a254, -1
    v_accvgpr_write_b32 a255, -1
    v_min_u32 v52, 55, v0
    v_lshlrev_b32 v52, 5, v52
    s_mul_i32 s96, s89, 1792
    s_lshl_b32 s3, s90, 4
    s_add_u32 s96, s96, s3
    v_lshlrev_b32 v54, 5, v0
    v_add_u32 v54, 158720, v54
    s_lshl_b32 s3, s88, 3
    v_add_u32 v53, s3, v54
    v_lshlrev_b32 v43, 7, v61
    v_cmp_gt_u32 vcc, 8, v61
    s_mul_i32 s97, s99, 28672
    s_add_u32 s97, s97, 512
    v_cndmask_b32 v55, v63, v43, vcc
    v_cmp_gt_u32 vcc, 56, v61
    v_mov_b32 v51, v63
    s_nop 0
    v_cndmask_b32 v60, v63, v43, vcc
    v_cndmask_b32 v30, v63, v42, vcc
    s_mov_b64 exec, 0
    s_cmp_eq_u32 s88, 0
    s_cbranch_scc1 L_hop0_0
    s_cmp_eq_u32 s88, 1
    s_cbranch_scc1 L_hop0_1
    s_cmp_eq_u32 s88, 2
    s_cbranch_scc1 L_hop0_2
    s_branch L_hop0_3
L_hopback0:
    s_mov_b64 exec, -1
    s_cmp_lt_u32 s71, 84
    s_cbranch_scc0 L_nomod2
    s_mov_b32 s70, 0xbfb8aa3b
    v_lshrrev_b32 v40, 4, v61
    v_lshlrev_b32 v40, 7, v40
    v_lshl_add_u32 v40, v33, 5, v40
    v_add_u32 v40, 101376, v40
    v_lshlrev_b32 v41, 4, v35
    v_add_u32 v42, 101376, v41
    s_mul_i32 s3, s71, 4682
    s_lshr_b32 s3, s3, 16
    s_cmp_eq_u32 s3, 1
    s_cselect_b32 s62, 1.0, 0
    s_cmp_eq_u32 s3, 4
    s_cselect_b32 s62, 1.0, s62
    v_cmp_gt_u32 vcc, 8, v61
    s_lshl_b32 s3, s71, 7
    v_add_u32 v41, s3, v41
    v_cndmask_b32 v51, v63, v41, vcc
    v_and_b32 v41, 12, v0
    v_cmp_eq_u32 vcc, 0, v41
    v_mov_b32 v176, 0
    v_mov_b32 v177, 0
    v_mov_b32 v178, 0
    v_mov_b32 v179, 0
    v_mov_b32 v180, 0
    v_mov_b32 v181, 0
    v_mov_b32 v182, 0
    v_mov_b32 v183, 0
    s_waitcnt vmcnt(8)
    v_lshlrev_b32 v160, 16, v160
    v_lshlrev_b32 v161, 16, v161
    v_lshlrev_b32 v162, 16, v162
    v_lshlrev_b32 v163, 16, v163
    v_lshlrev_b32 v164, 16, v164
    v_lshlrev_b32 v165, 16, v165
    v_lshlrev_b32 v166, 16, v166
    v_mul_f32 v168, s70, v160
    v_mul_f32 v169, s70, v161
    v_mul_f32 v170, s70, v162
    v_mul_f32 v171, s70, v163
    v_mul_f32 v172, s70, v164
    v_mul_f32 v173, s70, v165
    v_mul_f32 v174, s70, v166
    v_exp_f32 v168, v168
    v_exp_f32 v169, v169
    v_exp_f32 v170, v170
    v_exp_f32 v171, v171
    v_exp_f32 v172, v172
    v_exp_f32 v173, v173
    v_exp_f32 v174, v174
    v_add_f32 v168, 1.0, v168
    v_add_f32 v169, 1.0, v169
    v_add_f32 v170, 1.0, v170
    v_add_f32 v171, 1.0, v171
    v_add_f32 v172, 1.0, v172
    v_add_f32 v173, 1.0, v173
    v_add_f32 v174, 1.0, v174
    v_rcp_f32 v168, v168
    v_rcp_f32 v169, v169
    v_rcp_f32 v170, v170
    v_rcp_f32 v171, v171
    v_rcp_f32 v172, v172
    v_rcp_f32 v173, v173
    v_rcp_f32 v174, v174
    v_mul_f32 v160, v160, v168
    v_mul_f32 v161, v161, v169
    v_mul_f32 v162, v162, v170
    v_mul_f32 v163, v163, v171
    v_mul_f32 v164, v164, v172
    v_mul_f32 v165, v165, v173
    v_mul_f32 v166, v166, v174
    v_cvt_pk_bf16_f32 v160, v160, 0
    v_cvt_pk_bf16_f32 v161, v161, 0
    v_cvt_pk_bf16_f32 v162, v162, 0
    v_cvt_pk_bf16_f32 v163, v163, 0
    v_cvt_pk_bf16_f32 v164, v164, 0
    v_cvt_pk_bf16_f32 v165, v165, 0
    v_cvt_pk_bf16_f32 v166, v166, 0
    v_lshlrev_b32 v168, 16, v160
    v_lshlrev_b32 v169, 16, v161
    v_lshlrev_b32 v170, 16, v162
    v_lshlrev_b32 v171, 16, v163
    v_lshlrev_b32 v172, 16, v164
    v_lshlrev_b32 v173, 16, v165
    v_lshlrev_b32 v174, 16, v166
    s_waitcnt vmcnt(7)
    v_dot2c_f32_bf16 v176, v128, v160
    v_dot2c_f32_bf16 v177, v128, v168
    v_dot2c_f32_bf16 v178, v129, v160
    v_dot2c_f32_bf16 v179, v129, v168
    v_dot2c_f32_bf16 v180, v130, v160
    v_dot2c_f32_bf16 v181, v130, v168
    v_dot2c_f32_bf16 v182, v131, v160
    v_dot2c_f32_bf16 v183, v131, v168
    s_waitcnt vmcnt(6)
    v_dot2c_f32_bf16 v176, v132, v161
    v_dot2c_f32_bf16 v177, v132, v169
    v_dot2c_f32_bf16 v178, v133, v161
    v_dot2c_f32_bf16 v179, v133, v169
    v_dot2c_f32_bf16 v180, v134, v161
    v_dot2c_f32_bf16 v181, v134, v169
    v_dot2c_f32_bf16 v182, v135, v161
    v_dot2c_f32_bf16 v183, v135, v169
    s_waitcnt vmcnt(5)
    v_dot2c_f32_bf16 v176, v136, v162
    v_dot2c_f32_bf16 v177, v136, v170
    v_dot2c_f32_bf16 v178, v137, v162
    v_dot2c_f32_bf16 v179, v137, v170
    v_dot2c_f32_bf16 v180, v138, v162
    v_dot2c_f32_bf16 v181, v138, v170
    v_dot2c_f32_bf16 v182, v139, v162
    v_dot2c_f32_bf16 v183, v139, v170
    s_waitcnt vmcnt(4)
    s_load_dwordx2 s[94:95], s[58:59], 0
    buffer_load_dwordx4 v[64:67], v57, s[24:27], s69 offen
    buffer_load_dwordx4 v[68:71], v57, s[24:27], s69 offen offset:896
    v_dot2c_f32_bf16 v176, v140, v163
    v_dot2c_f32_bf16 v177, v140, v171
    v_dot2c_f32_bf16 v178, v141, v163
    v_dot2c_f32_bf16 v179, v141, v171
    v_dot2c_f32_bf16 v180, v142, v163
    v_dot2c_f32_bf16 v181, v142, v171
    v_dot2c_f32_bf16 v182, v143, v163
    v_dot2c_f32_bf16 v183, v143, v171
    s_waitcnt vmcnt(5)
    buffer_load_dwordx4 v[72:75], v57, s[24:27], s69 offen offset:1792
    buffer_load_dwordx4 v[76:79], v57, s[24:27], s69 offen offset:2688
    v_dot2c_f32_bf16 v176, v144, v164
    v_dot2c_f32_bf16 v177, v144, v172
    v_dot2c_f32_bf16 v178, v145, v164
    v_dot2c_f32_bf16 v179, v145, v172
    v_dot2c_f32_bf16 v180, v146, v164
    v_dot2c_f32_bf16 v181, v146, v172
    v_dot2c_f32_bf16 v182, v147, v164
    v_dot2c_f32_bf16 v183, v147, v172
    s_waitcnt vmcnt(6)
    s_add_u32 s69, s69, 3584
    buffer_load_dwordx4 v[80:83], v57, s[24:27], s69 offen
    buffer_load_dwordx4 v[84:87], v57, s[24:27], s69 offen offset:896
    v_dot2c_f32_bf16 v176, v148, v165
    v_dot2c_f32_bf16 v177, v148, v173
    v_dot2c_f32_bf16 v178, v149, v165
    v_dot2c_f32_bf16 v179, v149, v173
    v_dot2c_f32_bf16 v180, v150, v165
    v_dot2c_f32_bf16 v181, v150, v173
    v_dot2c_f32_bf16 v182, v151, v165
    v_dot2c_f32_bf16 v183, v151, v173
    s_waitcnt vmcnt(7)
    buffer_load_dwordx4 v[88:91], v57, s[24:27], s69 offen offset:1792
    buffer_load_dwordx4 v[92:95], v57, s[24:27], s69 offen offset:2688
    v_dot2c_f32_bf16 v176, v152, v166
    v_dot2c_f32_bf16 v177, v152, v174
    v_dot2c_f32_bf16 v178, v153, v166
    v_dot2c_f32_bf16 v179, v153, v174
    v_dot2c_f32_bf16 v180, v154, v166
    v_dot2c_f32_bf16 v181, v154, v174
    v_dot2c_f32_bf16 v182, v155, v166
    v_dot2c_f32_bf16 v183, v155, v174
    v_add_f32_dpp v176, v176, v176 row_ror:4 row_mask:0xf bank_mask:0xf
    v_add_f32_dpp v177, v177, v177 row_ror:4 row_mask:0xf bank_mask:0xf
    v_add_f32_dpp v178, v178, v178 row_ror:4 row_mask:0xf bank_mask:0xf
    v_add_f32_dpp v179, v179, v179 row_ror:4 row_mask:0xf bank_mask:0xf
    v_add_f32_dpp v180, v180, v180 row_ror:4 row_mask:0xf bank_mask:0xf
    v_add_f32_dpp v181, v181, v181 row_ror:4 row_mask:0xf bank_mask:0xf
    v_add_f32_dpp v182, v182, v182 row_ror:4 row_mask:0xf bank_mask:0xf
    v_add_f32_dpp v183, v183, v183 row_ror:4 row_mask:0xf bank_mask:0xf
    v_add_f32_dpp v176, v176, v176 row_ror:8 row_mask:0xf bank_mask:0xf
    v_add_f32_dpp v177, v177, v177 row_ror:8 row_mask:0xf bank_mask:0xf
    v_add_f32_dpp v178, v178, v178 row_ror:8 row_mask:0xf bank_mask:0xf
    v_add_f32_dpp v179, v179, v179 row_ror:8 row_mask:0xf bank_mask:0xf
    v_add_f32_dpp v180, v180, v180 row_ror:8 row_mask:0xf bank_mask:0xf
    v_add_f32_dpp v181, v181, v181 row_ror:8 row_mask:0xf bank_mask:0xf
    v_add_f32_dpp v182, v182, v182 row_ror:8 row_mask:0xf bank_mask:0xf
    v_add_f32_dpp v183, v183, v183 row_ror:8 row_mask:0xf bank_mask:0xf
    s_and_saveexec_b64 s[64:65], vcc
    ds_write_b128 v40, v[176:179]
    ds_write_b128 v40, v[180:183] offset:16
    s_mov_b64 exec, -1
    s_add_u32 s69, s69, 3584
    buffer_load_dwordx4 v[96:99], v57, s[24:27], s69 offen
    buffer_load_dwordx4 v[100:103], v57, s[24:27], s69 offen offset:896
    buffer_load_dwordx4 v[104:107], v57, s[24:27], s69 offen offset:1792
    buffer_load_dwordx4 v[108:111], v57, s[24:27], s69 offen offset:2688
    s_waitcnt lgkmcnt(0)
    s_barrier
    s_cmp_lg_u32 s88, 0
    s_cbranch_scc1 L_mod_x
    ds_read_b128 v[128:131], v42 offset:0
    ds_read_b128 v[132:135], v42 offset:256
    ds_read_b128 v[136:139], v42 offset:512
    ds_read_b128 v[140:143], v42 offset:768
    ds_read_b128 v[144:147], v42 offset:1024
    ds_read_b128 v[148:151], v42 offset:1280
    ds_read_b128 v[152:155], v42 offset:1536
    ds_read_b128 v[156:159], v42 offset:1792
L_mod_x:
    s_add_u32 s69, s69, 3584
    buffer_load_dwordx4 v[112:115], v57, s[24:27], s69 offen
    buffer_load_dwordx4 v[116:119], v57, s[24:27], s69 offen offset:896
    buffer_load_dwordx4 v[120:123], v57, s[24:27], s69 offen offset:1792
    buffer_load_dwordx4 v[124:127], v57, s[24:27], s69 offen offset:2688
    s_cmp_lg_u32 s88, 0
    s_cbranch_scc1 L_nomod2
    s_waitcnt lgkmcnt(0)
    v_pk_add_f32 v[128:129], v[128:129], v[144:145]
    v_pk_add_f32 v[130:131], v[130:131], v[146:147]
    v_pk_add_f32 v[132:133], v[132:133], v[148:149]
    v_pk_add_f32 v[134:135], v[134:135], v[150:151]
    v_pk_add_f32 v[136:137], v[136:137], v[152:153]
    v_pk_add_f32 v[138:139], v[138:139], v[154:155]
    v_pk_add_f32 v[140:141], v[140:141], v[156:157]
    v_pk_add_f32 v[142:143], v[142:143], v[158:159]
    v_pk_add_f32 v[128:129], v[128:129], v[136:137]
    v_pk_add_f32 v[130:131], v[130:131], v[138:139]
    v_pk_add_f32 v[132:133], v[132:133], v[140:141]
    v_pk_add_f32 v[134:135], v[134:135], v[142:143]
    v_pk_add_f32 v[128:129], v[128:129], v[132:133]
    v_pk_add_f32 v[130:131], v[130:131], v[134:135]
    s_nop 0
    v_add_f32_dpp v128, v128, v128 row_ror:8 row_mask:0xf bank_mask:0xf
    v_add_f32_dpp v129, v129, v129 row_ror:8 row_mask:0xf bank_mask:0xf
    v_add_f32_dpp v130, v130, v130 row_ror:8 row_mask:0xf bank_mask:0xf
    v_add_f32_dpp v131, v131, v131 row_ror:8 row_mask:0xf bank_mask:0xf
    v_cvt_pk_bf16_f32 v132, v128, v129
    v_cvt_pk_bf16_f32 v133, v130, v131
    v_lshlrev_b32 v128, 16, v132
    v_and_b32 v129, s68, v132
    v_lshlrev_b32 v130, 16, v133
    v_and_b32 v131, s68, v133
    v_add_f32 v128, s62, v128
    v_add_f32 v129, s62, v129
    v_add_f32 v130, s62, v130
    v_add_f32 v131, s62, v131
    v_cvt_pk_bf16_f32 v40, v128, v129
    v_cvt_pk_bf16_f32 v41, v130, v131
    s_cmp_eq_u32 s94, 0
    s_cbranch_scc1 L_non1_retry
L_non1_done:
    v_mov_b32 v42, s94
    v_mov_b32 v43, s95
L_nomod2:
    buffer_store_dwordx4 v[40:43], v51, s[28:31], 0 offen sc1
    buffer_load_dword v28, v31, s[12:15], s100 offen
    buffer_load_dword v28, v31, s[16:19], s100 offen
    s_waitcnt vmcnt(15)
    v_lshlrev_b32 v128, 16, v64
    v_and_b32 v129, s68, v64
    v_lshlrev_b32 v130, 16, v65
    v_and_b32 v131, s68, v65
    v_lshlrev_b32 v132, 16, v66
    v_and_b32 v133, s68, v66
    v_lshlrev_b32 v134, 16, v67
    v_and_b32 v135, s68, v67
    v_pk_add_f32 v[32:33], v[128:129], v[130:131]
    v_pk_mul_f32 v[36:37], v[128:129], v[128:129]
    v_pk_add_f32 v[34:35], v[132:133], v[134:135]
    v_pk_fma_f32 v[36:37], v[130:131], v[130:131], v[36:37]
    v_pk_add_f32 v[32:33], v[32:33], v[34:35]
    v_pk_fma_f32 v[36:37], v[132:133], v[132:133], v[36:37]
    v_add_f32 v64, v32, v33
    v_pk_fma_f32 v[36:37], v[134:135], v[134:135], v[36:37]
    v_add_f32 v65, v36, v37
    v_lshlrev_b32 v136, 16, v68
    v_and_b32 v137, s68, v68
    v_lshlrev_b32 v138, 16, v69
    v_and_b32 v139, s68, v69
    v_lshlrev_b32 v140, 16, v70
    v_and_b32 v141, s68, v70
    v_lshlrev_b32 v142, 16, v71
    v_and_b32 v143, s68, v71
    v_pk_add_f32 v[32:33], v[136:137], v[138:139]
    v_pk_mul_f32 v[36:37], v[136:137], v[136:137]
    v_pk_add_f32 v[34:35], v[140:141], v[142:143]
    v_pk_fma_f32 v[36:37], v[138:139], v[138:139], v[36:37]
    v_pk_add_f32 v[32:33], v[32:33], v[34:35]
    v_pk_fma_f32 v[36:37], v[140:141], v[140:141], v[36:37]
    v_add_f32 v68, v32, v33
    v_pk_fma_f32 v[36:37], v[142:143], v[142:143], v[36:37]
    v_add_f32 v69, v36, v37
    v_lshlrev_b32 v144, 16, v72
    v_and_b32 v145, s68, v72
    v_lshlrev_b32 v146, 16, v73
    v_and_b32 v147, s68, v73
    v_lshlrev_b32 v148, 16, v74
    v_and_b32 v149, s68, v74
    v_lshlrev_b32 v150, 16, v75
    v_and_b32 v151, s68, v75
    v_pk_add_f32 v[32:33], v[144:145], v[146:147]
    v_pk_mul_f32 v[36:37], v[144:145], v[144:145]
    v_pk_add_f32 v[34:35], v[148:149], v[150:151]
    v_pk_fma_f32 v[36:37], v[146:147], v[146:147], v[36:37]
    v_pk_add_f32 v[32:33], v[32:33], v[34:35]
    v_pk_fma_f32 v[36:37], v[148:149], v[148:149], v[36:37]
    v_add_f32 v72, v32, v33
    v_pk_fma_f32 v[36:37], v[150:151], v[150:151], v[36:37]
    v_add_f32 v73, v36, v37
    v_lshlrev_b32 v152, 16, v76
    v_and_b32 v153, s68, v76
    v_lshlrev_b32 v154, 16, v77
    v_and_b32 v155, s68, v77
    v_lshlrev_b32 v156, 16, v78
    v_and_b32 v157, s68, v78
    v_lshlrev_b32 v158, 16, v79
    v_and_b32 v159, s68, v79
    v_pk_add_f32 v[32:33], v[152:153], v[154:155]
    v_pk_mul_f32 v[36:37], v[152:153], v[152:153]
    v_pk_add_f32 v[34:35], v[156:157], v[158:159]
    v_pk_fma_f32 v[36:37], v[154:155], v[154:155], v[36:37]
    v_pk_add_f32 v[32:33], v[32:33], v[34:35]
    v_pk_fma_f32 v[36:37], v[156:157], v[156:157], v[36:37]
    v_add_f32 v76, v32, v33
    v_pk_fma_f32 v[36:37], v[158:159], v[158:159], v[36:37]
    v_add_f32 v77, v36, v37
    s_waitcnt vmcnt(11)
    v_lshlrev_b32 v160, 16, v80
    v_and_b32 v161, s68, v80
    v_lshlrev_b32 v162, 16, v81
    v_and_b32 v163, s68, v81
    v_lshlrev_b32 v164, 16, v82
    v_and_b32 v165, s68, v82
    v_lshlrev_b32 v166, 16, v83
    v_and_b32 v167, s68, v83
    v_pk_add_f32 v[32:33], v[160:161], v[162:163]
    v_pk_mul_f32 v[36:37], v[160:161], v[160:161]
    v_pk_add_f32 v[34:35], v[164:165], v[166:167]
    v_pk_fma_f32 v[36:37], v[162:163], v[162:163], v[36:37]
    v_pk_add_f32 v[32:33], v[32:33], v[34:35]
    v_pk_fma_f32 v[36:37], v[164:165], v[164:165], v[36:37]
    v_add_f32 v80, v32, v33
    v_pk_fma_f32 v[36:37], v[166:167], v[166:167], v[36:37]
    v_add_f32 v81, v36, v37
    v_lshlrev_b32 v168, 16, v84
    v_and_b32 v169, s68, v84
    v_lshlrev_b32 v170, 16, v85
    v_and_b32 v171, s68, v85
    v_lshlrev_b32 v172, 16, v86
    v_and_b32 v173, s68, v86
    v_lshlrev_b32 v174, 16, v87
    v_and_b32 v175, s68, v87
    v_pk_add_f32 v[32:33], v[168:169], v[170:171]
    v_pk_mul_f32 v[36:37], v[168:169], v[168:169]
    v_pk_add_f32 v[34:35], v[172:173], v[174:175]
    v_pk_fma_f32 v[36:37], v[170:171], v[170:171], v[36:37]
    v_pk_add_f32 v[32:33], v[32:33], v[34:35]
    v_pk_fma_f32 v[36:37], v[172:173], v[172:173], v[36:37]
    v_add_f32 v84, v32, v33
    v_pk_fma_f32 v[36:37], v[174:175], v[174:175], v[36:37]
    v_add_f32 v85, v36, v37
    v_lshlrev_b32 v176, 16, v88
    v_and_b32 v177, s68, v88
    v_lshlrev_b32 v178, 16, v89
    v_and_b32 v179, s68, v89
    v_lshlrev_b32 v180, 16, v90
    v_and_b32 v181, s68, v90
    v_lshlrev_b32 v182, 16, v91
    v_and_b32 v183, s68, v91
    v_pk_add_f32 v[32:33], v[176:177], v[178:179]
    v_pk_mul_f32 v[36:37], v[176:177], v[176:177]
    v_pk_add_f32 v[34:35], v[180:181], v[182:183]
    v_pk_fma_f32 v[36:37], v[178:179], v[178:179], v[36:37]
    v_pk_add_f32 v[32:33], v[32:33], v[34:35]
    v_pk_fma_f32 v[36:37], v[180:181], v[180:181], v[36:37]
    v_add_f32 v88, v32, v33
    v_pk_fma_f32 v[36:37], v[182:183], v[182:183], v[36:37]
    v_add_f32 v89, v36, v37
    v_lshlrev_b32 v184, 16, v92
    v_and_b32 v185, s68, v92
    v_lshlrev_b32 v186, 16, v93
    v_and_b32 v187, s68, v93
    v_lshlrev_b32 v188, 16, v94
    v_and_b32 v189, s68, v94
    v_lshlrev_b32 v190, 16, v95
    v_and_b32 v191, s68, v95
    v_pk_add_f32 v[32:33], v[184:185], v[186:187]
    v_pk_mul_f32 v[36:37], v[184:185], v[184:185]
    v_pk_add_f32 v[34:35], v[188:189], v[190:191]
    v_pk_fma_f32 v[36:37], v[186:187], v[186:187], v[36:37]
    v_pk_add_f32 v[32:33], v[32:33], v[34:35]
    v_pk_fma_f32 v[36:37], v[188:189], v[188:189], v[36:37]
    v_add_f32 v92, v32, v33
    v_pk_fma_f32 v[36:37], v[190:191], v[190:191], v[36:37]
    v_add_f32 v93, v36, v37
    s_waitcnt vmcnt(7)
    s_load_dwordx2 s[94:95], s[58:59], 0
    s_add_u32 s77, s74, 0
    s_add_u32 m0, s72, 0
    s_nop 0
    buffer_load_dwordx4 v15, s[8:11], s77 offen lds
    v_lshlrev_b32 v192, 16, v96
    v_and_b32 v193, s68, v96
    v_lshlrev_b32 v194, 16, v97
    v_and_b32 v195, s68, v97
    v_lshlrev_b32 v196, 16, v98
    v_and_b32 v197, s68, v98
    v_lshlrev_b32 v198, 16, v99
    v_and_b32 v199, s68, v99
    v_pk_add_f32 v[32:33], v[192:193], v[194:195]
    v_pk_mul_f32 v[36:37], v[192:193], v[192:193]
    v_pk_add_f32 v[34:35], v[196:197], v[198:199]
    v_pk_fma_f32 v[36:37], v[194:195], v[194:195], v[36:37]
    v_pk_add_f32 v[32:33], v[32:33], v[34:35]
    v_pk_fma_f32 v[36:37], v[196:197], v[196:197], v[36:37]
    v_add_f32 v96, v32, v33
    v_pk_fma_f32 v[36:37], v[198:199], v[198:199], v[36:37]
    v_add_f32 v97, v36, v37
    buffer_load_dwordx4 v16, s[8:11], s77 offen offset:1032 lds
    v_lshlrev_b32 v200, 16, v100
    v_and_b32 v201, s68, v100
    v_lshlrev_b32 v202, 16, v101
    v_and_b32 v203, s68, v101
    v_lshlrev_b32 v204, 16, v102
    v_and_b32 v205, s68, v102
    v_lshlrev_b32 v206, 16, v103
    v_and_b32 v207, s68, v103
    v_pk_add_f32 v[32:33], v[200:201], v[202:203]
    v_pk_mul_f32 v[36:37], v[200:201], v[200:201]
    v_pk_add_f32 v[34:35], v[204:205], v[206:207]
    v_pk_fma_f32 v[36:37], v[202:203], v[202:203], v[36:37]
    v_pk_add_f32 v[32:33], v[32:33], v[34:35]
    v_pk_fma_f32 v[36:37], v[204:205], v[204:205], v[36:37]
    v_add_f32 v100, v32, v33
    v_pk_fma_f32 v[36:37], v[206:207], v[206:207], v[36:37]
    v_add_f32 v101, v36, v37
    buffer_load_dwordx4 v17, s[8:11], s77 offen offset:2112 lds
    v_lshlrev_b32 v208, 16, v104
    v_and_b32 v209, s68, v104
    v_lshlrev_b32 v210, 16, v105
    v_and_b32 v211, s68, v105
    v_lshlrev_b32 v212, 16, v106
    v_and_b32 v213, s68, v106
    v_lshlrev_b32 v214, 16, v107
    v_and_b32 v215, s68, v107
    v_pk_add_f32 v[32:33], v[208:209], v[210:211]
    v_pk_mul_f32 v[36:37], v[208:209], v[208:209]
    v_pk_add_f32 v[34:35], v[212:213], v[214:215]
    v_pk_fma_f32 v[36:37], v[210:211], v[210:211], v[36:37]
    v_pk_add_f32 v[32:33], v[32:33], v[34:35]
    v_pk_fma_f32 v[36:37], v[212:213], v[212:213], v[36:37]
    v_add_f32 v104, v32, v33
    v_pk_fma_f32 v[36:37], v[214:215], v[214:215], v[36:37]
    v_add_f32 v105, v36, v37
    buffer_load_dwordx4 v18, s[8:11], s77 offen offset:3144 lds
    v_lshlrev_b32 v216, 16, v108
    v_and_b32 v217, s68, v108
    v_lshlrev_b32 v218, 16, v109
    v_and_b32 v219, s68, v109
    v_lshlrev_b32 v220, 16, v110
    v_and_b32 v221, s68, v110
    v_lshlrev_b32 v222, 16, v111
    v_and_b32 v223, s68, v111
    v_pk_add_f32 v[32:33], v[216:217], v[218:219]
    v_pk_mul_f32 v[36:37], v[216:217], v[216:217]
    v_pk_add_f32 v[34:35], v[220:221], v[222:223]
    v_pk_fma_f32 v[36:37], v[218:219], v[218:219], v[36:37]
    v_pk_add_f32 v[32:33], v[32:33], v[34:35]
    v_pk_fma_f32 v[36:37], v[220:221], v[220:221], v[36:37]
    v_add_f32 v108, v32, v33
    v_pk_fma_f32 v[36:37], v[222:223], v[222:223], v[36:37]
    v_add_f32 v109, v36, v37
    s_waitcnt vmcnt(7)
    s_add_u32 s78, s74, 65536
    s_add_u32 m0, s72, 4224
    s_nop 0
    buffer_load_dwordx4 v15, s[8:11], s78 offen lds
    v_lshlrev_b32 v224, 16, v112
    v_and_b32 v225, s68, v112
    v_lshlrev_b32 v226, 16, v113
    v_and_b32 v227, s68, v113
    v_lshlrev_b32 v228, 16, v114
    v_and_b32 v229, s68, v114
    v_lshlrev_b32 v230, 16, v115
    v_and_b32 v231, s68, v115
    v_pk_add_f32 v[32:33], v[224:225], v[226:227]
    v_pk_mul_f32 v[36:37], v[224:225], v[224:225]
    v_pk_add_f32 v[34:35], v[228:229], v[230:231]
    v_pk_fma_f32 v[36:37], v[226:227], v[226:227], v[36:37]
    v_pk_add_f32 v[32:33], v[32:33], v[34:35]
    v_pk_fma_f32 v[36:37], v[228:229], v[228:229], v[36:37]
    v_add_f32 v112, v32, v33
    v_pk_fma_f32 v[36:37], v[230:231], v[230:231], v[36:37]
    v_add_f32 v113, v36, v37
    buffer_load_dwordx4 v16, s[8:11], s78 offen offset:1032 lds
    v_lshlrev_b32 v232, 16, v116
    v_and_b32 v233, s68, v116
    v_lshlrev_b32 v234, 16, v117
    v_and_b32 v235, s68, v117
    v_lshlrev_b32 v236, 16, v118
    v_and_b32 v237, s68, v118
    v_lshlrev_b32 v238, 16, v119
    v_and_b32 v239, s68, v119
    v_pk_add_f32 v[32:33], v[232:233], v[234:235]
    v_pk_mul_f32 v[36:37], v[232:233], v[232:233]
    v_pk_add_f32 v[34:35], v[236:237], v[238:239]
    v_pk_fma_f32 v[36:37], v[234:235], v[234:235], v[36:37]
    v_pk_add_f32 v[32:33], v[32:33], v[34:35]
    v_pk_fma_f32 v[36:37], v[236:237], v[236:237], v[36:37]
    v_add_f32 v116, v32, v33
    v_pk_fma_f32 v[36:37], v[238:239], v[238:239], v[36:37]
    v_add_f32 v117, v36, v37
    buffer_load_dwordx4 v17, s[8:11], s78 offen offset:2112 lds
    v_lshlrev_b32 v240, 16, v120
    v_and_b32 v241, s68, v120
    v_lshlrev_b32 v242, 16, v121
    v_and_b32 v243, s68, v121
    v_lshlrev_b32 v244, 16, v122
    v_and_b32 v245, s68, v122
    v_lshlrev_b32 v246, 16, v123
    v_and_b32 v247, s68, v123
    v_pk_add_f32 v[32:33], v[240:241], v[242:243]
    v_pk_mul_f32 v[36:37], v[240:241], v[240:241]
    v_pk_add_f32 v[34:35], v[244:245], v[246:247]
    v_pk_fma_f32 v[36:37], v[242:243], v[242:243], v[36:37]
    v_pk_add_f32 v[32:33], v[32:33], v[34:35]
    v_pk_fma_f32 v[36:37], v[244:245], v[244:245], v[36:37]
    v_add_f32 v120, v32, v33
    v_pk_fma_f32 v[36:37], v[246:247], v[246:247], v[36:37]
    v_add_f32 v121, v36, v37
    buffer_load_dwordx4 v18, s[8:11], s78 offen offset:3144 lds
    v_lshlrev_b32 v248, 16, v124
    v_and_b32 v249, s68, v124
    v_lshlrev_b32 v250, 16, v125
    v_and_b32 v251, s68, v125
    v_lshlrev_b32 v252, 16, v126
    v_and_b32 v253, s68, v126
    v_lshlrev_b32 v254, 16, v127
    v_and_b32 v255, s68, v127
    v_pk_add_f32 v[32:33], v[248:249], v[250:251]
    v_pk_mul_f32 v[36:37], v[248:249], v[248:249]
L_hop0_0:
    s_cbranch_execz L_hop0_4
    v_pk_add_f32 v[34:35], v[252:253], v[254:255]
    v_pk_fma_f32 v[36:37], v[250:251], v[250:251], v[36:37]
    v_pk_add_f32 v[32:33], v[32:33], v[34:35]
    v_pk_fma_f32 v[36:37], v[252:253], v[252:253], v[36:37]
    v_add_f32 v124, v32, v33
    v_pk_fma_f32 v[36:37], v[254:255], v[254:255], v[36:37]
    v_add_f32 v125, v36, v37
    s_add_u32 s77, s74, 1048576
    s_add_u32 m0, s72, 33792
    s_nop 0
    buffer_load_dwordx4 v15, s[8:11], s77 offen lds
    v_permlane32_swap_b32 v64, v96
    v_permlane32_swap_b32 v65, v97
    v_permlane32_swap_b32 v68, v100
    v_permlane32_swap_b32 v69, v101
    buffer_load_dwordx4 v16, s[8:11], s77 offen offset:1032 lds
    v_permlane32_swap_b32 v72, v104
    v_permlane32_swap_b32 v73, v105
    v_permlane32_swap_b32 v76, v108
    v_permlane32_swap_b32 v77, v109
    buffer_load_dwordx4 v17, s[8:11], s77 offen offset:2112 lds
    v_permlane32_swap_b32 v80, v112
    v_permlane32_swap_b32 v81, v113
    v_permlane32_swap_b32 v84, v116
    v_permlane32_swap_b32 v85, v117
    buffer_load_dwordx4 v18, s[8:11], s77 offen offset:3144 lds
    v_permlane32_swap_b32 v88, v120
    v_permlane32_swap_b32 v89, v121
    v_permlane32_swap_b32 v92, v124
    v_permlane32_swap_b32 v93, v125
    v_pk_add_f32 v[64:65], v[64:65], v[96:97]
    v_pk_add_f32 v[68:69], v[68:69], v[100:101]
    v_pk_add_f32 v[72:73], v[72:73], v[104:105]
    v_pk_add_f32 v[76:77], v[76:77], v[108:109]
    v_pk_add_f32 v[80:81], v[80:81], v[112:113]
    v_pk_add_f32 v[84:85], v[84:85], v[116:117]
    v_pk_add_f32 v[88:89], v[88:89], v[120:121]
    v_pk_add_f32 v[92:93], v[92:93], v[124:125]
    v_permlane16_swap_b32 v64, v80
    v_permlane16_swap_b32 v65, v81
    v_permlane16_swap_b32 v68, v84
    v_permlane16_swap_b32 v69, v85
    v_permlane16_swap_b32 v72, v88
    v_permlane16_swap_b32 v73, v89
    v_permlane16_swap_b32 v76, v92
    v_permlane16_swap_b32 v77, v93
    v_pk_add_f32 v[64:65], v[64:65], v[80:81]
    v_pk_add_f32 v[68:69], v[68:69], v[84:85]
    v_pk_add_f32 v[72:73], v[72:73], v[88:89]
    v_pk_add_f32 v[76:77], v[76:77], v[92:93]
    s_add_u32 s78, s74, 1114112
    s_add_u32 m0, s72, 38016
    s_nop 0
    buffer_load_dwordx4 v15, s[8:11], s78 offen lds
    v_add_f32_dpp v64, v64, v64 row_ror:1 row_mask:0xf bank_mask:0xf
    v_add_f32_dpp v65, v65, v65 row_ror:1 row_mask:0xf bank_mask:0xf
    v_add_f32_dpp v68, v68, v68 row_ror:1 row_mask:0xf bank_mask:0xf
    v_add_f32_dpp v69, v69, v69 row_ror:1 row_mask:0xf bank_mask:0xf
    v_add_f32_dpp v72, v72, v72 row_ror:1 row_mask:0xf bank_mask:0xf
    v_add_f32_dpp v73, v73, v73 row_ror:1 row_mask:0xf bank_mask:0xf
    v_add_f32_dpp v76, v76, v76 row_ror:1 row_mask:0xf bank_mask:0xf
    v_add_f32_dpp v77, v77, v77 row_ror:1 row_mask:0xf bank_mask:0xf
    buffer_load_dwordx4 v16, s[8:11], s78 offen offset:1032 lds
    v_add_f32_dpp v64, v64, v64 row_ror:2 row_mask:0xf bank_mask:0xf
    v_add_f32_dpp v65, v65, v65 row_ror:2 row_mask:0xf bank_mask:0xf
    v_add_f32_dpp v68, v68, v68 row_ror:2 row_mask:0xf bank_mask:0xf
    v_add_f32_dpp v69, v69, v69 row_ror:2 row_mask:0xf bank_mask:0xf
    v_add_f32_dpp v72, v72, v72 row_ror:2 row_mask:0xf bank_mask:0xf
    v_add_f32_dpp v73, v73, v73 row_ror:2 row_mask:0xf bank_mask:0xf
    v_add_f32_dpp v76, v76, v76 row_ror:2 row_mask:0xf bank_mask:0xf
    v_add_f32_dpp v77, v77, v77 row_ror:2 row_mask:0xf bank_mask:0xf
    buffer_load_dwordx4 v17, s[8:11], s78 offen offset:2112 lds
    v_add_f32_dpp v64, v64, v64 row_ror:4 row_mask:0xf bank_mask:0xf
    v_add_f32_dpp v65, v65, v65 row_ror:4 row_mask:0xf bank_mask:0xf
    v_add_f32_dpp v68, v68, v68 row_ror:4 row_mask:0xf bank_mask:0xf
    v_add_f32_dpp v69, v69, v69 row_ror:4 row_mask:0xf bank_mask:0xf
    v_add_f32_dpp v72, v72, v72 row_ror:4 row_mask:0xf bank_mask:0xf
    v_add_f32_dpp v73, v73, v73 row_ror:4 row_mask:0xf bank_mask:0xf
    v_add_f32_dpp v76, v76, v76 row_ror:4 row_mask:0xf bank_mask:0xf
    v_add_f32_dpp v77, v77, v77 row_ror:4 row_mask:0xf bank_mask:0xf
    buffer_load_dwordx4 v18, s[8:11], s78 offen offset:3144 lds
    v_add_f32_dpp v64, v64, v64 row_ror:8 row_mask:0xf bank_mask:0xf
    v_add_f32_dpp v65, v65, v65 row_ror:8 row_mask:0xf bank_mask:0xf
    v_add_f32_dpp v68, v68, v68 row_ror:8 row_mask:0xf bank_mask:0xf
    v_add_f32_dpp v69, v69, v69 row_ror:8 row_mask:0xf bank_mask:0xf
    v_add_f32_dpp v72, v72, v72 row_ror:8 row_mask:0xf bank_mask:0xf
    v_add_f32_dpp v73, v73, v73 row_ror:8 row_mask:0xf bank_mask:0xf
    v_add_f32_dpp v76, v76, v76 row_ror:8 row_mask:0xf bank_mask:0xf
    v_add_f32_dpp v77, v77, v77 row_ror:8 row_mask:0xf bank_mask:0xf
    s_mov_b32 s70, 0x3b124925
    v_mov_b32 v62, 0x3727c5ac
    v_pk_mul_f32 v[64:65], v[64:65], s[70:71] op_sel:[0,0] op_sel_hi:[1,0]
    v_pk_mul_f32 v[68:69], v[68:69], s[70:71] op_sel:[0,0] op_sel_hi:[1,0]
    v_pk_mul_f32 v[72:73], v[72:73], s[70:71] op_sel:[0,0] op_sel_hi:[1,0]
    v_pk_mul_f32 v[76:77], v[76:77], s[70:71] op_sel:[0,0] op_sel_hi:[1,0]
    v_fma_f32 v65, -v64, v64, v65
    v_fma_f32 v69, -v68, v68, v69
    v_fma_f32 v73, -v72, v72, v73
    v_fma_f32 v77, -v76, v76, v77
    v_max_f32 v65, 0, v65
    v_max_f32 v69, 0, v69
    v_max_f32 v73, 0, v73
    v_max_f32 v77, 0, v77
    v_add_f32 v65, v62, v65
    v_add_f32 v69, v62, v69
    v_add_f32 v73, v62, v73
    v_add_f32 v77, v62, v77
    v_rsq_f32 v65, v65
    v_rsq_f32 v69, v69
    v_rsq_f32 v73, v73
    v_rsq_f32 v77, v77
    v_mul_f32 v64, -v64, v65
    v_mul_f32 v68, -v68, v69
    v_mul_f32 v72, -v72, v73
    v_mul_f32 v76, -v76, v77
    s_waitcnt lgkmcnt(0)
    v_readlane_b32 s36, v65, 0
    v_readlane_b32 s37, v64, 0
    v_readlane_b32 s38, v69, 0
    v_readlane_b32 s39, v68, 0
    v_readlane_b32 s40, v73, 0
    v_readlane_b32 s41, v72, 0
    v_readlane_b32 s42, v77, 0
    v_readlane_b32 s43, v76, 0
    v_readlane_b32 s44, v65, 16
    v_readlane_b32 s45, v64, 16
    v_readlane_b32 s46, v69, 16
    v_readlane_b32 s47, v68, 16
    v_readlane_b32 s48, v73, 16
    v_readlane_b32 s49, v72, 16
    v_readlane_b32 s50, v77, 16
    v_readlane_b32 s51, v76, 16
    v_readlane_b32 s52, v65, 32
    v_readlane_b32 s53, v64, 32
    v_readlane_b32 s54, v69, 32
    v_readlane_b32 s55, v68, 32
    v_readlane_b32 s56, v73, 32
    v_readlane_b32 s57, v72, 32
    v_readlane_b32 s58, v77, 32
    v_readlane_b32 s59, v76, 32
    v_readlane_b32 s60, v65, 48
    v_readlane_b32 s61, v64, 48
    v_readlane_b32 s62, v69, 48
    v_readlane_b32 s63, v68, 48
    v_readlane_b32 s64, v73, 48
    v_readlane_b32 s65, v72, 48
    v_readlane_b32 s66, v77, 48
    v_readlane_b32 s67, v76, 48
    s_add_u32 s77, s74, 2097152
    s_add_u32 m0, s72, 67584
    s_nop 0
    buffer_load_dwordx4 v15, s[8:11], s77 offen lds
    v_pk_fma_f32 v[128:129], v[128:129], s[36:37], s[36:37] op_sel:[0,0,1] op_sel_hi:[1,0,1]
    v_pk_fma_f32 v[130:131], v[130:131], s[36:37], s[36:37] op_sel:[0,0,1] op_sel_hi:[1,0,1]
    v_pk_fma_f32 v[132:133], v[132:133], s[36:37], s[36:37] op_sel:[0,0,1] op_sel_hi:[1,0,1]
    v_pk_fma_f32 v[134:135], v[134:135], s[36:37], s[36:37] op_sel:[0,0,1] op_sel_hi:[1,0,1]
    buffer_load_dwordx4 v16, s[8:11], s77 offen offset:1032 lds
    v_pk_fma_f32 v[136:137], v[136:137], s[38:39], s[38:39] op_sel:[0,0,1] op_sel_hi:[1,0,1]
    v_pk_fma_f32 v[138:139], v[138:139], s[38:39], s[38:39] op_sel:[0,0,1] op_sel_hi:[1,0,1]
    v_pk_fma_f32 v[140:141], v[140:141], s[38:39], s[38:39] op_sel:[0,0,1] op_sel_hi:[1,0,1]
    v_pk_fma_f32 v[142:143], v[142:143], s[38:39], s[38:39] op_sel:[0,0,1] op_sel_hi:[1,0,1]
    buffer_load_dwordx4 v17, s[8:11], s77 offen offset:2112 lds
    v_pk_fma_f32 v[144:145], v[144:145], s[40:41], s[40:41] op_sel:[0,0,1] op_sel_hi:[1,0,1]
    v_pk_fma_f32 v[146:147], v[146:147], s[40:41], s[40:41] op_sel:[0,0,1] op_sel_hi:[1,0,1]
    v_pk_fma_f32 v[148:149], v[148:149], s[40:41], s[40:41] op_sel:[0,0,1] op_sel_hi:[1,0,1]
    v_pk_fma_f32 v[150:151], v[150:151], s[40:41], s[40:41] op_sel:[0,0,1] op_sel_hi:[1,0,1]
    buffer_load_dwordx4 v18, s[8:11], s77 offen offset:3144 lds
    v_pk_fma_f32 v[152:153], v[152:153], s[42:43], s[42:43] op_sel:[0,0,1] op_sel_hi:[1,0,1]
    v_pk_fma_f32 v[154:155], v[154:155], s[42:43], s[42:43] op_sel:[0,0,1] op_sel_hi:[1,0,1]
    v_pk_fma_f32 v[156:157], v[156:157], s[42:43], s[42:43] op_sel:[0,0,1] op_sel_hi:[1,0,1]
    v_pk_fma_f32 v[158:159], v[158:159], s[42:43], s[42:43] op_sel:[0,0,1] op_sel_hi:[1,0,1]
    s_add_u32 s78, s74, 2162688
    s_add_u32 m0, s72, 71808
    s_nop 0
    buffer_load_dwordx4 v15, s[8:11], s78 offen lds
    v_pk_fma_f32 v[160:161], v[160:161], s[44:45], s[44:45] op_sel:[0,0,1] op_sel_hi:[1,0,1]
    v_pk_fma_f32 v[162:163], v[162:163], s[44:45], s[44:45] op_sel:[0,0,1] op_sel_hi:[1,0,1]
    v_pk_fma_f32 v[164:165], v[164:165], s[44:45], s[44:45] op_sel:[0,0,1] op_sel_hi:[1,0,1]
    v_pk_fma_f32 v[166:167], v[166:167], s[44:45], s[44:45] op_sel:[0,0,1] op_sel_hi:[1,0,1]
    buffer_load_dwordx4 v16, s[8:11], s78 offen offset:1032 lds
    v_pk_fma_f32 v[168:169], v[168:169], s[46:47], s[46:47] op_sel:[0,0,1] op_sel_hi:[1,0,1]
    v_pk_fma_f32 v[170:171], v[170:171], s[46:47], s[46:47] op_sel:[0,0,1] op_sel_hi:[1,0,1]
    v_pk_fma_f32 v[172:173], v[172:173], s[46:47], s[46:47] op_sel:[0,0,1] op_sel_hi:[1,0,1]
    v_pk_fma_f32 v[174:175], v[174:175], s[46:47], s[46:47] op_sel:[0,0,1] op_sel_hi:[1,0,1]
    buffer_load_dwordx4 v17, s[8:11], s78 offen offset:2112 lds
    v_pk_fma_f32 v[176:177], v[176:177], s[48:49], s[48:49] op_sel:[0,0,1] op_sel_hi:[1,0,1]
    v_pk_fma_f32 v[178:179], v[178:179], s[48:49], s[48:49] op_sel:[0,0,1] op_sel_hi:[1,0,1]
    v_pk_fma_f32 v[180:181], v[180:181], s[48:49], s[48:49] op_sel:[0,0,1] op_sel_hi:[1,0,1]
    v_pk_fma_f32 v[182:183], v[182:183], s[48:49], s[48:49] op_sel:[0,0,1] op_sel_hi:[1,0,1]
    buffer_load_dwordx4 v18, s[8:11], s78 offen offset:3144 lds
    v_pk_fma_f32 v[184:185], v[184:185], s[50:51], s[50:51] op_sel:[0,0,1] op_sel_hi:[1,0,1]
    v_pk_fma_f32 v[186:187], v[186:187], s[50:51], s[50:51] op_sel:[0,0,1] op_sel_hi:[1,0,1]
    v_pk_fma_f32 v[188:189], v[188:189], s[50:51], s[50:51] op_sel:[0,0,1] op_sel_hi:[1,0,1]
    v_pk_fma_f32 v[190:191], v[190:191], s[50:51], s[50:51] op_sel:[0,0,1] op_sel_hi:[1,0,1]
    v_pk_fma_f32 v[192:193], v[192:193], s[52:53], s[52:53] op_sel:[0,0,1] op_sel_hi:[1,0,1]
    v_pk_fma_f32 v[194:195], v[194:195], s[52:53], s[52:53] op_sel:[0,0,1] op_sel_hi:[1,0,1]
    v_pk_fma_f32 v[196:197], v[196:197], s[52:53], s[52:53] op_sel:[0,0,1] op_sel_hi:[1,0,1]
    v_pk_fma_f32 v[198:199], v[198:199], s[52:53], s[52:53] op_sel:[0,0,1] op_sel_hi:[1,0,1]
    v_pk_fma_f32 v[200:201], v[200:201], s[54:55], s[54:55] op_sel:[0,0,1] op_sel_hi:[1,0,1]
    v_pk_fma_f32 v[202:203], v[202:203], s[54:55], s[54:55] op_sel:[0,0,1] op_sel_hi:[1,0,1]
    v_pk_fma_f32 v[204:205], v[204:205], s[54:55], s[54:55] op_sel:[0,0,1] op_sel_hi:[1,0,1]
    v_pk_fma_f32 v[206:207], v[206:207], s[54:55], s[54:55] op_sel:[0,0,1] op_sel_hi:[1,0,1]
    buffer_load_dwordx4 v[32:35], v52, s[28:31], s96 offen sc1
    v_pk_fma_f32 v[208:209], v[208:209], s[56:57], s[56:57] op_sel:[0,0,1] op_sel_hi:[1,0,1]
    v_pk_fma_f32 v[210:211], v[210:211], s[56:57], s[56:57] op_sel:[0,0,1] op_sel_hi:[1,0,1]
    v_pk_fma_f32 v[212:213], v[212:213], s[56:57], s[56:57] op_sel:[0,0,1] op_sel_hi:[1,0,1]
    v_pk_fma_f32 v[214:215], v[214:215], s[56:57], s[56:57] op_sel:[0,0,1] op_sel_hi:[1,0,1]
    v_pk_fma_f32 v[216:217], v[216:217], s[58:59], s[58:59] op_sel:[0,0,1] op_sel_hi:[1,0,1]
    v_pk_fma_f32 v[218:219], v[218:219], s[58:59], s[58:59] op_sel:[0,0,1] op_sel_hi:[1,0,1]
    v_pk_fma_f32 v[220:221], v[220:221], s[58:59], s[58:59] op_sel:[0,0,1] op_sel_hi:[1,0,1]
    v_pk_fma_f32 v[222:223], v[222:223], s[58:59], s[58:59] op_sel:[0,0,1] op_sel_hi:[1,0,1]
    v_pk_fma_f32 v[224:225], v[224:225], s[60:61], s[60:61] op_sel:[0,0,1] op_sel_hi:[1,0,1]
    v_pk_fma_f32 v[226:227], v[226:227], s[60:61], s[60:61] op_sel:[0,0,1] op_sel_hi:[1,0,1]
    v_pk_fma_f32 v[228:229], v[228:229], s[60:61], s[60:61] op_sel:[0,0,1] op_sel_hi:[1,0,1]
    v_pk_fma_f32 v[230:231], v[230:231], s[60:61], s[60:61] op_sel:[0,0,1] op_sel_hi:[1,0,1]
    v_pk_fma_f32 v[232:233], v[232:233], s[62:63], s[62:63] op_sel:[0,0,1] op_sel_hi:[1,0,1]
    v_pk_fma_f32 v[234:235], v[234:235], s[62:63], s[62:63] op_sel:[0,0,1] op_sel_hi:[1,0,1]
    v_pk_fma_f32 v[236:237], v[236:237], s[62:63], s[62:63] op_sel:[0,0,1] op_sel_hi:[1,0,1]
    v_pk_fma_f32 v[238:239], v[238:239], s[62:63], s[62:63] op_sel:[0,0,1] op_sel_hi:[1,0,1]
    v_pk_fma_f32 v[240:241], v[240:241], s[64:65], s[64:65] op_sel:[0,0,1] op_sel_hi:[1,0,1]
    v_pk_fma_f32 v[242:243], v[242:243], s[64:65], s[64:65] op_sel:[0,0,1] op_sel_hi:[1,0,1]
    v_pk_fma_f32 v[244:245], v[244:245], s[64:65], s[64:65] op_sel:[0,0,1] op_sel_hi:[1,0,1]
    v_pk_fma_f32 v[246:247], v[246:247], s[64:65], s[64:65] op_sel:[0,0,1] op_sel_hi:[1,0,1]
    v_pk_fma_f32 v[248:249], v[248:249], s[66:67], s[66:67] op_sel:[0,0,1] op_sel_hi:[1,0,1]
    v_pk_fma_f32 v[250:251], v[250:251], s[66:67], s[66:67] op_sel:[0,0,1] op_sel_hi:[1,0,1]
    v_pk_fma_f32 v[252:253], v[252:253], s[66:67], s[66:67] op_sel:[0,0,1] op_sel_hi:[1,0,1]
    v_pk_fma_f32 v[254:255], v[254:255], s[66:67], s[66:67] op_sel:[0,0,1] op_sel_hi:[1,0,1]
    s_load_dwordx4 s[36:39], s[0:1], 48
    s_load_dwordx2 s[50:51], s[0:1], 80
    v_mov_b32 v61, v60
    v_mov_b32 v62, v30
    v_mul_u32_u24 v60, 4736, v0
    s_mul_i32 s3, s88, 262400
    s_add_u32 s3, s3, 1277952
    v_add_u32 v60, s3, v60
    s_cmp_eq_u32 s71, 0x82
    s_cselect_b32 s3, 2, 0
    s_cselect_b32 s53, 1, 0
    v_cmp_gt_u32 vcc, s3, v0
    s_lshl_b32 s54, s87, 21
    s_nop 0
    v_cndmask_b32 v60, v63, v60, vcc
    v_cmp_gt_u32 vcc, s53, v55
    s_add_u32 s54, s54, 2097152
    s_nop 0
    v_cndmask_b32 v51, v63, v59, vcc
    s_xor_b32 s55, s54, 0x2000
    s_mov_b32 s52, -11
    s_waitcnt vmcnt(0)
    s_cmp_eq_u32 s94, 0
    s_cbranch_scc1 L_non2_retry
L_non2_done:
    s_mov_b32 s93, 60000
L_gran:
    v_cmp_ne_u64 vcc, s[94:95], v[34:35]
    s_cbranch_vccnz L_gran_retry
L_gran_done:
    ds_write_b64 v53, v[32:33]
    s_mov_b32 s70, 0x3db8aa3b
    s_waitcnt lgkmcnt(0)
    s_barrier
    ds_read_b128 v[32:35], v54
    ds_read_b128 v[36:39], v54 offset:16
    s_add_u32 s101, s101, 256
    buffer_load_dword v28, v29, s[4:7], s101 offen
    buffer_store_dword v63, v60, s[28:31], s54 offen sc1
    buffer_store_dword v63, v60, s[28:31], s55 offen sc1
    s_waitcnt lgkmcnt(0)
    v_lshlrev_b32 v64, 16, v32
    v_and_b32 v65, s68, v32
    v_lshlrev_b32 v66, 16, v33
    v_and_b32 v67, s68, v33
    v_lshlrev_b32 v68, 16, v34
    v_and_b32 v69, s68, v34
    v_lshlrev_b32 v70, 16, v35
    v_and_b32 v71, s68, v35
    v_lshlrev_b32 v72, 16, v36
    v_and_b32 v73, s68, v36
    v_lshlrev_b32 v74, 16, v37
    v_and_b32 v75, s68, v37
    v_lshlrev_b32 v76, 16, v38
    v_and_b32 v77, s68, v38
    v_lshlrev_b32 v78, 16, v39
    v_and_b32 v79, s68, v39
    v_pk_mul_f32 v[64:65], v[64:65], s[70:71] op_sel:[0,0] op_sel_hi:[1,0]
    v_pk_mul_f32 v[66:67], v[66:67], s[70:71] op_sel:[0,0] op_sel_hi:[1,0]
    v_pk_mul_f32 v[68:69], v[68:69], s[70:71] op_sel:[0,0] op_sel_hi:[1,0]
    v_pk_mul_f32 v[70:71], v[70:71], s[70:71] op_sel:[0,0] op_sel_hi:[1,0]
    v_pk_mul_f32 v[72:73], v[72:73], s[70:71] op_sel:[0,0] op_sel_hi:[1,0]
    v_pk_mul_f32 v[74:75], v[74:75], s[70:71] op_sel:[0,0] op_sel_hi:[1,0]
    v_pk_mul_f32 v[76:77], v[76:77], s[70:71] op_sel:[0,0] op_sel_hi:[1,0]
    v_pk_mul_f32 v[78:79], v[78:79], s[70:71] op_sel:[0,0] op_sel_hi:[1,0]
    v_xor_b32 v53, 64, v10
    v_mov_b32 v123, s95
    v_mov_b32 v122, s94
    v_pk_fma_f32 v[128:129], v[128:129], v[72:73], v[64:65]
    v_pk_fma_f32 v[130:131], v[130:131], v[74:75], v[66:67]
    v_pk_fma_f32 v[132:133], v[132:133], v[76:77], v[68:69]
    v_pk_fma_f32 v[134:135], v[134:135], v[78:79], v[70:71]
    v_cvt_pk_bf16_f32 v80, v128, v129
    v_cvt_pk_bf16_f32 v81, v130, v131
    v_cvt_pk_bf16_f32 v82, v132, v133
    v_cvt_pk_bf16_f32 v83, v134, v135
    ds_write_b128 v58, v[80:83] offset:0
    v_pk_fma_f32 v[136:137], v[136:137], v[72:73], v[64:65]
    v_pk_fma_f32 v[138:139], v[138:139], v[74:75], v[66:67]
    v_pk_fma_f32 v[140:141], v[140:141], v[76:77], v[68:69]
    v_pk_fma_f32 v[142:143], v[142:143], v[78:79], v[70:71]
    ds_read_b64_tr_b16 a[0:1], v2 offset:0
    ds_read_b64_tr_b16 a[2:3], v2 offset:256
    ds_read_b64_tr_b16 a[4:5], v2 offset:512
    v_cvt_pk_bf16_f32 v84, v136, v137
    v_cvt_pk_bf16_f32 v85, v138, v139
    v_cvt_pk_bf16_f32 v86, v140, v141
    v_cvt_pk_bf16_f32 v87, v142, v143
    ds_write_b128 v44, v[84:87] offset:0
    v_pk_fma_f32 v[144:145], v[144:145], v[72:73], v[64:65]
    v_pk_fma_f32 v[146:147], v[146:147], v[74:75], v[66:67]
    v_pk_fma_f32 v[148:149], v[148:149], v[76:77], v[68:69]
    v_pk_fma_f32 v[150:151], v[150:151], v[78:79], v[70:71]
    ds_read_b64_tr_b16 a[6:7], v2 offset:768
    ds_read_b64_tr_b16 a[8:9], v2 offset:8448
    ds_read_b64_tr_b16 a[10:11], v2 offset:8704
    v_cvt_pk_bf16_f32 v88, v144, v145
    v_cvt_pk_bf16_f32 v89, v146, v147
    v_cvt_pk_bf16_f32 v90, v148, v149
    v_cvt_pk_bf16_f32 v91, v150, v151
    ds_write_b128 v45, v[88:91] offset:0
    v_pk_fma_f32 v[152:153], v[152:153], v[72:73], v[64:65]
    v_pk_fma_f32 v[154:155], v[154:155], v[74:75], v[66:67]
    v_pk_fma_f32 v[156:157], v[156:157], v[76:77], v[68:69]
    v_pk_fma_f32 v[158:159], v[158:159], v[78:79], v[70:71]
    ds_read_b64_tr_b16 a[12:13], v2 offset:8960
    ds_read_b64_tr_b16 a[14:15], v2 offset:9216
    ds_read_b64_tr_b16 a[16:17], v2 offset:8
    v_cvt_pk_bf16_f32 v92, v152, v153
    v_cvt_pk_bf16_f32 v93, v154, v155
    v_cvt_pk_bf16_f32 v94, v156, v157
    v_cvt_pk_bf16_f32 v95, v158, v159
    ds_write_b128 v46, v[92:95] offset:0
    v_pk_fma_f32 v[160:161], v[160:161], v[72:73], v[64:65]
    v_pk_fma_f32 v[162:163], v[162:163], v[74:75], v[66:67]
    v_pk_fma_f32 v[164:165], v[164:165], v[76:77], v[68:69]
    v_pk_fma_f32 v[166:167], v[166:167], v[78:79], v[70:71]
    ds_read_b64_tr_b16 a[18:19], v2 offset:264
    ds_read_b64_tr_b16 a[20:21], v2 offset:520
    ds_read_b64_tr_b16 a[22:23], v2 offset:776
    v_cvt_pk_bf16_f32 v96, v160, v161
    v_cvt_pk_bf16_f32 v97, v162, v163
    v_cvt_pk_bf16_f32 v98, v164, v165
    v_cvt_pk_bf16_f32 v99, v166, v167
    ds_write_b128 v47, v[96:99] offset:0
    v_pk_fma_f32 v[168:169], v[168:169], v[72:73], v[64:65]
    v_pk_fma_f32 v[170:171], v[170:171], v[74:75], v[66:67]
    v_pk_fma_f32 v[172:173], v[172:173], v[76:77], v[68:69]
    v_pk_fma_f32 v[174:175], v[174:175], v[78:79], v[70:71]
    ds_read_b64_tr_b16 a[24:25], v2 offset:8456
    ds_read_b64_tr_b16 a[26:27], v2 offset:8712
    ds_read_b64_tr_b16 a[28:29], v2 offset:8968
    v_cvt_pk_bf16_f32 v100, v168, v169
    v_cvt_pk_bf16_f32 v101, v170, v171
    v_cvt_pk_bf16_f32 v102, v172, v173
    v_cvt_pk_bf16_f32 v103, v174, v175
    ds_write_b128 v48, v[100:103] offset:0
    v_pk_fma_f32 v[176:177], v[176:177], v[72:73], v[64:65]
    v_pk_fma_f32 v[178:179], v[178:179], v[74:75], v[66:67]
    v_pk_fma_f32 v[180:181], v[180:181], v[76:77], v[68:69]
    v_pk_fma_f32 v[182:183], v[182:183], v[78:79], v[70:71]
    ds_read_b64_tr_b16 a[30:31], v2 offset:9224
    ds_read_b64_tr_b16 a[32:33], v2 offset:64
    ds_read_b64_tr_b16 a[34:35], v2 offset:320
    v_cvt_pk_bf16_f32 v104, v176, v177
    v_cvt_pk_bf16_f32 v105, v178, v179
    v_cvt_pk_bf16_f32 v106, v180, v181
    v_cvt_pk_bf16_f32 v107, v182, v183
    ds_write_b128 v49, v[104:107] offset:0
    v_pk_fma_f32 v[184:185], v[184:185], v[72:73], v[64:65]
    v_pk_fma_f32 v[186:187], v[186:187], v[74:75], v[66:67]
    v_pk_fma_f32 v[188:189], v[188:189], v[76:77], v[68:69]
    v_pk_fma_f32 v[190:191], v[190:191], v[78:79], v[70:71]
    ds_read_b64_tr_b16 a[36:37], v2 offset:576
    ds_read_b64_tr_b16 a[38:39], v2 offset:832
    ds_read_b64_tr_b16 a[40:41], v2 offset:8512
    v_cvt_pk_bf16_f32 v108, v184, v185
    v_cvt_pk_bf16_f32 v109, v186, v187
    v_cvt_pk_bf16_f32 v110, v188, v189
    v_cvt_pk_bf16_f32 v111, v190, v191
    ds_write_b128 v50, v[108:111] offset:0
    v_pk_fma_f32 v[192:193], v[192:193], v[72:73], v[64:65]
    v_pk_fma_f32 v[194:195], v[194:195], v[74:75], v[66:67]
    v_pk_fma_f32 v[196:197], v[196:197], v[76:77], v[68:69]
    v_pk_fma_f32 v[198:199], v[198:199], v[78:79], v[70:71]
    ds_read_b64_tr_b16 a[42:43], v2 offset:8768
    ds_read_b64_tr_b16 a[44:45], v2 offset:9024
    ds_read_b64_tr_b16 a[46:47], v2 offset:9280
    v_cvt_pk_bf16_f32 v80, v192, v193
    v_cvt_pk_bf16_f32 v81, v194, v195
    v_cvt_pk_bf16_f32 v82, v196, v197
    v_cvt_pk_bf16_f32 v83, v198, v199
    ds_write_b128 v58, v[80:83] offset:128
    v_pk_fma_f32 v[200:201], v[200:201], v[72:73], v[64:65]
    v_pk_fma_f32 v[202:203], v[202:203], v[74:75], v[66:67]
    v_pk_fma_f32 v[204:205], v[204:205], v[76:77], v[68:69]
    v_pk_fma_f32 v[206:207], v[206:207], v[78:79], v[70:71]
    ds_read_b64_tr_b16 a[48:49], v2 offset:72
    ds_read_b64_tr_b16 a[50:51], v2 offset:328
    ds_read_b64_tr_b16 a[52:53], v2 offset:584
    v_cvt_pk_bf16_f32 v84, v200, v201
    v_cvt_pk_bf16_f32 v85, v202, v203
    v_cvt_pk_bf16_f32 v86, v204, v205
    v_cvt_pk_bf16_f32 v87, v206, v207
    ds_write_b128 v44, v[84:87] offset:128
    v_pk_fma_f32 v[208:209], v[208:209], v[72:73], v[64:65]
    v_pk_fma_f32 v[210:211], v[210:211], v[74:75], v[66:67]
    v_pk_fma_f32 v[212:213], v[212:213], v[76:77], v[68:69]
    v_pk_fma_f32 v[214:215], v[214:215], v[78:79], v[70:71]
    ds_read_b64_tr_b16 a[54:55], v2 offset:840
    ds_read_b64_tr_b16 a[56:57], v2 offset:8520
    ds_read_b64_tr_b16 a[58:59], v2 offset:8776
    v_cvt_pk_bf16_f32 v88, v208, v209
    v_cvt_pk_bf16_f32 v89, v210, v211
    v_cvt_pk_bf16_f32 v90, v212, v213
    v_cvt_pk_bf16_f32 v91, v214, v215
    ds_write_b128 v45, v[88:91] offset:128
    v_pk_fma_f32 v[216:217], v[216:217], v[72:73], v[64:65]
    v_pk_fma_f32 v[218:219], v[218:219], v[74:75], v[66:67]
    v_pk_fma_f32 v[220:221], v[220:221], v[76:77], v[68:69]
    v_pk_fma_f32 v[222:223], v[222:223], v[78:79], v[70:71]
    ds_read_b64_tr_b16 a[60:61], v2 offset:9032
    ds_read_b64_tr_b16 a[62:63], v2 offset:9288
    v_cvt_pk_bf16_f32 v92, v216, v217
    v_cvt_pk_bf16_f32 v93, v218, v219
    v_cvt_pk_bf16_f32 v94, v220, v221
    v_cvt_pk_bf16_f32 v95, v222, v223
    ds_write_b128 v46, v[92:95] offset:128
    v_pk_fma_f32 v[224:225], v[224:225], v[72:73], v[64:65]
    v_pk_fma_f32 v[226:227], v[226:227], v[74:75], v[66:67]
    v_pk_fma_f32 v[228:229], v[228:229], v[76:77], v[68:69]
    v_pk_fma_f32 v[230:231], v[230:231], v[78:79], v[70:71]
    v_cvt_pk_bf16_f32 v96, v224, v225
    v_cvt_pk_bf16_f32 v97, v226, v227
    v_cvt_pk_bf16_f32 v98, v228, v229
    v_cvt_pk_bf16_f32 v99, v230, v231
    ds_write_b128 v47, v[96:99] offset:128
    v_pk_fma_f32 v[232:233], v[232:233], v[72:73], v[64:65]
    v_pk_fma_f32 v[234:235], v[234:235], v[74:75], v[66:67]
    v_pk_fma_f32 v[236:237], v[236:237], v[76:77], v[68:69]
    v_pk_fma_f32 v[238:239], v[238:239], v[78:79], v[70:71]
    v_cvt_pk_bf16_f32 v100, v232, v233
    v_cvt_pk_bf16_f32 v101, v234, v235
    v_cvt_pk_bf16_f32 v102, v236, v237
    v_cvt_pk_bf16_f32 v103, v238, v239
    ds_write_b128 v48, v[100:103] offset:128
    v_pk_fma_f32 v[240:241], v[240:241], v[72:73], v[64:65]
    v_pk_fma_f32 v[242:243], v[242:243], v[74:75], v[66:67]
    v_pk_fma_f32 v[244:245], v[244:245], v[76:77], v[68:69]
    v_pk_fma_f32 v[246:247], v[246:247], v[78:79], v[70:71]
    v_cvt_pk_bf16_f32 v104, v240, v241
    v_cvt_pk_bf16_f32 v105, v242, v243
    v_cvt_pk_bf16_f32 v106, v244, v245
    v_cvt_pk_bf16_f32 v107, v246, v247
    ds_write_b128 v49, v[104:107] offset:128
    v_pk_fma_f32 v[248:249], v[248:249], v[72:73], v[64:65]
    v_pk_fma_f32 v[250:251], v[250:251], v[74:75], v[66:67]
    v_pk_fma_f32 v[252:253], v[252:253], v[76:77], v[68:69]
    v_pk_fma_f32 v[254:255], v[254:255], v[78:79], v[70:71]
    v_cvt_pk_bf16_f32 v108, v248, v249
    v_cvt_pk_bf16_f32 v109, v250, v251
    v_cvt_pk_bf16_f32 v110, v252, v253
    v_cvt_pk_bf16_f32 v111, v254, v255
    ds_write_b128 v50, v[108:111] offset:128
    s_waitcnt lgkmcnt(0)
    s_barrier
    ds_read_b128 a[128:131], v10 offset:0
    ds_read_b128 a[136:139], v53 offset:1024
    ds_read_b128 a[144:147], v10 offset:2048
    ds_read_b128 a[152:155], v53 offset:3072
    ds_read_b128 a[156:159], v53 offset:17408
    s_waitcnt lgkmcnt(4)
    v_mfma_f32_16x16x32_bf16 v[128:131], a[0:3], a[128:131], 0
    s_waitcnt lgkmcnt(3)
    ds_read_b128 a[148:151], v10 offset:16384
    ds_read_b128 a[140:143], v53 offset:15360
    v_mfma_f32_16x16x32_bf16 v[128:131], a[4:7], a[136:139], v[128:131]
    s_waitcnt lgkmcnt(4)
    ds_read_b128 a[132:135], v10 offset:14336
    v_mfma_f32_16x16x32_bf16 v[128:131], a[8:11], a[144:147], v[128:131]
    s_waitcnt lgkmcnt(4)
    ds_read_b128 a[160:163], v10 offset:4096
    ds_read_b128 a[168:171], v53 offset:5120
    v_mfma_f32_16x16x32_bf16 v[128:131], a[12:15], a[152:155], v[128:131]
    s_waitcnt lgkmcnt(5)
    ds_read_b128 a[176:179], v10 offset:6144
    v_mfma_f32_16x16x32_bf16 v[136:139], a[12:15], a[156:159], 0
    s_waitcnt lgkmcnt(5)
    ds_read_b128 a[184:187], v53 offset:7168
    ds_read_b128 a[188:191], v53 offset:21504
    v_mfma_f32_16x16x32_bf16 v[136:139], a[8:11], a[148:151], v[136:139]
    s_waitcnt lgkmcnt(6)
    ds_read_b128 a[180:183], v10 offset:20480
    v_mfma_f32_16x16x32_bf16 v[136:139], a[4:7], a[140:143], v[136:139]
    s_waitcnt lgkmcnt(6)
    s_mov_b32 s40, s36
    ds_read_b128 a[172:175], v53 offset:19456
    v_mfma_f32_16x16x32_bf16 v[136:139], a[0:3], a[132:135], v[136:139]
    s_mov_b32 s41, s37
    ds_read_b128 a[164:167], v10 offset:18432
    ds_read_b128 a[192:195], v10 offset:8192
    v_mfma_f32_16x16x32_bf16 v[132:135], a[16:19], a[128:131], 0
    ds_read_b128 a[200:203], v53 offset:9216
    v_mfma_f32_16x16x32_bf16 v[132:135], a[20:23], a[136:139], v[132:135]
    ds_read_b128 a[208:211], v10 offset:10240
    ds_read_b128 a[216:219], v53 offset:11264
    v_mfma_f32_16x16x32_bf16 v[132:135], a[24:27], a[144:147], v[132:135]
    s_mov_b32 s42, 1605632
    ds_read_b128 a[220:223], v53 offset:25600
    v_mfma_f32_16x16x32_bf16 v[132:135], a[28:31], a[152:155], v[132:135]
    ds_read_b128 a[212:215], v10 offset:24576
    ds_read_b128 a[204:207], v53 offset:23552
    v_mfma_f32_16x16x32_bf16 v[140:143], a[28:31], a[156:159], 0
    ds_read_b128 a[196:199], v10 offset:22528
    v_mfma_f32_16x16x32_bf16 v[140:143], a[24:27], a[148:151], v[140:143]
    s_mov_b32 s43, 0x20000
    ds_read_b128 a[224:227], v10 offset:12288
    ds_read_b128 a[232:235], v53 offset:13312
    v_mfma_f32_16x16x32_bf16 v[140:143], a[20:23], a[140:143], v[140:143]
    ds_read_b128 a[236:239], v53 offset:27648
    v_mfma_f32_16x16x32_bf16 v[140:143], a[16:19], a[132:135], v[140:143]
    ds_read_b128 a[228:231], v10 offset:26624
    v_mfma_f32_16x16x32_bf16 v[144:147], a[32:35], a[128:131], 0
    s_mov_b32 s44, s38
    v_mfma_f32_16x16x32_bf16 v[144:147], a[36:39], a[136:139], v[144:147]
    v_mfma_f32_16x16x32_bf16 v[144:147], a[40:43], a[144:147], v[144:147]
    v_mfma_f32_16x16x32_bf16 v[144:147], a[44:47], a[152:155], v[144:147]
    s_waitcnt lgkmcnt(0)
    s_barrier
    ds_read_b64_tr_b16 a[0:1], v2 offset:33792
    v_mfma_f32_16x16x32_bf16 v[152:155], a[44:47], a[156:159], 0
    s_add_u32 s77, s92, 3145728
    ds_read_b64_tr_b16 a[2:3], v2 offset:34048
    v_mfma_f32_16x16x32_bf16 v[152:155], a[40:43], a[148:151], v[152:155]
    s_mov_b32 s45, s39
    ds_read_b64_tr_b16 a[4:5], v2 offset:34304
    v_mfma_f32_16x16x32_bf16 v[152:155], a[36:39], a[140:143], v[152:155]
    s_add_u32 m0, s72, 101376
    s_nop 0
    buffer_load_dwordx4 v15, s[8:11], s77 offen lds
    v_mfma_f32_16x16x32_bf16 v[152:155], a[32:35], a[132:135], v[152:155]
    s_mov_b32 s46, 1605632
    ds_read_b64_tr_b16 a[6:7], v2 offset:34560
    v_mfma_f32_16x16x32_bf16 v[148:151], a[48:51], a[128:131], 0
    ds_read_b64_tr_b16 a[8:9], v2 offset:42240
    v_mfma_f32_16x16x32_bf16 v[148:151], a[52:55], a[136:139], v[148:151]
    s_mov_b32 s47, 0x20000
    ds_read_b64_tr_b16 a[10:11], v2 offset:42496
    v_mfma_f32_16x16x32_bf16 v[148:151], a[56:59], a[144:147], v[148:151]
    ds_read_b64_tr_b16 a[12:13], v2 offset:42752
    v_mfma_f32_16x16x32_bf16 v[148:151], a[60:63], a[152:155], v[148:151]
    buffer_load_dwordx4 v16, s[8:11], s77 offen offset:1032 lds
    v_mfma_f32_16x16x32_bf16 v[156:159], a[60:63], a[156:159], 0
    s_mul_i32 s64, s88, 1792
    ds_read_b64_tr_b16 a[14:15], v2 offset:43008
    ds_read_b64_tr_b16 a[16:17], v2 offset:33800
    v_mfma_f32_16x16x32_bf16 v[156:159], a[56:59], a[148:151], v[156:159]
L_hop0_1:
    s_cbranch_execz L_hop0_5
    ds_read_b64_tr_b16 a[18:19], v2 offset:34056
    v_mfma_f32_16x16x32_bf16 v[156:159], a[52:55], a[140:143], v[156:159]
    ds_read_b64_tr_b16 a[20:21], v2 offset:34312
    v_mfma_f32_16x16x32_bf16 v[156:159], a[48:51], a[132:135], v[156:159]
    s_waitcnt lgkmcnt(7)
    buffer_load_dwordx4 v17, s[8:11], s77 offen offset:2112 lds
    v_mfma_f32_16x16x32_bf16 v[128:131], a[0:3], a[160:163], v[128:131]
    s_add_u32 s64, s64, 3584
    ds_read_b64_tr_b16 a[22:23], v2 offset:34568
    ds_read_b64_tr_b16 a[24:25], v2 offset:42248
    v_mfma_f32_16x16x32_bf16 v[128:131], a[4:7], a[168:171], v[128:131]
    s_waitcnt lgkmcnt(7)
    ds_read_b64_tr_b16 a[26:27], v2 offset:42504
    v_mfma_f32_16x16x32_bf16 v[128:131], a[8:11], a[176:179], v[128:131]
    s_waitcnt lgkmcnt(6)
    ds_read_b64_tr_b16 a[28:29], v2 offset:42760
    v_mfma_f32_16x16x32_bf16 v[128:131], a[12:15], a[184:187], v[128:131]
    s_mul_i32 s48, s99, 100352
    buffer_load_dwordx4 v18, s[8:11], s77 offen offset:3144 lds
    v_mfma_f32_16x16x32_bf16 v[136:139], a[12:15], a[188:191], v[136:139]
    s_add_u32 s78, s92, 3211264
    ds_read_b64_tr_b16 a[30:31], v2 offset:43016
    ds_read_b64_tr_b16 a[32:33], v2 offset:33856
    v_mfma_f32_16x16x32_bf16 v[136:139], a[8:11], a[180:183], v[136:139]
    s_add_u32 m0, s72, 105600
    ds_read_b64_tr_b16 a[34:35], v2 offset:34112
    v_mfma_f32_16x16x32_bf16 v[136:139], a[4:7], a[172:175], v[136:139]
    s_mul_i32 s3, s86, 448
    ds_read_b64_tr_b16 a[36:37], v2 offset:34368
    v_mfma_f32_16x16x32_bf16 v[136:139], a[0:3], a[164:167], v[136:139]
    s_waitcnt lgkmcnt(8)
    buffer_load_dwordx4 v15, s[8:11], s78 offen lds
    v_mfma_f32_16x16x32_bf16 v[132:135], a[16:19], a[160:163], v[132:135]
    s_waitcnt lgkmcnt(6)
    ds_read_b64_tr_b16 a[38:39], v2 offset:34624
    ds_read_b64_tr_b16 a[40:41], v2 offset:42304
    v_mfma_f32_16x16x32_bf16 v[132:135], a[20:23], a[168:171], v[132:135]
    s_waitcnt lgkmcnt(7)
    ds_read_b64_tr_b16 a[42:43], v2 offset:42560
    v_mfma_f32_16x16x32_bf16 v[132:135], a[24:27], a[176:179], v[132:135]
    s_waitcnt lgkmcnt(6)
    s_add_u32 s48, s48, s3
    ds_read_b64_tr_b16 a[44:45], v2 offset:42816
    v_mfma_f32_16x16x32_bf16 v[132:135], a[28:31], a[184:187], v[132:135]
    s_mul_i32 s49, s86, 200704
    buffer_load_dwordx4 v16, s[8:11], s78 offen offset:1032 lds
    v_mfma_f32_16x16x32_bf16 v[140:143], a[28:31], a[188:191], v[140:143]
    ds_read_b64_tr_b16 a[46:47], v2 offset:43072
    ds_read_b64_tr_b16 a[48:49], v2 offset:33864
    v_mfma_f32_16x16x32_bf16 v[140:143], a[24:27], a[180:183], v[140:143]
    ds_read_b64_tr_b16 a[50:51], v2 offset:34120
    v_mfma_f32_16x16x32_bf16 v[140:143], a[20:23], a[172:175], v[140:143]
    s_mul_i32 s3, s99, 12544
    ds_read_b64_tr_b16 a[52:53], v2 offset:34376
    v_mfma_f32_16x16x32_bf16 v[140:143], a[16:19], a[164:167], v[140:143]
    s_waitcnt lgkmcnt(8)
    buffer_load_dwordx4 v17, s[8:11], s78 offen offset:2112 lds
    v_mfma_f32_16x16x32_bf16 v[144:147], a[32:35], a[160:163], v[144:147]
    s_waitcnt lgkmcnt(6)
    ds_read_b64_tr_b16 a[54:55], v2 offset:34632
    ds_read_b64_tr_b16 a[56:57], v2 offset:42312
    v_mfma_f32_16x16x32_bf16 v[144:147], a[36:39], a[168:171], v[144:147]
    s_waitcnt lgkmcnt(7)
    ds_read_b64_tr_b16 a[58:59], v2 offset:42568
    v_mfma_f32_16x16x32_bf16 v[144:147], a[40:43], a[176:179], v[144:147]
    s_waitcnt lgkmcnt(6)
    buffer_load_dwordx4 v18, s[8:11], s78 offen offset:3144 lds
    v_mfma_f32_16x16x32_bf16 v[144:147], a[44:47], a[184:187], v[144:147]
    s_barrier
    ds_read_b64_tr_b16 a[60:61], v2 offset:42824
    s_add_u32 s49, s49, s3
    v_mfma_f32_16x16x32_bf16 v[152:155], a[44:47], a[188:191], v[152:155]
    s_add_u32 s77, s74, 524416
    ds_read_b64_tr_b16 a[62:63], v2 offset:43080
    ds_read_b64_tr_b16 a[0:1], v3 offset:0
    v_mfma_f32_16x16x32_bf16 v[152:155], a[40:43], a[180:183], v[152:155]
    s_add_u32 m0, s72, 0
    ds_read_b64_tr_b16 a[2:3], v3 offset:256
    v_mfma_f32_16x16x32_bf16 v[152:155], a[36:39], a[172:175], v[152:155]
    s_min_u32 s69, s88, 1
    ds_read_b64_tr_b16 a[4:5], v3 offset:512
    v_mfma_f32_16x16x32_bf16 v[152:155], a[32:35], a[164:167], v[152:155]
    s_waitcnt lgkmcnt(8)
    buffer_load_dwordx4 v15, s[8:11], s77 offen lds
    v_mfma_f32_16x16x32_bf16 v[148:151], a[48:51], a[160:163], v[148:151]
    s_waitcnt lgkmcnt(6)
    ds_read_b64_tr_b16 a[6:7], v3 offset:768
    ds_read_b64_tr_b16 a[8:9], v3 offset:8448
    v_mfma_f32_16x16x32_bf16 v[148:151], a[52:55], a[168:171], v[148:151]
    s_waitcnt lgkmcnt(7)
    s_lshl_b32 s69, s69, 13
    ds_read_b64_tr_b16 a[10:11], v3 offset:8704
    v_mfma_f32_16x16x32_bf16 v[148:151], a[56:59], a[176:179], v[148:151]
    s_waitcnt lgkmcnt(6)
    ds_read_b64_tr_b16 a[12:13], v3 offset:8960
    v_mfma_f32_16x16x32_bf16 v[148:151], a[60:63], a[184:187], v[148:151]
    s_add_u32 s69, s69, 6144
    buffer_load_dwordx4 v16, s[8:11], s77 offen offset:1032 lds
    v_mfma_f32_16x16x32_bf16 v[156:159], a[60:63], a[188:191], v[156:159]
    ds_read_b64_tr_b16 a[14:15], v3 offset:9216
    ds_read_b64_tr_b16 a[16:17], v3 offset:8
    v_mfma_f32_16x16x32_bf16 v[156:159], a[56:59], a[180:183], v[156:159]
    s_lshl_b32 s67, s87, 7
    ds_read_b64_tr_b16 a[18:19], v3 offset:264
    v_mfma_f32_16x16x32_bf16 v[156:159], a[52:55], a[172:175], v[156:159]
    ds_read_b64_tr_b16 a[20:21], v3 offset:520
    v_mfma_f32_16x16x32_bf16 v[156:159], a[48:51], a[164:167], v[156:159]
    s_waitcnt lgkmcnt(8)
    buffer_load_dwordx4 v17, s[8:11], s77 offen offset:2112 lds
    v_mfma_f32_16x16x32_bf16 v[128:131], a[0:3], a[192:195], v[128:131]
    s_waitcnt lgkmcnt(6)
    ds_read_b64_tr_b16 a[22:23], v3 offset:776
    ds_read_b64_tr_b16 a[24:25], v3 offset:8456
    v_mfma_f32_16x16x32_bf16 v[128:131], a[4:7], a[200:203], v[128:131]
    s_waitcnt lgkmcnt(7)
    ds_read_b64_tr_b16 a[26:27], v3 offset:8712
    v_mfma_f32_16x16x32_bf16 v[128:131], a[8:11], a[208:211], v[128:131]
    s_waitcnt lgkmcnt(6)
    s_add_u32 s67, s67, 16384
    ds_read_b64_tr_b16 a[28:29], v3 offset:8968
    v_mfma_f32_16x16x32_bf16 v[128:131], a[12:15], a[216:219], v[128:131]
    s_lshl_b32 s62, s87, 21
    buffer_load_dwordx4 v18, s[8:11], s77 offen offset:3144 lds
    v_mfma_f32_16x16x32_bf16 v[136:139], a[12:15], a[220:223], v[136:139]
    s_add_u32 s78, s74, 589952
    ds_read_b64_tr_b16 a[30:31], v3 offset:9224
    ds_read_b64_tr_b16 a[32:33], v3 offset:64
    v_mfma_f32_16x16x32_bf16 v[136:139], a[8:11], a[212:215], v[136:139]
    s_add_u32 m0, s72, 4224
    ds_read_b64_tr_b16 a[34:35], v3 offset:320
    v_mfma_f32_16x16x32_bf16 v[136:139], a[4:7], a[204:207], v[136:139]
    s_add_u32 s62, s62, 2097152
    ds_read_b64_tr_b16 a[36:37], v3 offset:576
    v_mfma_f32_16x16x32_bf16 v[136:139], a[0:3], a[196:199], v[136:139]
    s_waitcnt lgkmcnt(8)
    buffer_load_dwordx4 v15, s[8:11], s78 offen lds
    v_mfma_f32_16x16x32_bf16 v[132:135], a[16:19], a[192:195], v[132:135]
    s_waitcnt lgkmcnt(6)
    ds_read_b64_tr_b16 a[38:39], v3 offset:832
    ds_read_b64_tr_b16 a[40:41], v3 offset:8512
    v_mfma_f32_16x16x32_bf16 v[132:135], a[20:23], a[200:203], v[132:135]
    s_waitcnt lgkmcnt(7)
    ds_read_b64_tr_b16 a[42:43], v3 offset:8768
    v_mfma_f32_16x16x32_bf16 v[132:135], a[24:27], a[208:211], v[132:135]
    s_waitcnt lgkmcnt(6)
    ds_read_b64_tr_b16 a[44:45], v3 offset:9024
    v_mfma_f32_16x16x32_bf16 v[132:135], a[28:31], a[216:219], v[132:135]
    s_lshr_b32 s63, s86, 1
    buffer_load_dwordx4 v16, s[8:11], s78 offen offset:1032 lds
    v_mfma_f32_16x16x32_bf16 v[140:143], a[28:31], a[220:223], v[140:143]
    s_lshl_b32 s63, s63, 18
    ds_read_b64_tr_b16 a[46:47], v3 offset:9280
    ds_read_b64_tr_b16 a[48:49], v3 offset:72
    v_mfma_f32_16x16x32_bf16 v[140:143], a[24:27], a[212:215], v[140:143]
    ds_read_b64_tr_b16 a[50:51], v3 offset:328
    v_mfma_f32_16x16x32_bf16 v[140:143], a[20:23], a[204:207], v[140:143]
    ds_read_b64_tr_b16 a[52:53], v3 offset:584
    v_mfma_f32_16x16x32_bf16 v[140:143], a[16:19], a[196:199], v[140:143]
    s_waitcnt lgkmcnt(8)
    buffer_load_dwordx4 v17, s[8:11], s78 offen offset:2112 lds
    v_mfma_f32_16x16x32_bf16 v[144:147], a[32:35], a[192:195], v[144:147]
    s_waitcnt lgkmcnt(6)
    ds_read_b64_tr_b16 a[54:55], v3 offset:840
    ds_read_b64_tr_b16 a[56:57], v3 offset:8520
    v_mfma_f32_16x16x32_bf16 v[144:147], a[36:39], a[200:203], v[144:147]
    s_waitcnt lgkmcnt(7)
    s_and_b32 s3, s86, 1
    ds_read_b64_tr_b16 a[58:59], v3 offset:8776
    v_mfma_f32_16x16x32_bf16 v[144:147], a[40:43], a[208:211], v[144:147]
    s_waitcnt lgkmcnt(6)
    buffer_load_dwordx4 v18, s[8:11], s78 offen offset:3144 lds
    v_mfma_f32_16x16x32_bf16 v[144:147], a[44:47], a[216:219], v[144:147]
    s_waitcnt vmcnt(8)
    s_barrier
    ds_read_b64_tr_b16 a[60:61], v3 offset:9032
    v_mfma_f32_16x16x32_bf16 v[152:155], a[44:47], a[220:223], v[152:155]
    s_lshl_b32 s3, s3, 7
    ds_read_b64_tr_b16 a[62:63], v3 offset:9288
    ds_read_b64_tr_b16 a[0:1], v3 offset:33792
    v_mfma_f32_16x16x32_bf16 v[152:155], a[40:43], a[212:215], v[152:155]
    s_add_u32 s77, s74, 1572992
    ds_read_b64_tr_b16 a[2:3], v3 offset:34048
    v_mfma_f32_16x16x32_bf16 v[152:155], a[36:39], a[204:207], v[152:155]
    s_add_u32 m0, s72, 33792
    ds_read_b64_tr_b16 a[4:5], v3 offset:34304
    v_mfma_f32_16x16x32_bf16 v[152:155], a[32:35], a[196:199], v[152:155]
    s_waitcnt lgkmcnt(8)
    buffer_load_dwordx4 v15, s[8:11], s77 offen lds
    v_mfma_f32_16x16x32_bf16 v[148:151], a[48:51], a[192:195], v[148:151]
    s_waitcnt lgkmcnt(6)
    s_add_u32 s63, s63, s3
    ds_read_b64_tr_b16 a[6:7], v3 offset:34560
    v_mfma_f32_16x16x32_bf16 v[148:151], a[52:55], a[200:203], v[148:151]
    s_waitcnt lgkmcnt(6)
    ds_read_b64_tr_b16 a[8:9], v3 offset:33800
    ds_read_b64_tr_b16 a[10:11], v3 offset:34056
    v_mfma_f32_16x16x32_bf16 v[148:151], a[56:59], a[208:211], v[148:151]
    s_waitcnt lgkmcnt(6)
    s_add_u32 s63, s63, 229376
    ds_read_b64_tr_b16 a[12:13], v3 offset:34312
    v_mfma_f32_16x16x32_bf16 v[148:151], a[60:63], a[216:219], v[148:151]
    s_bfe_u32 s34, s87, 0x30001
    buffer_load_dwordx4 v16, s[8:11], s77 offen offset:1032 lds
    v_mfma_f32_16x16x32_bf16 v[156:159], a[60:63], a[220:223], v[156:159]
    ds_read_b64_tr_b16 a[14:15], v3 offset:34568
    ds_read_b64_tr_b16 a[16:17], v3 offset:33856
    v_mfma_f32_16x16x32_bf16 v[156:159], a[56:59], a[212:215], v[156:159]
    ds_read_b64_tr_b16 a[18:19], v3 offset:34112
    v_mfma_f32_16x16x32_bf16 v[156:159], a[52:55], a[204:207], v[156:159]
    s_and_b32 s34, s34, 7
    ds_read_b64_tr_b16 a[20:21], v3 offset:34368
    v_mfma_f32_16x16x32_bf16 v[156:159], a[48:51], a[196:199], v[156:159]
    s_waitcnt lgkmcnt(8)
    buffer_load_dwordx4 v17, s[8:11], s77 offen offset:2112 lds
    v_mfma_f32_16x16x32_bf16 v[128:131], a[0:3], a[224:227], v[128:131]
    s_waitcnt lgkmcnt(7)
    ds_read_b64_tr_b16 a[22:23], v3 offset:34624
    ds_read_b64_tr_b16 a[24:25], v3 offset:33864
    v_mfma_f32_16x16x32_bf16 v[128:131], a[4:7], a[232:235], v[128:131]
    s_lshl_b32 s34, s34, 18
    ds_read_b64_tr_b16 a[26:27], v3 offset:34120
    v_mfma_f32_16x16x32_bf16 v[136:139], a[4:7], a[236:239], v[136:139]
    ds_read_b64_tr_b16 a[28:29], v3 offset:34376
    v_mfma_f32_16x16x32_bf16 v[136:139], a[0:3], a[228:231], v[136:139]
    s_waitcnt lgkmcnt(8)
    buffer_load_dwordx4 v18, s[8:11], s77 offen offset:3144 lds
    v_mfma_f32_16x16x32_bf16 v[132:135], a[8:11], a[224:227], v[132:135]
    s_waitcnt lgkmcnt(6)
    ds_read_b64_tr_b16 a[30:31], v3 offset:34632
    ds_read_b64_tr_b16 a[32:33], v3 offset:42240
    v_mfma_f32_16x16x32_bf16 v[132:135], a[12:15], a[232:235], v[132:135]
    s_add_u32 s78, s74, 1638528
    ds_read_b64_tr_b16 a[34:35], v3 offset:42496
    v_mfma_f32_16x16x32_bf16 v[140:143], a[12:15], a[236:239], v[140:143]
    s_add_u32 m0, s72, 38016
    s_xor_b32 s63, s63, s34
    ds_read_b64_tr_b16 a[36:37], v3 offset:42752
    v_mfma_f32_16x16x32_bf16 v[140:143], a[8:11], a[228:231], v[140:143]
    s_waitcnt lgkmcnt(8)
    buffer_load_dwordx4 v15, s[8:11], s78 offen lds
    v_mfma_f32_16x16x32_bf16 v[144:147], a[16:19], a[224:227], v[144:147]
    s_waitcnt lgkmcnt(6)
    ds_read_b64_tr_b16 a[38:39], v3 offset:43008
    ds_read_b64_tr_b16 a[40:41], v3 offset:42248
    v_mfma_f32_16x16x32_bf16 v[144:147], a[20:23], a[232:235], v[144:147]
    s_xor_b32 s79, s79, s34
    ds_read_b64_tr_b16 a[42:43], v3 offset:42504
    v_mfma_f32_16x16x32_bf16 v[152:155], a[20:23], a[236:239], v[152:155]
    s_xor_b32 s81, s81, s34
    ds_read_b64_tr_b16 a[44:45], v3 offset:42760
    v_cvt_pk_bf16_f32 v128, v128, v129
    v_mfma_f32_16x16x32_bf16 v[152:155], a[16:19], a[228:231], v[152:155]
    s_waitcnt lgkmcnt(8)
    buffer_load_dwordx4 v16, s[8:11], s78 offen offset:1032 lds
    v_mfma_f32_16x16x32_bf16 v[148:151], a[24:27], a[224:227], v[148:151]
    s_waitcnt lgkmcnt(6)
    ds_read_b64_tr_b16 a[46:47], v3 offset:43016
    ds_read_b64_tr_b16 a[48:49], v3 offset:42304
    v_mfma_f32_16x16x32_bf16 v[148:151], a[28:31], a[232:235], v[148:151]
    s_lshl_b32 s66, s88, 11
    ds_read_b64_tr_b16 a[50:51], v3 offset:42560
    v_mfma_f32_16x16x32_bf16 v[156:159], a[28:31], a[236:239], v[156:159]
    ds_read_b64_tr_b16 a[52:53], v3 offset:42816
    v_cvt_pk_bf16_f32 v129, v130, v131
    v_mfma_f32_16x16x32_bf16 v[156:159], a[24:27], a[228:231], v[156:159]
    s_waitcnt lgkmcnt(8)
    buffer_load_dwordx4 v17, s[8:11], s78 offen offset:2112 lds
    v_mfma_f32_16x16x32_bf16 v[160:163], a[32:35], a[128:131], 0
    s_waitcnt lgkmcnt(6)
    ds_read_b64_tr_b16 a[54:55], v3 offset:43072
    ds_read_b64_tr_b16 a[56:57], v3 offset:42312
    v_mfma_f32_16x16x32_bf16 v[160:163], a[36:39], a[136:139], v[160:163]
    s_add_u32 s66, s66, s63
    ds_read_b64_tr_b16 a[58:59], v3 offset:42568
    v_mfma_f32_16x16x32_bf16 v[168:171], a[36:39], a[140:143], 0
    buffer_load_dwordx4 v18, s[8:11], s78 offen offset:3144 lds
    v_mfma_f32_16x16x32_bf16 v[168:171], a[32:35], a[132:135], v[168:171]
    s_waitcnt vmcnt(8)
    s_barrier
    s_waitcnt lgkmcnt(7)
    v_mfma_f32_16x16x32_bf16 v[164:167], a[40:43], a[128:131], 0
    s_waitcnt lgkmcnt(5)
    buffer_store_dword v63, v60, s[28:31], s54 offen sc1
    v_mfma_f32_16x16x32_bf16 v[164:167], a[44:47], a[136:139], v[164:167]
    s_add_u32 s77, s74, 2621568
    ds_read_b64_tr_b16 a[60:61], v3 offset:42824
    ds_read_b64_tr_b16 a[62:63], v3 offset:43080
    v_mfma_f32_16x16x32_bf16 v[172:175], a[44:47], a[140:143], 0
    s_add_u32 m0, s72, 67584
    ds_read_b64_tr_b16 a[0:1], v2 offset:0
    ds_read_b64_tr_b16 a[2:3], v2 offset:256
    v_cvt_pk_bf16_f32 v130, v132, v133
    v_mfma_f32_16x16x32_bf16 v[172:175], a[40:43], a[132:135], v[172:175]
    s_waitcnt lgkmcnt(7)
    ds_read_b64_tr_b16 a[4:5], v2 offset:512
    ds_read_b64_tr_b16 a[6:7], v2 offset:768
    v_mfma_f32_16x16x32_bf16 v[176:179], a[48:51], a[128:131], 0
    s_waitcnt lgkmcnt(7)
    buffer_load_dwordx4 v15, s[8:11], s77 offen lds
    v_mfma_f32_16x16x32_bf16 v[176:179], a[52:55], a[136:139], v[176:179]
    ds_read_b64_tr_b16 a[8:9], v2 offset:8448
    ds_read_b64_tr_b16 a[10:11], v2 offset:8704
    v_mfma_f32_16x16x32_bf16 v[184:187], a[52:55], a[140:143], 0
    ds_read_b64_tr_b16 a[12:13], v2 offset:8960
    v_cvt_pk_bf16_f32 v131, v134, v135
    v_mfma_f32_16x16x32_bf16 v[184:187], a[48:51], a[132:135], v[184:187]
    s_waitcnt lgkmcnt(9)
    buffer_load_dwordx4 v16, s[8:11], s77 offen offset:1032 lds
    v_mfma_f32_16x16x32_bf16 v[180:183], a[56:59], a[128:131], 0
    s_waitcnt lgkmcnt(7)
    ds_read_b64_tr_b16 a[14:15], v2 offset:9216
    ds_read_b64_tr_b16 a[16:17], v2 offset:8
    v_mfma_f32_16x16x32_bf16 v[180:183], a[60:63], a[136:139], v[180:183]
    ds_read_b64_tr_b16 a[18:19], v2 offset:264
    v_cvt_pk_bf16_f32 v136, v136, v137
    v_mfma_f32_16x16x32_bf16 v[188:191], a[60:63], a[140:143], 0
    ds_read_b64_tr_b16 a[20:21], v2 offset:520
    v_cvt_pk_bf16_f32 v137, v138, v139
    v_mfma_f32_16x16x32_bf16 v[188:191], a[56:59], a[132:135], v[188:191]
    s_waitcnt lgkmcnt(7)
    s_getreg_b32 s53, hwreg(HW_REG_IB_STS, 0, 4)
    ds_read_b64_tr_b16 a[22:23], v2 offset:776
    v_mfma_f32_16x16x32_bf16 v[160:163], a[0:3], a[144:147], v[160:163]
    s_add_u32 s52, s52, s53
    buffer_load_dwordx4 v17, s[8:11], s77 offen offset:2112 lds
    v_mfma_f32_16x16x32_bf16 v[160:163], a[4:7], a[152:155], v[160:163]
    s_waitcnt lgkmcnt(6)
    ds_read_b64_tr_b16 a[24:25], v2 offset:8456
    ds_read_b64_tr_b16 a[26:27], v2 offset:8712
    v_mfma_f32_16x16x32_bf16 v[160:163], a[8:11], a[160:163], v[160:163]
    s_waitcnt lgkmcnt(6)
    ds_read_b64_tr_b16 a[28:29], v2 offset:8968
    v_cvt_pk_bf16_f32 v138, v140, v141
    v_mfma_f32_16x16x32_bf16 v[160:163], a[12:15], a[168:171], v[160:163]
    s_getreg_b32 s53, hwreg(HW_REG_IB_STS, 0, 4)
    buffer_load_dwordx4 v18, s[8:11], s77 offen offset:3144 lds
    v_mfma_f32_16x16x32_bf16 v[168:171], a[12:15], a[172:175], v[168:171]
    s_add_u32 s78, s74, 2687104
    ds_read_b64_tr_b16 a[30:31], v2 offset:9224
    ds_read_b64_tr_b16 a[32:33], v2 offset:64
    v_mfma_f32_16x16x32_bf16 v[168:171], a[8:11], a[164:167], v[168:171]
    s_add_u32 m0, s72, 71808
    ds_read_b64_tr_b16 a[34:35], v2 offset:320
    v_mfma_f32_16x16x32_bf16 v[168:171], a[4:7], a[156:159], v[168:171]
    s_add_u32 s52, s52, s53
    ds_read_b64_tr_b16 a[36:37], v2 offset:576
    v_cvt_pk_bf16_f32 v139, v142, v143
    v_cvt_pk_bf16_f32 v144, v144, v145
    v_cvt_pk_bf16_f32 v145, v146, v147
    v_mfma_f32_16x16x32_bf16 v[168:171], a[0:3], a[148:151], v[168:171]
    s_waitcnt lgkmcnt(7)
    s_getreg_b32 s53, hwreg(HW_REG_IB_STS, 0, 4)
    v_cvt_pk_bf16_f32 v146, v148, v149
    v_cvt_pk_bf16_f32 v147, v150, v151
    v_cvt_pk_bf16_f32 v152, v152, v153
    v_mfma_f32_16x16x32_bf16 v[164:167], a[16:19], a[144:147], v[164:167]
    s_add_u32 s52, s52, s53
    buffer_load_dwordx4 v15, s[8:11], s78 offen lds
    v_mfma_f32_16x16x32_bf16 v[164:167], a[20:23], a[152:155], v[164:167]
    s_waitcnt lgkmcnt(5)
    ds_read_b64_tr_b16 a[38:39], v2 offset:832
    ds_read_b64_tr_b16 a[40:41], v2 offset:8512
    v_mfma_f32_16x16x32_bf16 v[164:167], a[24:27], a[160:163], v[164:167]
    s_waitcnt lgkmcnt(5)
    ds_read_b64_tr_b16 a[42:43], v2 offset:8768
    ds_read_b64_tr_b16 a[44:45], v2 offset:9024
    v_cvt_pk_bf16_f32 v153, v154, v155
    v_mfma_f32_16x16x32_bf16 v[164:167], a[28:31], a[168:171], v[164:167]
    s_getreg_b32 s53, hwreg(HW_REG_IB_STS, 0, 4)
    buffer_load_dwordx4 v16, s[8:11], s78 offen offset:1032 lds
    v_mfma_f32_16x16x32_bf16 v[172:175], a[28:31], a[172:175], v[172:175]
    s_add_u32 s52, s52, s53
    ds_read_b64_tr_b16 a[46:47], v2 offset:9280
    ds_read_b64_tr_b16 a[48:49], v2 offset:72
    v_mfma_f32_16x16x32_bf16 v[172:175], a[24:27], a[164:167], v[172:175]
    ds_read_b64_tr_b16 a[50:51], v2 offset:328
    v_cvt_pk_bf16_f32 v154, v156, v157
    v_mfma_f32_16x16x32_bf16 v[172:175], a[20:23], a[156:159], v[172:175]
    ds_read_b64_tr_b16 a[52:53], v2 offset:584
    v_cvt_pk_bf16_f32 v155, v158, v159
    v_mfma_f32_16x16x32_bf16 v[172:175], a[16:19], a[148:151], v[172:175]
    s_waitcnt lgkmcnt(8)
    s_getreg_b32 s53, hwreg(HW_REG_IB_STS, 0, 4)
    ds_read_b64_tr_b16 a[54:55], v2 offset:840
    v_mfma_f32_16x16x32_bf16 v[176:179], a[32:35], a[144:147], v[176:179]
    s_waitcnt lgkmcnt(8)
    buffer_load_dwordx4 v17, s[8:11], s78 offen offset:2112 lds
    v_mfma_f32_16x16x32_bf16 v[176:179], a[36:39], a[152:155], v[176:179]
    s_waitcnt lgkmcnt(6)
    ds_read_b64_tr_b16 a[56:57], v2 offset:8520
    ds_read_b64_tr_b16 a[58:59], v2 offset:8776
    v_mfma_f32_16x16x32_bf16 v[176:179], a[40:43], a[160:163], v[176:179]
    s_waitcnt lgkmcnt(6)
    buffer_load_dwordx4 v18, s[8:11], s78 offen offset:3144 lds
    s_add_u32 s52, s52, s53
    v_mfma_f32_16x16x32_bf16 v[176:179], a[44:47], a[168:171], v[176:179]
    s_waitcnt vmcnt(9)
    s_barrier
    s_getreg_b32 s53, hwreg(HW_REG_IB_STS, 0, 4)
    v_mfma_f32_16x16x32_bf16 v[184:187], a[44:47], a[172:175], v[184:187]
    s_add_u32 s77, s74, 256
    ds_read_b64_tr_b16 a[60:61], v2 offset:9032
    ds_read_b64_tr_b16 a[62:63], v2 offset:9288
    v_mfma_f32_16x16x32_bf16 v[184:187], a[40:43], a[164:167], v[184:187]
    s_add_u32 m0, s72, 101376
    ds_read_b64_tr_b16 a[0:1], v2 offset:33792
    ds_read_b64_tr_b16 a[2:3], v2 offset:34048
    v_mfma_f32_16x16x32_bf16 v[184:187], a[36:39], a[156:159], v[184:187]
    s_add_u32 s52, s52, s53
    ds_read_b64_tr_b16 a[4:5], v2 offset:34304
    v_mfma_f32_16x16x32_bf16 v[184:187], a[32:35], a[148:151], v[184:187]
    s_waitcnt lgkmcnt(7)
    s_getreg_b32 s53, hwreg(HW_REG_IB_STS, 0, 4)
    ds_read_b64_tr_b16 a[6:7], v2 offset:34560
    v_mfma_f32_16x16x32_bf16 v[180:183], a[48:51], a[144:147], v[180:183]
    s_add_u32 s52, s52, s53
    buffer_load_dwordx4 v15, s[8:11], s77 offen lds
    v_mfma_f32_16x16x32_bf16 v[180:183], a[52:55], a[152:155], v[180:183]
    s_waitcnt lgkmcnt(6)
    ds_read_b64_tr_b16 a[8:9], v2 offset:42240
    ds_read_b64_tr_b16 a[10:11], v2 offset:42496
    v_mfma_f32_16x16x32_bf16 v[180:183], a[56:59], a[160:163], v[180:183]
    s_waitcnt lgkmcnt(6)
    ds_read_b64_tr_b16 a[12:13], v2 offset:42752
    v_mfma_f32_16x16x32_bf16 v[180:183], a[60:63], a[168:171], v[180:183]
    s_getreg_b32 s53, hwreg(HW_REG_IB_STS, 0, 4)
    buffer_load_dwordx4 v16, s[8:11], s77 offen offset:1032 lds
    v_mfma_f32_16x16x32_bf16 v[188:191], a[60:63], a[172:175], v[188:191]
    s_add_u32 s52, s52, s53
    ds_read_b64_tr_b16 a[14:15], v2 offset:43008
    ds_read_b64_tr_b16 a[16:17], v2 offset:33800
    v_mfma_f32_16x16x32_bf16 v[188:191], a[56:59], a[164:167], v[188:191]
    ds_read_b64_tr_b16 a[18:19], v2 offset:34056
    v_accvgpr_write_b32 a64, v128
    v_mfma_f32_16x16x32_bf16 v[188:191], a[52:55], a[156:159], v[188:191]
    ds_read_b64_tr_b16 a[20:21], v2 offset:34312
    v_mfma_f32_16x16x32_bf16 v[188:191], a[48:51], a[148:151], v[188:191]
    s_waitcnt lgkmcnt(7)
    s_getreg_b32 s53, hwreg(HW_REG_IB_STS, 0, 4)
    ds_read_b64_tr_b16 a[22:23], v2 offset:34568
    v_mfma_f32_16x16x32_bf16 v[160:163], a[0:3], a[176:179], v[160:163]
    s_add_u32 s52, s52, s53
    buffer_load_dwordx4 v17, s[8:11], s77 offen offset:2112 lds
    v_mfma_f32_16x16x32_bf16 v[160:163], a[4:7], a[184:187], v[160:163]
    s_waitcnt lgkmcnt(6)
    ds_read_b64_tr_b16 a[24:25], v2 offset:42248
    ds_read_b64_tr_b16 a[26:27], v2 offset:42504
    v_mfma_f32_16x16x32_bf16 v[160:163], a[8:11], a[192:195], v[160:163]
    s_waitcnt lgkmcnt(6)
    ds_read_b64_tr_b16 a[28:29], v2 offset:42760
    v_accvgpr_write_b32 a65, v129
    v_mfma_f32_16x16x32_bf16 v[160:163], a[12:15], a[200:203], v[160:163]
    s_getreg_b32 s53, hwreg(HW_REG_IB_STS, 0, 4)
    buffer_load_dwordx4 v18, s[8:11], s77 offen offset:3144 lds
    v_mfma_f32_16x16x32_bf16 v[168:171], a[12:15], a[204:207], v[168:171]
    s_add_u32 s78, s74, 65792
    ds_read_b64_tr_b16 a[30:31], v2 offset:43016
    ds_read_b64_tr_b16 a[32:33], v2 offset:33856
    v_mfma_f32_16x16x32_bf16 v[168:171], a[8:11], a[196:199], v[168:171]
    s_add_u32 m0, s72, 105600
    ds_read_b64_tr_b16 a[34:35], v2 offset:34112
    v_accvgpr_write_b32 a66, v130
    v_mfma_f32_16x16x32_bf16 v[168:171], a[4:7], a[188:191], v[168:171]
    s_add_u32 s52, s52, s53
    ds_read_b64_tr_b16 a[36:37], v2 offset:34368
    v_accvgpr_write_b32 a67, v131
    v_mfma_f32_16x16x32_bf16 v[168:171], a[0:3], a[180:183], v[168:171]
    s_waitcnt lgkmcnt(7)
    s_getreg_b32 s53, hwreg(HW_REG_IB_STS, 0, 4)
    ds_read_b64_tr_b16 a[38:39], v2 offset:34624
    v_mfma_f32_16x16x32_bf16 v[164:167], a[16:19], a[176:179], v[164:167]
    s_add_u32 s52, s52, s53
    buffer_load_dwordx4 v15, s[8:11], s78 offen lds
    v_mfma_f32_16x16x32_bf16 v[164:167], a[20:23], a[184:187], v[164:167]
    s_waitcnt lgkmcnt(6)
    ds_read_b64_tr_b16 a[40:41], v2 offset:42304
    ds_read_b64_tr_b16 a[42:43], v2 offset:42560
    v_mfma_f32_16x16x32_bf16 v[164:167], a[24:27], a[192:195], v[164:167]
    s_waitcnt lgkmcnt(6)
    ds_read_b64_tr_b16 a[44:45], v2 offset:42816
    v_accvgpr_write_b32 a68, v136
    v_mfma_f32_16x16x32_bf16 v[164:167], a[28:31], a[200:203], v[164:167]
    buffer_load_dwordx4 v16, s[8:11], s78 offen offset:1032 lds
    v_mfma_f32_16x16x32_bf16 v[172:175], a[28:31], a[204:207], v[172:175]
    ds_read_b64_tr_b16 a[46:47], v2 offset:43072
    ds_read_b64_tr_b16 a[48:49], v2 offset:33864
    v_mfma_f32_16x16x32_bf16 v[172:175], a[24:27], a[196:199], v[172:175]
    ds_read_b64_tr_b16 a[50:51], v2 offset:34120
    v_accvgpr_write_b32 a69, v137
    v_mfma_f32_16x16x32_bf16 v[172:175], a[20:23], a[188:191], v[172:175]
    ds_read_b64_tr_b16 a[52:53], v2 offset:34376
    v_mfma_f32_16x16x32_bf16 v[172:175], a[16:19], a[180:183], v[172:175]
    s_waitcnt lgkmcnt(7)
    buffer_load_dwordx4 v17, s[8:11], s78 offen offset:2112 lds
    v_mfma_f32_16x16x32_bf16 v[176:179], a[32:35], a[176:179], v[176:179]
    ds_read_b64_tr_b16 a[54:55], v2 offset:34632
    ds_read_b64_tr_b16 a[56:57], v2 offset:42312
    v_mfma_f32_16x16x32_bf16 v[176:179], a[36:39], a[184:187], v[176:179]
    s_waitcnt lgkmcnt(7)
    ds_read_b64_tr_b16 a[58:59], v2 offset:42568
    v_accvgpr_write_b32 a70, v138
    v_mfma_f32_16x16x32_bf16 v[176:179], a[40:43], a[192:195], v[176:179]
    s_waitcnt lgkmcnt(6)
    buffer_load_dwordx4 v18, s[8:11], s78 offen offset:3144 lds
    v_mfma_f32_16x16x32_bf16 v[176:179], a[44:47], a[200:203], v[176:179]
    s_waitcnt vmcnt(8)
    s_barrier
    ds_read_b64_tr_b16 a[60:61], v2 offset:42824
    v_mfma_f32_16x16x32_bf16 v[184:187], a[44:47], a[204:207], v[184:187]
    s_add_u32 s77, s74, 1048832
    buffer_store_dword v63, v60, s[28:31], s55 offen sc1
    v_mfma_f32_16x16x32_bf16 v[184:187], a[40:43], a[196:199], v[184:187]
    s_add_u32 m0, s72, 0
    ds_read_b64_tr_b16 a[62:63], v2 offset:43080
    ds_read_b64_tr_b16 a[0:1], v3 offset:0
    v_mfma_f32_16x16x32_bf16 v[184:187], a[36:39], a[188:191], v[184:187]
    ds_read_b64_tr_b16 a[2:3], v3 offset:256
    ds_read_b64_tr_b16 a[4:5], v3 offset:512
    v_accvgpr_write_b32 a71, v139
    v_accvgpr_write_b32 a72, v144
    v_mfma_f32_16x16x32_bf16 v[184:187], a[32:35], a[180:183], v[184:187]
    s_waitcnt lgkmcnt(8)
    ds_read_b64_tr_b16 a[6:7], v3 offset:768
    v_accvgpr_write_b32 a73, v145
    v_accvgpr_write_b32 a74, v146
    v_accvgpr_write_b32 a75, v147
    v_mfma_f32_16x16x32_bf16 v[180:183], a[48:51], a[176:179], v[180:183]
    s_waitcnt lgkmcnt(7)
    ds_read_b64_tr_b16 a[8:9], v3 offset:8448
    v_accvgpr_write_b32 a76, v152
    v_accvgpr_write_b32 a77, v153
    v_mfma_f32_16x16x32_bf16 v[180:183], a[52:55], a[184:187], v[180:183]
    s_waitcnt lgkmcnt(7)
    buffer_load_dwordx4 v15, s[8:11], s77 offen lds
    v_mfma_f32_16x16x32_bf16 v[180:183], a[56:59], a[192:195], v[180:183]
    s_waitcnt lgkmcnt(5)
    ds_read_b64_tr_b16 a[10:11], v3 offset:8704
    ds_read_b64_tr_b16 a[12:13], v3 offset:8960
    v_mfma_f32_16x16x32_bf16 v[180:183], a[60:63], a[200:203], v[180:183]
    buffer_load_dwordx4 v16, s[8:11], s77 offen offset:1032 lds
    v_accvgpr_write_b32 a78, v154
    v_mfma_f32_16x16x32_bf16 v[188:191], a[60:63], a[204:207], v[188:191]
    ds_read_b64_tr_b16 a[14:15], v3 offset:9216
    ds_read_b64_tr_b16 a[16:17], v3 offset:8
    v_mfma_f32_16x16x32_bf16 v[188:191], a[56:59], a[196:199], v[188:191]
    ds_read_b64_tr_b16 a[18:19], v3 offset:264
    v_accvgpr_write_b32 a79, v155
    v_mfma_f32_16x16x32_bf16 v[188:191], a[52:55], a[188:191], v[188:191]
    ds_read_b64_tr_b16 a[20:21], v3 offset:520
    v_mfma_f32_16x16x32_bf16 v[188:191], a[48:51], a[180:183], v[188:191]
    s_waitcnt lgkmcnt(7)
    s_getreg_b32 s53, hwreg(HW_REG_IB_STS, 0, 4)
    ds_read_b64_tr_b16 a[22:23], v3 offset:776
    v_mfma_f32_16x16x32_bf16 v[160:163], a[0:3], a[208:211], v[160:163]
    s_sub_u32 s52, s52, s53
    buffer_load_dwordx4 v17, s[8:11], s77 offen offset:2112 lds
    v_mfma_f32_16x16x32_bf16 v[160:163], a[4:7], a[216:219], v[160:163]
    s_waitcnt lgkmcnt(6)
    ds_read_b64_tr_b16 a[24:25], v3 offset:8456
    ds_read_b64_tr_b16 a[26:27], v3 offset:8712
    v_mfma_f32_16x16x32_bf16 v[160:163], a[8:11], a[224:227], v[160:163]
    s_waitcnt lgkmcnt(6)
    ds_read_b64_tr_b16 a[28:29], v3 offset:8968
    v_mfma_f32_16x16x32_bf16 v[160:163], a[12:15], a[232:235], v[160:163]
    s_getreg_b32 s53, hwreg(HW_REG_IB_STS, 0, 4)
    buffer_load_dwordx4 v18, s[8:11], s77 offen offset:3144 lds
    v_mfma_f32_16x16x32_bf16 v[168:171], a[12:15], a[236:239], v[168:171]
    s_add_u32 s78, s74, 1114368
    ds_read_b64_tr_b16 a[30:31], v3 offset:9224
    ds_read_b64_tr_b16 a[32:33], v3 offset:64
    v_mfma_f32_16x16x32_bf16 v[168:171], a[8:11], a[228:231], v[168:171]
    s_add_u32 m0, s72, 4224
    ds_read_b64_tr_b16 a[34:35], v3 offset:320
    v_mfma_f32_16x16x32_bf16 v[168:171], a[4:7], a[220:223], v[168:171]
    s_sub_u32 s52, s52, s53
    ds_read_b64_tr_b16 a[36:37], v3 offset:576
    v_mfma_f32_16x16x32_bf16 v[168:171], a[0:3], a[212:215], v[168:171]
L_hop0_2:
    s_cbranch_execz L_hop0_6
    s_waitcnt lgkmcnt(7)
    s_getreg_b32 s53, hwreg(HW_REG_IB_STS, 0, 4)
    ds_read_b64_tr_b16 a[38:39], v3 offset:832
    v_mfma_f32_16x16x32_bf16 v[164:167], a[16:19], a[208:211], v[164:167]
    s_sub_u32 s52, s52, s53
    buffer_load_dwordx4 v15, s[8:11], s78 offen lds
    v_mfma_f32_16x16x32_bf16 v[164:167], a[20:23], a[216:219], v[164:167]
    s_waitcnt lgkmcnt(6)
    ds_read_b64_tr_b16 a[40:41], v3 offset:8512
    ds_read_b64_tr_b16 a[42:43], v3 offset:8768
    v_mfma_f32_16x16x32_bf16 v[164:167], a[24:27], a[224:227], v[164:167]
    s_waitcnt lgkmcnt(6)
    ds_read_b64_tr_b16 a[44:45], v3 offset:9024
    v_mfma_f32_16x16x32_bf16 v[164:167], a[28:31], a[232:235], v[164:167]
    s_getreg_b32 s53, hwreg(HW_REG_IB_STS, 0, 4)
    buffer_load_dwordx4 v16, s[8:11], s78 offen offset:1032 lds
    v_mfma_f32_16x16x32_bf16 v[172:175], a[28:31], a[236:239], v[172:175]
    s_sub_u32 s52, s52, s53
    ds_read_b64_tr_b16 a[46:47], v3 offset:9280
    ds_read_b64_tr_b16 a[48:49], v3 offset:72
    v_mfma_f32_16x16x32_bf16 v[172:175], a[24:27], a[228:231], v[172:175]
    ds_read_b64_tr_b16 a[50:51], v3 offset:328
    v_mfma_f32_16x16x32_bf16 v[172:175], a[20:23], a[220:223], v[172:175]
    ds_read_b64_tr_b16 a[52:53], v3 offset:584
    v_mfma_f32_16x16x32_bf16 v[172:175], a[16:19], a[212:215], v[172:175]
    s_waitcnt lgkmcnt(7)
    s_getreg_b32 s53, hwreg(HW_REG_IB_STS, 0, 4)
    ds_read_b64_tr_b16 a[54:55], v3 offset:840
    v_mfma_f32_16x16x32_bf16 v[176:179], a[32:35], a[208:211], v[176:179]
    s_sub_u32 s52, s52, s53
    buffer_load_dwordx4 v17, s[8:11], s78 offen offset:2112 lds
    v_mfma_f32_16x16x32_bf16 v[176:179], a[36:39], a[216:219], v[176:179]
    s_waitcnt lgkmcnt(6)
    ds_read_b64_tr_b16 a[56:57], v3 offset:8520
    ds_read_b64_tr_b16 a[58:59], v3 offset:8776
    v_mfma_f32_16x16x32_bf16 v[176:179], a[40:43], a[224:227], v[176:179]
    s_waitcnt lgkmcnt(6)
    buffer_load_dwordx4 v18, s[8:11], s78 offen offset:3144 lds
    v_mfma_f32_16x16x32_bf16 v[176:179], a[44:47], a[232:235], v[176:179]
    s_waitcnt vmcnt(9)
    s_barrier
    s_getreg_b32 s53, hwreg(HW_REG_IB_STS, 0, 4)
    v_mfma_f32_16x16x32_bf16 v[184:187], a[44:47], a[236:239], v[184:187]
    s_add_u32 s77, s74, 2097408
    ds_read_b64_tr_b16 a[60:61], v3 offset:9032
    ds_read_b64_tr_b16 a[62:63], v3 offset:9288
    v_mfma_f32_16x16x32_bf16 v[184:187], a[40:43], a[228:231], v[184:187]
    s_add_u32 m0, s72, 33792
    ds_read_b64_tr_b16 a[0:1], v3 offset:33792
    ds_read_b64_tr_b16 a[2:3], v3 offset:34048
    v_mfma_f32_16x16x32_bf16 v[184:187], a[36:39], a[220:223], v[184:187]
    s_sub_u32 s52, s52, s53
    ds_read_b64_tr_b16 a[4:5], v3 offset:34304
    v_cvt_pk_bf16_f32 v160, v160, v161
    v_mfma_f32_16x16x32_bf16 v[184:187], a[32:35], a[212:215], v[184:187]
    s_waitcnt lgkmcnt(7)
    s_getreg_b32 s53, hwreg(HW_REG_IB_STS, 0, 4)
    ds_read_b64_tr_b16 a[6:7], v3 offset:34560
    v_mfma_f32_16x16x32_bf16 v[180:183], a[48:51], a[208:211], v[180:183]
    s_sub_u32 s52, s52, s53
    buffer_load_dwordx4 v15, s[8:11], s77 offen lds
    v_mfma_f32_16x16x32_bf16 v[180:183], a[52:55], a[216:219], v[180:183]
    s_waitcnt lgkmcnt(6)
    ds_read_b64_tr_b16 a[8:9], v3 offset:42240
    ds_read_b64_tr_b16 a[10:11], v3 offset:42496
    v_mfma_f32_16x16x32_bf16 v[180:183], a[56:59], a[224:227], v[180:183]
    s_waitcnt lgkmcnt(6)
    ds_read_b64_tr_b16 a[12:13], v3 offset:42752
    v_cvt_pk_bf16_f32 v161, v162, v163
    v_mfma_f32_16x16x32_bf16 v[180:183], a[60:63], a[232:235], v[180:183]
    s_getreg_b32 s53, hwreg(HW_REG_IB_STS, 0, 4)
    buffer_load_dwordx4 v16, s[8:11], s77 offen offset:1032 lds
    v_mfma_f32_16x16x32_bf16 v[188:191], a[60:63], a[236:239], v[188:191]
    s_sub_u32 s52, s52, s53
    ds_read_b64_tr_b16 a[14:15], v3 offset:43008
    ds_read_b64_tr_b16 a[16:17], v3 offset:33800
    v_mfma_f32_16x16x32_bf16 v[188:191], a[56:59], a[228:231], v[188:191]
    ds_read_b64_tr_b16 a[18:19], v3 offset:34056
    v_cvt_pk_bf16_f32 v162, v164, v165
    v_mfma_f32_16x16x32_bf16 v[188:191], a[52:55], a[220:223], v[188:191]
    ds_read_b64_tr_b16 a[20:21], v3 offset:34312
    v_cvt_pk_bf16_f32 v163, v166, v167
    v_mfma_f32_16x16x32_bf16 v[188:191], a[48:51], a[212:215], v[188:191]
    s_waitcnt lgkmcnt(7)
    s_getreg_b32 s53, hwreg(HW_REG_IB_STS, 0, 4)
    ds_read_b64_tr_b16 a[22:23], v3 offset:34568
    v_mfma_f32_16x16x32_bf16 v[192:195], a[0:3], a[128:131], 0
    s_sub_u32 s52, s52, s53
    buffer_load_dwordx4 v17, s[8:11], s77 offen offset:2112 lds
    v_mfma_f32_16x16x32_bf16 v[192:195], a[4:7], a[136:139], v[192:195]
    s_waitcnt lgkmcnt(6)
    ds_read_b64_tr_b16 a[24:25], v3 offset:42248
    ds_read_b64_tr_b16 a[26:27], v3 offset:42504
    v_mfma_f32_16x16x32_bf16 v[192:195], a[8:11], a[144:147], v[192:195]
    s_waitcnt lgkmcnt(6)
    ds_read_b64_tr_b16 a[28:29], v3 offset:42760
    v_cvt_pk_bf16_f32 v168, v168, v169
    v_mfma_f32_16x16x32_bf16 v[192:195], a[12:15], a[152:155], v[192:195]
    s_getreg_b32 s53, hwreg(HW_REG_IB_STS, 0, 4)
    buffer_load_dwordx4 v18, s[8:11], s77 offen offset:3144 lds
    v_mfma_f32_16x16x32_bf16 v[200:203], a[12:15], a[156:159], 0
    s_add_u32 s78, s74, 2162944
    ds_read_b64_tr_b16 a[30:31], v3 offset:43016
    ds_read_b64_tr_b16 a[32:33], v3 offset:33856
    v_mfma_f32_16x16x32_bf16 v[200:203], a[8:11], a[148:151], v[200:203]
    s_add_u32 m0, s72, 38016
    ds_read_b64_tr_b16 a[34:35], v3 offset:34112
    v_mfma_f32_16x16x32_bf16 v[200:203], a[4:7], a[140:143], v[200:203]
    s_sub_u32 s52, s52, s53
    ds_read_b64_tr_b16 a[36:37], v3 offset:34368
    v_cvt_pk_bf16_f32 v169, v170, v171
    v_mfma_f32_16x16x32_bf16 v[200:203], a[0:3], a[132:135], v[200:203]
    s_waitcnt lgkmcnt(7)
    s_getreg_b32 s53, hwreg(HW_REG_IB_STS, 0, 4)
    ds_read_b64_tr_b16 a[38:39], v3 offset:34624
    v_mfma_f32_16x16x32_bf16 v[196:199], a[16:19], a[128:131], 0
    s_sub_u32 s52, s52, s53
    buffer_load_dwordx4 v15, s[8:11], s78 offen lds
    v_mfma_f32_16x16x32_bf16 v[196:199], a[20:23], a[136:139], v[196:199]
    s_waitcnt lgkmcnt(6)
    ds_read_b64_tr_b16 a[40:41], v3 offset:42304
    ds_read_b64_tr_b16 a[42:43], v3 offset:42560
    v_mfma_f32_16x16x32_bf16 v[196:199], a[24:27], a[144:147], v[196:199]
    s_waitcnt lgkmcnt(6)
    ds_read_b64_tr_b16 a[44:45], v3 offset:42816
    v_cvt_pk_bf16_f32 v170, v172, v173
    v_mfma_f32_16x16x32_bf16 v[196:199], a[28:31], a[152:155], v[196:199]
    buffer_load_dwordx4 v16, s[8:11], s78 offen offset:1032 lds
    v_mfma_f32_16x16x32_bf16 v[204:207], a[28:31], a[156:159], 0
    ds_read_b64_tr_b16 a[46:47], v3 offset:43072
    ds_read_b64_tr_b16 a[48:49], v3 offset:33864
    v_mfma_f32_16x16x32_bf16 v[204:207], a[24:27], a[148:151], v[204:207]
    ds_read_b64_tr_b16 a[50:51], v3 offset:34120
    v_mfma_f32_16x16x32_bf16 v[204:207], a[20:23], a[140:143], v[204:207]
    ds_read_b64_tr_b16 a[52:53], v3 offset:34376
    v_cvt_pk_bf16_f32 v171, v174, v175
    v_cvt_pk_bf16_f32 v176, v176, v177
    v_cvt_pk_bf16_f32 v177, v178, v179
    v_mfma_f32_16x16x32_bf16 v[204:207], a[16:19], a[132:135], v[204:207]
    s_waitcnt lgkmcnt(7)
    buffer_load_dwordx4 v17, s[8:11], s78 offen offset:2112 lds
    v_cvt_pk_bf16_f32 v178, v180, v181
    v_mfma_f32_16x16x32_bf16 v[208:211], a[32:35], a[128:131], 0
    ds_read_b64_tr_b16 a[54:55], v3 offset:34632
    ds_read_b64_tr_b16 a[56:57], v3 offset:42312
    v_mfma_f32_16x16x32_bf16 v[208:211], a[36:39], a[136:139], v[208:211]
    s_waitcnt lgkmcnt(7)
    ds_read_b64_tr_b16 a[58:59], v3 offset:42568
    v_cvt_pk_bf16_f32 v179, v182, v183
    v_mfma_f32_16x16x32_bf16 v[208:211], a[40:43], a[144:147], v[208:211]
    s_waitcnt lgkmcnt(6)
    buffer_load_dwordx4 v18, s[8:11], s78 offen offset:3144 lds
    v_mfma_f32_16x16x32_bf16 v[208:211], a[44:47], a[152:155], v[208:211]
    s_waitcnt vmcnt(8)
    s_barrier
    ds_read_b64_tr_b16 a[60:61], v3 offset:42824
    v_mfma_f32_16x16x32_bf16 v[216:219], a[44:47], a[156:159], 0
    s_add_u32 s77, s92, 3145984
    buffer_store_dword v63, v60, s[28:31], s55 offen sc1
    v_mfma_f32_16x16x32_bf16 v[216:219], a[40:43], a[148:151], v[216:219]
    s_add_u32 m0, s72, 67584
    ds_read_b64_tr_b16 a[62:63], v3 offset:43080
    ds_read_b64_tr_b16 a[0:1], v2 offset:0
    v_mfma_f32_16x16x32_bf16 v[216:219], a[36:39], a[140:143], v[216:219]
    ds_read_b64_tr_b16 a[2:3], v2 offset:256
    ds_read_b64_tr_b16 a[4:5], v2 offset:512
    v_cvt_pk_bf16_f32 v184, v184, v185
    v_mfma_f32_16x16x32_bf16 v[216:219], a[32:35], a[132:135], v[216:219]
    s_waitcnt lgkmcnt(8)
    buffer_load_dwordx4 v15, s[8:11], s77 offen lds
    v_mfma_f32_16x16x32_bf16 v[212:215], a[48:51], a[128:131], 0
    s_waitcnt lgkmcnt(6)
    ds_read_b64_tr_b16 a[6:7], v2 offset:768
    ds_read_b64_tr_b16 a[8:9], v2 offset:8448
    v_mfma_f32_16x16x32_bf16 v[212:215], a[52:55], a[136:139], v[212:215]
    s_waitcnt lgkmcnt(7)
    ds_read_b64_tr_b16 a[10:11], v2 offset:8704
    v_cvt_pk_bf16_f32 v185, v186, v187
    v_mfma_f32_16x16x32_bf16 v[212:215], a[56:59], a[144:147], v[212:215]
    s_waitcnt lgkmcnt(6)
    ds_read_b64_tr_b16 a[12:13], v2 offset:8960
    v_cvt_pk_bf16_f32 v186, v188, v189
    v_mfma_f32_16x16x32_bf16 v[212:215], a[60:63], a[152:155], v[212:215]
    buffer_load_dwordx4 v16, s[8:11], s77 offen offset:1032 lds
    v_mfma_f32_16x16x32_bf16 v[220:223], a[60:63], a[156:159], 0
    ds_read_b64_tr_b16 a[14:15], v2 offset:9216
    ds_read_b64_tr_b16 a[16:17], v2 offset:8
    v_mfma_f32_16x16x32_bf16 v[220:223], a[56:59], a[148:151], v[220:223]
    ds_read_b64_tr_b16 a[18:19], v2 offset:264
    v_mfma_f32_16x16x32_bf16 v[220:223], a[52:55], a[140:143], v[220:223]
    ds_read_b64_tr_b16 a[20:21], v2 offset:520
    v_cvt_pk_bf16_f32 v187, v190, v191
    v_mfma_f32_16x16x32_bf16 v[220:223], a[48:51], a[132:135], v[220:223]
    s_waitcnt lgkmcnt(8)
    s_getreg_b32 s53, hwreg(HW_REG_IB_STS, 0, 4)
    ds_read_b64_tr_b16 a[22:23], v2 offset:776
    v_mfma_f32_16x16x32_bf16 v[192:195], a[0:3], a[160:163], v[192:195]
    s_waitcnt lgkmcnt(7)
    buffer_load_dwordx4 v17, s[8:11], s77 offen offset:2112 lds
    v_mfma_f32_16x16x32_bf16 v[192:195], a[4:7], a[168:171], v[192:195]
    s_waitcnt lgkmcnt(6)
    ds_read_b64_tr_b16 a[24:25], v2 offset:8456
    ds_read_b64_tr_b16 a[26:27], v2 offset:8712
    v_mfma_f32_16x16x32_bf16 v[192:195], a[8:11], a[176:179], v[192:195]
    s_waitcnt lgkmcnt(6)
    s_sub_u32 s52, s52, s53
    ds_read_b64_tr_b16 a[28:29], v2 offset:8968
    v_mfma_f32_16x16x32_bf16 v[192:195], a[12:15], a[184:187], v[192:195]
    s_getreg_b32 s53, hwreg(HW_REG_IB_STS, 0, 4)
    buffer_load_dwordx4 v18, s[8:11], s77 offen offset:3144 lds
    v_mfma_f32_16x16x32_bf16 v[200:203], a[12:15], a[188:191], v[200:203]
    s_add_u32 s78, s92, 3211520
    ds_read_b64_tr_b16 a[30:31], v2 offset:9224
    ds_read_b64_tr_b16 a[32:33], v2 offset:64
    v_mfma_f32_16x16x32_bf16 v[200:203], a[8:11], a[180:183], v[200:203]
    s_add_u32 m0, s72, 71808
    ds_read_b64_tr_b16 a[34:35], v2 offset:320
    v_accvgpr_write_b32 a80, v160
    v_mfma_f32_16x16x32_bf16 v[200:203], a[4:7], a[172:175], v[200:203]
    s_sub_u32 s52, s52, s53
    ds_read_b64_tr_b16 a[36:37], v2 offset:576
    v_mfma_f32_16x16x32_bf16 v[200:203], a[0:3], a[164:167], v[200:203]
    s_waitcnt lgkmcnt(7)
    s_getreg_b32 s53, hwreg(HW_REG_IB_STS, 0, 4)
    ds_read_b64_tr_b16 a[38:39], v2 offset:832
    v_mfma_f32_16x16x32_bf16 v[196:199], a[16:19], a[160:163], v[196:199]
    s_sub_u32 s52, s52, s53
    buffer_load_dwordx4 v15, s[8:11], s78 offen lds
    v_mfma_f32_16x16x32_bf16 v[196:199], a[20:23], a[168:171], v[196:199]
    s_waitcnt lgkmcnt(6)
    ds_read_b64_tr_b16 a[40:41], v2 offset:8512
    ds_read_b64_tr_b16 a[42:43], v2 offset:8768
    v_mfma_f32_16x16x32_bf16 v[196:199], a[24:27], a[176:179], v[196:199]
    s_waitcnt lgkmcnt(6)
    ds_read_b64_tr_b16 a[44:45], v2 offset:9024
    v_accvgpr_write_b32 a81, v161
    v_mfma_f32_16x16x32_bf16 v[196:199], a[28:31], a[184:187], v[196:199]
    s_getreg_b32 s53, hwreg(HW_REG_IB_STS, 0, 4)
    buffer_load_dwordx4 v16, s[8:11], s78 offen offset:1032 lds
    v_mfma_f32_16x16x32_bf16 v[204:207], a[28:31], a[188:191], v[204:207]
    s_sub_u32 s52, s52, s53
    ds_read_b64_tr_b16 a[46:47], v2 offset:9280
    ds_read_b64_tr_b16 a[48:49], v2 offset:72
    v_mfma_f32_16x16x32_bf16 v[204:207], a[24:27], a[180:183], v[204:207]
    ds_read_b64_tr_b16 a[50:51], v2 offset:328
    v_accvgpr_write_b32 a82, v162
    v_mfma_f32_16x16x32_bf16 v[204:207], a[20:23], a[172:175], v[204:207]
    ds_read_b64_tr_b16 a[52:53], v2 offset:584
    v_accvgpr_write_b32 a83, v163
    v_mfma_f32_16x16x32_bf16 v[204:207], a[16:19], a[164:167], v[204:207]
    s_waitcnt lgkmcnt(7)
    s_getreg_b32 s53, hwreg(HW_REG_IB_STS, 0, 4)
    ds_read_b64_tr_b16 a[54:55], v2 offset:840
    v_mfma_f32_16x16x32_bf16 v[208:211], a[32:35], a[160:163], v[208:211]
    s_sub_u32 s52, s52, s53
    buffer_load_dwordx4 v17, s[8:11], s78 offen offset:2112 lds
    v_mfma_f32_16x16x32_bf16 v[208:211], a[36:39], a[168:171], v[208:211]
    s_waitcnt lgkmcnt(6)
    ds_read_b64_tr_b16 a[56:57], v2 offset:8520
    ds_read_b64_tr_b16 a[58:59], v2 offset:8776
    v_mfma_f32_16x16x32_bf16 v[208:211], a[40:43], a[176:179], v[208:211]
    s_waitcnt lgkmcnt(6)
    buffer_load_dwordx4 v18, s[8:11], s78 offen offset:3144 lds
    v_mfma_f32_16x16x32_bf16 v[208:211], a[44:47], a[184:187], v[208:211]
    s_waitcnt vmcnt(9)
    s_barrier
    s_getreg_b32 s53, hwreg(HW_REG_IB_STS, 0, 4)
    v_mfma_f32_16x16x32_bf16 v[216:219], a[44:47], a[188:191], v[216:219]
    s_add_u32 s77, s74, 524672
    ds_read_b64_tr_b16 a[60:61], v2 offset:9032
    ds_read_b64_tr_b16 a[62:63], v2 offset:9288
    v_mfma_f32_16x16x32_bf16 v[216:219], a[40:43], a[180:183], v[216:219]
    s_add_u32 m0, s72, 101376
    ds_read_b64_tr_b16 a[0:1], v2 offset:33792
    ds_read_b64_tr_b16 a[2:3], v2 offset:34048
    v_accvgpr_write_b32 a84, v168
    v_mfma_f32_16x16x32_bf16 v[216:219], a[36:39], a[172:175], v[216:219]
    s_sub_u32 s52, s52, s53
    ds_read_b64_tr_b16 a[4:5], v2 offset:34304
    v_accvgpr_write_b32 a85, v169
    v_mfma_f32_16x16x32_bf16 v[216:219], a[32:35], a[164:167], v[216:219]
    s_waitcnt lgkmcnt(7)
    s_getreg_b32 s53, hwreg(HW_REG_IB_STS, 0, 4)
    ds_read_b64_tr_b16 a[6:7], v2 offset:34560
    v_mfma_f32_16x16x32_bf16 v[212:215], a[48:51], a[160:163], v[212:215]
    s_sub_u32 s52, s52, s53
    buffer_load_dwordx4 v15, s[8:11], s77 offen lds
    v_mfma_f32_16x16x32_bf16 v[212:215], a[52:55], a[168:171], v[212:215]
    s_waitcnt lgkmcnt(6)
    ds_read_b64_tr_b16 a[8:9], v2 offset:42240
    ds_read_b64_tr_b16 a[10:11], v2 offset:42496
    v_mfma_f32_16x16x32_bf16 v[212:215], a[56:59], a[176:179], v[212:215]
    s_waitcnt lgkmcnt(6)
    ds_read_b64_tr_b16 a[12:13], v2 offset:42752
    v_accvgpr_write_b32 a86, v170
    v_mfma_f32_16x16x32_bf16 v[212:215], a[60:63], a[184:187], v[212:215]
    s_getreg_b32 s53, hwreg(HW_REG_IB_STS, 0, 4)
    buffer_load_dwordx4 v16, s[8:11], s77 offen offset:1032 lds
    v_mfma_f32_16x16x32_bf16 v[220:223], a[60:63], a[188:191], v[220:223]
    s_sub_u32 s52, s52, s53
    ds_read_b64_tr_b16 a[14:15], v2 offset:43008
    ds_read_b64_tr_b16 a[16:17], v2 offset:33800
    v_mfma_f32_16x16x32_bf16 v[220:223], a[56:59], a[180:183], v[220:223]
    ds_read_b64_tr_b16 a[18:19], v2 offset:34056
    v_accvgpr_write_b32 a87, v171
    v_accvgpr_write_b32 a88, v176
    v_accvgpr_write_b32 a89, v177
    v_mfma_f32_16x16x32_bf16 v[220:223], a[52:55], a[172:175], v[220:223]
    ds_read_b64_tr_b16 a[20:21], v2 offset:34312
    v_accvgpr_write_b32 a90, v178
    v_mfma_f32_16x16x32_bf16 v[220:223], a[48:51], a[164:167], v[220:223]
    s_waitcnt lgkmcnt(7)
    s_getreg_b32 s53, hwreg(HW_REG_IB_STS, 0, 4)
    ds_read_b64_tr_b16 a[22:23], v2 offset:34568
    v_mfma_f32_16x16x32_bf16 v[192:195], a[0:3], a[192:195], v[192:195]
    s_sub_u32 s52, s52, s53
    buffer_load_dwordx4 v17, s[8:11], s77 offen offset:2112 lds
    v_mfma_f32_16x16x32_bf16 v[192:195], a[4:7], a[200:203], v[192:195]
    s_waitcnt lgkmcnt(6)
    ds_read_b64_tr_b16 a[24:25], v2 offset:42248
    ds_read_b64_tr_b16 a[26:27], v2 offset:42504
    v_mfma_f32_16x16x32_bf16 v[192:195], a[8:11], a[208:211], v[192:195]
    s_waitcnt lgkmcnt(6)
    ds_read_b64_tr_b16 a[28:29], v2 offset:42760
    v_accvgpr_write_b32 a91, v179
    v_mfma_f32_16x16x32_bf16 v[192:195], a[12:15], a[216:219], v[192:195]
    s_getreg_b32 s53, hwreg(HW_REG_IB_STS, 0, 4)
    buffer_load_dwordx4 v18, s[8:11], s77 offen offset:3144 lds
    v_mfma_f32_16x16x32_bf16 v[200:203], a[12:15], a[220:223], v[200:203]
    s_add_u32 s78, s74, 590208
    ds_read_b64_tr_b16 a[30:31], v2 offset:43016
    ds_read_b64_tr_b16 a[32:33], v2 offset:33856
    v_mfma_f32_16x16x32_bf16 v[200:203], a[8:11], a[212:215], v[200:203]
    s_add_u32 m0, s72, 105600
    ds_read_b64_tr_b16 a[34:35], v2 offset:34112
    v_accvgpr_write_b32 a92, v184
    v_mfma_f32_16x16x32_bf16 v[200:203], a[4:7], a[204:207], v[200:203]
    s_sub_u32 s52, s52, s53
    ds_read_b64_tr_b16 a[36:37], v2 offset:34368
    v_accvgpr_write_b32 a93, v185
    v_mfma_f32_16x16x32_bf16 v[200:203], a[0:3], a[196:199], v[200:203]
    s_waitcnt lgkmcnt(7)
    s_getreg_b32 s53, hwreg(HW_REG_IB_STS, 0, 4)
    ds_read_b64_tr_b16 a[38:39], v2 offset:34624
    v_mfma_f32_16x16x32_bf16 v[196:199], a[16:19], a[192:195], v[196:199]
    s_sub_u32 s52, s52, s53
    buffer_load_dwordx4 v15, s[8:11], s78 offen lds
    v_mfma_f32_16x16x32_bf16 v[196:199], a[20:23], a[200:203], v[196:199]
    s_waitcnt lgkmcnt(6)
    ds_read_b64_tr_b16 a[40:41], v2 offset:42304
    ds_read_b64_tr_b16 a[42:43], v2 offset:42560
    v_mfma_f32_16x16x32_bf16 v[196:199], a[24:27], a[208:211], v[196:199]
    s_waitcnt lgkmcnt(6)
    ds_read_b64_tr_b16 a[44:45], v2 offset:42816
    v_accvgpr_write_b32 a94, v186
    v_mfma_f32_16x16x32_bf16 v[196:199], a[28:31], a[216:219], v[196:199]
    buffer_load_dwordx4 v16, s[8:11], s78 offen offset:1032 lds
    v_mfma_f32_16x16x32_bf16 v[204:207], a[28:31], a[220:223], v[204:207]
    ds_read_b64_tr_b16 a[46:47], v2 offset:43072
    ds_read_b64_tr_b16 a[48:49], v2 offset:33864
    v_mfma_f32_16x16x32_bf16 v[204:207], a[24:27], a[212:215], v[204:207]
    ds_read_b64_tr_b16 a[50:51], v2 offset:34120
    v_accvgpr_write_b32 a95, v187
    v_mfma_f32_16x16x32_bf16 v[204:207], a[20:23], a[204:207], v[204:207]
    ds_read_b64_tr_b16 a[52:53], v2 offset:34376
    v_mfma_f32_16x16x32_bf16 v[204:207], a[16:19], a[196:199], v[204:207]
    s_waitcnt lgkmcnt(7)
    buffer_load_dwordx4 v17, s[8:11], s78 offen offset:2112 lds
    v_mfma_f32_16x16x32_bf16 v[208:211], a[32:35], a[192:195], v[208:211]
    ds_read_b64_tr_b16 a[54:55], v2 offset:34632
    ds_read_b64_tr_b16 a[56:57], v2 offset:42312
    v_mfma_f32_16x16x32_bf16 v[208:211], a[36:39], a[200:203], v[208:211]
    s_waitcnt lgkmcnt(7)
    ds_read_b64_tr_b16 a[58:59], v2 offset:42568
    v_mfma_f32_16x16x32_bf16 v[208:211], a[40:43], a[208:211], v[208:211]
    s_waitcnt lgkmcnt(6)
    buffer_load_dwordx4 v18, s[8:11], s78 offen offset:3144 lds
    v_mfma_f32_16x16x32_bf16 v[208:211], a[44:47], a[216:219], v[208:211]
    s_waitcnt vmcnt(8)
    s_barrier
    ds_read_b64_tr_b16 a[60:61], v2 offset:42824
    v_mfma_f32_16x16x32_bf16 v[216:219], a[44:47], a[220:223], v[216:219]
    s_add_u32 s77, s74, 1573248
    buffer_store_dword v63, v60, s[28:31], s54 offen sc1
    v_mfma_f32_16x16x32_bf16 v[216:219], a[40:43], a[212:215], v[216:219]
    s_add_u32 m0, s72, 0
    ds_read_b64_tr_b16 a[62:63], v2 offset:43080
    ds_read_b64_tr_b16 a[0:1], v3 offset:0
    v_mfma_f32_16x16x32_bf16 v[216:219], a[36:39], a[204:207], v[216:219]
    ds_read_b64_tr_b16 a[2:3], v3 offset:256
    ds_read_b64_tr_b16 a[4:5], v3 offset:512
    v_mfma_f32_16x16x32_bf16 v[216:219], a[32:35], a[196:199], v[216:219]
    s_waitcnt lgkmcnt(8)
    buffer_load_dwordx4 v15, s[8:11], s77 offen lds
    v_mfma_f32_16x16x32_bf16 v[212:215], a[48:51], a[192:195], v[212:215]
    s_waitcnt lgkmcnt(6)
    ds_read_b64_tr_b16 a[6:7], v3 offset:768
    ds_read_b64_tr_b16 a[8:9], v3 offset:8
    v_mfma_f32_16x16x32_bf16 v[212:215], a[52:55], a[200:203], v[212:215]
    s_waitcnt lgkmcnt(7)
    ds_read_b64_tr_b16 a[10:11], v3 offset:264
    v_mfma_f32_16x16x32_bf16 v[212:215], a[56:59], a[208:211], v[212:215]
    s_waitcnt lgkmcnt(6)
    ds_read_b64_tr_b16 a[12:13], v3 offset:520
    v_mfma_f32_16x16x32_bf16 v[212:215], a[60:63], a[216:219], v[212:215]
    buffer_load_dwordx4 v16, s[8:11], s77 offen offset:1032 lds
    v_mfma_f32_16x16x32_bf16 v[220:223], a[60:63], a[220:223], v[220:223]
    ds_read_b64_tr_b16 a[14:15], v3 offset:776
    ds_read_b64_tr_b16 a[16:17], v3 offset:64
    v_mfma_f32_16x16x32_bf16 v[220:223], a[56:59], a[212:215], v[220:223]
    ds_read_b64_tr_b16 a[18:19], v3 offset:320
    v_mfma_f32_16x16x32_bf16 v[220:223], a[52:55], a[204:207], v[220:223]
    ds_read_b64_tr_b16 a[20:21], v3 offset:576
    v_mfma_f32_16x16x32_bf16 v[220:223], a[48:51], a[196:199], v[220:223]
    s_waitcnt lgkmcnt(8)
    s_getreg_b32 s53, hwreg(HW_REG_IB_STS, 0, 4)
    ds_read_b64_tr_b16 a[22:23], v3 offset:832
    v_mfma_f32_16x16x32_bf16 v[192:195], a[0:3], a[224:227], v[192:195]
    s_waitcnt lgkmcnt(7)
    buffer_load_dwordx4 v17, s[8:11], s77 offen offset:2112 lds
    v_mfma_f32_16x16x32_bf16 v[192:195], a[4:7], a[232:235], v[192:195]
    s_add_u32 s52, s52, s53
    ds_read_b64_tr_b16 a[24:25], v3 offset:72
    ds_read_b64_tr_b16 a[26:27], v3 offset:328
    v_mfma_f32_16x16x32_bf16 v[200:203], a[4:7], a[236:239], v[200:203]
    ds_read_b64_tr_b16 a[28:29], v3 offset:584
    v_mfma_f32_16x16x32_bf16 v[200:203], a[0:3], a[228:231], v[200:203]
    s_waitcnt lgkmcnt(8)
    s_getreg_b32 s53, hwreg(HW_REG_IB_STS, 0, 4)
    ds_read_b64_tr_b16 a[30:31], v3 offset:840
    v_mfma_f32_16x16x32_bf16 v[196:199], a[8:11], a[224:227], v[196:199]
    s_waitcnt lgkmcnt(7)
    buffer_load_dwordx4 v18, s[8:11], s77 offen offset:3144 lds
    v_mfma_f32_16x16x32_bf16 v[196:199], a[12:15], a[232:235], v[196:199]
    s_add_u32 s78, s74, 1638784
    ds_read_b64_tr_b16 a[32:33], v3 offset:8448
    ds_read_b64_tr_b16 a[34:35], v3 offset:8704
    v_mfma_f32_16x16x32_bf16 v[204:207], a[12:15], a[236:239], v[204:207]
    s_add_u32 m0, s72, 4224
    s_add_u32 s52, s52, s53
    ds_read_b64_tr_b16 a[36:37], v3 offset:8960
    v_mfma_f32_16x16x32_bf16 v[204:207], a[8:11], a[228:231], v[204:207]
    s_waitcnt lgkmcnt(7)
    s_getreg_b32 s53, hwreg(HW_REG_IB_STS, 0, 4)
    ds_read_b64_tr_b16 a[38:39], v3 offset:9216
    v_mfma_f32_16x16x32_bf16 v[208:211], a[16:19], a[224:227], v[208:211]
    s_add_u32 s52, s52, s53
    buffer_load_dwordx4 v15, s[8:11], s78 offen lds
    v_mfma_f32_16x16x32_bf16 v[208:211], a[20:23], a[232:235], v[208:211]
    ds_read_b64_tr_b16 a[40:41], v3 offset:8456
    ds_read_b64_tr_b16 a[42:43], v3 offset:8712
    v_mfma_f32_16x16x32_bf16 v[216:219], a[20:23], a[236:239], v[216:219]
    ds_read_b64_tr_b16 a[44:45], v3 offset:8968
    v_cvt_pk_bf16_f32 v192, v192, v193
    v_mfma_f32_16x16x32_bf16 v[216:219], a[16:19], a[228:231], v[216:219]
    s_waitcnt lgkmcnt(7)
    s_getreg_b32 s53, hwreg(HW_REG_IB_STS, 0, 4)
    ds_read_b64_tr_b16 a[46:47], v3 offset:9224
    v_mfma_f32_16x16x32_bf16 v[212:215], a[24:27], a[224:227], v[212:215]
    s_add_u32 s52, s52, s53
    buffer_load_dwordx4 v16, s[8:11], s78 offen offset:1032 lds
    v_mfma_f32_16x16x32_bf16 v[212:215], a[28:31], a[232:235], v[212:215]
    ds_read_b64_tr_b16 a[48:49], v3 offset:8512
    ds_read_b64_tr_b16 a[50:51], v3 offset:8768
    v_mfma_f32_16x16x32_bf16 v[220:223], a[28:31], a[236:239], v[220:223]
    ds_read_b64_tr_b16 a[52:53], v3 offset:9024
    v_cvt_pk_bf16_f32 v193, v194, v195
    v_mfma_f32_16x16x32_bf16 v[220:223], a[24:27], a[228:231], v[220:223]
    s_waitcnt lgkmcnt(7)
    s_getreg_b32 s53, hwreg(HW_REG_IB_STS, 0, 4)
    ds_read_b64_tr_b16 a[54:55], v3 offset:9280
    v_mfma_f32_16x16x32_bf16 v[224:227], a[32:35], a[128:131], 0
    s_add_u32 s52, s52, s53
    buffer_load_dwordx4 v17, s[8:11], s78 offen offset:2112 lds
    v_mfma_f32_16x16x32_bf16 v[224:227], a[36:39], a[136:139], v[224:227]
    ds_read_b64_tr_b16 a[56:57], v3 offset:8520
    ds_read_b64_tr_b16 a[58:59], v3 offset:8776
    v_mfma_f32_16x16x32_bf16 v[232:235], a[36:39], a[140:143], 0
    buffer_load_dwordx4 v18, s[8:11], s78 offen offset:3144 lds
    v_mfma_f32_16x16x32_bf16 v[232:235], a[32:35], a[132:135], v[232:235]
    s_waitcnt vmcnt(9)
    s_barrier
    s_waitcnt lgkmcnt(6)
    s_getreg_b32 s53, hwreg(HW_REG_IB_STS, 0, 4)
    v_mfma_f32_16x16x32_bf16 v[228:231], a[40:43], a[128:131], 0
    s_add_u32 s77, s74, 2621824
    ds_read_b64_tr_b16 a[60:61], v3 offset:9032
    ds_read_b64_tr_b16 a[62:63], v3 offset:9288
    v_mfma_f32_16x16x32_bf16 v[228:231], a[44:47], a[136:139], v[228:231]
    s_add_u32 m0, s72, 33792
    ds_read_b64_tr_b16 a[0:1], v3 offset:33792
    ds_read_b64_tr_b16 a[2:3], v3 offset:34048
    v_mfma_f32_16x16x32_bf16 v[236:239], a[44:47], a[140:143], 0
    s_add_u32 s52, s52, s53
    ds_read_b64_tr_b16 a[4:5], v3 offset:34304
    v_cvt_pk_bf16_f32 v194, v196, v197
    v_mfma_f32_16x16x32_bf16 v[236:239], a[40:43], a[132:135], v[236:239]
    s_waitcnt lgkmcnt(7)
    s_getreg_b32 s53, hwreg(HW_REG_IB_STS, 0, 4)
    ds_read_b64_tr_b16 a[6:7], v3 offset:34560
    v_mfma_f32_16x16x32_bf16 v[240:243], a[48:51], a[128:131], 0
    s_add_u32 s52, s52, s53
    buffer_load_dwordx4 v15, s[8:11], s77 offen lds
    v_mfma_f32_16x16x32_bf16 v[240:243], a[52:55], a[136:139], v[240:243]
    ds_read_b64_tr_b16 a[8:9], v3 offset:42240
    ds_read_b64_tr_b16 a[10:11], v3 offset:42496
    v_mfma_f32_16x16x32_bf16 v[248:251], a[52:55], a[140:143], 0
    ds_read_b64_tr_b16 a[12:13], v3 offset:42752
    v_cvt_pk_bf16_f32 v195, v198, v199
    v_mfma_f32_16x16x32_bf16 v[248:251], a[48:51], a[132:135], v[248:251]
    s_waitcnt lgkmcnt(9)
    s_getreg_b32 s53, hwreg(HW_REG_IB_STS, 0, 4)
    ds_read_b64_tr_b16 a[14:15], v3 offset:43008
    v_mfma_f32_16x16x32_bf16 v[244:247], a[56:59], a[128:131], 0
    s_waitcnt lgkmcnt(8)
    buffer_load_dwordx4 v16, s[8:11], s77 offen offset:1032 lds
    v_mfma_f32_16x16x32_bf16 v[244:247], a[60:63], a[136:139], v[244:247]
    s_add_u32 s52, s52, s53
    ds_read_b64_tr_b16 a[16:17], v3 offset:33800
    ds_read_b64_tr_b16 a[18:19], v3 offset:34056
    v_mfma_f32_16x16x32_bf16 v[252:255], a[60:63], a[140:143], 0
    ds_read_b64_tr_b16 a[20:21], v3 offset:34312
    v_cvt_pk_bf16_f32 v200, v200, v201
    v_mfma_f32_16x16x32_bf16 v[252:255], a[56:59], a[132:135], v[252:255]
    s_waitcnt lgkmcnt(7)
    s_getreg_b32 s53, hwreg(HW_REG_IB_STS, 0, 4)
    ds_read_b64_tr_b16 a[22:23], v3 offset:34568
    v_mfma_f32_16x16x32_bf16 v[224:227], a[0:3], a[144:147], v[224:227]
    s_add_u32 s52, s52, s53
    buffer_load_dwordx4 v17, s[8:11], s77 offen offset:2112 lds
    v_mfma_f32_16x16x32_bf16 v[224:227], a[4:7], a[152:155], v[224:227]
    s_waitcnt lgkmcnt(6)
    ds_read_b64_tr_b16 a[24:25], v3 offset:42248
    ds_read_b64_tr_b16 a[26:27], v3 offset:42504
    v_mfma_f32_16x16x32_bf16 v[224:227], a[8:11], a[160:163], v[224:227]
    s_waitcnt lgkmcnt(6)
    ds_read_b64_tr_b16 a[28:29], v3 offset:42760
    v_cvt_pk_bf16_f32 v201, v202, v203
    v_mfma_f32_16x16x32_bf16 v[224:227], a[12:15], a[168:171], v[224:227]
    s_getreg_b32 s53, hwreg(HW_REG_IB_STS, 0, 4)
    buffer_load_dwordx4 v18, s[8:11], s77 offen offset:3144 lds
    v_mfma_f32_16x16x32_bf16 v[232:235], a[12:15], a[172:175], v[232:235]
    s_add_u32 s78, s74, 2687360
    ds_read_b64_tr_b16 a[30:31], v3 offset:43016
    ds_read_b64_tr_b16 a[32:33], v3 offset:33856
    v_mfma_f32_16x16x32_bf16 v[232:235], a[8:11], a[164:167], v[232:235]
    s_add_u32 m0, s72, 38016
    ds_read_b64_tr_b16 a[34:35], v3 offset:34112
    v_cvt_pk_bf16_f32 v202, v204, v205
    v_mfma_f32_16x16x32_bf16 v[232:235], a[4:7], a[156:159], v[232:235]
    s_add_u32 s52, s52, s53
    ds_read_b64_tr_b16 a[36:37], v3 offset:34368
    v_cvt_pk_bf16_f32 v203, v206, v207
    v_cvt_pk_bf16_f32 v208, v208, v209
    v_cvt_pk_bf16_f32 v209, v210, v211
    v_mfma_f32_16x16x32_bf16 v[232:235], a[0:3], a[148:151], v[232:235]
    s_waitcnt lgkmcnt(7)
    s_getreg_b32 s53, hwreg(HW_REG_IB_STS, 0, 4)
    v_cvt_pk_bf16_f32 v210, v212, v213
    v_cvt_pk_bf16_f32 v211, v214, v215
    v_cvt_pk_bf16_f32 v216, v216, v217
    v_mfma_f32_16x16x32_bf16 v[228:231], a[16:19], a[144:147], v[228:231]
    s_add_u32 s52, s52, s53
    buffer_load_dwordx4 v15, s[8:11], s78 offen lds
    v_mfma_f32_16x16x32_bf16 v[228:231], a[20:23], a[152:155], v[228:231]
    s_waitcnt lgkmcnt(5)
    ds_read_b64_tr_b16 a[38:39], v3 offset:34624
    ds_read_b64_tr_b16 a[40:41], v3 offset:42304
    v_mfma_f32_16x16x32_bf16 v[228:231], a[24:27], a[160:163], v[228:231]
    s_waitcnt lgkmcnt(5)
    ds_read_b64_tr_b16 a[42:43], v3 offset:42560
    ds_read_b64_tr_b16 a[44:45], v3 offset:42816
    v_cvt_pk_bf16_f32 v217, v218, v219
    v_mfma_f32_16x16x32_bf16 v[228:231], a[28:31], a[168:171], v[228:231]
    s_lshl_b32 s53, s88, 2
    buffer_load_dwordx4 v16, s[8:11], s78 offen offset:1032 lds
    v_mfma_f32_16x16x32_bf16 v[236:239], a[28:31], a[172:175], v[236:239]
    s_add_u32 s53, s53, 163584
    ds_read_b64_tr_b16 a[46:47], v3 offset:43072
    ds_read_b64_tr_b16 a[48:49], v3 offset:33864
    v_mfma_f32_16x16x32_bf16 v[236:239], a[24:27], a[164:167], v[236:239]
L_hop0_3:
    s_cbranch_execz L_hop0_7
    ds_read_b64_tr_b16 a[50:51], v3 offset:34120
    v_cvt_pk_bf16_f32 v218, v220, v221
    v_mfma_f32_16x16x32_bf16 v[236:239], a[20:23], a[156:159], v[236:239]
    ds_read_b64_tr_b16 a[52:53], v3 offset:34376
    v_mov_b32 v36, s53
    v_mfma_f32_16x16x32_bf16 v[236:239], a[16:19], a[148:151], v[236:239]
    s_waitcnt lgkmcnt(8)
    buffer_load_dwordx4 v17, s[8:11], s78 offen offset:2112 lds
    v_mov_b32 v37, s52
    v_mfma_f32_16x16x32_bf16 v[240:243], a[32:35], a[144:147], v[240:243]
    s_waitcnt lgkmcnt(7)
    ds_write_b32 v36, v37
    v_mfma_f32_16x16x32_bf16 v[240:243], a[36:39], a[152:155], v[240:243]
    s_waitcnt lgkmcnt(6)
    ds_read_b64_tr_b16 a[54:55], v3 offset:34632
    v_mov_b32 v38, 163584
    v_mfma_f32_16x16x32_bf16 v[240:243], a[40:43], a[160:163], v[240:243]
    s_waitcnt lgkmcnt(5)
    buffer_load_dwordx4 v18, s[8:11], s78 offen offset:3144 lds
    v_cvt_pk_bf16_f32 v219, v222, v223
    v_mfma_f32_16x16x32_bf16 v[240:243], a[44:47], a[168:171], v[240:243]
    s_waitcnt vmcnt(8)
    s_barrier
    ds_read_b64_tr_b16 a[56:57], v3 offset:42312
    v_mfma_f32_16x16x32_bf16 v[248:251], a[44:47], a[172:175], v[248:251]
    s_add_u32 s77, s75, 0
    ds_read_b64_tr_b16 a[58:59], v3 offset:42568
    ds_read_b64_tr_b16 a[60:61], v3 offset:42824
    v_mfma_f32_16x16x32_bf16 v[248:251], a[40:43], a[164:167], v[248:251]
    s_add_u32 m0, s73, 67584
    ds_read_b64_tr_b16 a[62:63], v3 offset:43080
    ds_read_b64_tr_b16 a[0:1], v2 offset:0
    v_mfma_f32_16x16x32_bf16 v[248:251], a[36:39], a[156:159], v[248:251]
    ds_read_b64_tr_b16 a[2:3], v2 offset:256
    ds_read_b64_tr_b16 a[4:5], v2 offset:512
    v_mfma_f32_16x16x32_bf16 v[248:251], a[32:35], a[148:151], v[248:251]
    s_waitcnt lgkmcnt(9)
    buffer_load_dwordx4 v19, s[12:15], s77 offen lds
    v_mfma_f32_16x16x32_bf16 v[244:247], a[48:51], a[144:147], v[244:247]
    s_waitcnt lgkmcnt(7)
    ds_read_b64_tr_b16 a[6:7], v2 offset:768
    ds_read_b64_tr_b16 a[8:9], v2 offset:8448
    v_mfma_f32_16x16x32_bf16 v[244:247], a[52:55], a[152:155], v[244:247]
    s_waitcnt lgkmcnt(7)
    ds_read_b64_tr_b16 a[10:11], v2 offset:8704
    v_mfma_f32_16x16x32_bf16 v[244:247], a[56:59], a[160:163], v[244:247]
    s_waitcnt lgkmcnt(6)
    ds_read_b64_tr_b16 a[12:13], v2 offset:8960
    v_mfma_f32_16x16x32_bf16 v[244:247], a[60:63], a[168:171], v[244:247]
    buffer_load_dwordx4 v20, s[12:15], s77 offen offset:1056 lds
    v_mfma_f32_16x16x32_bf16 v[252:255], a[60:63], a[172:175], v[252:255]
    ds_read_b64_tr_b16 a[14:15], v2 offset:9216
    ds_read_b64_tr_b16 a[16:17], v2 offset:8
    v_mfma_f32_16x16x32_bf16 v[252:255], a[56:59], a[164:167], v[252:255]
    ds_read_b64_tr_b16 a[18:19], v2 offset:264
    v_accvgpr_write_b32 a96, v192
    v_mfma_f32_16x16x32_bf16 v[252:255], a[52:55], a[156:159], v[252:255]
    ds_read_b64_tr_b16 a[20:21], v2 offset:520
    v_mfma_f32_16x16x32_bf16 v[252:255], a[48:51], a[148:151], v[252:255]
    s_waitcnt lgkmcnt(8)
    buffer_load_dwordx4 v21, s[12:15], s77 offen offset:2112 lds
    v_mfma_f32_16x16x32_bf16 v[224:227], a[0:3], a[176:179], v[224:227]
    s_waitcnt lgkmcnt(6)
    ds_read_b64_tr_b16 a[22:23], v2 offset:776
    ds_read_b64_tr_b16 a[24:25], v2 offset:8456
    v_mfma_f32_16x16x32_bf16 v[224:227], a[4:7], a[184:187], v[224:227]
    s_waitcnt lgkmcnt(7)
    ds_read_b64_tr_b16 a[26:27], v2 offset:8712
    v_accvgpr_write_b32 a97, v193
    v_mfma_f32_16x16x32_bf16 v[224:227], a[8:11], a[192:195], v[224:227]
    s_waitcnt lgkmcnt(6)
    ds_read_b64_tr_b16 a[28:29], v2 offset:8968
    v_mfma_f32_16x16x32_bf16 v[224:227], a[12:15], a[200:203], v[224:227]
    buffer_load_dwordx4 v22, s[12:15], s77 offen offset:3168 lds
    v_mfma_f32_16x16x32_bf16 v[232:235], a[12:15], a[204:207], v[232:235]
    s_add_u32 s78, s75, 16384
    ds_read_b64_tr_b16 a[30:31], v2 offset:9224
    ds_read_b64_tr_b16 a[32:33], v2 offset:64
    v_mfma_f32_16x16x32_bf16 v[232:235], a[8:11], a[196:199], v[232:235]
    s_add_u32 m0, s73, 84480
    ds_read_b64_tr_b16 a[34:35], v2 offset:320
    v_accvgpr_write_b32 a98, v194
    v_mfma_f32_16x16x32_bf16 v[232:235], a[4:7], a[188:191], v[232:235]
    ds_read_b64_tr_b16 a[36:37], v2 offset:576
    v_accvgpr_write_b32 a99, v195
    v_mfma_f32_16x16x32_bf16 v[232:235], a[0:3], a[180:183], v[232:235]
    s_waitcnt lgkmcnt(8)
    buffer_load_dwordx4 v19, s[12:15], s78 offen lds
    v_mfma_f32_16x16x32_bf16 v[228:231], a[16:19], a[176:179], v[228:231]
    s_waitcnt lgkmcnt(6)
    ds_read_b64_tr_b16 a[38:39], v2 offset:832
    ds_read_b64_tr_b16 a[40:41], v2 offset:8512
    v_mfma_f32_16x16x32_bf16 v[228:231], a[20:23], a[184:187], v[228:231]
    s_waitcnt lgkmcnt(7)
    ds_read_b64_tr_b16 a[42:43], v2 offset:8768
    v_accvgpr_write_b32 a100, v200
    v_mfma_f32_16x16x32_bf16 v[228:231], a[24:27], a[192:195], v[228:231]
    s_waitcnt lgkmcnt(6)
    ds_read_b64_tr_b16 a[44:45], v2 offset:9024
    v_mfma_f32_16x16x32_bf16 v[228:231], a[28:31], a[200:203], v[228:231]
    buffer_load_dwordx4 v20, s[12:15], s78 offen offset:1056 lds
    v_mfma_f32_16x16x32_bf16 v[236:239], a[28:31], a[204:207], v[236:239]
    ds_read_b64_tr_b16 a[46:47], v2 offset:9280
    ds_read_b64_tr_b16 a[48:49], v2 offset:72
    v_mfma_f32_16x16x32_bf16 v[236:239], a[24:27], a[196:199], v[236:239]
    ds_read_b64_tr_b16 a[50:51], v2 offset:328
    v_accvgpr_write_b32 a101, v201
    v_mfma_f32_16x16x32_bf16 v[236:239], a[20:23], a[188:191], v[236:239]
    ds_read_b64_tr_b16 a[52:53], v2 offset:584
    v_mfma_f32_16x16x32_bf16 v[236:239], a[16:19], a[180:183], v[236:239]
    s_waitcnt lgkmcnt(8)
    buffer_load_dwordx4 v21, s[12:15], s78 offen offset:2112 lds
    v_mfma_f32_16x16x32_bf16 v[240:243], a[32:35], a[176:179], v[240:243]
    s_waitcnt lgkmcnt(6)
    ds_read_b64_tr_b16 a[54:55], v2 offset:840
    ds_read_b64_tr_b16 a[56:57], v2 offset:8520
    v_mfma_f32_16x16x32_bf16 v[240:243], a[36:39], a[184:187], v[240:243]
    s_waitcnt lgkmcnt(7)
    ds_read_b64_tr_b16 a[58:59], v2 offset:8776
    v_accvgpr_write_b32 a102, v202
    v_mfma_f32_16x16x32_bf16 v[240:243], a[40:43], a[192:195], v[240:243]
    s_waitcnt lgkmcnt(6)
    buffer_load_dwordx4 v22, s[12:15], s78 offen offset:3168 lds
    v_mfma_f32_16x16x32_bf16 v[240:243], a[44:47], a[200:203], v[240:243]
    s_waitcnt vmcnt(8)
    s_barrier
    ds_read_b64_tr_b16 a[60:61], v2 offset:9032
    v_mfma_f32_16x16x32_bf16 v[248:251], a[44:47], a[204:207], v[248:251]
    s_add_u32 s77, s75, 32768
    ds_read_b64_tr_b16 a[62:63], v2 offset:9288
    ds_read_b64_tr_b16 a[0:1], v2 offset:33792
    v_mfma_f32_16x16x32_bf16 v[248:251], a[40:43], a[196:199], v[248:251]
    s_add_u32 m0, s73, 101376
    ds_read_b64_tr_b16 a[2:3], v2 offset:34048
    ds_read_b128 v[32:35], v38
    v_mfma_f32_16x16x32_bf16 v[248:251], a[36:39], a[188:191], v[248:251]
    ds_read_b64_tr_b16 a[4:5], v2 offset:34304
    v_accvgpr_write_b32 a103, v203
    v_accvgpr_write_b32 a104, v208
    v_accvgpr_write_b32 a105, v209
    v_mfma_f32_16x16x32_bf16 v[248:251], a[32:35], a[180:183], v[248:251]
    s_waitcnt lgkmcnt(9)
    ds_read_b64_tr_b16 a[6:7], v2 offset:34560
    v_accvgpr_write_b32 a106, v210
    v_accvgpr_write_b32 a107, v211
    v_accvgpr_write_b32 a108, v216
    v_mfma_f32_16x16x32_bf16 v[244:247], a[48:51], a[176:179], v[244:247]
    s_waitcnt lgkmcnt(8)
    buffer_load_dwordx4 v19, s[12:15], s77 offen lds
    v_accvgpr_write_b32 a109, v217
    v_mfma_f32_16x16x32_bf16 v[244:247], a[52:55], a[184:187], v[244:247]
    s_waitcnt lgkmcnt(7)
    ds_read_b64_tr_b16 a[8:9], v2 offset:42240
    ds_read_b64_tr_b16 a[10:11], v2 offset:42496
    v_mfma_f32_16x16x32_bf16 v[244:247], a[56:59], a[192:195], v[244:247]
    s_waitcnt lgkmcnt(7)
    ds_read_b64_tr_b16 a[12:13], v2 offset:42752
    v_accvgpr_write_b32 a110, v218
    v_mfma_f32_16x16x32_bf16 v[244:247], a[60:63], a[200:203], v[244:247]
    buffer_load_dwordx4 v20, s[12:15], s77 offen offset:1056 lds
    v_mfma_f32_16x16x32_bf16 v[252:255], a[60:63], a[204:207], v[252:255]
    ds_read_b64_tr_b16 a[14:15], v2 offset:43008
    ds_read_b64_tr_b16 a[16:17], v2 offset:33800
    v_mfma_f32_16x16x32_bf16 v[252:255], a[56:59], a[196:199], v[252:255]
    ds_read_b64_tr_b16 a[18:19], v2 offset:34056
    v_accvgpr_write_b32 a111, v219
    v_mfma_f32_16x16x32_bf16 v[252:255], a[52:55], a[188:191], v[252:255]
    ds_read_b64_tr_b16 a[20:21], v2 offset:34312
    v_mfma_f32_16x16x32_bf16 v[252:255], a[48:51], a[180:183], v[252:255]
    s_waitcnt lgkmcnt(7)
    buffer_load_dwordx4 v21, s[12:15], s77 offen offset:2112 lds
    v_mfma_f32_16x16x32_bf16 v[224:227], a[0:3], a[208:211], v[224:227]
    ds_read_b64_tr_b16 a[22:23], v2 offset:34568
    ds_read_b64_tr_b16 a[24:25], v2 offset:42248
    v_mfma_f32_16x16x32_bf16 v[224:227], a[4:7], a[216:219], v[224:227]
    s_waitcnt lgkmcnt(7)
    ds_read_b64_tr_b16 a[26:27], v2 offset:42504
    v_add3_u32 v41, v32, v33, v34
    v_mfma_f32_16x16x32_bf16 v[224:227], a[8:11], a[224:227], v[224:227]
    s_waitcnt lgkmcnt(6)
    buffer_load_dwordx4 v22, s[12:15], s77 offen offset:3168 lds
    v_mfma_f32_16x16x32_bf16 v[224:227], a[12:15], a[232:235], v[224:227]
    s_add_u32 s78, s75, 0
    ds_read_b64_tr_b16 a[28:29], v2 offset:42760
    ds_read_b64_tr_b16 a[30:31], v2 offset:43016
    v_add_u32 v41, v41, v35
    v_mov_b32 v42, 0x2000
    v_mfma_f32_16x16x32_bf16 v[232:235], a[12:15], a[236:239], v[232:235]
    s_add_u32 m0, s73, 118272
    ds_read_b64_tr_b16 a[32:33], v2 offset:33856
    v_cmp_lt_i32 vcc, 0, v41
    v_mov_b32 v43, 0
    s_nop 0
    v_cndmask_b32 v40, v43, v42, vcc
    v_mfma_f32_16x16x32_bf16 v[232:235], a[8:11], a[228:231], v[232:235]
    ds_read_b64_tr_b16 a[34:35], v2 offset:34112
    v_mov_b32 v42, s94
    v_mov_b32 v43, s95
    v_mfma_f32_16x16x32_bf16 v[232:235], a[4:7], a[220:223], v[232:235]
    buffer_store_dwordx4 v[40:43], v51, s[28:31], s67 offen sc1
    v_mfma_f32_16x16x32_bf16 v[232:235], a[0:3], a[212:215], v[232:235]
    s_waitcnt lgkmcnt(7)
    buffer_load_dwordx4 v19, s[16:19], s78 offen lds
    v_mfma_f32_16x16x32_bf16 v[228:231], a[16:19], a[208:211], v[228:231]
    s_waitcnt lgkmcnt(5)
    ds_read_b64_tr_b16 a[36:37], v2 offset:34368
    ds_read_b64_tr_b16 a[38:39], v2 offset:34624
    v_mfma_f32_16x16x32_bf16 v[228:231], a[20:23], a[216:219], v[228:231]
    s_waitcnt lgkmcnt(6)
    ds_read_b64_tr_b16 a[40:41], v2 offset:42304
    ds_read_b64_tr_b16 a[42:43], v2 offset:42560
    v_mfma_f32_16x16x32_bf16 v[228:231], a[24:27], a[224:227], v[228:231]
    s_waitcnt lgkmcnt(6)
    buffer_load_dwordx4 v20, s[16:19], s78 offen offset:1056 lds
    v_mfma_f32_16x16x32_bf16 v[228:231], a[28:31], a[232:235], v[228:231]
    ds_read_b64_tr_b16 a[44:45], v2 offset:42816
    ds_read_b64_tr_b16 a[46:47], v2 offset:43072
    v_mfma_f32_16x16x32_bf16 v[236:239], a[28:31], a[236:239], v[236:239]
    ds_read_b64_tr_b16 a[48:49], v2 offset:33864
    v_mfma_f32_16x16x32_bf16 v[236:239], a[24:27], a[228:231], v[236:239]
    buffer_load_dwordx4 v21, s[16:19], s78 offen offset:2112 lds
    v_mfma_f32_16x16x32_bf16 v[236:239], a[20:23], a[220:223], v[236:239]
    ds_read_b64_tr_b16 a[50:51], v2 offset:34120
    ds_read_b64_tr_b16 a[52:53], v2 offset:34376
    v_mfma_f32_16x16x32_bf16 v[236:239], a[16:19], a[212:215], v[236:239]
    s_waitcnt lgkmcnt(9)
    ds_read_b64_tr_b16 a[54:55], v2 offset:34632
    v_mfma_f32_16x16x32_bf16 v[240:243], a[32:35], a[208:211], v[240:243]
    s_waitcnt lgkmcnt(8)
    buffer_load_dwordx4 v22, s[16:19], s78 offen offset:3168 lds
    v_mfma_f32_16x16x32_bf16 v[240:243], a[36:39], a[216:219], v[240:243]
    s_waitcnt lgkmcnt(6)
    ds_read_b64_tr_b16 a[56:57], v2 offset:42312
    ds_read_b64_tr_b16 a[58:59], v2 offset:42568
    v_mfma_f32_16x16x32_bf16 v[240:243], a[40:43], a[224:227], v[240:243]
    s_waitcnt lgkmcnt(6)
    s_add_u32 s65, s100, 65536
    buffer_load_dword v59, v31, s[12:15], s65 offen
    v_mfma_f32_16x16x32_bf16 v[240:243], a[44:47], a[232:235], v[240:243]
    s_waitcnt vmcnt(10)
    s_barrier
    ds_read_b64_tr_b16 a[60:61], v2 offset:42824
    v_mfma_f32_16x16x32_bf16 v[248:251], a[44:47], a[236:239], v[248:251]
    s_add_u32 s77, s75, 49152
    ds_read_b64_tr_b16 a[62:63], v2 offset:43080
    ds_read_b128 a[0:3], v5 offset:0
    v_mfma_f32_16x16x32_bf16 v[248:251], a[40:43], a[228:231], v[248:251]
    s_add_u32 m0, s73, 0
    ds_read_b128 a[4:7], v5 offset:64
    v_cvt_pk_bf16_f32 v224, v224, v225
    v_mfma_f32_16x16x32_bf16 v[248:251], a[36:39], a[220:223], v[248:251]
    ds_read_b128 a[8:11], v5 offset:128
    v_cvt_pk_bf16_f32 v225, v226, v227
    v_cvt_pk_bf16_f32 v226, v228, v229
    v_cvt_pk_bf16_f32 v227, v230, v231
    v_mfma_f32_16x16x32_bf16 v[248:251], a[32:35], a[212:215], v[248:251]
    s_waitcnt lgkmcnt(7)
    ds_read_b128 a[12:15], v5 offset:192
    v_cvt_pk_bf16_f32 v232, v232, v233
    v_cvt_pk_bf16_f32 v233, v234, v235
    v_cvt_pk_bf16_f32 v234, v236, v237
    v_mfma_f32_16x16x32_bf16 v[244:247], a[48:51], a[208:211], v[244:247]
    v_cvt_pk_bf16_f32 v235, v238, v239
    v_mfma_f32_16x16x32_bf16 v[244:247], a[52:55], a[216:219], v[244:247]
    s_waitcnt lgkmcnt(6)
    buffer_load_dwordx4 v19, s[12:15], s77 offen lds
    v_mfma_f32_16x16x32_bf16 v[244:247], a[56:59], a[224:227], v[244:247]
    s_waitcnt lgkmcnt(4)
    ds_read_b128 a[16:19], v5 offset:256
    v_mfma_f32_16x16x32_bf16 v[244:247], a[60:63], a[232:235], v[244:247]
    v_mfma_f32_16x16x32_bf16 v[252:255], a[60:63], a[236:239], v[252:255]
    ds_read_b128 a[20:23], v5 offset:320
    v_mfma_f32_16x16x32_bf16 v[252:255], a[56:59], a[228:231], v[252:255]
    ds_read_b128 a[24:27], v5 offset:384
    v_mfma_f32_16x16x32_bf16 v[252:255], a[52:55], a[220:223], v[252:255]
    v_mfma_f32_16x16x32_bf16 v[252:255], a[48:51], a[212:215], v[252:255]
    s_waitcnt lgkmcnt(3)
    ds_read_b128 a[28:31], v5 offset:448
    v_mfma_f32_16x16x32_bf16 v[64:67], a[0:3], v[128:131], 0
    buffer_load_dwordx4 v20, s[12:15], s77 offen offset:1056 lds
    v_mfma_f32_16x16x32_bf16 v[64:67], a[4:7], v[144:147], v[64:67]
    ds_read_b128 a[32:35], v5 offset:512
    v_mfma_f32_16x16x32_bf16 v[64:67], a[8:11], v[160:163], v[64:67]
    ds_read_b128 a[36:39], v5 offset:576
    v_cvt_pk_bf16_f32 v240, v240, v241
    v_mfma_f32_16x16x32_bf16 v[64:67], a[12:15], v[176:179], v[64:67]
    v_cvt_pk_bf16_f32 v241, v242, v243
    v_cvt_pk_bf16_f32 v242, v244, v245
    v_mfma_f32_16x16x32_bf16 v[72:75], a[12:15], v[184:187], 0
    ds_read_b128 a[40:43], v5 offset:640
    v_cvt_pk_bf16_f32 v243, v246, v247
    v_mfma_f32_16x16x32_bf16 v[72:75], a[8:11], v[168:171], v[72:75]
    ds_read_b128 a[44:47], v5 offset:704
    v_cvt_pk_bf16_f32 v248, v248, v249
    v_mfma_f32_16x16x32_bf16 v[72:75], a[4:7], v[152:155], v[72:75]
    v_cvt_pk_bf16_f32 v249, v250, v251
    v_cvt_pk_bf16_f32 v250, v252, v253
    v_cvt_pk_bf16_f32 v251, v254, v255
    v_mfma_f32_16x16x32_bf16 v[72:75], a[0:3], v[136:139], v[72:75]
    s_waitcnt lgkmcnt(4)
    buffer_load_dwordx4 v21, s[12:15], s77 offen offset:2112 lds
    v_mfma_f32_16x16x32_bf16 v[72:75], a[16:19], v[200:203], v[72:75]
    ds_read_b128 a[48:51], v5 offset:768
    v_mfma_f32_16x16x32_bf16 v[72:75], a[20:23], v[216:219], v[72:75]
    ds_read_b128 a[52:55], v5 offset:832
    v_accvgpr_write_b32 a112, v224
    v_mfma_f32_16x16x32_bf16 v[72:75], a[24:27], v[232:235], v[72:75]
    v_mfma_f32_16x16x32_bf16 v[72:75], a[28:31], v[248:251], v[72:75]
    v_mfma_f32_16x16x32_bf16 v[64:67], a[28:31], v[240:243], v[64:67]
    ds_read_b128 a[56:59], v5 offset:896
    v_accvgpr_write_b32 a113, v225
    v_mfma_f32_16x16x32_bf16 v[64:67], a[24:27], v[224:227], v[64:67]
    v_mfma_f32_16x16x32_bf16 v[64:67], a[20:23], v[208:211], v[64:67]
    ds_read_b128 a[60:63], v5 offset:960
    v_mfma_f32_16x16x32_bf16 v[64:67], a[16:19], v[192:195], v[64:67]
    s_waitcnt lgkmcnt(4)
    buffer_load_dwordx4 v22, s[12:15], s77 offen offset:3168 lds
    v_mfma_f32_16x16x32_bf16 v[68:71], a[32:35], v[128:131], 0
    ds_read_b128 a[0:3], v5 offset:16896
    v_accvgpr_write_b32 a114, v226
    v_mfma_f32_16x16x32_bf16 v[68:71], a[36:39], v[144:147], v[68:71]
    ds_read_b128 a[4:7], v5 offset:16960
    v_mfma_f32_16x16x32_bf16 v[68:71], a[40:43], v[160:163], v[68:71]
    s_add_u32 s78, s75, 16384
    ds_read_b128 a[8:11], v5 offset:17024
    v_accvgpr_write_b32 a115, v227
    v_mfma_f32_16x16x32_bf16 v[68:71], a[44:47], v[176:179], v[68:71]
    s_add_u32 m0, s73, 16896
    v_max3_f32 v48, v64, v65, v66
    v_max_f32 v48, v48, v67
    v_mfma_f32_16x16x32_bf16 v[76:79], a[44:47], v[184:187], 0
    ds_read_b128 a[12:15], v5 offset:17088
    v_max3_f32 v49, v72, v73, v74
    v_mfma_f32_16x16x32_bf16 v[76:79], a[40:43], v[168:171], v[76:79]
    v_max_f32 v49, v49, v75
    v_mov_b32 v50, v48
    v_mfma_f32_16x16x32_bf16 v[76:79], a[36:39], v[152:155], v[76:79]
    buffer_load_dwordx4 v19, s[16:19], s78 offen lds
    v_mfma_f32_16x16x32_bf16 v[76:79], a[32:35], v[136:139], v[76:79]
    s_waitcnt lgkmcnt(4)
    ds_read_b128 a[16:19], v5 offset:17152
    v_mov_b32 v51, v49
    v_mfma_f32_16x16x32_bf16 v[76:79], a[48:51], v[200:203], v[76:79]
    ds_read_b128 a[20:23], v5 offset:17216
    v_accvgpr_write_b32 a116, v232
    v_mfma_f32_16x16x32_bf16 v[76:79], a[52:55], v[216:219], v[76:79]
    ds_read_b128 a[24:27], v5 offset:17280
    v_permlane16_swap_b32 v48, v50
    v_permlane16_swap_b32 v49, v51
    v_mfma_f32_16x16x32_bf16 v[76:79], a[56:59], v[232:235], v[76:79]
    v_max_f32 v48, v48, v50
    v_max_f32 v49, v49, v51
    v_mfma_f32_16x16x32_bf16 v[76:79], a[60:63], v[248:251], v[76:79]
    ds_read_b128 a[28:31], v5 offset:17344
    v_mov_b32 v50, v48
    v_mov_b32 v51, v49
    v_mfma_f32_16x16x32_bf16 v[68:71], a[60:63], v[240:243], v[68:71]
    v_accvgpr_write_b32 a117, v233
    v_permlane32_swap_b32 v48, v50
    v_permlane32_swap_b32 v49, v51
    v_mfma_f32_16x16x32_bf16 v[68:71], a[56:59], v[224:227], v[68:71]
    ds_read_b128 a[32:35], v5 offset:17408
    v_max_f32 v48, v48, v50
    v_max_f32 v49, v49, v51
    v_mfma_f32_16x16x32_bf16 v[68:71], a[52:55], v[208:211], v[68:71]
    v_sub_f32 v112, 0xc2400000, v48
    v_sub_f32 v113, 0xc2400000, v48
    v_sub_f32 v114, 0xc2400000, v48
    v_sub_f32 v115, 0xc2400000, v48
    v_sub_f32 v116, 0xc2400000, v49
    v_sub_f32 v117, 0xc2400000, v49
    v_sub_f32 v118, 0xc2400000, v49
    v_sub_f32 v119, 0xc2400000, v49
    v_mfma_f32_16x16x32_bf16 v[68:71], a[48:51], v[192:195], v[68:71]
    s_waitcnt lgkmcnt(4)
    buffer_load_dwordx4 v20, s[16:19], s78 offen offset:1056 lds
    v_accvgpr_write_b32 a118, v234
    v_mfma_f32_16x16x32_bf16 v[80:83], a[0:3], v[128:131], v[112:115]
    ds_read_b128 a[36:39], v5 offset:17472
    v_accvgpr_write_b32 a119, v235
    v_accvgpr_write_b32 a120, v240
    v_accvgpr_write_b32 a121, v241
    v_mfma_f32_16x16x32_bf16 v[80:83], a[4:7], v[144:147], v[80:83]
    ds_read_b128 a[40:43], v5 offset:17536
    v_accvgpr_write_b32 a122, v242
    v_accvgpr_write_b32 a123, v243
    v_accvgpr_write_b32 a124, v248
    v_mfma_f32_16x16x32_bf16 v[80:83], a[8:11], v[160:163], v[80:83]
    ds_read_b128 a[44:47], v5 offset:17600
    v_accvgpr_write_b32 a125, v249
    v_accvgpr_write_b32 a126, v250
    v_add_f32 v64, v112, v64
    v_mfma_f32_16x16x32_bf16 v[80:83], a[12:15], v[176:179], v[80:83]
    v_add_f32 v65, v112, v65
    v_accvgpr_write_b32 a127, v251
    v_add_f32 v66, v112, v66
    v_add_f32 v67, v112, v67
    v_mfma_f32_16x16x32_bf16 v[88:91], a[12:15], v[184:187], v[116:119]
    v_exp_f32 v64, v64
    v_mfma_f32_16x16x32_bf16 v[88:91], a[8:11], v[168:171], v[88:91]
    v_exp_f32 v65, v65
    v_mfma_f32_16x16x32_bf16 v[88:91], a[4:7], v[152:155], v[88:91]
    v_exp_f32 v66, v66
    v_mfma_f32_16x16x32_bf16 v[88:91], a[0:3], v[136:139], v[88:91]
    v_exp_f32 v67, v67
    v_mfma_f32_16x16x32_bf16 v[88:91], a[16:19], v[200:203], v[88:91]
    s_waitcnt lgkmcnt(2)
    ds_read_b128 a[48:51], v5 offset:17664
    ds_read_b128 a[52:55], v5 offset:17728
    v_cvt_pk_bf16_f32 v96, v64, v65
    v_mfma_f32_16x16x32_bf16 v[88:91], a[20:23], v[216:219], v[88:91]
    buffer_load_dwordx4 v21, s[16:19], s78 offen offset:2112 lds
    v_cvt_pk_bf16_f32 v97, v66, v67
    v_mfma_f32_16x16x32_bf16 v[88:91], a[24:27], v[232:235], v[88:91]
    ds_read_b128 a[56:59], v5 offset:17792
    v_add_f32 v72, v116, v72
    v_add_f32 v73, v116, v73
    v_mfma_f32_16x16x32_bf16 v[88:91], a[28:31], v[248:251], v[88:91]
    ds_read_b128 a[60:63], v5 offset:17856
    v_add_f32 v74, v116, v74
    v_add_f32 v75, v116, v75
    v_mfma_f32_16x16x32_bf16 v[80:83], a[28:31], v[240:243], v[80:83]
    v_exp_f32 v72, v72
    v_mfma_f32_16x16x32_bf16 v[80:83], a[24:27], v[224:227], v[80:83]
    v_exp_f32 v73, v73
    v_mfma_f32_16x16x32_bf16 v[80:83], a[20:23], v[208:211], v[80:83]
    v_exp_f32 v74, v74
    v_mfma_f32_16x16x32_bf16 v[80:83], a[16:19], v[192:195], v[80:83]
    v_exp_f32 v75, v75
    v_mfma_f32_16x16x32_bf16 v[84:87], a[32:35], v[128:131], v[112:115]
    buffer_load_dwordx4 v22, s[16:19], s78 offen offset:3168 lds
    v_cvt_pk_bf16_f32 v100, v72, v73
    v_mfma_f32_16x16x32_bf16 v[84:87], a[36:39], v[144:147], v[84:87]
    s_waitcnt lgkmcnt(2)
    v_cvt_pk_bf16_f32 v101, v74, v75
    v_add_f32 v68, v112, v68
    v_mfma_f32_16x16x32_bf16 v[84:87], a[40:43], v[160:163], v[84:87]
    s_add_u32 s65, s100, 65536
    buffer_load_dword v59, v31, s[16:19], s65 offen
    s_add_u32 s65, s97, 0
    buffer_load_dword v59, v61, s[20:23], s65 offen
    v_add_f32 v69, v112, v69
    v_mfma_f32_16x16x32_bf16 v[84:87], a[44:47], v[176:179], v[84:87]
    s_waitcnt vmcnt(11) lgkmcnt(0)
    s_barrier
    v_add_f32 v70, v112, v70
    v_add_f32 v71, v112, v71
    v_mfma_f32_16x16x32_bf16 v[92:95], a[44:47], v[184:187], v[116:119]
    s_add_u32 s77, s75, 65536
    v_exp_f32 v68, v68
    v_mfma_f32_16x16x32_bf16 v[92:95], a[40:43], v[168:171], v[92:95]
    s_add_u32 m0, s73, 67584
    v_exp_f32 v69, v69
    v_mfma_f32_16x16x32_bf16 v[92:95], a[36:39], v[152:155], v[92:95]
    v_exp_f32 v70, v70
    v_mfma_f32_16x16x32_bf16 v[92:95], a[32:35], v[136:139], v[92:95]
    ds_read_b128 a[0:3], v5 offset:33792
    ds_read_b128 a[4:7], v5 offset:33856
    v_exp_f32 v71, v71
    v_mfma_f32_16x16x32_bf16 v[92:95], a[48:51], v[200:203], v[92:95]
    ds_read_b128 a[8:11], v5 offset:33920
    ds_read_b128 a[12:15], v5 offset:33984
    v_cvt_pk_bf16_f32 v98, v68, v69
    v_mfma_f32_16x16x32_bf16 v[92:95], a[52:55], v[216:219], v[92:95]
    buffer_load_dwordx4 v19, s[12:15], s77 offen lds
    v_cvt_pk_bf16_f32 v99, v70, v71
    v_mfma_f32_16x16x32_bf16 v[92:95], a[56:59], v[232:235], v[92:95]
    ds_read_b128 a[16:19], v5 offset:34048
    ds_read_b128 a[20:23], v5 offset:34112
    v_add_f32 v76, v116, v76
    v_add_f32 v77, v116, v77
    v_mfma_f32_16x16x32_bf16 v[92:95], a[60:63], v[248:251], v[92:95]
    ds_read_b128 a[24:27], v5 offset:34176
    v_add_f32 v78, v116, v78
    v_add_f32 v79, v116, v79
    v_mfma_f32_16x16x32_bf16 v[84:87], a[60:63], v[240:243], v[84:87]
    v_exp_f32 v76, v76
    v_mfma_f32_16x16x32_bf16 v[84:87], a[56:59], v[224:227], v[84:87]
    v_exp_f32 v77, v77
    v_mfma_f32_16x16x32_bf16 v[84:87], a[52:55], v[208:211], v[84:87]
    v_exp_f32 v78, v78
    v_exp_f32 v79, v79
    v_cvt_pk_bf16_f32 v102, v76, v77
    v_cvt_pk_bf16_f32 v103, v78, v79
    v_mfma_f32_16x16x32_bf16 v[84:87], a[48:51], v[192:195], v[84:87]
    s_waitcnt lgkmcnt(5)
    ds_read_b128 a[28:31], v5 offset:34240
    ds_read_b64_tr_b16 a[32:33], v7 offset:50688
    v_mfma_f32_16x16x32_bf16 v[64:67], a[0:3], a[64:67], v[112:115]
    ds_read_b64_tr_b16 a[34:35], v7 offset:51200
    ds_read_b64_tr_b16 a[36:37], v7 offset:50720
    v_mfma_f32_16x16x32_bf16 v[64:67], a[4:7], a[72:75], v[64:67]
    s_waitcnt lgkmcnt(7)
    buffer_load_dwordx4 v20, s[12:15], s77 offen offset:1056 lds
    v_mfma_f32_16x16x32_bf16 v[64:67], a[8:11], a[80:83], v[64:67]
    ds_read_b64_tr_b16 a[38:39], v7 offset:51232
    v_mfma_f32_16x16x32_bf16 v[64:67], a[12:15], a[88:91], v[64:67]
    ds_read_b64_tr_b16 a[40:41], v7 offset:50752
    v_mfma_f32_16x16x32_bf16 v[72:75], a[12:15], a[92:95], v[116:119]
    ds_read_b64_tr_b16 a[42:43], v7 offset:51264
    v_mfma_f32_16x16x32_bf16 v[72:75], a[8:11], a[84:87], v[72:75]
    ds_read_b64_tr_b16 a[44:45], v7 offset:50784
    v_mfma_f32_16x16x32_bf16 v[72:75], a[4:7], a[76:79], v[72:75]
    ds_read_b64_tr_b16 a[46:47], v7 offset:51296
    v_mfma_f32_16x16x32_bf16 v[72:75], a[0:3], a[68:71], v[72:75]
    s_waitcnt lgkmcnt(7)
    ds_read_b64_tr_b16 a[48:49], v7 offset:50816
    v_mfma_f32_16x16x32_bf16 v[72:75], a[16:19], a[100:103], v[72:75]
    buffer_load_dwordx4 v21, s[12:15], s77 offen offset:2112 lds
    v_mfma_f32_16x16x32_bf16 v[72:75], a[20:23], a[108:111], v[72:75]
    ds_read_b64_tr_b16 a[50:51], v7 offset:51328
    v_mfma_f32_16x16x32_bf16 v[72:75], a[24:27], a[116:119], v[72:75]
    ds_read_b64_tr_b16 a[52:53], v7 offset:50848
    v_mfma_f32_16x16x32_bf16 v[72:75], a[28:31], a[124:127], v[72:75]
    ds_read_b64_tr_b16 a[54:55], v7 offset:51360
    v_mfma_f32_16x16x32_bf16 v[64:67], a[28:31], a[120:123], v[64:67]
    ds_read_b64_tr_b16 a[56:57], v7 offset:50880
    v_mfma_f32_16x16x32_bf16 v[64:67], a[24:27], a[112:115], v[64:67]
    ds_read_b64_tr_b16 a[58:59], v7 offset:51392
    v_mfma_f32_16x16x32_bf16 v[64:67], a[20:23], a[104:107], v[64:67]
    ds_read_b64_tr_b16 a[60:61], v7 offset:50912
    v_mfma_f32_16x16x32_bf16 v[64:67], a[16:19], a[96:99], v[64:67]
    s_waitcnt lgkmcnt(6)
    v_exp_f32 v80, v80
    v_mfma_f32_16x16x32_bf16 v[128:131], a[32:35], v[96:99], 0
    ds_read_b64_tr_b16 a[62:63], v7 offset:51424
    v_mfma_f32_16x16x32_bf16 v[136:139], a[32:35], v[100:103], 0
    buffer_load_dwordx4 v22, s[12:15], s77 offen offset:3168 lds
    v_mfma_f32_16x16x32_bf16 v[140:143], a[36:39], v[100:103], 0
    v_exp_f32 v81, v81
    v_mfma_f32_16x16x32_bf16 v[132:135], a[36:39], v[96:99], 0
    s_add_u32 s78, s75, 32768
    ds_read_b128 a[0:3], v5 offset:34304
    ds_read_b128 a[4:7], v5 offset:34368
    v_mfma_f32_16x16x32_bf16 v[144:147], a[40:43], v[96:99], 0
    s_add_u32 m0, s73, 84480
    ds_read_b128 a[8:11], v5 offset:34432
    v_mfma_f32_16x16x32_bf16 v[152:155], a[40:43], v[100:103], 0
    v_exp_f32 v82, v82
    v_mfma_f32_16x16x32_bf16 v[156:159], a[44:47], v[100:103], 0
    ds_read_b128 a[12:15], v5 offset:34496
    v_mfma_f32_16x16x32_bf16 v[148:151], a[44:47], v[96:99], 0
    s_waitcnt lgkmcnt(5)
    v_exp_f32 v83, v83
    v_mfma_f32_16x16x32_bf16 v[160:163], a[48:51], v[96:99], 0
    ds_read_b128 a[16:19], v5 offset:34560
    ds_read_b128 a[20:23], v5 offset:34624
    v_mfma_f32_16x16x32_bf16 v[168:171], a[48:51], v[100:103], 0
    buffer_load_dwordx4 v19, s[16:19], s78 offen lds
    v_mfma_f32_16x16x32_bf16 v[172:175], a[52:55], v[100:103], 0
    ds_read_b128 a[24:27], v5 offset:34688
    ds_read_b128 a[28:31], v5 offset:34752
    v_mfma_f32_16x16x32_bf16 v[164:167], a[52:55], v[96:99], 0
    ds_read_b64_tr_b16 a[32:33], v7 offset:50944
    v_cvt_pk_bf16_f32 v104, v80, v81
    v_mfma_f32_16x16x32_bf16 v[176:179], a[56:59], v[96:99], 0
    ds_read_b64_tr_b16 a[34:35], v7 offset:51456
    v_cvt_pk_bf16_f32 v105, v82, v83
    v_mfma_f32_16x16x32_bf16 v[184:187], a[56:59], v[100:103], 0
    s_waitcnt lgkmcnt(7)
    v_exp_f32 v88, v88
    v_mfma_f32_16x16x32_bf16 v[188:191], a[60:63], v[100:103], 0
    ds_read_b64_tr_b16 a[36:37], v7 offset:50976
    v_mfma_f32_16x16x32_bf16 v[180:183], a[60:63], v[96:99], 0
    v_exp_f32 v89, v89
    v_mfma_f32_16x16x32_bf16 a[240:243], a[248:251], v[96:99], 0
    ds_read_b64_tr_b16 a[38:39], v7 offset:51488
    v_mfma_f32_16x16x32_bf16 a[244:247], a[248:251], v[100:103], 0
    buffer_load_dwordx4 v20, s[16:19], s78 offen offset:1056 lds
    v_mfma_f32_16x16x32_bf16 v[68:71], a[0:3], a[64:67], v[112:115]
    v_exp_f32 v90, v90
    v_mfma_f32_16x16x32_bf16 v[68:71], a[4:7], a[72:75], v[68:71]
    ds_read_b64_tr_b16 a[40:41], v7 offset:51008
    ds_read_b64_tr_b16 a[42:43], v7 offset:51520
L_hop0_4:
    s_cbranch_execz L_hop0_8
    v_mfma_f32_16x16x32_bf16 v[68:71], a[8:11], a[80:83], v[68:71]
    s_waitcnt lgkmcnt(4)
    ds_read_b64_tr_b16 a[44:45], v7 offset:51040
    ds_read_b64_tr_b16 a[46:47], v7 offset:51552
    v_mfma_f32_16x16x32_bf16 v[68:71], a[12:15], a[88:91], v[68:71]
    v_exp_f32 v91, v91
    v_mfma_f32_16x16x32_bf16 v[76:79], a[12:15], a[92:95], v[116:119]
    ds_read_b64_tr_b16 a[48:49], v7 offset:51072
    v_cvt_pk_bf16_f32 v108, v88, v89
    v_mfma_f32_16x16x32_bf16 v[76:79], a[8:11], a[84:87], v[76:79]
    ds_read_b64_tr_b16 a[50:51], v7 offset:51584
    v_cvt_pk_bf16_f32 v109, v90, v91
    v_mfma_f32_16x16x32_bf16 v[76:79], a[4:7], a[76:79], v[76:79]
    ds_read_b64_tr_b16 a[52:53], v7 offset:51104
    v_mfma_f32_16x16x32_bf16 v[76:79], a[0:3], a[68:71], v[76:79]
    buffer_load_dwordx4 v21, s[16:19], s78 offen offset:2112 lds
    v_mfma_f32_16x16x32_bf16 v[76:79], a[16:19], a[100:103], v[76:79]
    v_exp_f32 v84, v84
    v_mfma_f32_16x16x32_bf16 v[76:79], a[20:23], a[108:111], v[76:79]
    ds_read_b64_tr_b16 a[54:55], v7 offset:51616
    ds_read_b64_tr_b16 a[56:57], v7 offset:51136
    v_mfma_f32_16x16x32_bf16 v[76:79], a[24:27], a[116:119], v[76:79]
    v_exp_f32 v85, v85
    v_mfma_f32_16x16x32_bf16 v[76:79], a[28:31], a[124:127], v[76:79]
    ds_read_b64_tr_b16 a[58:59], v7 offset:51648
    ds_read_b64_tr_b16 a[60:61], v7 offset:51168
    v_mfma_f32_16x16x32_bf16 v[68:71], a[28:31], a[120:123], v[68:71]
    v_exp_f32 v86, v86
    v_mfma_f32_16x16x32_bf16 v[68:71], a[24:27], a[112:115], v[68:71]
    ds_read_b64_tr_b16 a[62:63], v7 offset:51680
    v_mfma_f32_16x16x32_bf16 v[68:71], a[20:23], a[104:107], v[68:71]
    v_exp_f32 v87, v87
    v_mfma_f32_16x16x32_bf16 v[68:71], a[16:19], a[96:99], v[68:71]
    buffer_load_dwordx4 v22, s[16:19], s78 offen offset:3168 lds
    v_mfma_f32_16x16x32_bf16 v[192:195], a[32:35], v[96:99], 0
    v_cvt_pk_bf16_f32 v106, v84, v85
    v_cvt_pk_bf16_f32 v107, v86, v87
    v_mfma_f32_16x16x32_bf16 v[200:203], a[32:35], v[100:103], 0
    s_waitcnt lgkmcnt(3)
    v_exp_f32 v92, v92
    v_mfma_f32_16x16x32_bf16 v[204:207], a[36:39], v[100:103], 0
    s_add_u32 s65, s100, 131072
    buffer_load_dword v59, v31, s[12:15], s65 offen
    s_add_u32 s65, s97, 7168
    buffer_load_dword v59, v61, s[20:23], s65 offen
    v_mfma_f32_16x16x32_bf16 v[196:199], a[36:39], v[96:99], 0
    s_waitcnt vmcnt(12) lgkmcnt(0)
    s_barrier
    ds_read_b128 a[0:3], v4 offset:0
    v_mfma_f32_16x16x32_bf16 v[208:211], a[40:43], v[96:99], 0
    s_add_u32 s77, s75, 81920
    ds_read_b128 a[4:7], v4 offset:64
    v_mfma_f32_16x16x32_bf16 v[216:219], a[40:43], v[100:103], 0
    s_add_u32 m0, s73, 101376
    v_exp_f32 v93, v93
    v_mfma_f32_16x16x32_bf16 v[220:223], a[44:47], v[100:103], 0
    ds_read_b128 a[8:11], v4 offset:128
    v_mfma_f32_16x16x32_bf16 v[212:215], a[44:47], v[96:99], 0
    ds_read_b128 a[12:15], v4 offset:192
    v_mfma_f32_16x16x32_bf16 v[224:227], a[48:51], v[96:99], 0
    v_exp_f32 v94, v94
    v_mfma_f32_16x16x32_bf16 v[232:235], a[48:51], v[100:103], 0
    buffer_load_dwordx4 v19, s[12:15], s77 offen lds
    v_mfma_f32_16x16x32_bf16 v[236:239], a[52:55], v[100:103], 0
    ds_read_b128 a[16:19], v4 offset:256
    ds_read_b128 a[20:23], v4 offset:320
    v_mfma_f32_16x16x32_bf16 v[228:231], a[52:55], v[96:99], 0
    v_exp_f32 v95, v95
    v_mfma_f32_16x16x32_bf16 v[240:243], a[56:59], v[96:99], 0
    ds_read_b128 a[24:27], v4 offset:384
    ds_read_b128 a[28:31], v4 offset:448
    v_mfma_f32_16x16x32_bf16 v[248:251], a[56:59], v[100:103], 0
    ds_read_b64_tr_b16 a[32:33], v6 offset:16896
    v_cvt_pk_bf16_f32 v110, v92, v93
    v_mfma_f32_16x16x32_bf16 v[252:255], a[60:63], v[100:103], 0
    ds_read_b64_tr_b16 a[34:35], v6 offset:17408
    v_cvt_pk_bf16_f32 v111, v94, v95
    v_mfma_f32_16x16x32_bf16 v[244:247], a[60:63], v[96:99], 0
    s_waitcnt lgkmcnt(6)
    ds_read_b64_tr_b16 a[36:37], v6 offset:16928
    v_mfma_f32_16x16x32_bf16 v[80:83], a[0:3], a[64:67], v[112:115]
    buffer_load_dwordx4 v20, s[12:15], s77 offen offset:1056 lds
    v_mfma_f32_16x16x32_bf16 v[80:83], a[4:7], a[72:75], v[80:83]
    ds_read_b64_tr_b16 a[38:39], v6 offset:17440
    v_mfma_f32_16x16x32_bf16 v[80:83], a[8:11], a[80:83], v[80:83]
    ds_read_b64_tr_b16 a[40:41], v6 offset:16960
    v_mfma_f32_16x16x32_bf16 v[80:83], a[12:15], a[88:91], v[80:83]
    ds_read_b64_tr_b16 a[42:43], v6 offset:17472
    v_mfma_f32_16x16x32_bf16 v[88:91], a[12:15], a[92:95], v[116:119]
    ds_read_b64_tr_b16 a[44:45], v6 offset:16992
    v_mfma_f32_16x16x32_bf16 v[88:91], a[8:11], a[84:87], v[88:91]
    ds_read_b64_tr_b16 a[46:47], v6 offset:17504
    v_mfma_f32_16x16x32_bf16 v[88:91], a[4:7], a[76:79], v[88:91]
    v_mfma_f32_16x16x32_bf16 v[88:91], a[0:3], a[68:71], v[88:91]
    s_waitcnt lgkmcnt(5)
    ds_read_b64_tr_b16 a[48:49], v6 offset:17024
    v_mfma_f32_16x16x32_bf16 v[88:91], a[16:19], a[100:103], v[88:91]
    buffer_load_dwordx4 v21, s[12:15], s77 offen offset:2112 lds
    v_mfma_f32_16x16x32_bf16 v[88:91], a[20:23], a[108:111], v[88:91]
    ds_read_b64_tr_b16 a[50:51], v6 offset:17536
    v_mfma_f32_16x16x32_bf16 v[88:91], a[24:27], a[116:119], v[88:91]
    ds_read_b64_tr_b16 a[52:53], v6 offset:17056
    v_mfma_f32_16x16x32_bf16 v[88:91], a[28:31], a[124:127], v[88:91]
    ds_read_b64_tr_b16 a[54:55], v6 offset:17568
    v_mfma_f32_16x16x32_bf16 v[80:83], a[28:31], a[120:123], v[80:83]
    ds_read_b64_tr_b16 a[56:57], v6 offset:17088
    v_mfma_f32_16x16x32_bf16 v[80:83], a[24:27], a[112:115], v[80:83]
    ds_read_b64_tr_b16 a[58:59], v6 offset:17600
    v_mfma_f32_16x16x32_bf16 v[80:83], a[20:23], a[104:107], v[80:83]
    ds_read_b64_tr_b16 a[60:61], v6 offset:17120
    v_mfma_f32_16x16x32_bf16 v[80:83], a[16:19], a[96:99], v[80:83]
    v_exp_f32 v64, v64
    v_mfma_f32_16x16x32_bf16 v[128:131], a[32:35], v[104:107], v[128:131]
    ds_read_b64_tr_b16 a[62:63], v6 offset:17632
    v_mfma_f32_16x16x32_bf16 v[136:139], a[32:35], v[108:111], v[136:139]
    s_waitcnt lgkmcnt(6)
    buffer_load_dwordx4 v22, s[12:15], s77 offen offset:3168 lds
    v_mfma_f32_16x16x32_bf16 v[140:143], a[36:39], v[108:111], v[140:143]
    v_exp_f32 v65, v65
    v_mfma_f32_16x16x32_bf16 v[132:135], a[36:39], v[104:107], v[132:135]
    s_add_u32 s78, s75, 49152
    ds_read_b128 a[0:3], v4 offset:512
    ds_read_b128 a[4:7], v4 offset:576
    v_mfma_f32_16x16x32_bf16 v[144:147], a[40:43], v[104:107], v[144:147]
    s_add_u32 m0, s73, 118272
    ds_read_b128 a[8:11], v4 offset:640
    v_mfma_f32_16x16x32_bf16 v[152:155], a[40:43], v[108:111], v[152:155]
    v_exp_f32 v66, v66
    v_mfma_f32_16x16x32_bf16 v[156:159], a[44:47], v[108:111], v[156:159]
    ds_read_b128 a[12:15], v4 offset:704
    v_mfma_f32_16x16x32_bf16 v[148:151], a[44:47], v[104:107], v[148:151]
    v_exp_f32 v67, v67
    v_mfma_f32_16x16x32_bf16 v[160:163], a[48:51], v[104:107], v[160:163]
    ds_read_b128 a[16:19], v4 offset:768
    ds_read_b128 a[20:23], v4 offset:832
    v_mfma_f32_16x16x32_bf16 v[168:171], a[48:51], v[108:111], v[168:171]
    s_waitcnt lgkmcnt(6)
    buffer_load_dwordx4 v19, s[16:19], s78 offen lds
    v_mfma_f32_16x16x32_bf16 v[172:175], a[52:55], v[108:111], v[172:175]
    ds_read_b128 a[24:27], v4 offset:896
    ds_read_b128 a[28:31], v4 offset:960
    v_mfma_f32_16x16x32_bf16 v[164:167], a[52:55], v[104:107], v[164:167]
    ds_read_b64_tr_b16 a[32:33], v6 offset:17152
    v_cvt_pk_bf16_f32 v96, v64, v65
    v_mfma_f32_16x16x32_bf16 v[176:179], a[56:59], v[104:107], v[176:179]
    ds_read_b64_tr_b16 a[34:35], v6 offset:17664
    v_cvt_pk_bf16_f32 v97, v66, v67
    v_mfma_f32_16x16x32_bf16 v[184:187], a[56:59], v[108:111], v[184:187]
    v_exp_f32 v72, v72
    v_mfma_f32_16x16x32_bf16 v[188:191], a[60:63], v[108:111], v[188:191]
    ds_read_b64_tr_b16 a[36:37], v6 offset:17184
    v_mfma_f32_16x16x32_bf16 v[180:183], a[60:63], v[104:107], v[180:183]
    v_exp_f32 v73, v73
    v_mfma_f32_16x16x32_bf16 a[240:243], a[248:251], v[104:107], a[240:243]
    ds_read_b64_tr_b16 a[38:39], v6 offset:17696
    v_mfma_f32_16x16x32_bf16 a[244:247], a[248:251], v[108:111], a[244:247]
    s_waitcnt lgkmcnt(6)
    buffer_load_dwordx4 v20, s[16:19], s78 offen offset:1056 lds
    v_mfma_f32_16x16x32_bf16 v[84:87], a[0:3], a[64:67], v[112:115]
    v_exp_f32 v74, v74
    v_mfma_f32_16x16x32_bf16 v[84:87], a[4:7], a[72:75], v[84:87]
    ds_read_b64_tr_b16 a[40:41], v6 offset:17216
    ds_read_b64_tr_b16 a[42:43], v6 offset:17728
    v_mfma_f32_16x16x32_bf16 v[84:87], a[8:11], a[80:83], v[84:87]
    ds_read_b64_tr_b16 a[44:45], v6 offset:17248
    ds_read_b64_tr_b16 a[46:47], v6 offset:17760
    v_mfma_f32_16x16x32_bf16 v[84:87], a[12:15], a[88:91], v[84:87]
    v_exp_f32 v75, v75
    v_mfma_f32_16x16x32_bf16 v[92:95], a[12:15], a[92:95], v[116:119]
    ds_read_b64_tr_b16 a[48:49], v6 offset:17280
    v_cvt_pk_bf16_f32 v100, v72, v73
    v_mfma_f32_16x16x32_bf16 v[92:95], a[8:11], a[84:87], v[92:95]
    ds_read_b64_tr_b16 a[50:51], v6 offset:17792
    v_cvt_pk_bf16_f32 v101, v74, v75
    v_mfma_f32_16x16x32_bf16 v[92:95], a[4:7], a[76:79], v[92:95]
    ds_read_b64_tr_b16 a[52:53], v6 offset:17312
    v_mfma_f32_16x16x32_bf16 v[92:95], a[0:3], a[68:71], v[92:95]
    buffer_load_dwordx4 v21, s[16:19], s78 offen offset:2112 lds
    v_mfma_f32_16x16x32_bf16 v[92:95], a[16:19], a[100:103], v[92:95]
    v_exp_f32 v68, v68
    v_mfma_f32_16x16x32_bf16 v[92:95], a[20:23], a[108:111], v[92:95]
    s_waitcnt lgkmcnt(5)
    ds_read_b64_tr_b16 a[54:55], v6 offset:17824
    ds_read_b64_tr_b16 a[56:57], v6 offset:17344
    v_mfma_f32_16x16x32_bf16 v[92:95], a[24:27], a[116:119], v[92:95]
    v_exp_f32 v69, v69
    v_mfma_f32_16x16x32_bf16 v[92:95], a[28:31], a[124:127], v[92:95]
    ds_read_b64_tr_b16 a[58:59], v6 offset:17856
    ds_read_b64_tr_b16 a[60:61], v6 offset:17376
    v_mfma_f32_16x16x32_bf16 v[84:87], a[28:31], a[120:123], v[84:87]
    v_exp_f32 v70, v70
    v_mfma_f32_16x16x32_bf16 v[84:87], a[24:27], a[112:115], v[84:87]
    ds_read_b64_tr_b16 a[62:63], v6 offset:17888
    v_mfma_f32_16x16x32_bf16 v[84:87], a[20:23], a[104:107], v[84:87]
    v_exp_f32 v71, v71
    v_mfma_f32_16x16x32_bf16 v[84:87], a[16:19], a[96:99], v[84:87]
    buffer_load_dwordx4 v22, s[16:19], s78 offen offset:3168 lds
    v_mfma_f32_16x16x32_bf16 v[192:195], a[32:35], v[104:107], v[192:195]
    v_cvt_pk_bf16_f32 v98, v68, v69
    v_cvt_pk_bf16_f32 v99, v70, v71
    v_mfma_f32_16x16x32_bf16 v[200:203], a[32:35], v[108:111], v[200:203]
    s_add_u32 s65, s100, 131072
    buffer_load_dword v59, v31, s[16:19], s65 offen
    v_mfma_f32_16x16x32_bf16 v[204:207], a[36:39], v[108:111], v[204:207]
    s_add_u32 s65, s97, 14336
    buffer_load_dword v59, v61, s[20:23], s65 offen
    v_mfma_f32_16x16x32_bf16 v[196:199], a[36:39], v[104:107], v[196:199]
    s_waitcnt vmcnt(12) lgkmcnt(0)
    s_barrier
    ds_read_b128 a[0:3], v5 offset:0
    v_mfma_f32_16x16x32_bf16 v[208:211], a[40:43], v[104:107], v[208:211]
    s_add_u32 s77, s75, 98304
    v_exp_f32 v76, v76
    v_mfma_f32_16x16x32_bf16 v[216:219], a[40:43], v[108:111], v[216:219]
    s_add_u32 m0, s73, 0
    ds_read_b128 a[4:7], v5 offset:64
    v_mfma_f32_16x16x32_bf16 v[220:223], a[44:47], v[108:111], v[220:223]
    v_exp_f32 v77, v77
    v_mfma_f32_16x16x32_bf16 v[212:215], a[44:47], v[104:107], v[212:215]
    ds_read_b128 a[8:11], v5 offset:128
    ds_read_b128 a[12:15], v5 offset:192
    v_mfma_f32_16x16x32_bf16 v[224:227], a[48:51], v[104:107], v[224:227]
    v_exp_f32 v78, v78
    v_mfma_f32_16x16x32_bf16 v[232:235], a[48:51], v[108:111], v[232:235]
    buffer_load_dwordx4 v19, s[12:15], s77 offen lds
    v_mfma_f32_16x16x32_bf16 v[236:239], a[52:55], v[108:111], v[236:239]
    ds_read_b128 a[16:19], v5 offset:256
    ds_read_b128 a[20:23], v5 offset:320
    v_mfma_f32_16x16x32_bf16 v[228:231], a[52:55], v[104:107], v[228:231]
    v_exp_f32 v79, v79
    v_mfma_f32_16x16x32_bf16 v[240:243], a[56:59], v[104:107], v[240:243]
    ds_read_b128 a[24:27], v5 offset:384
    ds_read_b128 a[28:31], v5 offset:448
    v_mfma_f32_16x16x32_bf16 v[248:251], a[56:59], v[108:111], v[248:251]
    ds_read_b64_tr_b16 a[32:33], v7 offset:16896
    v_cvt_pk_bf16_f32 v102, v76, v77
    v_mfma_f32_16x16x32_bf16 v[252:255], a[60:63], v[108:111], v[252:255]
    ds_read_b64_tr_b16 a[34:35], v7 offset:17408
    v_cvt_pk_bf16_f32 v103, v78, v79
    v_mfma_f32_16x16x32_bf16 v[244:247], a[60:63], v[104:107], v[244:247]
    s_waitcnt lgkmcnt(6)
    ds_read_b64_tr_b16 a[36:37], v7 offset:16928
    v_mfma_f32_16x16x32_bf16 v[64:67], a[0:3], a[64:67], v[112:115]
    buffer_load_dwordx4 v20, s[12:15], s77 offen offset:1056 lds
    v_mfma_f32_16x16x32_bf16 v[64:67], a[4:7], a[72:75], v[64:67]
    ds_read_b64_tr_b16 a[38:39], v7 offset:17440
    v_mfma_f32_16x16x32_bf16 v[64:67], a[8:11], a[80:83], v[64:67]
    ds_read_b64_tr_b16 a[40:41], v7 offset:16960
    v_mfma_f32_16x16x32_bf16 v[64:67], a[12:15], a[88:91], v[64:67]
    ds_read_b64_tr_b16 a[42:43], v7 offset:17472
    v_mfma_f32_16x16x32_bf16 v[72:75], a[12:15], a[92:95], v[116:119]
    ds_read_b64_tr_b16 a[44:45], v7 offset:16992
    v_mfma_f32_16x16x32_bf16 v[72:75], a[8:11], a[84:87], v[72:75]
    ds_read_b64_tr_b16 a[46:47], v7 offset:17504
    v_mfma_f32_16x16x32_bf16 v[72:75], a[4:7], a[76:79], v[72:75]
    v_mfma_f32_16x16x32_bf16 v[72:75], a[0:3], a[68:71], v[72:75]
    s_waitcnt lgkmcnt(5)
    ds_read_b64_tr_b16 a[48:49], v7 offset:17024
    v_mfma_f32_16x16x32_bf16 v[72:75], a[16:19], a[100:103], v[72:75]
    buffer_load_dwordx4 v21, s[12:15], s77 offen offset:2112 lds
    v_mfma_f32_16x16x32_bf16 v[72:75], a[20:23], a[108:111], v[72:75]
    ds_read_b64_tr_b16 a[50:51], v7 offset:17536
    v_mfma_f32_16x16x32_bf16 v[72:75], a[24:27], a[116:119], v[72:75]
    ds_read_b64_tr_b16 a[52:53], v7 offset:17056
    v_mfma_f32_16x16x32_bf16 v[72:75], a[28:31], a[124:127], v[72:75]
    ds_read_b64_tr_b16 a[54:55], v7 offset:17568
    v_mfma_f32_16x16x32_bf16 v[64:67], a[28:31], a[120:123], v[64:67]
    ds_read_b64_tr_b16 a[56:57], v7 offset:17088
    v_mfma_f32_16x16x32_bf16 v[64:67], a[24:27], a[112:115], v[64:67]
    ds_read_b64_tr_b16 a[58:59], v7 offset:17600
    v_mfma_f32_16x16x32_bf16 v[64:67], a[20:23], a[104:107], v[64:67]
    ds_read_b64_tr_b16 a[60:61], v7 offset:17120
    v_mfma_f32_16x16x32_bf16 v[64:67], a[16:19], a[96:99], v[64:67]
    v_exp_f32 v80, v80
    v_mfma_f32_16x16x32_bf16 v[128:131], a[32:35], v[96:99], v[128:131]
    ds_read_b64_tr_b16 a[62:63], v7 offset:17632
    v_mfma_f32_16x16x32_bf16 v[136:139], a[32:35], v[100:103], v[136:139]
    s_waitcnt lgkmcnt(6)
    buffer_load_dwordx4 v22, s[12:15], s77 offen offset:3168 lds
    v_mfma_f32_16x16x32_bf16 v[140:143], a[36:39], v[100:103], v[140:143]
    v_exp_f32 v81, v81
    v_mfma_f32_16x16x32_bf16 v[132:135], a[36:39], v[96:99], v[132:135]
    s_add_u32 s78, s75, 65536
    ds_read_b128 a[0:3], v5 offset:512
    ds_read_b128 a[4:7], v5 offset:576
    v_mfma_f32_16x16x32_bf16 v[144:147], a[40:43], v[96:99], v[144:147]
    s_add_u32 m0, s73, 16896
    ds_read_b128 a[8:11], v5 offset:640
    v_mfma_f32_16x16x32_bf16 v[152:155], a[40:43], v[100:103], v[152:155]
    v_exp_f32 v82, v82
    v_mfma_f32_16x16x32_bf16 v[156:159], a[44:47], v[100:103], v[156:159]
    ds_read_b128 a[12:15], v5 offset:704
    v_mfma_f32_16x16x32_bf16 v[148:151], a[44:47], v[96:99], v[148:151]
    v_exp_f32 v83, v83
    v_mfma_f32_16x16x32_bf16 v[160:163], a[48:51], v[96:99], v[160:163]
    ds_read_b128 a[16:19], v5 offset:768
    ds_read_b128 a[20:23], v5 offset:832
    v_mfma_f32_16x16x32_bf16 v[168:171], a[48:51], v[100:103], v[168:171]
    s_waitcnt lgkmcnt(6)
    buffer_load_dwordx4 v19, s[16:19], s78 offen lds
    v_mfma_f32_16x16x32_bf16 v[172:175], a[52:55], v[100:103], v[172:175]
    ds_read_b128 a[24:27], v5 offset:896
    ds_read_b128 a[28:31], v5 offset:960
    v_mfma_f32_16x16x32_bf16 v[164:167], a[52:55], v[96:99], v[164:167]
    ds_read_b64_tr_b16 a[32:33], v7 offset:17152
    v_cvt_pk_bf16_f32 v104, v80, v81
    v_mfma_f32_16x16x32_bf16 v[176:179], a[56:59], v[96:99], v[176:179]
    ds_read_b64_tr_b16 a[34:35], v7 offset:17664
    v_cvt_pk_bf16_f32 v105, v82, v83
    v_mfma_f32_16x16x32_bf16 v[184:187], a[56:59], v[100:103], v[184:187]
    v_exp_f32 v88, v88
    v_mfma_f32_16x16x32_bf16 v[188:191], a[60:63], v[100:103], v[188:191]
    ds_read_b64_tr_b16 a[36:37], v7 offset:17184
    v_mfma_f32_16x16x32_bf16 v[180:183], a[60:63], v[96:99], v[180:183]
    v_exp_f32 v89, v89
    v_mfma_f32_16x16x32_bf16 a[240:243], a[248:251], v[96:99], a[240:243]
    ds_read_b64_tr_b16 a[38:39], v7 offset:17696
    v_mfma_f32_16x16x32_bf16 a[244:247], a[248:251], v[100:103], a[244:247]
    s_waitcnt lgkmcnt(6)
    buffer_load_dwordx4 v20, s[16:19], s78 offen offset:1056 lds
    v_mfma_f32_16x16x32_bf16 v[68:71], a[0:3], a[64:67], v[112:115]
    v_exp_f32 v90, v90
    v_mfma_f32_16x16x32_bf16 v[68:71], a[4:7], a[72:75], v[68:71]
    ds_read_b64_tr_b16 a[40:41], v7 offset:17216
    ds_read_b64_tr_b16 a[42:43], v7 offset:17728
    v_mfma_f32_16x16x32_bf16 v[68:71], a[8:11], a[80:83], v[68:71]
    ds_read_b64_tr_b16 a[44:45], v7 offset:17248
    ds_read_b64_tr_b16 a[46:47], v7 offset:17760
    v_mfma_f32_16x16x32_bf16 v[68:71], a[12:15], a[88:91], v[68:71]
    v_exp_f32 v91, v91
    v_mfma_f32_16x16x32_bf16 v[76:79], a[12:15], a[92:95], v[116:119]
    ds_read_b64_tr_b16 a[48:49], v7 offset:17280
    v_cvt_pk_bf16_f32 v108, v88, v89
    v_mfma_f32_16x16x32_bf16 v[76:79], a[8:11], a[84:87], v[76:79]
    ds_read_b64_tr_b16 a[50:51], v7 offset:17792
    v_cvt_pk_bf16_f32 v109, v90, v91
    v_mfma_f32_16x16x32_bf16 v[76:79], a[4:7], a[76:79], v[76:79]
    ds_read_b64_tr_b16 a[52:53], v7 offset:17312
    v_mfma_f32_16x16x32_bf16 v[76:79], a[0:3], a[68:71], v[76:79]
    buffer_load_dwordx4 v21, s[16:19], s78 offen offset:2112 lds
    v_mfma_f32_16x16x32_bf16 v[76:79], a[16:19], a[100:103], v[76:79]
    v_exp_f32 v84, v84
    v_mfma_f32_16x16x32_bf16 v[76:79], a[20:23], a[108:111], v[76:79]
    s_waitcnt lgkmcnt(5)
    ds_read_b64_tr_b16 a[54:55], v7 offset:17824
    ds_read_b64_tr_b16 a[56:57], v7 offset:17344
    v_mfma_f32_16x16x32_bf16 v[76:79], a[24:27], a[116:119], v[76:79]
    v_exp_f32 v85, v85
    v_mfma_f32_16x16x32_bf16 v[76:79], a[28:31], a[124:127], v[76:79]
    ds_read_b64_tr_b16 a[58:59], v7 offset:17856
    ds_read_b64_tr_b16 a[60:61], v7 offset:17376
    v_mfma_f32_16x16x32_bf16 v[68:71], a[28:31], a[120:123], v[68:71]
    v_exp_f32 v86, v86
    v_mfma_f32_16x16x32_bf16 v[68:71], a[24:27], a[112:115], v[68:71]
    ds_read_b64_tr_b16 a[62:63], v7 offset:17888
    v_mfma_f32_16x16x32_bf16 v[68:71], a[20:23], a[104:107], v[68:71]
    v_exp_f32 v87, v87
    v_mfma_f32_16x16x32_bf16 v[68:71], a[16:19], a[96:99], v[68:71]
    buffer_load_dwordx4 v22, s[16:19], s78 offen offset:3168 lds
    v_mfma_f32_16x16x32_bf16 v[192:195], a[32:35], v[96:99], v[192:195]
    v_cvt_pk_bf16_f32 v106, v84, v85
    v_cvt_pk_bf16_f32 v107, v86, v87
    v_mfma_f32_16x16x32_bf16 v[200:203], a[32:35], v[100:103], v[200:203]
    s_add_u32 s65, s97, 21504
    buffer_load_dword v59, v61, s[20:23], s65 offen
    v_mfma_f32_16x16x32_bf16 v[204:207], a[36:39], v[100:103], v[204:207]
    v_exp_f32 v92, v92
    v_mfma_f32_16x16x32_bf16 v[196:199], a[36:39], v[96:99], v[196:199]
    s_waitcnt vmcnt(11) lgkmcnt(0)
    s_barrier
    ds_read_b128 a[0:3], v5 offset:33792
    v_mfma_f32_16x16x32_bf16 v[208:211], a[40:43], v[96:99], v[208:211]
    s_add_u32 s77, s75, 114688
    ds_read_b128 a[4:7], v5 offset:33856
    v_mfma_f32_16x16x32_bf16 v[216:219], a[40:43], v[100:103], v[216:219]
    s_add_u32 m0, s73, 67584
    v_exp_f32 v93, v93
    v_mfma_f32_16x16x32_bf16 v[220:223], a[44:47], v[100:103], v[220:223]
    ds_read_b128 a[8:11], v5 offset:33920
    v_mfma_f32_16x16x32_bf16 v[212:215], a[44:47], v[96:99], v[212:215]
    ds_read_b128 a[12:15], v5 offset:33984
    v_mfma_f32_16x16x32_bf16 v[224:227], a[48:51], v[96:99], v[224:227]
    buffer_load_dwordx4 v19, s[12:15], s77 offen lds
    v_mfma_f32_16x16x32_bf16 v[232:235], a[48:51], v[100:103], v[232:235]
    v_exp_f32 v94, v94
    v_mfma_f32_16x16x32_bf16 v[236:239], a[52:55], v[100:103], v[236:239]
    ds_read_b128 a[16:19], v5 offset:34048
    ds_read_b128 a[20:23], v5 offset:34112
    v_mfma_f32_16x16x32_bf16 v[228:231], a[52:55], v[96:99], v[228:231]
    v_exp_f32 v95, v95
    v_mfma_f32_16x16x32_bf16 v[240:243], a[56:59], v[96:99], v[240:243]
    ds_read_b128 a[24:27], v5 offset:34176
    ds_read_b128 a[28:31], v5 offset:34240
    v_mfma_f32_16x16x32_bf16 v[248:251], a[56:59], v[100:103], v[248:251]
    buffer_load_dwordx4 v20, s[12:15], s77 offen offset:1056 lds
    v_mfma_f32_16x16x32_bf16 v[252:255], a[60:63], v[100:103], v[252:255]
    ds_read_b64_tr_b16 a[32:33], v7 offset:50688
    v_cvt_pk_bf16_f32 v110, v92, v93
    v_cvt_pk_bf16_f32 v111, v94, v95
    v_mfma_f32_16x16x32_bf16 v[244:247], a[60:63], v[96:99], v[244:247]
    s_waitcnt lgkmcnt(5)
    ds_read_b64_tr_b16 a[34:35], v7 offset:51200
    v_mfma_f32_16x16x32_bf16 v[80:83], a[0:3], a[64:67], v[112:115]
    ds_read_b64_tr_b16 a[36:37], v7 offset:50720
    v_mfma_f32_16x16x32_bf16 v[80:83], a[4:7], a[72:75], v[80:83]
    ds_read_b64_tr_b16 a[38:39], v7 offset:51232
    v_mfma_f32_16x16x32_bf16 v[80:83], a[8:11], a[80:83], v[80:83]
    buffer_load_dwordx4 v21, s[12:15], s77 offen offset:2112 lds
    v_mfma_f32_16x16x32_bf16 v[80:83], a[12:15], a[88:91], v[80:83]
    ds_read_b64_tr_b16 a[40:41], v7 offset:50752
    v_mfma_f32_16x16x32_bf16 v[88:91], a[12:15], a[92:95], v[116:119]
    ds_read_b64_tr_b16 a[42:43], v7 offset:51264
    v_mfma_f32_16x16x32_bf16 v[88:91], a[8:11], a[84:87], v[88:91]
    ds_read_b64_tr_b16 a[44:45], v7 offset:50784
    v_mfma_f32_16x16x32_bf16 v[88:91], a[4:7], a[76:79], v[88:91]
    ds_read_b64_tr_b16 a[46:47], v7 offset:51296
    v_mfma_f32_16x16x32_bf16 v[88:91], a[0:3], a[68:71], v[88:91]
    s_waitcnt lgkmcnt(6)
    buffer_load_dwordx4 v22, s[12:15], s77 offen offset:3168 lds
    v_mfma_f32_16x16x32_bf16 v[88:91], a[16:19], a[100:103], v[88:91]
    s_add_u32 s78, s75, 81920
    ds_read_b64_tr_b16 a[48:49], v7 offset:50816
    v_mfma_f32_16x16x32_bf16 v[88:91], a[20:23], a[108:111], v[88:91]
    s_add_u32 m0, s73, 84480
    ds_read_b64_tr_b16 a[50:51], v7 offset:51328
    v_mfma_f32_16x16x32_bf16 v[88:91], a[24:27], a[116:119], v[88:91]
    ds_read_b64_tr_b16 a[52:53], v7 offset:50848
    v_mfma_f32_16x16x32_bf16 v[88:91], a[28:31], a[124:127], v[88:91]
    ds_read_b64_tr_b16 a[54:55], v7 offset:51360
    v_mfma_f32_16x16x32_bf16 v[80:83], a[28:31], a[120:123], v[80:83]
    buffer_load_dwordx4 v19, s[16:19], s78 offen lds
    v_mfma_f32_16x16x32_bf16 v[80:83], a[24:27], a[112:115], v[80:83]
    ds_read_b64_tr_b16 a[56:57], v7 offset:50880
    v_mfma_f32_16x16x32_bf16 v[80:83], a[20:23], a[104:107], v[80:83]
    ds_read_b64_tr_b16 a[58:59], v7 offset:51392
    v_mfma_f32_16x16x32_bf16 v[80:83], a[16:19], a[96:99], v[80:83]
    ds_read_b64_tr_b16 a[60:61], v7 offset:50912
    v_mfma_f32_16x16x32_bf16 v[128:131], a[32:35], v[104:107], v[128:131]
    v_exp_f32 v64, v64
    v_mfma_f32_16x16x32_bf16 v[136:139], a[32:35], v[108:111], v[136:139]
    s_waitcnt lgkmcnt(5)
    ds_read_b64_tr_b16 a[62:63], v7 offset:51424
    v_mfma_f32_16x16x32_bf16 v[140:143], a[36:39], v[108:111], v[140:143]
    buffer_load_dwordx4 v20, s[16:19], s78 offen offset:1056 lds
    v_mfma_f32_16x16x32_bf16 v[132:135], a[36:39], v[104:107], v[132:135]
    v_exp_f32 v65, v65
    v_mfma_f32_16x16x32_bf16 v[144:147], a[40:43], v[104:107], v[144:147]
    ds_read_b128 a[0:3], v5 offset:34304
    ds_read_b128 a[4:7], v5 offset:34368
    v_mfma_f32_16x16x32_bf16 v[152:155], a[40:43], v[108:111], v[152:155]
    ds_read_b128 a[8:11], v5 offset:34432
    ds_read_b128 a[12:15], v5 offset:34496
    v_mfma_f32_16x16x32_bf16 v[156:159], a[44:47], v[108:111], v[156:159]
    v_exp_f32 v66, v66
    v_mfma_f32_16x16x32_bf16 v[148:151], a[44:47], v[104:107], v[148:151]
    v_exp_f32 v67, v67
    v_mfma_f32_16x16x32_bf16 v[160:163], a[48:51], v[104:107], v[160:163]
    ds_read_b128 a[16:19], v5 offset:34560
    ds_read_b128 a[20:23], v5 offset:34624
    v_mfma_f32_16x16x32_bf16 v[168:171], a[48:51], v[108:111], v[168:171]
    s_waitcnt lgkmcnt(6)
    buffer_load_dwordx4 v21, s[16:19], s78 offen offset:2112 lds
    v_mfma_f32_16x16x32_bf16 v[172:175], a[52:55], v[108:111], v[172:175]
    ds_read_b128 a[24:27], v5 offset:34688
    ds_read_b128 a[28:31], v5 offset:34752
    v_mfma_f32_16x16x32_bf16 v[164:167], a[52:55], v[104:107], v[164:167]
    ds_read_b64_tr_b16 a[32:33], v7 offset:50944
    v_cvt_pk_bf16_f32 v96, v64, v65
    v_mfma_f32_16x16x32_bf16 v[176:179], a[56:59], v[104:107], v[176:179]
    buffer_load_dwordx4 v22, s[16:19], s78 offen offset:3168 lds
    v_mfma_f32_16x16x32_bf16 v[184:187], a[56:59], v[108:111], v[184:187]
    s_add_u32 s77, s76, 0
    ds_read_b64_tr_b16 a[34:35], v7 offset:51456
    v_cvt_pk_bf16_f32 v97, v66, v67
    v_mfma_f32_16x16x32_bf16 v[188:191], a[60:63], v[108:111], v[188:191]
    s_add_u32 m0, s72, 33792
    v_exp_f32 v72, v72
    v_mfma_f32_16x16x32_bf16 v[180:183], a[60:63], v[104:107], v[180:183]
    ds_read_b64_tr_b16 a[36:37], v7 offset:50976
    ds_read_b64_tr_b16 a[38:39], v7 offset:51488
    v_mfma_f32_16x16x32_bf16 a[240:243], a[248:251], v[104:107], a[240:243]
    v_exp_f32 v73, v73
    v_mfma_f32_16x16x32_bf16 a[244:247], a[248:251], v[108:111], a[244:247]
    s_waitcnt lgkmcnt(6)
    v_exp_f32 v74, v74
    v_mfma_f32_16x16x32_bf16 v[84:87], a[0:3], a[64:67], v[112:115]
    ds_read_b64_tr_b16 a[40:41], v7 offset:51008
    ds_read_b64_tr_b16 a[42:43], v7 offset:51520
    v_mfma_f32_16x16x32_bf16 v[84:87], a[4:7], a[72:75], v[84:87]
    buffer_load_dwordx4 v23, s[20:23], s77 offen lds
    v_mfma_f32_16x16x32_bf16 v[84:87], a[8:11], a[80:83], v[84:87]
    ds_read_b64_tr_b16 a[44:45], v7 offset:51040
    ds_read_b64_tr_b16 a[46:47], v7 offset:51552
    v_mfma_f32_16x16x32_bf16 v[84:87], a[12:15], a[88:91], v[84:87]
    v_exp_f32 v75, v75
    v_mfma_f32_16x16x32_bf16 v[92:95], a[12:15], a[92:95], v[116:119]
    ds_read_b64_tr_b16 a[48:49], v7 offset:51072
    v_cvt_pk_bf16_f32 v100, v72, v73
    v_mfma_f32_16x16x32_bf16 v[92:95], a[8:11], a[84:87], v[92:95]
    buffer_load_dwordx4 v24, s[20:23], s77 offen offset:1032 lds
    v_mfma_f32_16x16x32_bf16 v[92:95], a[4:7], a[76:79], v[92:95]
    ds_read_b64_tr_b16 a[50:51], v7 offset:51584
    ds_read_b64_tr_b16 a[52:53], v7 offset:51104
    v_mfma_f32_16x16x32_bf16 v[92:95], a[0:3], a[68:71], v[92:95]
    ds_read_b64_tr_b16 a[54:55], v7 offset:51616
    v_cvt_pk_bf16_f32 v101, v74, v75
    v_mfma_f32_16x16x32_bf16 v[92:95], a[16:19], a[100:103], v[92:95]
    v_exp_f32 v68, v68
    v_mfma_f32_16x16x32_bf16 v[92:95], a[20:23], a[108:111], v[92:95]
    s_waitcnt lgkmcnt(6)
    v_exp_f32 v69, v69
    v_mfma_f32_16x16x32_bf16 v[92:95], a[24:27], a[116:119], v[92:95]
    ds_read_b64_tr_b16 a[56:57], v7 offset:51136
    ds_read_b64_tr_b16 a[58:59], v7 offset:51648
    v_mfma_f32_16x16x32_bf16 v[92:95], a[28:31], a[124:127], v[92:95]
    buffer_load_dwordx4 v25, s[20:23], s77 offen offset:2112 lds
    v_mfma_f32_16x16x32_bf16 v[84:87], a[28:31], a[120:123], v[84:87]
    ds_read_b64_tr_b16 a[60:61], v7 offset:51168
    ds_read_b64_tr_b16 a[62:63], v7 offset:51680
    v_mfma_f32_16x16x32_bf16 v[84:87], a[24:27], a[112:115], v[84:87]
    v_exp_f32 v70, v70
    v_mfma_f32_16x16x32_bf16 v[84:87], a[20:23], a[104:107], v[84:87]
    v_exp_f32 v71, v71
    v_mfma_f32_16x16x32_bf16 v[84:87], a[16:19], a[96:99], v[84:87]
    buffer_load_dwordx4 v26, s[20:23], s77 offen offset:3144 lds
    v_mfma_f32_16x16x32_bf16 v[192:195], a[32:35], v[104:107], v[192:195]
    v_cvt_pk_bf16_f32 v98, v68, v69
    v_cvt_pk_bf16_f32 v99, v70, v71
    v_mfma_f32_16x16x32_bf16 v[200:203], a[32:35], v[108:111], v[200:203]
    s_add_u32 s65, s100, 196608
    buffer_load_dword v59, v31, s[12:15], s65 offen
    v_mfma_f32_16x16x32_bf16 v[204:207], a[36:39], v[108:111], v[204:207]
    v_exp_f32 v76, v76
    v_mfma_f32_16x16x32_bf16 v[196:199], a[36:39], v[104:107], v[196:199]
    s_waitcnt vmcnt(14) lgkmcnt(0)
    s_barrier
    ds_read_b128 a[0:3], v4 offset:0
    v_mfma_f32_16x16x32_bf16 v[208:211], a[40:43], v[104:107], v[208:211]
    s_add_u32 s77, s75, 131072
    ds_read_b128 a[4:7], v4 offset:64
    v_mfma_f32_16x16x32_bf16 v[216:219], a[40:43], v[108:111], v[216:219]
    s_add_u32 m0, s73, 101376
    v_exp_f32 v77, v77
    v_mfma_f32_16x16x32_bf16 v[220:223], a[44:47], v[108:111], v[220:223]
    ds_read_b128 a[8:11], v4 offset:128
    v_mfma_f32_16x16x32_bf16 v[212:215], a[44:47], v[104:107], v[212:215]
    ds_read_b128 a[12:15], v4 offset:192
    v_mfma_f32_16x16x32_bf16 v[224:227], a[48:51], v[104:107], v[224:227]
    buffer_load_dwordx4 v19, s[12:15], s77 offen lds
    v_mfma_f32_16x16x32_bf16 v[232:235], a[48:51], v[108:111], v[232:235]
    v_exp_f32 v78, v78
    v_mfma_f32_16x16x32_bf16 v[236:239], a[52:55], v[108:111], v[236:239]
    ds_read_b128 a[16:19], v4 offset:256
    ds_read_b128 a[20:23], v4 offset:320
    v_mfma_f32_16x16x32_bf16 v[228:231], a[52:55], v[104:107], v[228:231]
L_hop0_5:
    s_cbranch_execz L_hop0_9
    v_exp_f32 v79, v79
    v_mfma_f32_16x16x32_bf16 v[240:243], a[56:59], v[104:107], v[240:243]
    ds_read_b128 a[24:27], v4 offset:384
    ds_read_b128 a[28:31], v4 offset:448
    v_mfma_f32_16x16x32_bf16 v[248:251], a[56:59], v[108:111], v[248:251]
    buffer_load_dwordx4 v20, s[12:15], s77 offen offset:1056 lds
    v_mfma_f32_16x16x32_bf16 v[252:255], a[60:63], v[108:111], v[252:255]
    ds_read_b64_tr_b16 a[32:33], v6 offset:16896
    v_cvt_pk_bf16_f32 v102, v76, v77
    v_cvt_pk_bf16_f32 v103, v78, v79
    v_mfma_f32_16x16x32_bf16 v[244:247], a[60:63], v[104:107], v[244:247]
    s_waitcnt lgkmcnt(5)
    ds_read_b64_tr_b16 a[34:35], v6 offset:17408
    v_mfma_f32_16x16x32_bf16 v[64:67], a[0:3], a[64:67], v[112:115]
    ds_read_b64_tr_b16 a[36:37], v6 offset:16928
    v_mfma_f32_16x16x32_bf16 v[64:67], a[4:7], a[72:75], v[64:67]
    ds_read_b64_tr_b16 a[38:39], v6 offset:17440
    v_mfma_f32_16x16x32_bf16 v[64:67], a[8:11], a[80:83], v[64:67]
    buffer_load_dwordx4 v21, s[12:15], s77 offen offset:2112 lds
    v_mfma_f32_16x16x32_bf16 v[64:67], a[12:15], a[88:91], v[64:67]
    ds_read_b64_tr_b16 a[40:41], v6 offset:16960
    v_mfma_f32_16x16x32_bf16 v[72:75], a[12:15], a[92:95], v[116:119]
    ds_read_b64_tr_b16 a[42:43], v6 offset:17472
    v_mfma_f32_16x16x32_bf16 v[72:75], a[8:11], a[84:87], v[72:75]
    ds_read_b64_tr_b16 a[44:45], v6 offset:16992
    v_mfma_f32_16x16x32_bf16 v[72:75], a[4:7], a[76:79], v[72:75]
    ds_read_b64_tr_b16 a[46:47], v6 offset:17504
    v_mfma_f32_16x16x32_bf16 v[72:75], a[0:3], a[68:71], v[72:75]
    s_waitcnt lgkmcnt(6)
    buffer_load_dwordx4 v22, s[12:15], s77 offen offset:3168 lds
    v_mfma_f32_16x16x32_bf16 v[72:75], a[16:19], a[100:103], v[72:75]
    s_add_u32 s78, s75, 98304
    ds_read_b64_tr_b16 a[48:49], v6 offset:17024
    v_mfma_f32_16x16x32_bf16 v[72:75], a[20:23], a[108:111], v[72:75]
    s_add_u32 m0, s73, 118272
    ds_read_b64_tr_b16 a[50:51], v6 offset:17536
    v_mfma_f32_16x16x32_bf16 v[72:75], a[24:27], a[116:119], v[72:75]
    ds_read_b64_tr_b16 a[52:53], v6 offset:17056
    v_mfma_f32_16x16x32_bf16 v[72:75], a[28:31], a[124:127], v[72:75]
    ds_read_b64_tr_b16 a[54:55], v6 offset:17568
    v_mfma_f32_16x16x32_bf16 v[64:67], a[28:31], a[120:123], v[64:67]
    buffer_load_dwordx4 v19, s[16:19], s78 offen lds
    v_mfma_f32_16x16x32_bf16 v[64:67], a[24:27], a[112:115], v[64:67]
    ds_read_b64_tr_b16 a[56:57], v6 offset:17088
    v_mfma_f32_16x16x32_bf16 v[64:67], a[20:23], a[104:107], v[64:67]
    ds_read_b64_tr_b16 a[58:59], v6 offset:17600
    v_mfma_f32_16x16x32_bf16 v[64:67], a[16:19], a[96:99], v[64:67]
    ds_read_b64_tr_b16 a[60:61], v6 offset:17120
    v_mfma_f32_16x16x32_bf16 v[128:131], a[32:35], v[96:99], v[128:131]
    v_exp_f32 v80, v80
    v_mfma_f32_16x16x32_bf16 v[136:139], a[32:35], v[100:103], v[136:139]
    s_waitcnt lgkmcnt(5)
    ds_read_b64_tr_b16 a[62:63], v6 offset:17632
    v_mfma_f32_16x16x32_bf16 v[140:143], a[36:39], v[100:103], v[140:143]
    buffer_load_dwordx4 v20, s[16:19], s78 offen offset:1056 lds
    v_mfma_f32_16x16x32_bf16 v[132:135], a[36:39], v[96:99], v[132:135]
    v_exp_f32 v81, v81
    v_mfma_f32_16x16x32_bf16 v[144:147], a[40:43], v[96:99], v[144:147]
    ds_read_b128 a[0:3], v4 offset:512
    ds_read_b128 a[4:7], v4 offset:576
    v_mfma_f32_16x16x32_bf16 v[152:155], a[40:43], v[100:103], v[152:155]
    ds_read_b128 a[8:11], v4 offset:640
    ds_read_b128 a[12:15], v4 offset:704
    v_mfma_f32_16x16x32_bf16 v[156:159], a[44:47], v[100:103], v[156:159]
    v_exp_f32 v82, v82
    v_mfma_f32_16x16x32_bf16 v[148:151], a[44:47], v[96:99], v[148:151]
    v_exp_f32 v83, v83
    v_mfma_f32_16x16x32_bf16 v[160:163], a[48:51], v[96:99], v[160:163]
    ds_read_b128 a[16:19], v4 offset:768
    ds_read_b128 a[20:23], v4 offset:832
    v_mfma_f32_16x16x32_bf16 v[168:171], a[48:51], v[100:103], v[168:171]
    s_waitcnt lgkmcnt(6)
    buffer_load_dwordx4 v21, s[16:19], s78 offen offset:2112 lds
    v_mfma_f32_16x16x32_bf16 v[172:175], a[52:55], v[100:103], v[172:175]
    ds_read_b128 a[24:27], v4 offset:896
    ds_read_b128 a[28:31], v4 offset:960
    v_mfma_f32_16x16x32_bf16 v[164:167], a[52:55], v[96:99], v[164:167]
    ds_read_b64_tr_b16 a[32:33], v6 offset:17152
    v_cvt_pk_bf16_f32 v104, v80, v81
    v_mfma_f32_16x16x32_bf16 v[176:179], a[56:59], v[96:99], v[176:179]
    buffer_load_dwordx4 v22, s[16:19], s78 offen offset:3168 lds
    v_mfma_f32_16x16x32_bf16 v[184:187], a[56:59], v[100:103], v[184:187]
    s_add_u32 s78, s76, 3584
    ds_read_b64_tr_b16 a[34:35], v6 offset:17664
    v_cvt_pk_bf16_f32 v105, v82, v83
    v_mfma_f32_16x16x32_bf16 v[188:191], a[60:63], v[100:103], v[188:191]
    s_add_u32 m0, s72, 38016
    v_exp_f32 v88, v88
    v_mfma_f32_16x16x32_bf16 v[180:183], a[60:63], v[96:99], v[180:183]
    ds_read_b64_tr_b16 a[36:37], v6 offset:17184
    ds_read_b64_tr_b16 a[38:39], v6 offset:17696
    v_mfma_f32_16x16x32_bf16 a[240:243], a[248:251], v[96:99], a[240:243]
    v_exp_f32 v89, v89
    v_mfma_f32_16x16x32_bf16 a[244:247], a[248:251], v[100:103], a[244:247]
    s_waitcnt lgkmcnt(6)
    v_exp_f32 v90, v90
    v_mfma_f32_16x16x32_bf16 v[68:71], a[0:3], a[64:67], v[112:115]
    ds_read_b64_tr_b16 a[40:41], v6 offset:17216
    ds_read_b64_tr_b16 a[42:43], v6 offset:17728
    v_mfma_f32_16x16x32_bf16 v[68:71], a[4:7], a[72:75], v[68:71]
    buffer_load_dwordx4 v23, s[20:23], s78 offen lds
    v_mfma_f32_16x16x32_bf16 v[68:71], a[8:11], a[80:83], v[68:71]
    ds_read_b64_tr_b16 a[44:45], v6 offset:17248
    ds_read_b64_tr_b16 a[46:47], v6 offset:17760
    v_mfma_f32_16x16x32_bf16 v[68:71], a[12:15], a[88:91], v[68:71]
    v_exp_f32 v91, v91
    v_mfma_f32_16x16x32_bf16 v[76:79], a[12:15], a[92:95], v[116:119]
    ds_read_b64_tr_b16 a[48:49], v6 offset:17280
    v_cvt_pk_bf16_f32 v108, v88, v89
    v_mfma_f32_16x16x32_bf16 v[76:79], a[8:11], a[84:87], v[76:79]
    buffer_load_dwordx4 v24, s[20:23], s78 offen offset:1032 lds
    v_mfma_f32_16x16x32_bf16 v[76:79], a[4:7], a[76:79], v[76:79]
    ds_read_b64_tr_b16 a[50:51], v6 offset:17792
    ds_read_b64_tr_b16 a[52:53], v6 offset:17312
    v_mfma_f32_16x16x32_bf16 v[76:79], a[0:3], a[68:71], v[76:79]
    ds_read_b64_tr_b16 a[54:55], v6 offset:17824
    v_cvt_pk_bf16_f32 v109, v90, v91
    v_mfma_f32_16x16x32_bf16 v[76:79], a[16:19], a[100:103], v[76:79]
    v_exp_f32 v84, v84
    v_mfma_f32_16x16x32_bf16 v[76:79], a[20:23], a[108:111], v[76:79]
    s_waitcnt lgkmcnt(6)
    v_exp_f32 v85, v85
    v_mfma_f32_16x16x32_bf16 v[76:79], a[24:27], a[116:119], v[76:79]
    ds_read_b64_tr_b16 a[56:57], v6 offset:17344
    ds_read_b64_tr_b16 a[58:59], v6 offset:17856
    v_mfma_f32_16x16x32_bf16 v[76:79], a[28:31], a[124:127], v[76:79]
    buffer_load_dwordx4 v25, s[20:23], s78 offen offset:2112 lds
    v_mfma_f32_16x16x32_bf16 v[68:71], a[28:31], a[120:123], v[68:71]
    ds_read_b64_tr_b16 a[60:61], v6 offset:17376
    ds_read_b64_tr_b16 a[62:63], v6 offset:17888
    v_mfma_f32_16x16x32_bf16 v[68:71], a[24:27], a[112:115], v[68:71]
    v_exp_f32 v86, v86
    v_mfma_f32_16x16x32_bf16 v[68:71], a[20:23], a[104:107], v[68:71]
    v_exp_f32 v87, v87
    v_mfma_f32_16x16x32_bf16 v[68:71], a[16:19], a[96:99], v[68:71]
    buffer_load_dwordx4 v26, s[20:23], s78 offen offset:3144 lds
    v_mfma_f32_16x16x32_bf16 v[192:195], a[32:35], v[96:99], v[192:195]
    v_cvt_pk_bf16_f32 v106, v84, v85
    v_cvt_pk_bf16_f32 v107, v86, v87
    v_mfma_f32_16x16x32_bf16 v[200:203], a[32:35], v[100:103], v[200:203]
    s_add_u32 s65, s100, 196608
    buffer_load_dword v59, v31, s[16:19], s65 offen
    v_mfma_f32_16x16x32_bf16 v[204:207], a[36:39], v[100:103], v[204:207]
    v_exp_f32 v92, v92
    v_mfma_f32_16x16x32_bf16 v[196:199], a[36:39], v[96:99], v[196:199]
    s_waitcnt vmcnt(18) lgkmcnt(0)
    s_barrier
    ds_read_b128 a[0:3], v5 offset:0
    v_mfma_f32_16x16x32_bf16 v[208:211], a[40:43], v[96:99], v[208:211]
    s_add_u32 s77, s75, 147456
    ds_read_b128 a[4:7], v5 offset:64
    v_mfma_f32_16x16x32_bf16 v[216:219], a[40:43], v[100:103], v[216:219]
    s_add_u32 m0, s73, 0
    v_exp_f32 v93, v93
    v_mfma_f32_16x16x32_bf16 v[220:223], a[44:47], v[100:103], v[220:223]
    ds_read_b128 a[8:11], v5 offset:128
    v_mfma_f32_16x16x32_bf16 v[212:215], a[44:47], v[96:99], v[212:215]
    ds_read_b128 a[12:15], v5 offset:192
    v_mfma_f32_16x16x32_bf16 v[224:227], a[48:51], v[96:99], v[224:227]
    v_exp_f32 v94, v94
    v_mfma_f32_16x16x32_bf16 v[232:235], a[48:51], v[100:103], v[232:235]
    buffer_load_dwordx4 v19, s[12:15], s77 offen lds
    v_mfma_f32_16x16x32_bf16 v[236:239], a[52:55], v[100:103], v[236:239]
    ds_read_b128 a[16:19], v5 offset:256
    ds_read_b128 a[20:23], v5 offset:320
    v_mfma_f32_16x16x32_bf16 v[228:231], a[52:55], v[96:99], v[228:231]
    v_exp_f32 v95, v95
    v_mfma_f32_16x16x32_bf16 v[240:243], a[56:59], v[96:99], v[240:243]
    ds_read_b128 a[24:27], v5 offset:384
    ds_read_b128 a[28:31], v5 offset:448
    v_mfma_f32_16x16x32_bf16 v[248:251], a[56:59], v[100:103], v[248:251]
    ds_read_b64_tr_b16 a[32:33], v7 offset:16896
    v_cvt_pk_bf16_f32 v110, v92, v93
    v_mfma_f32_16x16x32_bf16 v[252:255], a[60:63], v[100:103], v[252:255]
    ds_read_b64_tr_b16 a[34:35], v7 offset:17408
    v_cvt_pk_bf16_f32 v111, v94, v95
    v_mfma_f32_16x16x32_bf16 v[244:247], a[60:63], v[96:99], v[244:247]
    s_waitcnt lgkmcnt(6)
    ds_read_b64_tr_b16 a[36:37], v7 offset:16928
    v_mfma_f32_16x16x32_bf16 v[80:83], a[0:3], a[64:67], v[112:115]
    buffer_load_dwordx4 v20, s[12:15], s77 offen offset:1056 lds
    v_mfma_f32_16x16x32_bf16 v[80:83], a[4:7], a[72:75], v[80:83]
    ds_read_b64_tr_b16 a[38:39], v7 offset:17440
    v_mfma_f32_16x16x32_bf16 v[80:83], a[8:11], a[80:83], v[80:83]
    ds_read_b64_tr_b16 a[40:41], v7 offset:16960
    v_mfma_f32_16x16x32_bf16 v[80:83], a[12:15], a[88:91], v[80:83]
    ds_read_b64_tr_b16 a[42:43], v7 offset:17472
    v_mfma_f32_16x16x32_bf16 v[88:91], a[12:15], a[92:95], v[116:119]
    ds_read_b64_tr_b16 a[44:45], v7 offset:16992
    v_mfma_f32_16x16x32_bf16 v[88:91], a[8:11], a[84:87], v[88:91]
    ds_read_b64_tr_b16 a[46:47], v7 offset:17504
    v_mfma_f32_16x16x32_bf16 v[88:91], a[4:7], a[76:79], v[88:91]
    v_mfma_f32_16x16x32_bf16 v[88:91], a[0:3], a[68:71], v[88:91]
    s_waitcnt lgkmcnt(5)
    ds_read_b64_tr_b16 a[48:49], v7 offset:17024
    v_mfma_f32_16x16x32_bf16 v[88:91], a[16:19], a[100:103], v[88:91]
    buffer_load_dwordx4 v21, s[12:15], s77 offen offset:2112 lds
    v_mfma_f32_16x16x32_bf16 v[88:91], a[20:23], a[108:111], v[88:91]
    ds_read_b64_tr_b16 a[50:51], v7 offset:17536
    v_mfma_f32_16x16x32_bf16 v[88:91], a[24:27], a[116:119], v[88:91]
    ds_read_b64_tr_b16 a[52:53], v7 offset:17056
    v_mfma_f32_16x16x32_bf16 v[88:91], a[28:31], a[124:127], v[88:91]
    ds_read_b64_tr_b16 a[54:55], v7 offset:17568
    v_mfma_f32_16x16x32_bf16 v[80:83], a[28:31], a[120:123], v[80:83]
    ds_read_b64_tr_b16 a[56:57], v7 offset:17088
    v_mfma_f32_16x16x32_bf16 v[80:83], a[24:27], a[112:115], v[80:83]
    ds_read_b64_tr_b16 a[58:59], v7 offset:17600
    v_mfma_f32_16x16x32_bf16 v[80:83], a[20:23], a[104:107], v[80:83]
    ds_read_b64_tr_b16 a[60:61], v7 offset:17120
    v_mfma_f32_16x16x32_bf16 v[80:83], a[16:19], a[96:99], v[80:83]
    v_exp_f32 v64, v64
    v_mfma_f32_16x16x32_bf16 v[128:131], a[32:35], v[104:107], v[128:131]
    ds_read_b64_tr_b16 a[62:63], v7 offset:17632
    v_mfma_f32_16x16x32_bf16 v[136:139], a[32:35], v[108:111], v[136:139]
    s_waitcnt lgkmcnt(6)
    buffer_load_dwordx4 v22, s[12:15], s77 offen offset:3168 lds
    v_mfma_f32_16x16x32_bf16 v[140:143], a[36:39], v[108:111], v[140:143]
    v_exp_f32 v65, v65
    v_mfma_f32_16x16x32_bf16 v[132:135], a[36:39], v[104:107], v[132:135]
    s_add_u32 s78, s75, 114688
    ds_read_b128 a[0:3], v5 offset:512
    ds_read_b128 a[4:7], v5 offset:576
    v_mfma_f32_16x16x32_bf16 v[144:147], a[40:43], v[104:107], v[144:147]
    s_add_u32 m0, s73, 16896
    ds_read_b128 a[8:11], v5 offset:640
    v_mfma_f32_16x16x32_bf16 v[152:155], a[40:43], v[108:111], v[152:155]
    v_exp_f32 v66, v66
    v_mfma_f32_16x16x32_bf16 v[156:159], a[44:47], v[108:111], v[156:159]
    ds_read_b128 a[12:15], v5 offset:704
    v_mfma_f32_16x16x32_bf16 v[148:151], a[44:47], v[104:107], v[148:151]
    v_exp_f32 v67, v67
    v_mfma_f32_16x16x32_bf16 v[160:163], a[48:51], v[104:107], v[160:163]
    ds_read_b128 a[16:19], v5 offset:768
    ds_read_b128 a[20:23], v5 offset:832
    v_mfma_f32_16x16x32_bf16 v[168:171], a[48:51], v[108:111], v[168:171]
    s_waitcnt lgkmcnt(6)
    buffer_load_dwordx4 v19, s[16:19], s78 offen lds
    v_mfma_f32_16x16x32_bf16 v[172:175], a[52:55], v[108:111], v[172:175]
    ds_read_b128 a[24:27], v5 offset:896
    ds_read_b128 a[28:31], v5 offset:960
    v_mfma_f32_16x16x32_bf16 v[164:167], a[52:55], v[104:107], v[164:167]
    ds_read_b64_tr_b16 a[32:33], v7 offset:17152
    v_cvt_pk_bf16_f32 v96, v64, v65
    v_mfma_f32_16x16x32_bf16 v[176:179], a[56:59], v[104:107], v[176:179]
    ds_read_b64_tr_b16 a[34:35], v7 offset:17664
    v_cvt_pk_bf16_f32 v97, v66, v67
    v_mfma_f32_16x16x32_bf16 v[184:187], a[56:59], v[108:111], v[184:187]
    v_exp_f32 v72, v72
    v_mfma_f32_16x16x32_bf16 v[188:191], a[60:63], v[108:111], v[188:191]
    ds_read_b64_tr_b16 a[36:37], v7 offset:17184
    v_mfma_f32_16x16x32_bf16 v[180:183], a[60:63], v[104:107], v[180:183]
    v_exp_f32 v73, v73
    v_mfma_f32_16x16x32_bf16 a[240:243], a[248:251], v[104:107], a[240:243]
    ds_read_b64_tr_b16 a[38:39], v7 offset:17696
    v_mfma_f32_16x16x32_bf16 a[244:247], a[248:251], v[108:111], a[244:247]
    s_waitcnt lgkmcnt(6)
    buffer_load_dwordx4 v20, s[16:19], s78 offen offset:1056 lds
    v_mfma_f32_16x16x32_bf16 v[84:87], a[0:3], a[64:67], v[112:115]
    v_exp_f32 v74, v74
    v_mfma_f32_16x16x32_bf16 v[84:87], a[4:7], a[72:75], v[84:87]
    ds_read_b64_tr_b16 a[40:41], v7 offset:17216
    ds_read_b64_tr_b16 a[42:43], v7 offset:17728
    v_mfma_f32_16x16x32_bf16 v[84:87], a[8:11], a[80:83], v[84:87]
    ds_read_b64_tr_b16 a[44:45], v7 offset:17248
    ds_read_b64_tr_b16 a[46:47], v7 offset:17760
    v_mfma_f32_16x16x32_bf16 v[84:87], a[12:15], a[88:91], v[84:87]
    v_exp_f32 v75, v75
    v_mfma_f32_16x16x32_bf16 v[92:95], a[12:15], a[92:95], v[116:119]
    ds_read_b64_tr_b16 a[48:49], v7 offset:17280
    v_cvt_pk_bf16_f32 v100, v72, v73
    v_mfma_f32_16x16x32_bf16 v[92:95], a[8:11], a[84:87], v[92:95]
    ds_read_b64_tr_b16 a[50:51], v7 offset:17792
    v_cvt_pk_bf16_f32 v101, v74, v75
    v_mfma_f32_16x16x32_bf16 v[92:95], a[4:7], a[76:79], v[92:95]
    ds_read_b64_tr_b16 a[52:53], v7 offset:17312
    v_mfma_f32_16x16x32_bf16 v[92:95], a[0:3], a[68:71], v[92:95]
    buffer_load_dwordx4 v21, s[16:19], s78 offen offset:2112 lds
    v_mfma_f32_16x16x32_bf16 v[92:95], a[16:19], a[100:103], v[92:95]
    v_exp_f32 v68, v68
    v_mfma_f32_16x16x32_bf16 v[92:95], a[20:23], a[108:111], v[92:95]
    s_waitcnt lgkmcnt(5)
    ds_read_b64_tr_b16 a[54:55], v7 offset:17824
    ds_read_b64_tr_b16 a[56:57], v7 offset:17344
    v_mfma_f32_16x16x32_bf16 v[92:95], a[24:27], a[116:119], v[92:95]
    v_exp_f32 v69, v69
    v_mfma_f32_16x16x32_bf16 v[92:95], a[28:31], a[124:127], v[92:95]
    ds_read_b64_tr_b16 a[58:59], v7 offset:17856
    ds_read_b64_tr_b16 a[60:61], v7 offset:17376
    v_mfma_f32_16x16x32_bf16 v[84:87], a[28:31], a[120:123], v[84:87]
    v_exp_f32 v70, v70
    v_mfma_f32_16x16x32_bf16 v[84:87], a[24:27], a[112:115], v[84:87]
    ds_read_b64_tr_b16 a[62:63], v7 offset:17888
    v_mfma_f32_16x16x32_bf16 v[84:87], a[20:23], a[104:107], v[84:87]
    v_exp_f32 v71, v71
    v_mfma_f32_16x16x32_bf16 v[84:87], a[16:19], a[96:99], v[84:87]
    buffer_load_dwordx4 v22, s[16:19], s78 offen offset:3168 lds
    v_mfma_f32_16x16x32_bf16 v[192:195], a[32:35], v[104:107], v[192:195]
    v_cvt_pk_bf16_f32 v98, v68, v69
    v_cvt_pk_bf16_f32 v99, v70, v71
    v_mfma_f32_16x16x32_bf16 v[200:203], a[32:35], v[108:111], v[200:203]
    buffer_load_dword v59, v62, s[40:43], s48 offen
    v_mfma_f32_16x16x32_bf16 v[204:207], a[36:39], v[108:111], v[204:207]
    buffer_load_dwordx4 v[32:35], off, s[28:31], s67 sc1
    v_mfma_f32_16x16x32_bf16 v[196:199], a[36:39], v[104:107], v[196:199]
    s_waitcnt vmcnt(11) lgkmcnt(0)
    s_barrier
    ds_read_b128 a[0:3], v5 offset:33792
    v_mfma_f32_16x16x32_bf16 v[208:211], a[40:43], v[104:107], v[208:211]
    s_add_u32 s77, s75, 163840
    v_exp_f32 v76, v76
    v_mfma_f32_16x16x32_bf16 v[216:219], a[40:43], v[108:111], v[216:219]
    s_add_u32 m0, s73, 67584
    ds_read_b64_tr_b16 a[128:129], v12 offset:33792
    ds_read_b128 a[4:7], v5 offset:33856
    v_mfma_f32_16x16x32_bf16 v[220:223], a[44:47], v[108:111], v[220:223]
    v_exp_f32 v77, v77
    v_mfma_f32_16x16x32_bf16 v[212:215], a[44:47], v[104:107], v[212:215]
    ds_read_b128 a[8:11], v5 offset:33920
    ds_read_b128 a[12:15], v5 offset:33984
    v_mfma_f32_16x16x32_bf16 v[224:227], a[48:51], v[104:107], v[224:227]
    ds_read_b64_tr_b16 a[130:131], v12 offset:34048
    v_mfma_f32_16x16x32_bf16 v[232:235], a[48:51], v[108:111], v[232:235]
    v_exp_f32 v78, v78
    v_mfma_f32_16x16x32_bf16 v[236:239], a[52:55], v[108:111], v[236:239]
    buffer_load_dwordx4 v19, s[12:15], s77 offen lds
    v_mfma_f32_16x16x32_bf16 v[228:231], a[52:55], v[104:107], v[228:231]
    ds_read_b128 a[16:19], v5 offset:34048
    ds_read_b128 a[20:23], v5 offset:34112
    v_mfma_f32_16x16x32_bf16 v[240:243], a[56:59], v[104:107], v[240:243]
    v_exp_f32 v79, v79
    v_mfma_f32_16x16x32_bf16 v[248:251], a[56:59], v[108:111], v[248:251]
    ds_read_b128 a[24:27], v5 offset:34176
    ds_read_b64_tr_b16 a[132:133], v12 offset:34304
    v_mfma_f32_16x16x32_bf16 v[252:255], a[60:63], v[108:111], v[252:255]
    ds_read_b128 a[28:31], v5 offset:34240
    v_cvt_pk_bf16_f32 v102, v76, v77
    v_cvt_pk_bf16_f32 v103, v78, v79
    v_mfma_f32_16x16x32_bf16 v[244:247], a[60:63], v[104:107], v[244:247]
    s_waitcnt lgkmcnt(6)
    ds_read_b64_tr_b16 a[32:33], v7 offset:50688
    ds_read_b64_tr_b16 a[34:35], v7 offset:51200
    v_mfma_f32_16x16x32_bf16 v[64:67], a[0:3], a[64:67], v[112:115]
    ds_read_b64_tr_b16 a[134:135], v12 offset:34560
    ds_read_b64_tr_b16 a[36:37], v7 offset:50720
    v_mfma_f32_16x16x32_bf16 v[64:67], a[4:7], a[72:75], v[64:67]
    buffer_load_dwordx4 v20, s[12:15], s77 offen offset:1056 lds
    v_mfma_f32_16x16x32_bf16 v[64:67], a[8:11], a[80:83], v[64:67]
    ds_read_b64_tr_b16 a[38:39], v7 offset:51232
    v_mfma_f32_16x16x32_bf16 v[64:67], a[12:15], a[88:91], v[64:67]
    ds_read_b64_tr_b16 a[40:41], v7 offset:50752
    ds_read_b64_tr_b16 a[136:137], v12 offset:33800
    v_mfma_f32_16x16x32_bf16 v[72:75], a[12:15], a[92:95], v[116:119]
    ds_read_b64_tr_b16 a[42:43], v7 offset:51264
    v_mfma_f32_16x16x32_bf16 v[72:75], a[8:11], a[84:87], v[72:75]
    ds_read_b64_tr_b16 a[44:45], v7 offset:50784
    v_mfma_f32_16x16x32_bf16 v[72:75], a[4:7], a[76:79], v[72:75]
    ds_read_b64_tr_b16 a[46:47], v7 offset:51296
    v_mfma_f32_16x16x32_bf16 v[72:75], a[0:3], a[68:71], v[72:75]
    s_waitcnt lgkmcnt(8)
    ds_read_b64_tr_b16 a[138:139], v12 offset:34056
    v_mfma_f32_16x16x32_bf16 v[72:75], a[16:19], a[100:103], v[72:75]
    ds_read_b64_tr_b16 a[48:49], v7 offset:50816
    v_mfma_f32_16x16x32_bf16 v[72:75], a[20:23], a[108:111], v[72:75]
    buffer_load_dwordx4 v21, s[12:15], s77 offen offset:2112 lds
    v_mfma_f32_16x16x32_bf16 v[72:75], a[24:27], a[116:119], v[72:75]
    ds_read_b64_tr_b16 a[50:51], v7 offset:51328
    ds_read_b64_tr_b16 a[52:53], v7 offset:50848
    v_mfma_f32_16x16x32_bf16 v[72:75], a[28:31], a[124:127], v[72:75]
    ds_read_b64_tr_b16 a[54:55], v7 offset:51360
    ds_read_b64_tr_b16 a[140:141], v12 offset:34312
    v_mfma_f32_16x16x32_bf16 v[64:67], a[28:31], a[120:123], v[64:67]
    ds_read_b64_tr_b16 a[56:57], v7 offset:50880
    v_mfma_f32_16x16x32_bf16 v[64:67], a[24:27], a[112:115], v[64:67]
    ds_read_b64_tr_b16 a[58:59], v7 offset:51392
    v_mfma_f32_16x16x32_bf16 v[64:67], a[20:23], a[104:107], v[64:67]
    ds_read_b64_tr_b16 a[60:61], v7 offset:50912
    v_mfma_f32_16x16x32_bf16 v[64:67], a[16:19], a[96:99], v[64:67]
    ds_read_b64_tr_b16 a[142:143], v12 offset:34568
    v_mfma_f32_16x16x32_bf16 v[128:131], a[32:35], v[96:99], v[128:131]
    v_exp_f32 v80, v80
    v_mfma_f32_16x16x32_bf16 v[136:139], a[32:35], v[100:103], v[136:139]
    s_waitcnt lgkmcnt(8)
    ds_read_b64_tr_b16 a[62:63], v7 offset:51424
    v_mfma_f32_16x16x32_bf16 v[140:143], a[36:39], v[100:103], v[140:143]
    buffer_load_dwordx4 v22, s[12:15], s77 offen offset:3168 lds
    v_mfma_f32_16x16x32_bf16 v[132:135], a[36:39], v[96:99], v[132:135]
    s_add_u32 s78, s75, 131072
    v_exp_f32 v81, v81
    v_mfma_f32_16x16x32_bf16 v[144:147], a[40:43], v[96:99], v[144:147]
    s_add_u32 m0, s73, 84480
    ds_read_b128 a[0:3], v5 offset:34304
    ds_read_b128 a[4:7], v5 offset:34368
    v_mfma_f32_16x16x32_bf16 v[152:155], a[40:43], v[100:103], v[152:155]
    ds_read_b64_tr_b16 a[144:145], v8 offset:33792
    ds_read_b128 a[8:11], v5 offset:34432
    v_mfma_f32_16x16x32_bf16 v[156:159], a[44:47], v[100:103], v[156:159]
    v_exp_f32 v82, v82
    v_mfma_f32_16x16x32_bf16 v[148:151], a[44:47], v[96:99], v[148:151]
    s_waitcnt lgkmcnt(5)
    ds_read_b128 a[12:15], v5 offset:34496
    ds_read_b128 a[16:19], v5 offset:34560
    v_mfma_f32_16x16x32_bf16 v[160:163], a[48:51], v[96:99], v[160:163]
    v_exp_f32 v83, v83
    v_mfma_f32_16x16x32_bf16 v[168:171], a[48:51], v[100:103], v[168:171]
    ds_read_b64_tr_b16 a[146:147], v8 offset:34048
    ds_read_b128 a[20:23], v5 offset:34624
    v_mfma_f32_16x16x32_bf16 v[172:175], a[52:55], v[100:103], v[172:175]
    buffer_load_dwordx4 v19, s[16:19], s78 offen lds
    v_mfma_f32_16x16x32_bf16 v[164:167], a[52:55], v[96:99], v[164:167]
    ds_read_b128 a[24:27], v5 offset:34688
    ds_read_b128 a[28:31], v5 offset:34752
    v_mfma_f32_16x16x32_bf16 v[176:179], a[56:59], v[96:99], v[176:179]
    ds_read_b64_tr_b16 a[148:149], v8 offset:34304
    ds_read_b64_tr_b16 a[32:33], v7 offset:50944
    v_cvt_pk_bf16_f32 v104, v80, v81
    v_mfma_f32_16x16x32_bf16 v[184:187], a[56:59], v[100:103], v[184:187]
    s_waitcnt lgkmcnt(8)
    ds_read_b64_tr_b16 a[34:35], v7 offset:51456
    v_cvt_pk_bf16_f32 v105, v82, v83
    v_mfma_f32_16x16x32_bf16 v[188:191], a[60:63], v[100:103], v[188:191]
    v_exp_f32 v88, v88
    v_mfma_f32_16x16x32_bf16 v[180:183], a[60:63], v[96:99], v[180:183]
    ds_read_b64_tr_b16 a[36:37], v7 offset:50976
    ds_read_b64_tr_b16 a[38:39], v7 offset:51488
    v_mfma_f32_16x16x32_bf16 a[240:243], a[248:251], v[96:99], a[240:243]
    v_exp_f32 v89, v89
    v_mfma_f32_16x16x32_bf16 a[244:247], a[248:251], v[100:103], a[244:247]
    ds_read_b64_tr_b16 a[150:151], v8 offset:34560
    ds_read_b64_tr_b16 a[40:41], v7 offset:51008
    v_mfma_f32_16x16x32_bf16 v[68:71], a[0:3], a[64:67], v[112:115]
    buffer_load_dwordx4 v20, s[16:19], s78 offen offset:1056 lds
    v_mfma_f32_16x16x32_bf16 v[68:71], a[4:7], a[72:75], v[68:71]
    v_exp_f32 v90, v90
    v_mfma_f32_16x16x32_bf16 v[68:71], a[8:11], a[80:83], v[68:71]
    s_waitcnt lgkmcnt(5)
    ds_read_b64_tr_b16 a[42:43], v7 offset:51520
    ds_read_b64_tr_b16 a[44:45], v7 offset:51040
    v_mfma_f32_16x16x32_bf16 v[68:71], a[12:15], a[88:91], v[68:71]
    ds_read_b64_tr_b16 a[152:153], v8 offset:33800
    ds_read_b64_tr_b16 a[46:47], v7 offset:51552
    v_mfma_f32_16x16x32_bf16 v[76:79], a[12:15], a[92:95], v[116:119]
    v_exp_f32 v91, v91
    v_mfma_f32_16x16x32_bf16 v[76:79], a[8:11], a[84:87], v[76:79]
    ds_read_b64_tr_b16 a[48:49], v7 offset:51072
    ds_read_b64_tr_b16 a[50:51], v7 offset:51584
    v_mfma_f32_16x16x32_bf16 v[76:79], a[4:7], a[76:79], v[76:79]
    ds_read_b64_tr_b16 a[154:155], v8 offset:34056
    ds_read_b64_tr_b16 a[52:53], v7 offset:51104
    v_cvt_pk_bf16_f32 v108, v88, v89
    v_mfma_f32_16x16x32_bf16 v[76:79], a[0:3], a[68:71], v[76:79]
    buffer_load_dwordx4 v21, s[16:19], s78 offen offset:2112 lds
    v_cvt_pk_bf16_f32 v109, v90, v91
    v_mfma_f32_16x16x32_bf16 v[76:79], a[16:19], a[100:103], v[76:79]
    v_exp_f32 v84, v84
    v_mfma_f32_16x16x32_bf16 v[76:79], a[20:23], a[108:111], v[76:79]
    ds_read_b64_tr_b16 a[54:55], v7 offset:51616
    ds_read_b64_tr_b16 a[56:57], v7 offset:51136
    v_mfma_f32_16x16x32_bf16 v[76:79], a[24:27], a[116:119], v[76:79]
    v_exp_f32 v85, v85
    v_mfma_f32_16x16x32_bf16 v[76:79], a[28:31], a[124:127], v[76:79]
    ds_read_b64_tr_b16 a[156:157], v8 offset:34312
    ds_read_b64_tr_b16 a[58:59], v7 offset:51648
    v_mfma_f32_16x16x32_bf16 v[68:71], a[28:31], a[120:123], v[68:71]
    ds_read_b64_tr_b16 a[60:61], v7 offset:51168
    ds_read_b64_tr_b16 a[62:63], v7 offset:51680
    v_mfma_f32_16x16x32_bf16 v[68:71], a[24:27], a[112:115], v[68:71]
    v_exp_f32 v86, v86
    v_mfma_f32_16x16x32_bf16 v[68:71], a[20:23], a[104:107], v[68:71]
    ds_read_b64_tr_b16 a[158:159], v8 offset:34568
    v_mfma_f32_16x16x32_bf16 v[68:71], a[16:19], a[96:99], v[68:71]
    s_waitcnt lgkmcnt(7)
    v_exp_f32 v87, v87
    v_mfma_f32_16x16x32_bf16 v[192:195], a[32:35], v[96:99], v[192:195]
    buffer_load_dwordx4 v22, s[16:19], s78 offen offset:3168 lds
    v_mfma_f32_16x16x32_bf16 v[200:203], a[32:35], v[100:103], v[200:203]
    ds_read_b64_tr_b16 a[160:161], v12 offset:42240
    v_cvt_pk_bf16_f32 v106, v84, v85
    v_mfma_f32_16x16x32_bf16 v[204:207], a[36:39], v[100:103], v[204:207]
    buffer_load_dwordx4 v[28:31], v52, s[28:31], s64 offen sc1
    buffer_load_dwordx4 v[124:127], v52, s[28:31], s64 offen offset:16 sc1
    v_mfma_f32_16x16x32_bf16 v[196:199], a[36:39], v[96:99], v[196:199]
    s_waitcnt vmcnt(12) lgkmcnt(2)
    s_barrier
    ds_read_b128 a[0:3], v4 offset:0
    v_mfma_f32_16x16x32_bf16 v[208:211], a[40:43], v[96:99], v[208:211]
    s_add_u32 s77, s75, 180224
    ds_read_b64_tr_b16 a[162:163], v12 offset:42496
    v_cvt_pk_bf16_f32 v107, v86, v87
    v_mfma_f32_16x16x32_bf16 v[216:219], a[40:43], v[100:103], v[216:219]
    s_add_u32 m0, s73, 101376
    v_exp_f32 v92, v92
    v_mfma_f32_16x16x32_bf16 v[220:223], a[44:47], v[100:103], v[220:223]
    ds_read_b128 a[4:7], v4 offset:64
    ds_read_b128 a[8:11], v4 offset:128
    v_mfma_f32_16x16x32_bf16 v[212:215], a[44:47], v[96:99], v[212:215]
    v_exp_f32 v93, v93
    v_mfma_f32_16x16x32_bf16 v[224:227], a[48:51], v[96:99], v[224:227]
    ds_read_b128 a[12:15], v4 offset:192
    ds_read_b64_tr_b16 a[164:165], v12 offset:42752
    v_mfma_f32_16x16x32_bf16 v[232:235], a[48:51], v[100:103], v[232:235]
    v_exp_f32 v94, v94
    v_mfma_f32_16x16x32_bf16 v[236:239], a[52:55], v[100:103], v[236:239]
    buffer_load_dwordx4 v19, s[12:15], s77 offen lds
    v_mfma_f32_16x16x32_bf16 v[228:231], a[52:55], v[96:99], v[228:231]
    ds_read_b128 a[16:19], v4 offset:256
    ds_read_b128 a[20:23], v4 offset:320
    v_mfma_f32_16x16x32_bf16 v[240:243], a[56:59], v[96:99], v[240:243]
    v_exp_f32 v95, v95
    v_mfma_f32_16x16x32_bf16 v[248:251], a[56:59], v[100:103], v[248:251]
    ds_read_b128 a[24:27], v4 offset:384
    ds_read_b128 a[28:31], v4 offset:448
    v_mfma_f32_16x16x32_bf16 v[252:255], a[60:63], v[100:103], v[252:255]
    ds_read_b64_tr_b16 a[166:167], v12 offset:43008
    v_cvt_pk_bf16_f32 v110, v92, v93
    v_cvt_pk_bf16_f32 v111, v94, v95
    v_mfma_f32_16x16x32_bf16 v[244:247], a[60:63], v[96:99], v[244:247]
    s_waitcnt lgkmcnt(7)
    ds_read_b64_tr_b16 a[32:33], v6 offset:16896
    ds_read_b64_tr_b16 a[34:35], v6 offset:17408
    v_mfma_f32_16x16x32_bf16 v[80:83], a[0:3], a[64:67], v[112:115]
    ds_read_b64_tr_b16 a[36:37], v6 offset:16928
    ds_read_b64_tr_b16 a[168:169], v12 offset:42248
    v_mfma_f32_16x16x32_bf16 v[80:83], a[4:7], a[72:75], v[80:83]
    buffer_load_dwordx4 v20, s[12:15], s77 offen offset:1056 lds
    v_mfma_f32_16x16x32_bf16 v[80:83], a[8:11], a[80:83], v[80:83]
    s_waitcnt lgkmcnt(9)
    ds_read_b64_tr_b16 a[38:39], v6 offset:17440
    v_mfma_f32_16x16x32_bf16 v[80:83], a[12:15], a[88:91], v[80:83]
    ds_read_b64_tr_b16 a[40:41], v6 offset:16960
    v_mfma_f32_16x16x32_bf16 v[88:91], a[12:15], a[92:95], v[116:119]
    ds_read_b64_tr_b16 a[42:43], v6 offset:17472
    ds_read_b64_tr_b16 a[170:171], v12 offset:42504
    v_mfma_f32_16x16x32_bf16 v[88:91], a[8:11], a[84:87], v[88:91]
    ds_read_b64_tr_b16 a[44:45], v6 offset:16992
    v_mfma_f32_16x16x32_bf16 v[88:91], a[4:7], a[76:79], v[88:91]
    ds_read_b64_tr_b16 a[46:47], v6 offset:17504
    v_mfma_f32_16x16x32_bf16 v[88:91], a[0:3], a[68:71], v[88:91]
    s_waitcnt lgkmcnt(8)
    ds_read_b64_tr_b16 a[48:49], v6 offset:17024
    v_mfma_f32_16x16x32_bf16 v[88:91], a[16:19], a[100:103], v[88:91]
    ds_read_b64_tr_b16 a[172:173], v12 offset:42760
    v_mfma_f32_16x16x32_bf16 v[88:91], a[20:23], a[108:111], v[88:91]
    buffer_load_dwordx4 v21, s[12:15], s77 offen offset:2112 lds
    v_mfma_f32_16x16x32_bf16 v[88:91], a[24:27], a[116:119], v[88:91]
    ds_read_b64_tr_b16 a[50:51], v6 offset:17536
    ds_read_b64_tr_b16 a[52:53], v6 offset:17056
    v_mfma_f32_16x16x32_bf16 v[88:91], a[28:31], a[124:127], v[88:91]
    ds_read_b64_tr_b16 a[54:55], v6 offset:17568
    v_mfma_f32_16x16x32_bf16 v[80:83], a[28:31], a[120:123], v[80:83]
    ds_read_b64_tr_b16 a[174:175], v12 offset:43016
L_hop0_6:
    s_cbranch_execz L_hop0_10
    v_mfma_f32_16x16x32_bf16 v[80:83], a[24:27], a[112:115], v[80:83]
    ds_read_b64_tr_b16 a[56:57], v6 offset:17088
    v_mfma_f32_16x16x32_bf16 v[80:83], a[20:23], a[104:107], v[80:83]
    ds_read_b64_tr_b16 a[58:59], v6 offset:17600
    v_mfma_f32_16x16x32_bf16 v[80:83], a[16:19], a[96:99], v[80:83]
    ds_read_b64_tr_b16 a[60:61], v6 offset:17120
    v_mfma_f32_16x16x32_bf16 v[128:131], a[32:35], v[104:107], v[128:131]
    v_exp_f32 v64, v64
    v_mfma_f32_16x16x32_bf16 v[136:139], a[32:35], v[108:111], v[136:139]
    s_waitcnt lgkmcnt(7)
    ds_read_b64_tr_b16 a[62:63], v6 offset:17632
    ds_read_b64_tr_b16 a[176:177], v8 offset:42240
    v_mfma_f32_16x16x32_bf16 v[140:143], a[36:39], v[108:111], v[140:143]
    buffer_load_dwordx4 v22, s[12:15], s77 offen offset:3168 lds
    v_mfma_f32_16x16x32_bf16 v[132:135], a[36:39], v[104:107], v[132:135]
    s_add_u32 s78, s75, 147456
    v_exp_f32 v65, v65
    v_mfma_f32_16x16x32_bf16 v[144:147], a[40:43], v[104:107], v[144:147]
    s_add_u32 m0, s73, 118272
    ds_read_b128 a[0:3], v4 offset:512
    ds_read_b128 a[4:7], v4 offset:576
    v_mfma_f32_16x16x32_bf16 v[152:155], a[40:43], v[108:111], v[152:155]
    ds_read_b128 a[8:11], v4 offset:640
    ds_read_b64_tr_b16 a[178:179], v8 offset:42496
    v_mfma_f32_16x16x32_bf16 v[156:159], a[44:47], v[108:111], v[156:159]
    v_exp_f32 v66, v66
    v_mfma_f32_16x16x32_bf16 v[148:151], a[44:47], v[104:107], v[148:151]
    s_waitcnt lgkmcnt(6)
    ds_read_b128 a[12:15], v4 offset:704
    ds_read_b128 a[16:19], v4 offset:768
    v_mfma_f32_16x16x32_bf16 v[160:163], a[48:51], v[104:107], v[160:163]
    v_exp_f32 v67, v67
    v_mfma_f32_16x16x32_bf16 v[168:171], a[48:51], v[108:111], v[168:171]
    ds_read_b128 a[20:23], v4 offset:832
    ds_read_b64_tr_b16 a[180:181], v8 offset:42752
    v_mfma_f32_16x16x32_bf16 v[172:175], a[52:55], v[108:111], v[172:175]
    buffer_load_dwordx4 v19, s[16:19], s78 offen lds
    v_mfma_f32_16x16x32_bf16 v[164:167], a[52:55], v[104:107], v[164:167]
    ds_read_b128 a[24:27], v4 offset:896
    ds_read_b128 a[28:31], v4 offset:960
    v_mfma_f32_16x16x32_bf16 v[176:179], a[56:59], v[104:107], v[176:179]
    ds_read_b64_tr_b16 a[32:33], v6 offset:17152
    ds_read_b64_tr_b16 a[182:183], v8 offset:43008
    v_cvt_pk_bf16_f32 v96, v64, v65
    v_mfma_f32_16x16x32_bf16 v[184:187], a[56:59], v[108:111], v[184:187]
    s_waitcnt lgkmcnt(8)
    ds_read_b64_tr_b16 a[34:35], v6 offset:17664
    v_cvt_pk_bf16_f32 v97, v66, v67
    v_mfma_f32_16x16x32_bf16 v[188:191], a[60:63], v[108:111], v[188:191]
    v_exp_f32 v72, v72
    v_mfma_f32_16x16x32_bf16 v[180:183], a[60:63], v[104:107], v[180:183]
    ds_read_b64_tr_b16 a[36:37], v6 offset:17184
    ds_read_b64_tr_b16 a[38:39], v6 offset:17696
    v_mfma_f32_16x16x32_bf16 a[240:243], a[248:251], v[104:107], a[240:243]
    v_exp_f32 v73, v73
    v_mfma_f32_16x16x32_bf16 a[244:247], a[248:251], v[108:111], a[244:247]
    ds_read_b64_tr_b16 a[184:185], v8 offset:42248
    ds_read_b64_tr_b16 a[40:41], v6 offset:17216
    v_mfma_f32_16x16x32_bf16 v[84:87], a[0:3], a[64:67], v[112:115]
    buffer_load_dwordx4 v20, s[16:19], s78 offen offset:1056 lds
    v_mfma_f32_16x16x32_bf16 v[84:87], a[4:7], a[72:75], v[84:87]
    v_exp_f32 v74, v74
    v_mfma_f32_16x16x32_bf16 v[84:87], a[8:11], a[80:83], v[84:87]
    s_waitcnt lgkmcnt(5)
    ds_read_b64_tr_b16 a[42:43], v6 offset:17728
    ds_read_b64_tr_b16 a[44:45], v6 offset:17248
    v_mfma_f32_16x16x32_bf16 v[84:87], a[12:15], a[88:91], v[84:87]
    v_exp_f32 v75, v75
    v_mfma_f32_16x16x32_bf16 v[92:95], a[12:15], a[92:95], v[116:119]
    ds_read_b64_tr_b16 a[46:47], v6 offset:17760
    ds_read_b64_tr_b16 a[186:187], v8 offset:42504
    v_mfma_f32_16x16x32_bf16 v[92:95], a[8:11], a[84:87], v[92:95]
    ds_read_b64_tr_b16 a[48:49], v6 offset:17280
    ds_read_b64_tr_b16 a[50:51], v6 offset:17792
    v_mfma_f32_16x16x32_bf16 v[92:95], a[4:7], a[76:79], v[92:95]
    ds_read_b64_tr_b16 a[52:53], v6 offset:17312
    ds_read_b64_tr_b16 a[188:189], v8 offset:42760
    v_cvt_pk_bf16_f32 v100, v72, v73
    v_mfma_f32_16x16x32_bf16 v[92:95], a[0:3], a[68:71], v[92:95]
    buffer_load_dwordx4 v21, s[16:19], s78 offen offset:2112 lds
    v_cvt_pk_bf16_f32 v101, v74, v75
    v_mfma_f32_16x16x32_bf16 v[92:95], a[16:19], a[100:103], v[92:95]
    v_exp_f32 v68, v68
    v_mfma_f32_16x16x32_bf16 v[92:95], a[20:23], a[108:111], v[92:95]
    ds_read_b64_tr_b16 a[54:55], v6 offset:17824
    ds_read_b64_tr_b16 a[56:57], v6 offset:17344
    v_mfma_f32_16x16x32_bf16 v[92:95], a[24:27], a[116:119], v[92:95]
    v_exp_f32 v69, v69
    v_mfma_f32_16x16x32_bf16 v[92:95], a[28:31], a[124:127], v[92:95]
    ds_read_b64_tr_b16 a[58:59], v6 offset:17856
    ds_read_b64_tr_b16 a[190:191], v8 offset:43016
    v_mfma_f32_16x16x32_bf16 v[84:87], a[28:31], a[120:123], v[84:87]
    ds_read_b64_tr_b16 a[60:61], v6 offset:17376
    ds_read_b64_tr_b16 a[62:63], v6 offset:17888
    v_mfma_f32_16x16x32_bf16 v[84:87], a[24:27], a[112:115], v[84:87]
    v_exp_f32 v70, v70
    v_mfma_f32_16x16x32_bf16 v[84:87], a[20:23], a[104:107], v[84:87]
    v_exp_f32 v71, v71
    v_mfma_f32_16x16x32_bf16 v[84:87], a[16:19], a[96:99], v[84:87]
    s_waitcnt lgkmcnt(6)
    buffer_load_dwordx4 v22, s[16:19], s78 offen offset:3168 lds
    v_mfma_f32_16x16x32_bf16 v[192:195], a[32:35], v[104:107], v[192:195]
    v_cvt_pk_bf16_f32 v98, v68, v69
    v_cvt_pk_bf16_f32 v99, v70, v71
    v_mfma_f32_16x16x32_bf16 v[200:203], a[32:35], v[108:111], v[200:203]
    s_add_u32 s65, s48, 50176
    buffer_load_dword v59, v62, s[40:43], s65 offen
    v_mfma_f32_16x16x32_bf16 v[204:207], a[36:39], v[108:111], v[204:207]
    v_exp_f32 v76, v76
    v_mfma_f32_16x16x32_bf16 v[196:199], a[36:39], v[104:107], v[196:199]
    s_waitcnt vmcnt(11) lgkmcnt(0)
    s_barrier
    ds_read_b128 a[0:3], v5 offset:0
    v_mfma_f32_16x16x32_bf16 v[208:211], a[40:43], v[104:107], v[208:211]
    s_add_u32 s77, s75, 196608
    ds_read_b128 a[4:7], v5 offset:64
    v_mfma_f32_16x16x32_bf16 v[216:219], a[40:43], v[108:111], v[216:219]
    s_add_u32 m0, s73, 0
    v_exp_f32 v77, v77
    v_mfma_f32_16x16x32_bf16 v[220:223], a[44:47], v[108:111], v[220:223]
    ds_read_b128 a[8:11], v5 offset:128
    v_mfma_f32_16x16x32_bf16 v[212:215], a[44:47], v[104:107], v[212:215]
    ds_read_b128 a[12:15], v5 offset:192
    v_mfma_f32_16x16x32_bf16 v[224:227], a[48:51], v[104:107], v[224:227]
    buffer_load_dwordx4 v19, s[12:15], s77 offen lds
    v_mfma_f32_16x16x32_bf16 v[232:235], a[48:51], v[108:111], v[232:235]
    v_exp_f32 v78, v78
    v_mfma_f32_16x16x32_bf16 v[236:239], a[52:55], v[108:111], v[236:239]
    ds_read_b128 a[16:19], v5 offset:256
    ds_read_b128 a[20:23], v5 offset:320
    v_mfma_f32_16x16x32_bf16 v[228:231], a[52:55], v[104:107], v[228:231]
    v_exp_f32 v79, v79
    v_mfma_f32_16x16x32_bf16 v[240:243], a[56:59], v[104:107], v[240:243]
    ds_read_b128 a[24:27], v5 offset:384
    ds_read_b128 a[28:31], v5 offset:448
    v_mfma_f32_16x16x32_bf16 v[248:251], a[56:59], v[108:111], v[248:251]
    buffer_load_dwordx4 v20, s[12:15], s77 offen offset:1056 lds
    v_mfma_f32_16x16x32_bf16 v[252:255], a[60:63], v[108:111], v[252:255]
    ds_read_b64_tr_b16 a[32:33], v7 offset:16896
    v_cvt_pk_bf16_f32 v102, v76, v77
    v_cvt_pk_bf16_f32 v103, v78, v79
    v_mfma_f32_16x16x32_bf16 v[244:247], a[60:63], v[104:107], v[244:247]
    s_waitcnt lgkmcnt(5)
    ds_read_b64_tr_b16 a[34:35], v7 offset:17408
    v_mfma_f32_16x16x32_bf16 v[64:67], a[0:3], a[64:67], v[112:115]
    buffer_load_dwordx4 v21, s[12:15], s77 offen offset:2112 lds
    v_mfma_f32_16x16x32_bf16 v[64:67], a[4:7], a[72:75], v[64:67]
    ds_read_b64_tr_b16 a[36:37], v7 offset:16928
    ds_read_b64_tr_b16 a[38:39], v7 offset:17440
    v_mfma_f32_16x16x32_bf16 v[64:67], a[8:11], a[80:83], v[64:67]
    ds_read_b64_tr_b16 a[40:41], v7 offset:16960
    v_mfma_f32_16x16x32_bf16 v[64:67], a[12:15], a[88:91], v[64:67]
    buffer_load_dwordx4 v22, s[12:15], s77 offen offset:3168 lds
    v_mfma_f32_16x16x32_bf16 v[72:75], a[12:15], a[92:95], v[116:119]
    s_add_u32 s78, s75, 163840
    ds_read_b64_tr_b16 a[42:43], v7 offset:17472
    v_mfma_f32_16x16x32_bf16 v[72:75], a[8:11], a[84:87], v[72:75]
    s_add_u32 m0, s73, 16896
    ds_read_b64_tr_b16 a[44:45], v7 offset:16992
    v_mfma_f32_16x16x32_bf16 v[72:75], a[4:7], a[76:79], v[72:75]
    ds_read_b64_tr_b16 a[46:47], v7 offset:17504
    v_mfma_f32_16x16x32_bf16 v[72:75], a[0:3], a[68:71], v[72:75]
    s_waitcnt lgkmcnt(6)
    buffer_load_dwordx4 v19, s[16:19], s78 offen lds
    v_mfma_f32_16x16x32_bf16 v[72:75], a[16:19], a[100:103], v[72:75]
    ds_read_b64_tr_b16 a[48:49], v7 offset:17024
    v_mfma_f32_16x16x32_bf16 v[72:75], a[20:23], a[108:111], v[72:75]
    ds_read_b64_tr_b16 a[50:51], v7 offset:17536
    v_mfma_f32_16x16x32_bf16 v[72:75], a[24:27], a[116:119], v[72:75]
    ds_read_b64_tr_b16 a[52:53], v7 offset:17056
    v_mfma_f32_16x16x32_bf16 v[72:75], a[28:31], a[124:127], v[72:75]
    ds_read_b64_tr_b16 a[54:55], v7 offset:17568
    v_mfma_f32_16x16x32_bf16 v[64:67], a[28:31], a[120:123], v[64:67]
    buffer_load_dwordx4 v20, s[16:19], s78 offen offset:1056 lds
    v_mfma_f32_16x16x32_bf16 v[64:67], a[24:27], a[112:115], v[64:67]
    ds_read_b64_tr_b16 a[56:57], v7 offset:17088
    v_mfma_f32_16x16x32_bf16 v[64:67], a[20:23], a[104:107], v[64:67]
    ds_read_b64_tr_b16 a[58:59], v7 offset:17600
    v_mfma_f32_16x16x32_bf16 v[64:67], a[16:19], a[96:99], v[64:67]
    ds_read_b64_tr_b16 a[60:61], v7 offset:17120
    v_mfma_f32_16x16x32_bf16 v[128:131], a[32:35], v[96:99], v[128:131]
    buffer_load_dwordx4 v21, s[16:19], s78 offen offset:2112 lds
    v_mfma_f32_16x16x32_bf16 v[136:139], a[32:35], v[100:103], v[136:139]
    s_waitcnt lgkmcnt(5)
    v_exp_f32 v80, v80
    v_mfma_f32_16x16x32_bf16 v[140:143], a[36:39], v[100:103], v[140:143]
    ds_read_b64_tr_b16 a[62:63], v7 offset:17632
    ds_read_b128 a[0:3], v5 offset:512
    v_mfma_f32_16x16x32_bf16 v[132:135], a[36:39], v[96:99], v[132:135]
    v_exp_f32 v81, v81
    v_mfma_f32_16x16x32_bf16 v[144:147], a[40:43], v[96:99], v[144:147]
    ds_read_b128 a[4:7], v5 offset:576
    ds_read_b128 a[8:11], v5 offset:640
    v_mfma_f32_16x16x32_bf16 v[152:155], a[40:43], v[100:103], v[152:155]
    buffer_load_dwordx4 v22, s[16:19], s78 offen offset:3168 lds
    v_mfma_f32_16x16x32_bf16 v[156:159], a[44:47], v[100:103], v[156:159]
    s_add_u32 s77, s76, 114688
    v_exp_f32 v82, v82
    v_mfma_f32_16x16x32_bf16 v[148:151], a[44:47], v[96:99], v[148:151]
    s_add_u32 m0, s72, 33792
    ds_read_b128 a[12:15], v5 offset:704
    ds_read_b128 a[16:19], v5 offset:768
    v_mfma_f32_16x16x32_bf16 v[160:163], a[48:51], v[96:99], v[160:163]
    v_exp_f32 v83, v83
    v_mfma_f32_16x16x32_bf16 v[168:171], a[48:51], v[100:103], v[168:171]
    s_waitcnt lgkmcnt(6)
    buffer_load_dwordx4 v23, s[20:23], s77 offen lds
    v_mfma_f32_16x16x32_bf16 v[172:175], a[52:55], v[100:103], v[172:175]
    ds_read_b128 a[20:23], v5 offset:832
    ds_read_b128 a[24:27], v5 offset:896
    v_mfma_f32_16x16x32_bf16 v[164:167], a[52:55], v[96:99], v[164:167]
    ds_read_b128 a[28:31], v5 offset:960
    v_cvt_pk_bf16_f32 v104, v80, v81
    v_mfma_f32_16x16x32_bf16 v[176:179], a[56:59], v[96:99], v[176:179]
    buffer_load_dwordx4 v24, s[20:23], s77 offen offset:1032 lds
    v_mfma_f32_16x16x32_bf16 v[184:187], a[56:59], v[100:103], v[184:187]
    s_waitcnt lgkmcnt(5)
    ds_read_b64_tr_b16 a[32:33], v7 offset:17152
    ds_read_b64_tr_b16 a[34:35], v7 offset:17664
    v_cvt_pk_bf16_f32 v105, v82, v83
    v_mfma_f32_16x16x32_bf16 v[188:191], a[60:63], v[100:103], v[188:191]
    v_exp_f32 v88, v88
    v_mfma_f32_16x16x32_bf16 v[180:183], a[60:63], v[96:99], v[180:183]
    ds_read_b64_tr_b16 a[36:37], v7 offset:17184
    ds_read_b64_tr_b16 a[38:39], v7 offset:17696
    v_mfma_f32_16x16x32_bf16 a[240:243], a[248:251], v[96:99], a[240:243]
    v_exp_f32 v89, v89
    v_mfma_f32_16x16x32_bf16 a[244:247], a[248:251], v[100:103], a[244:247]
    buffer_load_dwordx4 v25, s[20:23], s77 offen offset:2112 lds
    v_mfma_f32_16x16x32_bf16 v[68:71], a[0:3], a[64:67], v[112:115]
    v_exp_f32 v90, v90
    v_mfma_f32_16x16x32_bf16 v[68:71], a[4:7], a[72:75], v[68:71]
    ds_read_b64_tr_b16 a[40:41], v7 offset:17216
    ds_read_b64_tr_b16 a[42:43], v7 offset:17728
    v_mfma_f32_16x16x32_bf16 v[68:71], a[8:11], a[80:83], v[68:71]
    s_waitcnt lgkmcnt(6)
    ds_read_b64_tr_b16 a[44:45], v7 offset:17248
    ds_read_b64_tr_b16 a[46:47], v7 offset:17760
    v_mfma_f32_16x16x32_bf16 v[68:71], a[12:15], a[88:91], v[68:71]
    buffer_load_dwordx4 v26, s[20:23], s77 offen offset:3144 lds
    v_mfma_f32_16x16x32_bf16 v[76:79], a[12:15], a[92:95], v[116:119]
    s_add_u32 s78, s76, 118272
    v_exp_f32 v91, v91
    v_mfma_f32_16x16x32_bf16 v[76:79], a[8:11], a[84:87], v[76:79]
    s_add_u32 m0, s72, 38016
    ds_read_b64_tr_b16 a[48:49], v7 offset:17280
    ds_read_b64_tr_b16 a[50:51], v7 offset:17792
    v_mfma_f32_16x16x32_bf16 v[76:79], a[4:7], a[76:79], v[76:79]
    buffer_load_dwordx4 v23, s[20:23], s78 offen lds
    v_cvt_pk_bf16_f32 v108, v88, v89
    v_mfma_f32_16x16x32_bf16 v[76:79], a[0:3], a[68:71], v[76:79]
    ds_read_b64_tr_b16 a[52:53], v7 offset:17312
    ds_read_b64_tr_b16 a[54:55], v7 offset:17824
    v_cvt_pk_bf16_f32 v109, v90, v91
    v_mfma_f32_16x16x32_bf16 v[76:79], a[16:19], a[100:103], v[76:79]
    v_exp_f32 v84, v84
    v_mfma_f32_16x16x32_bf16 v[76:79], a[20:23], a[108:111], v[76:79]
    v_exp_f32 v85, v85
    v_mfma_f32_16x16x32_bf16 v[76:79], a[24:27], a[116:119], v[76:79]
    ds_read_b64_tr_b16 a[56:57], v7 offset:17344
    ds_read_b64_tr_b16 a[58:59], v7 offset:17856
    v_mfma_f32_16x16x32_bf16 v[76:79], a[28:31], a[124:127], v[76:79]
    buffer_load_dwordx4 v24, s[20:23], s78 offen offset:1032 lds
    v_mfma_f32_16x16x32_bf16 v[68:71], a[28:31], a[120:123], v[68:71]
    ds_read_b64_tr_b16 a[60:61], v7 offset:17376
    ds_read_b64_tr_b16 a[62:63], v7 offset:17888
    v_mfma_f32_16x16x32_bf16 v[68:71], a[24:27], a[112:115], v[68:71]
    v_exp_f32 v86, v86
    v_mfma_f32_16x16x32_bf16 v[68:71], a[20:23], a[104:107], v[68:71]
    buffer_load_dwordx4 v25, s[20:23], s78 offen offset:2112 lds
    v_mfma_f32_16x16x32_bf16 v[68:71], a[16:19], a[96:99], v[68:71]
    s_waitcnt lgkmcnt(4)
    v_exp_f32 v87, v87
    v_mfma_f32_16x16x32_bf16 v[192:195], a[32:35], v[96:99], v[192:195]
    buffer_load_dwordx4 v26, s[20:23], s78 offen offset:3144 lds
    v_mfma_f32_16x16x32_bf16 v[200:203], a[32:35], v[100:103], v[200:203]
    v_cvt_pk_bf16_f32 v106, v84, v85
    v_cvt_pk_bf16_f32 v107, v86, v87
    v_mfma_f32_16x16x32_bf16 v[204:207], a[36:39], v[100:103], v[204:207]
    v_exp_f32 v92, v92
    v_mfma_f32_16x16x32_bf16 v[196:199], a[36:39], v[96:99], v[196:199]
    s_waitcnt vmcnt(17) lgkmcnt(0)
    s_barrier
    ds_read_b128 a[0:3], v5 offset:33792
    v_mfma_f32_16x16x32_bf16 v[208:211], a[40:43], v[96:99], v[208:211]
    s_add_u32 s77, s75, 212992
    ds_read_b128 a[4:7], v5 offset:33856
    v_mfma_f32_16x16x32_bf16 v[216:219], a[40:43], v[100:103], v[216:219]
    s_add_u32 m0, s73, 67584
    s_mov_b32 s93, 60000
L_tg:
    v_cmp_ne_u64 vcc, s[94:95], v[30:31]
    v_cmp_ne_u64 s[4:5], s[94:95], v[126:127]
    v_cmp_ne_u64 s[6:7], s[94:95], v[34:35]
    s_or_b64 vcc, vcc, s[4:5]
    s_or_b64 vcc, vcc, s[6:7]
    s_cbranch_scc1 L_tg_retry
L_tg_done:
    v_mfma_f32_16x16x32_bf16 v[220:223], a[44:47], v[100:103], v[220:223]
    v_exp_f32 v93, v93
    v_mfma_f32_16x16x32_bf16 v[212:215], a[44:47], v[96:99], v[212:215]
    ds_read_b128 a[8:11], v5 offset:33920
    ds_read_b128 a[12:15], v5 offset:33984
    v_mfma_f32_16x16x32_bf16 v[224:227], a[48:51], v[96:99], v[224:227]
    v_exp_f32 v94, v94
    v_mfma_f32_16x16x32_bf16 v[232:235], a[48:51], v[100:103], v[232:235]
    buffer_load_dwordx4 v19, s[12:15], s77 offen lds
    v_mov_b32 v30, v124
    v_mov_b32 v31, v125
    v_mfma_f32_16x16x32_bf16 v[236:239], a[52:55], v[100:103], v[236:239]
    ds_read_b128 a[16:19], v5 offset:34048
    v_readfirstlane_b32 s4, v32
    v_mfma_f32_16x16x32_bf16 v[228:231], a[52:55], v[96:99], v[228:231]
    s_and_b32 s4, s4, 0x2000
    ds_read_b128 a[20:23], v5 offset:34112
    s_add_u32 s4, s4, s62
    v_mfma_f32_16x16x32_bf16 v[240:243], a[56:59], v[96:99], v[240:243]
    v_exp_f32 v95, v95
    v_mfma_f32_16x16x32_bf16 v[248:251], a[56:59], v[100:103], v[248:251]
    ds_read_b128 a[24:27], v5 offset:34176
    ds_read_b128 a[28:31], v5 offset:34240
    s_add_u32 s28, s28, s4
    s_addc_u32 s29, s29, 0
    s_mov_b32 s30, 2088960
    v_mfma_f32_16x16x32_bf16 v[252:255], a[60:63], v[100:103], v[252:255]
    ds_read_b64_tr_b16 a[32:33], v7 offset:50688
    v_cvt_pk_bf16_f32 v110, v92, v93
    v_cvt_pk_bf16_f32 v111, v94, v95
    v_mfma_f32_16x16x32_bf16 v[244:247], a[60:63], v[96:99], v[244:247]
    s_waitcnt lgkmcnt(5)
    ds_read_b64_tr_b16 a[34:35], v7 offset:51200
    v_mfma_f32_16x16x32_bf16 v[80:83], a[0:3], a[64:67], v[112:115]
    ds_read_b64_tr_b16 a[36:37], v7 offset:50720
    v_mfma_f32_16x16x32_bf16 v[80:83], a[4:7], a[72:75], v[80:83]
    buffer_load_dwordx4 v20, s[12:15], s77 offen offset:1056 lds
    v_mfma_f32_16x16x32_bf16 v[80:83], a[8:11], a[80:83], v[80:83]
    ds_read_b64_tr_b16 a[38:39], v7 offset:51232
    v_mfma_f32_16x16x32_bf16 v[80:83], a[12:15], a[88:91], v[80:83]
    ds_read_b64_tr_b16 a[40:41], v7 offset:50752
    v_mfma_f32_16x16x32_bf16 v[88:91], a[12:15], a[92:95], v[116:119]
    ds_read_b64_tr_b16 a[42:43], v7 offset:51264
    v_mfma_f32_16x16x32_bf16 v[88:91], a[8:11], a[84:87], v[88:91]
    ds_read_b64_tr_b16 a[44:45], v7 offset:50784
    v_mfma_f32_16x16x32_bf16 v[88:91], a[4:7], a[76:79], v[88:91]
    ds_read_b64_tr_b16 a[46:47], v7 offset:51296
    v_mfma_f32_16x16x32_bf16 v[88:91], a[0:3], a[68:71], v[88:91]
    s_waitcnt lgkmcnt(6)
    ds_read_b64_tr_b16 a[48:49], v7 offset:50816
    v_mfma_f32_16x16x32_bf16 v[88:91], a[16:19], a[100:103], v[88:91]
    buffer_load_dwordx4 v21, s[12:15], s77 offen offset:2112 lds
    v_mfma_f32_16x16x32_bf16 v[88:91], a[20:23], a[108:111], v[88:91]
    ds_read_b64_tr_b16 a[50:51], v7 offset:51328
    v_mfma_f32_16x16x32_bf16 v[88:91], a[24:27], a[116:119], v[88:91]
    ds_read_b64_tr_b16 a[52:53], v7 offset:50848
    v_mfma_f32_16x16x32_bf16 v[88:91], a[28:31], a[124:127], v[88:91]
    ds_read_b64_tr_b16 a[54:55], v7 offset:51360
    v_mfma_f32_16x16x32_bf16 v[80:83], a[28:31], a[120:123], v[80:83]
    ds_read_b64_tr_b16 a[56:57], v7 offset:50880
    v_mfma_f32_16x16x32_bf16 v[80:83], a[24:27], a[112:115], v[80:83]
    ds_read_b64_tr_b16 a[58:59], v7 offset:51392
    v_mfma_f32_16x16x32_bf16 v[80:83], a[20:23], a[104:107], v[80:83]
    ds_read_b64_tr_b16 a[60:61], v7 offset:50912
    v_mfma_f32_16x16x32_bf16 v[80:83], a[16:19], a[96:99], v[80:83]
    v_exp_f32 v64, v64
    v_mfma_f32_16x16x32_bf16 v[128:131], a[32:35], v[104:107], v[128:131]
    ds_read_b64_tr_b16 a[62:63], v7 offset:51424
    v_mfma_f32_16x16x32_bf16 v[136:139], a[32:35], v[108:111], v[136:139]
    s_waitcnt lgkmcnt(6)
    buffer_load_dwordx4 v22, s[12:15], s77 offen offset:3168 lds
    v_mfma_f32_16x16x32_bf16 v[140:143], a[36:39], v[108:111], v[140:143]
    v_exp_f32 v65, v65
    v_mfma_f32_16x16x32_bf16 v[132:135], a[36:39], v[104:107], v[132:135]
    s_add_u32 s78, s75, 180224
    ds_read_b128 a[0:3], v5 offset:34304
    ds_read_b128 a[4:7], v5 offset:34368
    v_mfma_f32_16x16x32_bf16 v[144:147], a[40:43], v[104:107], v[144:147]
    s_add_u32 m0, s73, 84480
    ds_read_b128 a[8:11], v5 offset:34432
    v_mfma_f32_16x16x32_bf16 v[152:155], a[40:43], v[108:111], v[152:155]
    v_exp_f32 v66, v66
    v_mfma_f32_16x16x32_bf16 v[156:159], a[44:47], v[108:111], v[156:159]
    ds_read_b128 a[12:15], v5 offset:34496
    v_mfma_f32_16x16x32_bf16 v[148:151], a[44:47], v[104:107], v[148:151]
    v_exp_f32 v67, v67
    v_mfma_f32_16x16x32_bf16 v[160:163], a[48:51], v[104:107], v[160:163]
    ds_read_b128 a[16:19], v5 offset:34560
    ds_read_b128 a[20:23], v5 offset:34624
    v_mfma_f32_16x16x32_bf16 v[168:171], a[48:51], v[108:111], v[168:171]
    s_waitcnt lgkmcnt(6)
    buffer_load_dwordx4 v19, s[16:19], s78 offen lds
    v_mfma_f32_16x16x32_bf16 v[172:175], a[52:55], v[108:111], v[172:175]
    ds_read_b128 a[24:27], v5 offset:34688
    ds_read_b128 a[28:31], v5 offset:34752
    v_mfma_f32_16x16x32_bf16 v[164:167], a[52:55], v[104:107], v[164:167]
    ds_read_b64_tr_b16 a[32:33], v7 offset:50944
    v_cvt_pk_bf16_f32 v96, v64, v65
    v_mfma_f32_16x16x32_bf16 v[176:179], a[56:59], v[104:107], v[176:179]
    ds_read_b64_tr_b16 a[34:35], v7 offset:51456
    v_cvt_pk_bf16_f32 v97, v66, v67
    v_mfma_f32_16x16x32_bf16 v[184:187], a[56:59], v[108:111], v[184:187]
    v_exp_f32 v72, v72
    v_mfma_f32_16x16x32_bf16 v[188:191], a[60:63], v[108:111], v[188:191]
    ds_read_b64_tr_b16 a[36:37], v7 offset:50976
    v_mfma_f32_16x16x32_bf16 v[180:183], a[60:63], v[104:107], v[180:183]
    v_exp_f32 v73, v73
    v_mfma_f32_16x16x32_bf16 a[240:243], a[248:251], v[104:107], a[240:243]
    ds_read_b64_tr_b16 a[38:39], v7 offset:51488
    v_mfma_f32_16x16x32_bf16 a[244:247], a[248:251], v[108:111], a[244:247]
    s_waitcnt lgkmcnt(6)
    buffer_load_dwordx4 v20, s[16:19], s78 offen offset:1056 lds
    v_mfma_f32_16x16x32_bf16 v[84:87], a[0:3], a[64:67], v[112:115]
    v_exp_f32 v74, v74
    v_mfma_f32_16x16x32_bf16 v[84:87], a[4:7], a[72:75], v[84:87]
    ds_read_b64_tr_b16 a[40:41], v7 offset:51008
    ds_read_b64_tr_b16 a[42:43], v7 offset:51520
    v_mfma_f32_16x16x32_bf16 v[84:87], a[8:11], a[80:83], v[84:87]
    ds_read_b64_tr_b16 a[44:45], v7 offset:51040
    ds_read_b64_tr_b16 a[46:47], v7 offset:51552
    v_mfma_f32_16x16x32_bf16 v[84:87], a[12:15], a[88:91], v[84:87]
    v_exp_f32 v75, v75
    v_mfma_f32_16x16x32_bf16 v[92:95], a[12:15], a[92:95], v[116:119]
    ds_read_b64_tr_b16 a[48:49], v7 offset:51072
    v_cvt_pk_bf16_f32 v100, v72, v73
    v_mfma_f32_16x16x32_bf16 v[92:95], a[8:11], a[84:87], v[92:95]
    ds_read_b64_tr_b16 a[50:51], v7 offset:51584
    v_cvt_pk_bf16_f32 v101, v74, v75
    v_mfma_f32_16x16x32_bf16 v[92:95], a[4:7], a[76:79], v[92:95]
    ds_read_b64_tr_b16 a[52:53], v7 offset:51104
    v_mfma_f32_16x16x32_bf16 v[92:95], a[0:3], a[68:71], v[92:95]
    buffer_load_dwordx4 v21, s[16:19], s78 offen offset:2112 lds
    v_mfma_f32_16x16x32_bf16 v[92:95], a[16:19], a[100:103], v[92:95]
    v_exp_f32 v68, v68
    v_mfma_f32_16x16x32_bf16 v[92:95], a[20:23], a[108:111], v[92:95]
    s_waitcnt lgkmcnt(5)
    ds_read_b64_tr_b16 a[54:55], v7 offset:51616
    ds_read_b64_tr_b16 a[56:57], v7 offset:51136
    v_mfma_f32_16x16x32_bf16 v[92:95], a[24:27], a[116:119], v[92:95]
    v_exp_f32 v69, v69
    v_mfma_f32_16x16x32_bf16 v[92:95], a[28:31], a[124:127], v[92:95]
    ds_read_b64_tr_b16 a[58:59], v7 offset:51648
    ds_read_b64_tr_b16 a[60:61], v7 offset:51168
    v_mfma_f32_16x16x32_bf16 v[84:87], a[28:31], a[120:123], v[84:87]
    v_exp_f32 v70, v70
    v_mfma_f32_16x16x32_bf16 v[84:87], a[24:27], a[112:115], v[84:87]
    ds_read_b64_tr_b16 a[62:63], v7 offset:51680
    v_mfma_f32_16x16x32_bf16 v[84:87], a[20:23], a[104:107], v[84:87]
    v_exp_f32 v71, v71
    v_mfma_f32_16x16x32_bf16 v[84:87], a[16:19], a[96:99], v[84:87]
    buffer_load_dwordx4 v22, s[16:19], s78 offen offset:3168 lds
    v_mfma_f32_16x16x32_bf16 v[192:195], a[32:35], v[104:107], v[192:195]
    v_cvt_pk_bf16_f32 v98, v68, v69
    v_cvt_pk_bf16_f32 v99, v70, v71
    v_mfma_f32_16x16x32_bf16 v[200:203], a[32:35], v[108:111], v[200:203]
    buffer_load_dword v59, v61, s[44:47], s49 offen
    v_mfma_f32_16x16x32_bf16 v[204:207], a[36:39], v[108:111], v[204:207]
    v_exp_f32 v76, v76
    v_mfma_f32_16x16x32_bf16 v[196:199], a[36:39], v[104:107], v[196:199]
    s_waitcnt vmcnt(9) lgkmcnt(0)
    s_barrier
    ds_read_b128 a[0:3], v4 offset:0
    v_mfma_f32_16x16x32_bf16 v[208:211], a[40:43], v[104:107], v[208:211]
    s_add_u32 s77, s75, 229376
    ds_read_b64_tr_b16 v[32:33], v12 offset:33792
    v_mfma_f32_16x16x32_bf16 v[216:219], a[40:43], v[108:111], v[216:219]
    s_add_u32 m0, s73, 101376
    ds_read_b128 a[4:7], v4 offset:64
    v_mfma_f32_16x16x32_bf16 v[220:223], a[44:47], v[108:111], v[220:223]
    v_exp_f32 v77, v77
    v_mfma_f32_16x16x32_bf16 v[212:215], a[44:47], v[104:107], v[212:215]
    ds_read_b128 a[8:11], v4 offset:128
    ds_read_b128 a[12:15], v4 offset:192
    v_mfma_f32_16x16x32_bf16 v[224:227], a[48:51], v[104:107], v[224:227]
    v_exp_f32 v78, v78
    v_mfma_f32_16x16x32_bf16 v[232:235], a[48:51], v[108:111], v[232:235]
    buffer_load_dwordx4 v19, s[12:15], s77 offen lds
    v_mfma_f32_16x16x32_bf16 v[236:239], a[52:55], v[108:111], v[236:239]
    ds_read_b128 a[16:19], v4 offset:256
    ds_read_b128 a[20:23], v4 offset:320
    v_mfma_f32_16x16x32_bf16 v[228:231], a[52:55], v[104:107], v[228:231]
    ds_read_b64_tr_b16 v[34:35], v12 offset:34048
    ds_read_b128 a[24:27], v4 offset:384
    v_mfma_f32_16x16x32_bf16 v[240:243], a[56:59], v[104:107], v[240:243]
    v_exp_f32 v79, v79
    v_mfma_f32_16x16x32_bf16 v[248:251], a[56:59], v[108:111], v[248:251]
    ds_read_b128 a[28:31], v4 offset:448
    v_cvt_pk_bf16_f32 v102, v76, v77
    v_mfma_f32_16x16x32_bf16 v[252:255], a[60:63], v[108:111], v[252:255]
    ds_read_b64_tr_b16 a[32:33], v6 offset:16896
    v_cvt_pk_bf16_f32 v103, v78, v79
    v_mfma_f32_16x16x32_bf16 v[244:247], a[60:63], v[104:107], v[244:247]
    s_waitcnt lgkmcnt(6)
    ds_read_b64_tr_b16 a[34:35], v6 offset:17408
    v_mfma_f32_16x16x32_bf16 v[64:67], a[0:3], a[64:67], v[112:115]
    ds_read_b64_tr_b16 a[36:37], v6 offset:16928
    ds_read_b64_tr_b16 v[36:37], v12 offset:34304
    v_mfma_f32_16x16x32_bf16 v[64:67], a[4:7], a[72:75], v[64:67]
    buffer_load_dwordx4 v20, s[12:15], s77 offen offset:1056 lds
    v_mfma_f32_16x16x32_bf16 v[64:67], a[8:11], a[80:83], v[64:67]
    ds_read_b64_tr_b16 a[38:39], v6 offset:17440
    v_mfma_f32_16x16x32_bf16 v[64:67], a[12:15], a[88:91], v[64:67]
    ds_read_b64_tr_b16 a[40:41], v6 offset:16960
    v_mfma_f32_16x16x32_bf16 v[72:75], a[12:15], a[92:95], v[116:119]
    ds_read_b64_tr_b16 a[42:43], v6 offset:17472
    v_mfma_f32_16x16x32_bf16 v[72:75], a[8:11], a[84:87], v[72:75]
    ds_read_b64_tr_b16 a[44:45], v6 offset:16992
    v_mfma_f32_16x16x32_bf16 v[72:75], a[4:7], a[76:79], v[72:75]
    ds_read_b64_tr_b16 a[46:47], v6 offset:17504
    ds_read_b64_tr_b16 v[38:39], v12 offset:34560
    v_mfma_f32_16x16x32_bf16 v[72:75], a[0:3], a[68:71], v[72:75]
    s_waitcnt lgkmcnt(8)
    ds_read_b64_tr_b16 a[48:49], v6 offset:17024
    v_mfma_f32_16x16x32_bf16 v[72:75], a[16:19], a[100:103], v[72:75]
    buffer_load_dwordx4 v21, s[12:15], s77 offen offset:2112 lds
    v_mfma_f32_16x16x32_bf16 v[72:75], a[20:23], a[108:111], v[72:75]
    ds_read_b64_tr_b16 a[50:51], v6 offset:17536
    v_mfma_f32_16x16x32_bf16 v[72:75], a[24:27], a[116:119], v[72:75]
    ds_read_b64_tr_b16 a[52:53], v6 offset:17056
    v_mfma_f32_16x16x32_bf16 v[72:75], a[28:31], a[124:127], v[72:75]
    ds_read_b64_tr_b16 a[54:55], v6 offset:17568
    v_mfma_f32_16x16x32_bf16 v[64:67], a[28:31], a[120:123], v[64:67]
    ds_read_b64_tr_b16 v[40:41], v12 offset:33800
    v_mfma_f32_16x16x32_bf16 v[64:67], a[24:27], a[112:115], v[64:67]
    ds_read_b64_tr_b16 a[56:57], v6 offset:17088
    v_mfma_f32_16x16x32_bf16 v[64:67], a[20:23], a[104:107], v[64:67]
    ds_read_b64_tr_b16 a[58:59], v6 offset:17600
    v_mfma_f32_16x16x32_bf16 v[64:67], a[16:19], a[96:99], v[64:67]
    ds_read_b64_tr_b16 a[60:61], v6 offset:17120
    v_mfma_f32_16x16x32_bf16 v[128:131], a[32:35], v[96:99], v[128:131]
    v_exp_f32 v80, v80
    v_mfma_f32_16x16x32_bf16 v[136:139], a[32:35], v[100:103], v[136:139]
    s_waitcnt lgkmcnt(6)
    ds_read_b64_tr_b16 a[62:63], v6 offset:17632
    v_mfma_f32_16x16x32_bf16 v[140:143], a[36:39], v[100:103], v[140:143]
    buffer_load_dwordx4 v22, s[12:15], s77 offen offset:3168 lds
    v_mfma_f32_16x16x32_bf16 v[132:135], a[36:39], v[96:99], v[132:135]
    s_add_u32 s78, s75, 196608
    v_exp_f32 v81, v81
    v_mfma_f32_16x16x32_bf16 v[144:147], a[40:43], v[96:99], v[144:147]
    s_add_u32 m0, s73, 118272
    ds_read_b128 a[0:3], v4 offset:512
    ds_read_b64_tr_b16 v[42:43], v12 offset:34056
    v_mfma_f32_16x16x32_bf16 v[152:155], a[40:43], v[100:103], v[152:155]
    ds_read_b128 a[4:7], v4 offset:576
    ds_read_b128 a[8:11], v4 offset:640
    v_mfma_f32_16x16x32_bf16 v[156:159], a[44:47], v[100:103], v[156:159]
    v_exp_f32 v82, v82
    v_mfma_f32_16x16x32_bf16 v[148:151], a[44:47], v[96:99], v[148:151]
    ds_read_b128 a[12:15], v4 offset:704
    ds_read_b128 a[16:19], v4 offset:768
    v_mfma_f32_16x16x32_bf16 v[160:163], a[48:51], v[96:99], v[160:163]
    v_exp_f32 v83, v83
    v_mfma_f32_16x16x32_bf16 v[168:171], a[48:51], v[100:103], v[168:171]
    s_waitcnt lgkmcnt(6)
    ds_read_b128 a[20:23], v4 offset:832
    ds_read_b64_tr_b16 v[44:45], v12 offset:34312
    v_mfma_f32_16x16x32_bf16 v[172:175], a[52:55], v[100:103], v[172:175]
    buffer_load_dwordx4 v19, s[16:19], s78 offen lds
    v_mfma_f32_16x16x32_bf16 v[164:167], a[52:55], v[96:99], v[164:167]
    ds_read_b128 a[24:27], v4 offset:896
L_hop0_7:
    s_cbranch_execz L_hop0_11
    ds_read_b128 a[28:31], v4 offset:960
    v_mfma_f32_16x16x32_bf16 v[176:179], a[56:59], v[96:99], v[176:179]
    ds_read_b64_tr_b16 a[32:33], v6 offset:17152
    v_cvt_pk_bf16_f32 v104, v80, v81
    v_mfma_f32_16x16x32_bf16 v[184:187], a[56:59], v[100:103], v[184:187]
    ds_read_b64_tr_b16 a[34:35], v6 offset:17664
    v_cvt_pk_bf16_f32 v105, v82, v83
    v_mfma_f32_16x16x32_bf16 v[188:191], a[60:63], v[100:103], v[188:191]
    v_exp_f32 v88, v88
    v_mfma_f32_16x16x32_bf16 v[180:183], a[60:63], v[96:99], v[180:183]
    ds_read_b64_tr_b16 a[36:37], v6 offset:17184
    ds_read_b64_tr_b16 v[46:47], v12 offset:34568
    v_mfma_f32_16x16x32_bf16 a[240:243], a[248:251], v[96:99], a[240:243]
    v_exp_f32 v89, v89
    v_mfma_f32_16x16x32_bf16 a[244:247], a[248:251], v[100:103], a[244:247]
    s_waitcnt lgkmcnt(6)
    ds_read_b64_tr_b16 a[38:39], v6 offset:17696
    ds_read_b64_tr_b16 a[40:41], v6 offset:17216
    v_mfma_f32_16x16x32_bf16 v[68:71], a[0:3], a[64:67], v[112:115]
    buffer_load_dwordx4 v20, s[16:19], s78 offen offset:1056 lds
    v_mfma_f32_16x16x32_bf16 v[68:71], a[4:7], a[72:75], v[68:71]
    v_exp_f32 v90, v90
    v_mfma_f32_16x16x32_bf16 v[68:71], a[8:11], a[80:83], v[68:71]
    ds_read_b64_tr_b16 a[42:43], v6 offset:17728
    ds_read_b64_tr_b16 a[44:45], v6 offset:17248
    v_mfma_f32_16x16x32_bf16 v[68:71], a[12:15], a[88:91], v[68:71]
    v_exp_f32 v91, v91
    v_mfma_f32_16x16x32_bf16 v[76:79], a[12:15], a[92:95], v[116:119]
    ds_read_b64_tr_b16 a[46:47], v6 offset:17760
    ds_read_b64_tr_b16 a[192:193], v8 offset:33792
    v_mfma_f32_16x16x32_bf16 v[76:79], a[8:11], a[84:87], v[76:79]
    ds_read_b64_tr_b16 a[48:49], v6 offset:17280
    ds_read_b64_tr_b16 a[50:51], v6 offset:17792
    v_mfma_f32_16x16x32_bf16 v[76:79], a[4:7], a[76:79], v[76:79]
    ds_read_b64_tr_b16 a[52:53], v6 offset:17312
    v_cvt_pk_bf16_f32 v108, v88, v89
    v_mfma_f32_16x16x32_bf16 v[76:79], a[0:3], a[68:71], v[76:79]
    buffer_load_dwordx4 v21, s[16:19], s78 offen offset:2112 lds
    v_cvt_pk_bf16_f32 v109, v90, v91
    v_mfma_f32_16x16x32_bf16 v[76:79], a[16:19], a[100:103], v[76:79]
    v_exp_f32 v84, v84
    v_mfma_f32_16x16x32_bf16 v[76:79], a[20:23], a[108:111], v[76:79]
    s_waitcnt lgkmcnt(7)
    ds_read_b64_tr_b16 a[54:55], v6 offset:17824
    ds_read_b64_tr_b16 a[194:195], v8 offset:34048
    v_mfma_f32_16x16x32_bf16 v[76:79], a[24:27], a[116:119], v[76:79]
    v_exp_f32 v85, v85
    v_mfma_f32_16x16x32_bf16 v[76:79], a[28:31], a[124:127], v[76:79]
    ds_read_b64_tr_b16 a[56:57], v6 offset:17344
    ds_read_b64_tr_b16 a[58:59], v6 offset:17856
    v_mfma_f32_16x16x32_bf16 v[68:71], a[28:31], a[120:123], v[68:71]
    ds_read_b64_tr_b16 a[60:61], v6 offset:17376
    ds_read_b64_tr_b16 a[62:63], v6 offset:17888
    v_mfma_f32_16x16x32_bf16 v[68:71], a[24:27], a[112:115], v[68:71]
    v_exp_f32 v86, v86
    v_mfma_f32_16x16x32_bf16 v[68:71], a[20:23], a[104:107], v[68:71]
    v_exp_f32 v87, v87
    v_mfma_f32_16x16x32_bf16 v[68:71], a[16:19], a[96:99], v[68:71]
    ds_read_b64_tr_b16 a[196:197], v8 offset:34304
    v_cvt_pk_bf16_f32 v106, v84, v85
    v_mfma_f32_16x16x32_bf16 v[192:195], a[32:35], v[96:99], v[192:195]
    buffer_load_dwordx4 v22, s[16:19], s78 offen offset:3168 lds
    v_mfma_f32_16x16x32_bf16 v[200:203], a[32:35], v[100:103], v[200:203]
    s_add_u32 s65, s49, 6272
    buffer_load_dword v59, v61, s[44:47], s65 offen
    v_mfma_f32_16x16x32_bf16 v[204:207], a[36:39], v[100:103], v[204:207]
    ds_read_b64_tr_b16 a[198:199], v8 offset:34560
    v_cvt_pk_bf16_f32 v107, v86, v87
    v_mfma_f32_16x16x32_bf16 v[196:199], a[36:39], v[96:99], v[196:199]
    s_waitcnt vmcnt(10) lgkmcnt(2)
    s_barrier
    ds_read_b128 a[0:3], v5 offset:0
    v_mfma_f32_16x16x32_bf16 v[208:211], a[40:43], v[96:99], v[208:211]
    s_add_u32 s77, s75, 245760
    v_exp_f32 v92, v92
    v_mfma_f32_16x16x32_bf16 v[216:219], a[40:43], v[100:103], v[216:219]
    s_add_u32 m0, s73, 0
    ds_read_b128 a[4:7], v5 offset:64
    v_mfma_f32_16x16x32_bf16 v[220:223], a[44:47], v[100:103], v[220:223]
    v_exp_f32 v93, v93
    v_mfma_f32_16x16x32_bf16 v[212:215], a[44:47], v[96:99], v[212:215]
    ds_read_b128 a[8:11], v5 offset:128
    ds_read_b128 a[12:15], v5 offset:192
    v_mfma_f32_16x16x32_bf16 v[224:227], a[48:51], v[96:99], v[224:227]
    v_exp_f32 v94, v94
    v_mfma_f32_16x16x32_bf16 v[232:235], a[48:51], v[100:103], v[232:235]
    ds_read_b128 a[16:19], v5 offset:256
    v_mfma_f32_16x16x32_bf16 v[236:239], a[52:55], v[100:103], v[236:239]
    buffer_load_dwordx4 v19, s[12:15], s77 offen lds
    v_mfma_f32_16x16x32_bf16 v[228:231], a[52:55], v[96:99], v[228:231]
    ds_read_b128 a[20:23], v5 offset:320
    ds_read_b64_tr_b16 a[200:201], v8 offset:33800
    v_mfma_f32_16x16x32_bf16 v[240:243], a[56:59], v[96:99], v[240:243]
    v_exp_f32 v95, v95
    v_mfma_f32_16x16x32_bf16 v[248:251], a[56:59], v[100:103], v[248:251]
    ds_read_b128 a[24:27], v5 offset:384
    ds_read_b128 a[28:31], v5 offset:448
    v_mfma_f32_16x16x32_bf16 v[252:255], a[60:63], v[100:103], v[252:255]
    ds_read_b64_tr_b16 a[32:33], v7 offset:16896
    v_cvt_pk_bf16_f32 v110, v92, v93
    v_cvt_pk_bf16_f32 v111, v94, v95
    v_mfma_f32_16x16x32_bf16 v[244:247], a[60:63], v[96:99], v[244:247]
    s_waitcnt lgkmcnt(6)
    ds_read_b64_tr_b16 a[34:35], v7 offset:17408
    v_mfma_f32_16x16x32_bf16 v[80:83], a[0:3], a[64:67], v[112:115]
    ds_read_b64_tr_b16 a[36:37], v7 offset:16928
    ds_read_b64_tr_b16 a[202:203], v8 offset:34056
    v_mfma_f32_16x16x32_bf16 v[80:83], a[4:7], a[72:75], v[80:83]
    ds_read_b64_tr_b16 a[38:39], v7 offset:17440
    v_mfma_f32_16x16x32_bf16 v[80:83], a[8:11], a[80:83], v[80:83]
    buffer_load_dwordx4 v20, s[12:15], s77 offen offset:1056 lds
    v_mfma_f32_16x16x32_bf16 v[80:83], a[12:15], a[88:91], v[80:83]
    ds_read_b64_tr_b16 a[40:41], v7 offset:16960
    v_mfma_f32_16x16x32_bf16 v[88:91], a[12:15], a[92:95], v[116:119]
    ds_read_b64_tr_b16 a[42:43], v7 offset:17472
    v_mfma_f32_16x16x32_bf16 v[88:91], a[8:11], a[84:87], v[88:91]
    ds_read_b64_tr_b16 a[44:45], v7 offset:16992
    v_mfma_f32_16x16x32_bf16 v[88:91], a[4:7], a[76:79], v[88:91]
    ds_read_b64_tr_b16 a[46:47], v7 offset:17504
    ds_read_b64_tr_b16 a[204:205], v8 offset:34312
    v_mfma_f32_16x16x32_bf16 v[88:91], a[0:3], a[68:71], v[88:91]
    s_waitcnt lgkmcnt(8)
    ds_read_b64_tr_b16 a[48:49], v7 offset:17024
    v_mfma_f32_16x16x32_bf16 v[88:91], a[16:19], a[100:103], v[88:91]
    ds_read_b64_tr_b16 a[50:51], v7 offset:17536
    v_mfma_f32_16x16x32_bf16 v[88:91], a[20:23], a[108:111], v[88:91]
    buffer_load_dwordx4 v21, s[12:15], s77 offen offset:2112 lds
    v_mfma_f32_16x16x32_bf16 v[88:91], a[24:27], a[116:119], v[88:91]
    ds_read_b64_tr_b16 a[52:53], v7 offset:17056
    v_mfma_f32_16x16x32_bf16 v[88:91], a[28:31], a[124:127], v[88:91]
    ds_read_b64_tr_b16 a[54:55], v7 offset:17568
    v_mfma_f32_16x16x32_bf16 v[80:83], a[28:31], a[120:123], v[80:83]
    ds_read_b64_tr_b16 a[206:207], v8 offset:34568
    v_mfma_f32_16x16x32_bf16 v[80:83], a[24:27], a[112:115], v[80:83]
    ds_read_b64_tr_b16 a[56:57], v7 offset:17088
    v_mfma_f32_16x16x32_bf16 v[80:83], a[20:23], a[104:107], v[80:83]
    ds_read_b64_tr_b16 a[58:59], v7 offset:17600
    v_mfma_f32_16x16x32_bf16 v[80:83], a[16:19], a[96:99], v[80:83]
    ds_read_b64_tr_b16 a[60:61], v7 offset:17120
    v_mfma_f32_16x16x32_bf16 v[128:131], a[32:35], v[104:107], v[128:131]
    v_exp_f32 v64, v64
    v_mfma_f32_16x16x32_bf16 v[136:139], a[32:35], v[108:111], v[136:139]
    s_waitcnt lgkmcnt(6)
    ds_read_b64_tr_b16 a[62:63], v7 offset:17632
    v_mfma_f32_16x16x32_bf16 v[140:143], a[36:39], v[108:111], v[140:143]
    buffer_load_dwordx4 v22, s[12:15], s77 offen offset:3168 lds
    v_mfma_f32_16x16x32_bf16 v[132:135], a[36:39], v[104:107], v[132:135]
    v_exp_f32 v65, v65
    v_mfma_f32_16x16x32_bf16 v[144:147], a[40:43], v[104:107], v[144:147]
    s_add_u32 s78, s75, 212992
    ds_read_b128 a[0:3], v5 offset:512
    ds_read_b64_tr_b16 a[208:209], v12 offset:42240
    v_mfma_f32_16x16x32_bf16 v[152:155], a[40:43], v[108:111], v[152:155]
    s_add_u32 m0, s73, 16896
    ds_read_b128 a[4:7], v5 offset:576
    ds_read_b128 a[8:11], v5 offset:640
    v_mfma_f32_16x16x32_bf16 v[156:159], a[44:47], v[108:111], v[156:159]
    v_exp_f32 v66, v66
    v_mfma_f32_16x16x32_bf16 v[148:151], a[44:47], v[104:107], v[148:151]
    ds_read_b128 a[12:15], v5 offset:704
    ds_read_b128 a[16:19], v5 offset:768
    v_mfma_f32_16x16x32_bf16 v[160:163], a[48:51], v[104:107], v[160:163]
    v_exp_f32 v67, v67
    v_mfma_f32_16x16x32_bf16 v[168:171], a[48:51], v[108:111], v[168:171]
    s_waitcnt lgkmcnt(6)
    ds_read_b128 a[20:23], v5 offset:832
    ds_read_b64_tr_b16 a[210:211], v12 offset:42496
    v_mfma_f32_16x16x32_bf16 v[172:175], a[52:55], v[108:111], v[172:175]
    ds_read_b128 a[24:27], v5 offset:896
    ds_read_b128 a[28:31], v5 offset:960
    v_mfma_f32_16x16x32_bf16 v[164:167], a[52:55], v[104:107], v[164:167]
    buffer_load_dwordx4 v19, s[16:19], s78 offen lds
    v_mfma_f32_16x16x32_bf16 v[176:179], a[56:59], v[104:107], v[176:179]
    ds_read_b64_tr_b16 a[32:33], v7 offset:17152
    v_cvt_pk_bf16_f32 v96, v64, v65
    v_mfma_f32_16x16x32_bf16 v[184:187], a[56:59], v[108:111], v[184:187]
    ds_read_b64_tr_b16 a[34:35], v7 offset:17664
    v_cvt_pk_bf16_f32 v97, v66, v67
    v_mfma_f32_16x16x32_bf16 v[188:191], a[60:63], v[108:111], v[188:191]
    v_exp_f32 v72, v72
    v_mfma_f32_16x16x32_bf16 v[180:183], a[60:63], v[104:107], v[180:183]
    ds_read_b64_tr_b16 a[36:37], v7 offset:17184
    ds_read_b64_tr_b16 a[212:213], v12 offset:42752
    v_mfma_f32_16x16x32_bf16 a[240:243], a[248:251], v[104:107], a[240:243]
    v_exp_f32 v73, v73
    v_mfma_f32_16x16x32_bf16 a[244:247], a[248:251], v[108:111], a[244:247]
    s_waitcnt lgkmcnt(6)
    ds_read_b64_tr_b16 a[38:39], v7 offset:17696
    ds_read_b64_tr_b16 a[40:41], v7 offset:17216
    v_mfma_f32_16x16x32_bf16 v[84:87], a[0:3], a[64:67], v[112:115]
    v_exp_f32 v74, v74
    v_mfma_f32_16x16x32_bf16 v[84:87], a[4:7], a[72:75], v[84:87]
    buffer_load_dwordx4 v20, s[16:19], s78 offen offset:1056 lds
    v_mfma_f32_16x16x32_bf16 v[84:87], a[8:11], a[80:83], v[84:87]
    ds_read_b64_tr_b16 a[42:43], v7 offset:17728
    ds_read_b64_tr_b16 a[44:45], v7 offset:17248
    v_mfma_f32_16x16x32_bf16 v[84:87], a[12:15], a[88:91], v[84:87]
    v_exp_f32 v75, v75
    v_mfma_f32_16x16x32_bf16 v[92:95], a[12:15], a[92:95], v[116:119]
    ds_read_b64_tr_b16 a[46:47], v7 offset:17760
    ds_read_b64_tr_b16 a[214:215], v12 offset:43008
    v_mfma_f32_16x16x32_bf16 v[92:95], a[8:11], a[84:87], v[92:95]
    ds_read_b64_tr_b16 a[48:49], v7 offset:17280
    ds_read_b64_tr_b16 a[50:51], v7 offset:17792
    v_mfma_f32_16x16x32_bf16 v[92:95], a[4:7], a[76:79], v[92:95]
    ds_read_b64_tr_b16 a[52:53], v7 offset:17312
    v_cvt_pk_bf16_f32 v100, v72, v73
    v_mfma_f32_16x16x32_bf16 v[92:95], a[0:3], a[68:71], v[92:95]
    ds_read_b64_tr_b16 a[54:55], v7 offset:17824
    v_cvt_pk_bf16_f32 v101, v74, v75
    v_mfma_f32_16x16x32_bf16 v[92:95], a[16:19], a[100:103], v[92:95]
    v_exp_f32 v68, v68
    v_mfma_f32_16x16x32_bf16 v[92:95], a[20:23], a[108:111], v[92:95]
    s_waitcnt lgkmcnt(8)
    buffer_load_dwordx4 v21, s[16:19], s78 offen offset:2112 lds
    v_mfma_f32_16x16x32_bf16 v[92:95], a[24:27], a[116:119], v[92:95]
    ds_read_b64_tr_b16 a[216:217], v12 offset:42248
    ds_read_b64_tr_b16 a[56:57], v7 offset:17344
    v_mfma_f32_16x16x32_bf16 v[92:95], a[28:31], a[124:127], v[92:95]
    v_exp_f32 v69, v69
    v_mfma_f32_16x16x32_bf16 v[84:87], a[28:31], a[120:123], v[84:87]
    ds_read_b64_tr_b16 a[58:59], v7 offset:17856
    ds_read_b64_tr_b16 a[60:61], v7 offset:17376
    v_mfma_f32_16x16x32_bf16 v[84:87], a[24:27], a[112:115], v[84:87]
    v_exp_f32 v70, v70
    v_mfma_f32_16x16x32_bf16 v[84:87], a[20:23], a[104:107], v[84:87]
    ds_read_b64_tr_b16 a[62:63], v7 offset:17888
    ds_read_b64_tr_b16 a[218:219], v12 offset:42504
    v_mfma_f32_16x16x32_bf16 v[84:87], a[16:19], a[96:99], v[84:87]
    v_exp_f32 v71, v71
    v_mfma_f32_16x16x32_bf16 v[192:195], a[32:35], v[104:107], v[192:195]
    buffer_load_dwordx4 v22, s[16:19], s78 offen offset:3168 lds
    v_mfma_f32_16x16x32_bf16 v[200:203], a[32:35], v[108:111], v[200:203]
    v_cvt_pk_bf16_f32 v98, v68, v69
    v_cvt_pk_bf16_f32 v99, v70, v71
    v_mfma_f32_16x16x32_bf16 v[204:207], a[36:39], v[108:111], v[204:207]
    v_exp_f32 v76, v76
    v_mfma_f32_16x16x32_bf16 v[196:199], a[36:39], v[104:107], v[196:199]
    s_waitcnt vmcnt(9) lgkmcnt(1)
    s_barrier
    ds_read_b128 a[0:3], v5 offset:33792
    v_mfma_f32_16x16x32_bf16 v[208:211], a[40:43], v[104:107], v[208:211]
    s_add_u32 s77, s75, 245760
    ds_read_b64_tr_b16 a[220:221], v12 offset:42760
    v_mfma_f32_16x16x32_bf16 v[216:219], a[40:43], v[108:111], v[216:219]
    s_add_u32 m0, s73, 67584
    ds_read_b128 a[4:7], v5 offset:33856
    v_mfma_f32_16x16x32_bf16 v[220:223], a[44:47], v[108:111], v[220:223]
    v_exp_f32 v77, v77
    v_mfma_f32_16x16x32_bf16 v[212:215], a[44:47], v[104:107], v[212:215]
    ds_read_b128 a[8:11], v5 offset:33920
    ds_read_b128 a[12:15], v5 offset:33984
    v_mfma_f32_16x16x32_bf16 v[224:227], a[48:51], v[104:107], v[224:227]
    v_exp_f32 v78, v78
    v_mfma_f32_16x16x32_bf16 v[232:235], a[48:51], v[108:111], v[232:235]
    buffer_load_dwordx4 v19, s[16:19], s77 offen lds
    v_mfma_f32_16x16x32_bf16 v[236:239], a[52:55], v[108:111], v[236:239]
    ds_read_b128 a[16:19], v5 offset:34048
    ds_read_b128 a[20:23], v5 offset:34112
    v_mfma_f32_16x16x32_bf16 v[228:231], a[52:55], v[104:107], v[228:231]
    ds_read_b64_tr_b16 a[222:223], v12 offset:43016
    ds_read_b128 a[24:27], v5 offset:34176
    v_mfma_f32_16x16x32_bf16 v[240:243], a[56:59], v[104:107], v[240:243]
    v_exp_f32 v79, v79
    v_mfma_f32_16x16x32_bf16 v[248:251], a[56:59], v[108:111], v[248:251]
    ds_read_b128 a[28:31], v5 offset:34240
    v_cvt_pk_bf16_f32 v102, v76, v77
    v_mfma_f32_16x16x32_bf16 v[252:255], a[60:63], v[108:111], v[252:255]
    ds_read_b64_tr_b16 a[32:33], v7 offset:50688
    v_cvt_pk_bf16_f32 v103, v78, v79
    v_mfma_f32_16x16x32_bf16 v[244:247], a[60:63], v[104:107], v[244:247]
    s_waitcnt lgkmcnt(6)
    ds_read_b64_tr_b16 a[34:35], v7 offset:51200
    v_mfma_f32_16x16x32_bf16 v[64:67], a[0:3], a[64:67], v[112:115]
    ds_read_b64_tr_b16 a[36:37], v7 offset:50720
    ds_read_b64_tr_b16 a[224:225], v8 offset:42240
    v_mfma_f32_16x16x32_bf16 v[64:67], a[4:7], a[72:75], v[64:67]
    buffer_load_dwordx4 v20, s[16:19], s77 offen offset:1056 lds
    v_mfma_f32_16x16x32_bf16 v[64:67], a[8:11], a[80:83], v[64:67]
    ds_read_b64_tr_b16 a[38:39], v7 offset:51232
    v_mfma_f32_16x16x32_bf16 v[64:67], a[12:15], a[88:91], v[64:67]
    ds_read_b64_tr_b16 a[40:41], v7 offset:50752
    v_mfma_f32_16x16x32_bf16 v[72:75], a[12:15], a[92:95], v[116:119]
    ds_read_b64_tr_b16 a[42:43], v7 offset:51264
    v_mfma_f32_16x16x32_bf16 v[72:75], a[8:11], a[84:87], v[72:75]
    ds_read_b64_tr_b16 a[44:45], v7 offset:50784
    v_mfma_f32_16x16x32_bf16 v[72:75], a[4:7], a[76:79], v[72:75]
    ds_read_b64_tr_b16 a[46:47], v7 offset:51296
    ds_read_b64_tr_b16 a[226:227], v8 offset:42496
    v_mfma_f32_16x16x32_bf16 v[72:75], a[0:3], a[68:71], v[72:75]
    s_waitcnt lgkmcnt(8)
    ds_read_b64_tr_b16 a[48:49], v7 offset:50816
    v_mfma_f32_16x16x32_bf16 v[72:75], a[16:19], a[100:103], v[72:75]
    buffer_load_dwordx4 v21, s[16:19], s77 offen offset:2112 lds
    v_mfma_f32_16x16x32_bf16 v[72:75], a[20:23], a[108:111], v[72:75]
    ds_read_b64_tr_b16 a[50:51], v7 offset:51328
    v_mfma_f32_16x16x32_bf16 v[72:75], a[24:27], a[116:119], v[72:75]
    ds_read_b64_tr_b16 a[52:53], v7 offset:50848
    v_mfma_f32_16x16x32_bf16 v[72:75], a[28:31], a[124:127], v[72:75]
    ds_read_b64_tr_b16 a[54:55], v7 offset:51360
    v_mfma_f32_16x16x32_bf16 v[64:67], a[28:31], a[120:123], v[64:67]
    ds_read_b64_tr_b16 a[228:229], v8 offset:42752
    v_mfma_f32_16x16x32_bf16 v[64:67], a[24:27], a[112:115], v[64:67]
    ds_read_b64_tr_b16 a[56:57], v7 offset:50880
    v_mfma_f32_16x16x32_bf16 v[64:67], a[20:23], a[104:107], v[64:67]
    ds_read_b64_tr_b16 a[58:59], v7 offset:51392
    v_mfma_f32_16x16x32_bf16 v[64:67], a[16:19], a[96:99], v[64:67]
    ds_read_b64_tr_b16 a[60:61], v7 offset:50912
    v_mfma_f32_16x16x32_bf16 v[128:131], a[32:35], v[96:99], v[128:131]
    buffer_load_dwordx4 v22, s[16:19], s77 offen offset:3168 lds
    v_mfma_f32_16x16x32_bf16 v[136:139], a[32:35], v[100:103], v[136:139]
    s_waitcnt lgkmcnt(6)
    v_exp_f32 v80, v80
    v_mfma_f32_16x16x32_bf16 v[140:143], a[36:39], v[100:103], v[140:143]
    s_add_u32 s78, s75, 229376
    ds_read_b64_tr_b16 a[62:63], v7 offset:51424
    ds_read_b128 a[0:3], v5 offset:34304
    v_mfma_f32_16x16x32_bf16 v[132:135], a[36:39], v[96:99], v[132:135]
    s_add_u32 m0, s73, 84480
    v_exp_f32 v81, v81
    v_mfma_f32_16x16x32_bf16 v[144:147], a[40:43], v[96:99], v[144:147]
    ds_read_b64_tr_b16 a[230:231], v8 offset:43008
    ds_read_b128 a[4:7], v5 offset:34368
    v_mfma_f32_16x16x32_bf16 v[152:155], a[40:43], v[100:103], v[152:155]
    ds_read_b128 a[8:11], v5 offset:34432
    ds_read_b128 a[12:15], v5 offset:34496
    v_mfma_f32_16x16x32_bf16 v[156:159], a[44:47], v[100:103], v[156:159]
    v_exp_f32 v82, v82
    v_mfma_f32_16x16x32_bf16 v[148:151], a[44:47], v[96:99], v[148:151]
    v_exp_f32 v83, v83
    v_mfma_f32_16x16x32_bf16 v[160:163], a[48:51], v[96:99], v[160:163]
    ds_read_b128 a[16:19], v5 offset:34560
    ds_read_b128 a[20:23], v5 offset:34624
    v_mfma_f32_16x16x32_bf16 v[168:171], a[48:51], v[100:103], v[168:171]
    s_waitcnt lgkmcnt(8)
    buffer_load_dwordx4 v19, s[16:19], s78 offen lds
    v_mfma_f32_16x16x32_bf16 v[172:175], a[52:55], v[100:103], v[172:175]
    ds_read_b64_tr_b16 a[232:233], v8 offset:42248
    ds_read_b128 a[24:27], v5 offset:34688
    v_mfma_f32_16x16x32_bf16 v[164:167], a[52:55], v[96:99], v[164:167]
    ds_read_b128 a[28:31], v5 offset:34752
    v_cvt_pk_bf16_f32 v104, v80, v81
    v_mfma_f32_16x16x32_bf16 v[176:179], a[56:59], v[96:99], v[176:179]
    ds_read_b64_tr_b16 a[32:33], v7 offset:50944
    v_cvt_pk_bf16_f32 v105, v82, v83
    v_mfma_f32_16x16x32_bf16 v[184:187], a[56:59], v[100:103], v[184:187]
    s_waitcnt lgkmcnt(6)
    v_exp_f32 v88, v88
    v_mfma_f32_16x16x32_bf16 v[188:191], a[60:63], v[100:103], v[188:191]
    ds_read_b64_tr_b16 a[34:35], v7 offset:51456
    ds_read_b64_tr_b16 a[36:37], v7 offset:50976
    v_mfma_f32_16x16x32_bf16 v[180:183], a[60:63], v[96:99], v[180:183]
    ds_read_b64_tr_b16 a[234:235], v8 offset:42504
    ds_read_b64_tr_b16 a[38:39], v7 offset:51488
    v_mfma_f32_16x16x32_bf16 a[240:243], a[248:251], v[96:99], a[240:243]
    buffer_load_dwordx4 v20, s[16:19], s78 offen offset:1056 lds
    v_mfma_f32_16x16x32_bf16 a[244:247], a[248:251], v[100:103], a[244:247]
    v_exp_f32 v89, v89
    v_mfma_f32_16x16x32_bf16 v[68:71], a[0:3], a[64:67], v[112:115]
    v_exp_f32 v90, v90
    v_mfma_f32_16x16x32_bf16 v[68:71], a[4:7], a[72:75], v[68:71]
    ds_read_b64_tr_b16 a[40:41], v7 offset:51008
    ds_read_b64_tr_b16 a[42:43], v7 offset:51520
    v_mfma_f32_16x16x32_bf16 v[68:71], a[8:11], a[80:83], v[68:71]
    ds_read_b64_tr_b16 a[44:45], v7 offset:51040
    ds_read_b64_tr_b16 a[46:47], v7 offset:51552
    v_mfma_f32_16x16x32_bf16 v[68:71], a[12:15], a[88:91], v[68:71]
    v_exp_f32 v91, v91
    v_mfma_f32_16x16x32_bf16 v[76:79], a[12:15], a[92:95], v[116:119]
    ds_read_b64_tr_b16 a[236:237], v8 offset:42760
    ds_read_b64_tr_b16 a[48:49], v7 offset:51072
    v_mfma_f32_16x16x32_bf16 v[76:79], a[8:11], a[84:87], v[76:79]
    buffer_load_dwordx4 v21, s[16:19], s78 offen offset:2112 lds
    v_mfma_f32_16x16x32_bf16 v[76:79], a[4:7], a[76:79], v[76:79]
    ds_read_b64_tr_b16 a[50:51], v7 offset:51584
    ds_read_b64_tr_b16 a[52:53], v7 offset:51104
    v_cvt_pk_bf16_f32 v108, v88, v89
    v_mfma_f32_16x16x32_bf16 v[76:79], a[0:3], a[68:71], v[76:79]
    s_waitcnt lgkmcnt(8)
    ds_read_b64_tr_b16 a[54:55], v7 offset:51616
    v_cvt_pk_bf16_f32 v109, v90, v91
    v_mfma_f32_16x16x32_bf16 v[76:79], a[16:19], a[100:103], v[76:79]
    v_exp_f32 v84, v84
    v_mfma_f32_16x16x32_bf16 v[76:79], a[20:23], a[108:111], v[76:79]
    ds_read_b64_tr_b16 a[238:239], v8 offset:43016
    ds_read_b64_tr_b16 a[56:57], v7 offset:51136
    v_mfma_f32_16x16x32_bf16 v[76:79], a[24:27], a[116:119], v[76:79]
    v_exp_f32 v85, v85
    v_mfma_f32_16x16x32_bf16 v[76:79], a[28:31], a[124:127], v[76:79]
    ds_read_b64_tr_b16 a[58:59], v7 offset:51648
    ds_read_b64_tr_b16 a[60:61], v7 offset:51168
    v_mfma_f32_16x16x32_bf16 v[68:71], a[28:31], a[120:123], v[68:71]
    v_exp_f32 v86, v86
    v_mfma_f32_16x16x32_bf16 v[68:71], a[24:27], a[112:115], v[68:71]
    ds_read_b64_tr_b16 a[62:63], v7 offset:51680
    v_mfma_f32_16x16x32_bf16 v[68:71], a[20:23], a[104:107], v[68:71]
    buffer_load_dwordx4 v22, s[16:19], s78 offen offset:3168 lds
    v_mfma_f32_16x16x32_bf16 v[68:71], a[16:19], a[96:99], v[68:71]
    v_exp_f32 v87, v87
    v_mfma_f32_16x16x32_bf16 v[192:195], a[32:35], v[96:99], v[192:195]
    buffer_store_dwordx4 a[252:255], v1, s[28:31], s66 offen sc1
    v_mfma_f32_16x16x32_bf16 v[200:203], a[32:35], v[100:103], v[200:203]
    s_add_u32 s80, s66, s69
    buffer_store_dwordx4 a[252:255], v1, s[28:31], s80 offen sc1
    v_mfma_f32_16x16x32_bf16 v[204:207], a[36:39], v[100:103], v[204:207]
    v_cvt_pk_bf16_f32 v106, v84, v85
    v_cvt_pk_bf16_f32 v107, v86, v87
    v_mfma_f32_16x16x32_bf16 v[196:199], a[36:39], v[96:99], v[196:199]
    s_waitcnt vmcnt(10) lgkmcnt(0)
    s_barrier
    ds_read_b128 a[0:3], v4 offset:0
    v_mfma_f32_16x16x32_bf16 v[208:211], a[40:43], v[96:99], v[208:211]
    s_add_u32 s77, s76, 128
    v_exp_f32 v92, v92
    v_mfma_f32_16x16x32_bf16 v[216:219], a[40:43], v[100:103], v[216:219]
    s_add_u32 m0, s72, 33792
    ds_read_b128 a[4:7], v4 offset:64
    v_mfma_f32_16x16x32_bf16 v[220:223], a[44:47], v[100:103], v[220:223]
    v_exp_f32 v93, v93
    v_mfma_f32_16x16x32_bf16 v[212:215], a[44:47], v[96:99], v[212:215]
    ds_read_b128 a[8:11], v4 offset:128
    ds_read_b128 a[12:15], v4 offset:192
    v_mfma_f32_16x16x32_bf16 v[224:227], a[48:51], v[96:99], v[224:227]
    buffer_load_dwordx4 v23, s[20:23], s77 offen lds
    v_mfma_f32_16x16x32_bf16 v[232:235], a[48:51], v[100:103], v[232:235]
    v_exp_f32 v94, v94
    v_mfma_f32_16x16x32_bf16 v[236:239], a[52:55], v[100:103], v[236:239]
    ds_read_b128 a[16:19], v4 offset:256
    ds_read_b128 a[20:23], v4 offset:320
    v_mfma_f32_16x16x32_bf16 v[228:231], a[52:55], v[96:99], v[228:231]
    v_exp_f32 v95, v95
    v_mfma_f32_16x16x32_bf16 v[240:243], a[56:59], v[96:99], v[240:243]
    ds_read_b128 a[24:27], v4 offset:384
    ds_read_b128 a[28:31], v4 offset:448
    v_mfma_f32_16x16x32_bf16 v[248:251], a[56:59], v[100:103], v[248:251]
    buffer_load_dwordx4 v24, s[20:23], s77 offen offset:1032 lds
    v_mfma_f32_16x16x32_bf16 v[252:255], a[60:63], v[100:103], v[252:255]
    ds_read_b64_tr_b16 a[32:33], v6 offset:16896
    v_cvt_pk_bf16_f32 v110, v92, v93
    v_cvt_pk_bf16_f32 v111, v94, v95
    v_mfma_f32_16x16x32_bf16 v[244:247], a[60:63], v[96:99], v[244:247]
    s_waitcnt lgkmcnt(5)
    ds_read_b64_tr_b16 a[34:35], v6 offset:17408
    v_mfma_f32_16x16x32_bf16 v[80:83], a[0:3], a[64:67], v[112:115]
    buffer_load_dwordx4 v25, s[20:23], s77 offen offset:2112 lds
    v_mfma_f32_16x16x32_bf16 v[80:83], a[4:7], a[72:75], v[80:83]
    ds_read_b64_tr_b16 a[36:37], v6 offset:16928
    ds_read_b64_tr_b16 a[38:39], v6 offset:17440
    v_mfma_f32_16x16x32_bf16 v[80:83], a[8:11], a[80:83], v[80:83]
    ds_read_b64_tr_b16 a[40:41], v6 offset:16960
    v_mfma_f32_16x16x32_bf16 v[80:83], a[12:15], a[88:91], v[80:83]
    buffer_load_dwordx4 v26, s[20:23], s77 offen offset:3144 lds
    v_mfma_f32_16x16x32_bf16 v[88:91], a[12:15], a[92:95], v[116:119]
    s_add_u32 s78, s76, 3712
    ds_read_b64_tr_b16 a[42:43], v6 offset:17472
    v_mfma_f32_16x16x32_bf16 v[88:91], a[8:11], a[84:87], v[88:91]
    s_add_u32 m0, s72, 38016
    ds_read_b64_tr_b16 a[44:45], v6 offset:16992
    v_mfma_f32_16x16x32_bf16 v[88:91], a[4:7], a[76:79], v[88:91]
    ds_read_b64_tr_b16 a[46:47], v6 offset:17504
    v_mfma_f32_16x16x32_bf16 v[88:91], a[0:3], a[68:71], v[88:91]
    s_waitcnt lgkmcnt(6)
    buffer_load_dwordx4 v23, s[20:23], s78 offen lds
    v_mfma_f32_16x16x32_bf16 v[88:91], a[16:19], a[100:103], v[88:91]
    ds_read_b64_tr_b16 a[48:49], v6 offset:17024
    v_mfma_f32_16x16x32_bf16 v[88:91], a[20:23], a[108:111], v[88:91]
    ds_read_b64_tr_b16 a[50:51], v6 offset:17536
    v_mfma_f32_16x16x32_bf16 v[88:91], a[24:27], a[116:119], v[88:91]
    ds_read_b64_tr_b16 a[52:53], v6 offset:17056
    v_mfma_f32_16x16x32_bf16 v[88:91], a[28:31], a[124:127], v[88:91]
    ds_read_b64_tr_b16 a[54:55], v6 offset:17568
    v_mfma_f32_16x16x32_bf16 v[80:83], a[28:31], a[120:123], v[80:83]
    buffer_load_dwordx4 v24, s[20:23], s78 offen offset:1032 lds
    v_mfma_f32_16x16x32_bf16 v[80:83], a[24:27], a[112:115], v[80:83]
    ds_read_b64_tr_b16 a[56:57], v6 offset:17088
    v_mfma_f32_16x16x32_bf16 v[80:83], a[20:23], a[104:107], v[80:83]
    ds_read_b64_tr_b16 a[58:59], v6 offset:17600
    v_mfma_f32_16x16x32_bf16 v[80:83], a[16:19], a[96:99], v[80:83]
    ds_read_b64_tr_b16 a[60:61], v6 offset:17120
    v_mfma_f32_16x16x32_bf16 v[128:131], a[32:35], v[104:107], v[128:131]
    buffer_load_dwordx4 v25, s[20:23], s78 offen offset:2112 lds
    v_mfma_f32_16x16x32_bf16 v[136:139], a[32:35], v[108:111], v[136:139]
    s_waitcnt lgkmcnt(5)
    v_exp_f32 v64, v64
    v_mfma_f32_16x16x32_bf16 v[140:143], a[36:39], v[108:111], v[140:143]
    ds_read_b64_tr_b16 a[62:63], v6 offset:17632
    ds_read_b128 a[0:3], v4 offset:512
    v_mfma_f32_16x16x32_bf16 v[132:135], a[36:39], v[104:107], v[132:135]
    v_exp_f32 v65, v65
    v_mfma_f32_16x16x32_bf16 v[144:147], a[40:43], v[104:107], v[144:147]
    ds_read_b128 a[4:7], v4 offset:576
    ds_read_b128 a[8:11], v4 offset:640
    v_mfma_f32_16x16x32_bf16 v[152:155], a[40:43], v[108:111], v[152:155]
    buffer_load_dwordx4 v26, s[20:23], s78 offen offset:3144 lds
    v_mfma_f32_16x16x32_bf16 v[156:159], a[44:47], v[108:111], v[156:159]
    s_add_u32 s77, s76, 114816
    v_exp_f32 v66, v66
    v_mfma_f32_16x16x32_bf16 v[148:151], a[44:47], v[104:107], v[148:151]
    s_add_u32 m0, s72, 101376
    ds_read_b128 a[12:15], v4 offset:704
    ds_read_b128 a[16:19], v4 offset:768
    v_mfma_f32_16x16x32_bf16 v[160:163], a[48:51], v[104:107], v[160:163]
    v_exp_f32 v67, v67
    v_mfma_f32_16x16x32_bf16 v[168:171], a[48:51], v[108:111], v[168:171]
    s_waitcnt lgkmcnt(6)
    buffer_load_dwordx4 v23, s[20:23], s77 offen lds
    v_mfma_f32_16x16x32_bf16 v[172:175], a[52:55], v[108:111], v[172:175]
    ds_read_b128 a[20:23], v4 offset:832
    ds_read_b128 a[24:27], v4 offset:896
    v_mfma_f32_16x16x32_bf16 v[164:167], a[52:55], v[104:107], v[164:167]
    ds_read_b128 a[28:31], v4 offset:960
    v_cvt_pk_bf16_f32 v96, v64, v65
    v_mfma_f32_16x16x32_bf16 v[176:179], a[56:59], v[104:107], v[176:179]
    buffer_load_dwordx4 v24, s[20:23], s77 offen offset:1032 lds
    v_mfma_f32_16x16x32_bf16 v[184:187], a[56:59], v[108:111], v[184:187]
    s_waitcnt lgkmcnt(5)
    ds_read_b64_tr_b16 a[32:33], v6 offset:17152
    ds_read_b64_tr_b16 a[34:35], v6 offset:17664
    v_cvt_pk_bf16_f32 v97, v66, v67
    v_mfma_f32_16x16x32_bf16 v[188:191], a[60:63], v[108:111], v[188:191]
    v_exp_f32 v72, v72
    v_mfma_f32_16x16x32_bf16 v[180:183], a[60:63], v[104:107], v[180:183]
    ds_read_b64_tr_b16 a[36:37], v6 offset:17184
    ds_read_b64_tr_b16 a[38:39], v6 offset:17696
    v_mfma_f32_16x16x32_bf16 a[240:243], a[248:251], v[104:107], a[240:243]
    v_exp_f32 v73, v73
    v_mfma_f32_16x16x32_bf16 a[244:247], a[248:251], v[108:111], a[244:247]
    buffer_load_dwordx4 v25, s[20:23], s77 offen offset:2112 lds
    v_mfma_f32_16x16x32_bf16 v[84:87], a[0:3], a[64:67], v[112:115]
    v_exp_f32 v74, v74
    v_mfma_f32_16x16x32_bf16 v[84:87], a[4:7], a[72:75], v[84:87]
    ds_read_b64_tr_b16 a[40:41], v6 offset:17216
    ds_read_b64_tr_b16 a[42:43], v6 offset:17728
    v_mfma_f32_16x16x32_bf16 v[84:87], a[8:11], a[80:83], v[84:87]
    s_waitcnt lgkmcnt(6)
    ds_read_b64_tr_b16 a[44:45], v6 offset:17248
    ds_read_b64_tr_b16 a[46:47], v6 offset:17760
    v_mfma_f32_16x16x32_bf16 v[84:87], a[12:15], a[88:91], v[84:87]
    buffer_load_dwordx4 v26, s[20:23], s77 offen offset:3144 lds
    v_mfma_f32_16x16x32_bf16 v[92:95], a[12:15], a[92:95], v[116:119]
    s_add_u32 s78, s76, 118400
    v_exp_f32 v75, v75
    v_mfma_f32_16x16x32_bf16 v[92:95], a[8:11], a[84:87], v[92:95]
    s_add_u32 m0, s72, 105600
    ds_read_b64_tr_b16 a[48:49], v6 offset:17280
    ds_read_b64_tr_b16 a[50:51], v6 offset:17792
    v_mfma_f32_16x16x32_bf16 v[92:95], a[4:7], a[76:79], v[92:95]
    buffer_load_dwordx4 v23, s[20:23], s78 offen lds
    v_cvt_pk_bf16_f32 v100, v72, v73
    v_mfma_f32_16x16x32_bf16 v[92:95], a[0:3], a[68:71], v[92:95]
    ds_read_b64_tr_b16 a[52:53], v6 offset:17312
    ds_read_b64_tr_b16 a[54:55], v6 offset:17824
L_hop0_8:
    s_cbranch_execz L_hopback0
    v_cvt_pk_bf16_f32 v101, v74, v75
    v_mfma_f32_16x16x32_bf16 v[92:95], a[16:19], a[100:103], v[92:95]
    v_exp_f32 v68, v68
    v_mfma_f32_16x16x32_bf16 v[92:95], a[20:23], a[108:111], v[92:95]
    v_exp_f32 v69, v69
    v_mfma_f32_16x16x32_bf16 v[92:95], a[24:27], a[116:119], v[92:95]
    ds_read_b64_tr_b16 a[56:57], v6 offset:17344
    ds_read_b64_tr_b16 a[58:59], v6 offset:17856
    v_mfma_f32_16x16x32_bf16 v[92:95], a[28:31], a[124:127], v[92:95]
    buffer_load_dwordx4 v24, s[20:23], s78 offen offset:1032 lds
    v_mfma_f32_16x16x32_bf16 v[84:87], a[28:31], a[120:123], v[84:87]
    ds_read_b64_tr_b16 a[60:61], v6 offset:17376
    ds_read_b64_tr_b16 a[62:63], v6 offset:17888
    v_mfma_f32_16x16x32_bf16 v[84:87], a[24:27], a[112:115], v[84:87]
    v_exp_f32 v70, v70
    v_mfma_f32_16x16x32_bf16 v[84:87], a[20:23], a[104:107], v[84:87]
    buffer_load_dwordx4 v25, s[20:23], s78 offen offset:2112 lds
    v_mfma_f32_16x16x32_bf16 v[84:87], a[16:19], a[96:99], v[84:87]
    s_waitcnt lgkmcnt(4)
    v_exp_f32 v71, v71
    v_mfma_f32_16x16x32_bf16 v[192:195], a[32:35], v[104:107], v[192:195]
    buffer_load_dwordx4 v26, s[20:23], s78 offen offset:3144 lds
    v_mfma_f32_16x16x32_bf16 v[200:203], a[32:35], v[108:111], v[200:203]
    v_cvt_pk_bf16_f32 v98, v68, v69
    v_cvt_pk_bf16_f32 v99, v70, v71
    v_mfma_f32_16x16x32_bf16 v[204:207], a[36:39], v[108:111], v[204:207]
    v_exp_f32 v76, v76
    v_mfma_f32_16x16x32_bf16 v[196:199], a[36:39], v[104:107], v[196:199]
    s_waitcnt vmcnt(18) lgkmcnt(0)
    s_barrier
    ds_read_b64_tr_b16 a[0:1], v7 offset:16896
    v_mfma_f32_16x16x32_bf16 v[208:211], a[40:43], v[104:107], v[208:211]
    s_add_u32 s77, s76, 256
    ds_read_b64_tr_b16 a[2:3], v7 offset:17408
    v_mfma_f32_16x16x32_bf16 v[216:219], a[40:43], v[108:111], v[216:219]
    s_add_u32 m0, s72, 0
    ds_read_b64_tr_b16 a[4:5], v7 offset:16928
    v_mfma_f32_16x16x32_bf16 v[220:223], a[44:47], v[108:111], v[220:223]
    v_exp_f32 v77, v77
    v_mfma_f32_16x16x32_bf16 v[212:215], a[44:47], v[104:107], v[212:215]
    ds_read_b64_tr_b16 a[6:7], v7 offset:17440
    ds_read_b64_tr_b16 a[8:9], v7 offset:16960
    v_mfma_f32_16x16x32_bf16 v[224:227], a[48:51], v[104:107], v[224:227]
    v_exp_f32 v78, v78
    v_mfma_f32_16x16x32_bf16 v[232:235], a[48:51], v[108:111], v[232:235]
    ds_read_b64_tr_b16 a[10:11], v7 offset:17472
    ds_read_b64_tr_b16 a[12:13], v7 offset:16992
    v_mfma_f32_16x16x32_bf16 v[236:239], a[52:55], v[108:111], v[236:239]
    buffer_load_dwordx4 v23, s[20:23], s77 offen lds
    v_mfma_f32_16x16x32_bf16 v[228:231], a[52:55], v[104:107], v[228:231]
    ds_read_b64_tr_b16 a[14:15], v7 offset:17504
    ds_read_b64_tr_b16 a[16:17], v7 offset:17024
    v_mfma_f32_16x16x32_bf16 v[240:243], a[56:59], v[104:107], v[240:243]
    v_exp_f32 v79, v79
    v_mfma_f32_16x16x32_bf16 v[248:251], a[56:59], v[108:111], v[248:251]
    ds_read_b64_tr_b16 a[18:19], v7 offset:17536
    ds_read_b64_tr_b16 a[20:21], v7 offset:17056
    v_mfma_f32_16x16x32_bf16 v[252:255], a[60:63], v[108:111], v[252:255]
    ds_read_b64_tr_b16 a[22:23], v7 offset:17568
    v_cvt_pk_bf16_f32 v102, v76, v77
    v_cvt_pk_bf16_f32 v103, v78, v79
    v_mfma_f32_16x16x32_bf16 v[244:247], a[60:63], v[104:107], v[244:247]
    s_waitcnt lgkmcnt(7)
    ds_read_b64_tr_b16 a[24:25], v7 offset:17088
    v_mfma_f32_16x16x32_bf16 v[128:131], a[0:3], v[96:99], v[128:131]
    v_exp_f32 v80, v80
    v_mfma_f32_16x16x32_bf16 v[136:139], a[0:3], v[100:103], v[136:139]
    ds_read_b64_tr_b16 a[26:27], v7 offset:17600
    ds_read_b64_tr_b16 a[28:29], v7 offset:17120
    v_mfma_f32_16x16x32_bf16 v[140:143], a[4:7], v[100:103], v[140:143]
    v_exp_f32 v81, v81
    v_mfma_f32_16x16x32_bf16 v[132:135], a[4:7], v[96:99], v[132:135]
    s_waitcnt lgkmcnt(6)
    buffer_load_dwordx4 v24, s[20:23], s77 offen offset:1032 lds
    v_mfma_f32_16x16x32_bf16 v[144:147], a[8:11], v[96:99], v[144:147]
    ds_read_b64_tr_b16 a[30:31], v7 offset:17632
    ds_read_b64_tr_b16 a[32:33], v7 offset:17152
    v_mfma_f32_16x16x32_bf16 v[152:155], a[8:11], v[100:103], v[152:155]
    v_exp_f32 v82, v82
    v_mfma_f32_16x16x32_bf16 v[156:159], a[12:15], v[100:103], v[156:159]
    ds_read_b64_tr_b16 a[34:35], v7 offset:17664
    ds_read_b64_tr_b16 a[36:37], v7 offset:17184
    v_mfma_f32_16x16x32_bf16 v[148:151], a[12:15], v[96:99], v[148:151]
    s_waitcnt lgkmcnt(6)
    v_exp_f32 v83, v83
    v_mfma_f32_16x16x32_bf16 v[160:163], a[16:19], v[96:99], v[160:163]
    ds_read_b64_tr_b16 a[38:39], v7 offset:17696
    ds_read_b64_tr_b16 a[40:41], v7 offset:17216
    v_cvt_pk_bf16_f32 v104, v80, v81
    v_mfma_f32_16x16x32_bf16 v[168:171], a[16:19], v[100:103], v[168:171]
    ds_read_b64_tr_b16 a[42:43], v7 offset:17728
    ds_read_b64_tr_b16 a[44:45], v7 offset:17248
    v_cvt_pk_bf16_f32 v105, v82, v83
    v_mfma_f32_16x16x32_bf16 v[172:175], a[20:23], v[100:103], v[172:175]
    v_exp_f32 v88, v88
    v_mfma_f32_16x16x32_bf16 v[164:167], a[20:23], v[96:99], v[164:167]
    s_waitcnt lgkmcnt(8)
    buffer_load_dwordx4 v25, s[20:23], s77 offen offset:2112 lds
    v_mfma_f32_16x16x32_bf16 v[176:179], a[24:27], v[96:99], v[176:179]
    v_exp_f32 v89, v89
    v_mfma_f32_16x16x32_bf16 v[184:187], a[24:27], v[100:103], v[184:187]
    s_waitcnt lgkmcnt(6)
    ds_read_b64_tr_b16 a[46:47], v7 offset:17760
    ds_read_b64_tr_b16 a[48:49], v7 offset:17280
    v_exp_f32 v90, v90
    v_mfma_f32_16x16x32_bf16 v[188:191], a[28:31], v[100:103], v[188:191]
    ds_read_b64_tr_b16 a[50:51], v7 offset:17792
    ds_read_b64_tr_b16 a[52:53], v7 offset:17312
    v_mfma_f32_16x16x32_bf16 v[180:183], a[28:31], v[96:99], v[180:183]
    v_exp_f32 v91, v91
    v_mfma_f32_16x16x32_bf16 a[240:243], a[248:251], v[96:99], a[240:243]
    ds_read_b64_tr_b16 a[54:55], v7 offset:17824
    ds_read_b64_tr_b16 a[56:57], v7 offset:17344
    v_mfma_f32_16x16x32_bf16 a[244:247], a[248:251], v[100:103], a[244:247]
    s_waitcnt lgkmcnt(6)
    ds_read_b64_tr_b16 a[58:59], v7 offset:17856
    ds_read_b64_tr_b16 a[60:61], v7 offset:17376
    v_cvt_pk_bf16_f32 v108, v88, v89
    v_mfma_f32_16x16x32_bf16 v[192:195], a[32:35], v[96:99], v[192:195]
    ds_read_b64_tr_b16 a[62:63], v7 offset:17888
    v_cvt_pk_bf16_f32 v109, v90, v91
    v_mfma_f32_16x16x32_bf16 v[200:203], a[32:35], v[100:103], v[200:203]
    v_exp_f32 v84, v84
    v_mfma_f32_16x16x32_bf16 v[204:207], a[36:39], v[100:103], v[204:207]
    v_exp_f32 v85, v85
    v_mfma_f32_16x16x32_bf16 v[196:199], a[36:39], v[96:99], v[196:199]
    buffer_load_dwordx4 v26, s[20:23], s77 offen offset:3144 lds
    v_mfma_f32_16x16x32_bf16 v[208:211], a[40:43], v[96:99], v[208:211]
    s_add_u32 s78, s76, 3840
    ds_read_b64_tr_b16 a[0:1], v7 offset:0
    ds_read_b64_tr_b16 a[2:3], v7 offset:512
    v_exp_f32 v86, v86
    v_mfma_f32_16x16x32_bf16 v[216:219], a[40:43], v[100:103], v[216:219]
    s_waitcnt lgkmcnt(7)
    ds_read_b64_tr_b16 a[4:5], v7 offset:32
    ds_read_b64_tr_b16 a[6:7], v7 offset:544
    v_mfma_f32_16x16x32_bf16 v[220:223], a[44:47], v[100:103], v[220:223]
    s_add_u32 m0, s72, 4224
    v_exp_f32 v87, v87
    v_mfma_f32_16x16x32_bf16 v[212:215], a[44:47], v[96:99], v[212:215]
    ds_read_b64_tr_b16 a[8:9], v7 offset:64
    ds_read_b64_tr_b16 a[10:11], v7 offset:576
    v_cvt_pk_bf16_f32 v106, v84, v85
    v_mfma_f32_16x16x32_bf16 v[224:227], a[48:51], v[96:99], v[224:227]
    ds_read_b64_tr_b16 a[12:13], v7 offset:96
    ds_read_b64_tr_b16 a[14:15], v7 offset:608
    v_cvt_pk_bf16_f32 v107, v86, v87
    v_mfma_f32_16x16x32_bf16 v[232:235], a[48:51], v[100:103], v[232:235]
    s_waitcnt lgkmcnt(8)
    v_exp_f32 v92, v92
    v_mfma_f32_16x16x32_bf16 v[236:239], a[52:55], v[100:103], v[236:239]
    ds_read_b64_tr_b16 a[16:17], v7 offset:128
    ds_read_b64_tr_b16 a[18:19], v7 offset:640
    v_mfma_f32_16x16x32_bf16 v[228:231], a[52:55], v[96:99], v[228:231]
    buffer_load_dwordx4 v23, s[20:23], s78 offen lds
    v_exp_f32 v93, v93
    v_mfma_f32_16x16x32_bf16 v[240:243], a[56:59], v[96:99], v[240:243]
    v_exp_f32 v94, v94
    v_mfma_f32_16x16x32_bf16 v[248:251], a[56:59], v[100:103], v[248:251]
    ds_read_b64_tr_b16 a[20:21], v7 offset:160
    ds_read_b64_tr_b16 a[22:23], v7 offset:672
    v_mfma_f32_16x16x32_bf16 v[252:255], a[60:63], v[100:103], v[252:255]
    v_exp_f32 v95, v95
    v_cvt_pk_bf16_f32 v110, v92, v93
    v_cvt_pk_bf16_f32 v111, v94, v95
    v_mfma_f32_16x16x32_bf16 v[244:247], a[60:63], v[96:99], v[244:247]
    s_waitcnt lgkmcnt(6)
    ds_read_b64_tr_b16 a[24:25], v7 offset:192
    ds_read_b64_tr_b16 a[26:27], v7 offset:704
    v_mfma_f32_16x16x32_bf16 v[128:131], a[0:3], v[104:107], v[128:131]
    ds_read_b64_tr_b16 a[28:29], v7 offset:224
    ds_read_b64_tr_b16 a[30:31], v7 offset:736
    v_mfma_f32_16x16x32_bf16 v[136:139], a[0:3], v[108:111], v[136:139]
    ds_read_b64_tr_b16 a[32:33], v7 offset:256
    ds_read_b64_tr_b16 a[34:35], v7 offset:768
    v_mfma_f32_16x16x32_bf16 a[240:243], a[248:251], v[104:107], a[240:243]
    buffer_load_dwordx4 v24, s[20:23], s78 offen offset:1032 lds
    v_mfma_f32_16x16x32_bf16 a[244:247], a[248:251], v[108:111], a[244:247]
    ds_read_b64_tr_b16 a[36:37], v7 offset:288
    ds_read_b64_tr_b16 a[38:39], v7 offset:800
    v_mfma_f32_16x16x32_bf16 v[140:143], a[4:7], v[108:111], v[140:143]
    ds_read_b64_tr_b16 a[40:41], v7 offset:320
    v_mfma_f32_16x16x32_bf16 v[132:135], a[4:7], v[104:107], v[132:135]
    ds_read_b64_tr_b16 a[42:43], v7 offset:832
    v_mfma_f32_16x16x32_bf16 v[144:147], a[8:11], v[104:107], v[144:147]
    ds_read_b64_tr_b16 a[44:45], v7 offset:352
    v_accvgpr_read_b32 v48, a240
    v_mfma_f32_16x16x32_bf16 v[152:155], a[8:11], v[108:111], v[152:155]
    s_waitcnt lgkmcnt(9)
    ds_read_b64_tr_b16 a[46:47], v7 offset:864
    v_accvgpr_read_b32 v49, a244
    v_mfma_f32_16x16x32_bf16 v[156:159], a[12:15], v[108:111], v[156:159]
    s_mov_b32 s3, 0x63800000
    ds_read_b64_tr_b16 a[48:49], v7 offset:384
    v_cvt_pk_bf16_f32 v128, v128, v129
    v_mfma_f32_16x16x32_bf16 v[148:151], a[12:15], v[104:107], v[148:151]
    ds_read_b64_tr_b16 a[50:51], v7 offset:896
    v_cvt_pk_bf16_f32 v129, v130, v131
    v_mfma_f32_16x16x32_bf16 v[160:163], a[16:19], v[104:107], v[160:163]
    buffer_load_dwordx4 v25, s[20:23], s78 offen offset:2112 lds
    v_mfma_f32_16x16x32_bf16 v[168:171], a[16:19], v[108:111], v[168:171]
    ds_read_b64_tr_b16 a[52:53], v7 offset:416
    ds_read_b64_tr_b16 a[54:55], v7 offset:928
    v_mfma_f32_16x16x32_bf16 v[172:175], a[20:23], v[108:111], v[172:175]
    ds_read_b64_tr_b16 a[56:57], v7 offset:448
    v_cvt_pk_bf16_f32 v130, v132, v133
    v_cvt_pk_bf16_f32 v131, v134, v135
    v_cvt_pk_bf16_f32 v136, v136, v137
    v_mfma_f32_16x16x32_bf16 v[164:167], a[20:23], v[104:107], v[164:167]
    ds_read_b64_tr_b16 a[58:59], v7 offset:960
    v_cvt_pk_bf16_f32 v137, v138, v139
    v_cvt_pk_bf16_f32 v138, v140, v141
    v_cvt_pk_bf16_f32 v139, v142, v143
    v_mfma_f32_16x16x32_bf16 v[176:179], a[24:27], v[104:107], v[176:179]
    v_cmp_nle_f32 vcc, v48, s3
    v_cmp_nle_f32 s[4:5], v49, s3
    v_mfma_f32_16x16x32_bf16 v[184:187], a[24:27], v[108:111], v[184:187]
    s_waitcnt lgkmcnt(6)
    ds_read_b64_tr_b16 a[60:61], v7 offset:480
    ds_read_b64_tr_b16 a[62:63], v7 offset:992
    v_mfma_f32_16x16x32_bf16 v[188:191], a[28:31], v[108:111], v[188:191]
    v_cvt_pk_bf16_f32 v144, v144, v145
    v_cvt_pk_bf16_f32 v145, v146, v147
    v_cvt_pk_bf16_f32 v146, v148, v149
    v_cvt_pk_bf16_f32 v147, v150, v151
    v_mfma_f32_16x16x32_bf16 v[180:183], a[28:31], v[104:107], v[180:183]
    v_cvt_pk_bf16_f32 v152, v152, v153
    v_cvt_pk_bf16_f32 v153, v154, v155
    v_cvt_pk_bf16_f32 v154, v156, v157
    v_cvt_pk_bf16_f32 v155, v158, v159
    v_mfma_f32_16x16x32_bf16 v[192:195], a[32:35], v[104:107], v[192:195]
    s_or_b64 s[4:5], s[4:5], vcc
    s_cselect_b32 s7, 1, 0
    v_cvt_pk_bf16_f32 v160, v160, v161
    v_mfma_f32_16x16x32_bf16 v[200:203], a[32:35], v[108:111], v[200:203]
    s_lshl_b32 s4, s88, 2
    buffer_load_dwordx4 v26, s[20:23], s78 offen offset:3144 lds
    v_mfma_f32_16x16x32_bf16 v[204:207], a[36:39], v[108:111], v[204:207]
    s_add_u32 s4, s4, 163328
    v_cvt_pk_bf16_f32 v161, v162, v163
    v_cvt_pk_bf16_f32 v162, v164, v165
    v_cvt_pk_bf16_f32 v163, v166, v167
    v_cvt_pk_bf16_f32 v168, v168, v169
    v_mfma_f32_16x16x32_bf16 v[196:199], a[36:39], v[104:107], v[196:199]
    s_waitcnt vmcnt(16) lgkmcnt(0)
    s_barrier
    v_cvt_pk_bf16_f32 v169, v170, v171
    v_cvt_pk_bf16_f32 v170, v172, v173
    v_cvt_pk_bf16_f32 v171, v174, v175
    v_mfma_f32_16x16x32_bf16 v[208:211], a[40:43], v[104:107], v[208:211]
    s_add_u32 s77, s76, 114944
    ds_read_b64_tr_b16 a[0:1], v12 offset:33792
    ds_read_b64_tr_b16 a[2:3], v12 offset:34048
    v_mfma_f32_16x16x32_bf16 v[216:219], a[40:43], v[108:111], v[216:219]
    s_add_u32 m0, s72, 67584
    ds_read_b64_tr_b16 a[4:5], v12 offset:34304
    v_cvt_pk_bf16_f32 v176, v176, v177
    v_mfma_f32_16x16x32_bf16 v[220:223], a[44:47], v[108:111], v[220:223]
    ds_read_b64_tr_b16 a[6:7], v12 offset:34560
    v_cvt_pk_bf16_f32 v177, v178, v179
    v_cvt_pk_bf16_f32 v178, v180, v181
    v_cvt_pk_bf16_f32 v179, v182, v183
    v_mfma_f32_16x16x32_bf16 v[212:215], a[44:47], v[104:107], v[212:215]
    ds_read_b64_tr_b16 a[8:9], v12 offset:42240
    v_cvt_pk_bf16_f32 v184, v184, v185
    v_cvt_pk_bf16_f32 v185, v186, v187
    v_cvt_pk_bf16_f32 v186, v188, v189
    v_mfma_f32_16x16x32_bf16 v[224:227], a[48:51], v[104:107], v[224:227]
    ds_read_b64_tr_b16 a[10:11], v12 offset:42496
    v_cvt_pk_bf16_f32 v187, v190, v191
    v_mov_b32 v60, s4
    v_mfma_f32_16x16x32_bf16 v[232:235], a[48:51], v[108:111], v[232:235]
    buffer_load_dwordx4 v23, s[20:23], s77 offen lds
    v_mfma_f32_16x16x32_bf16 v[236:239], a[52:55], v[108:111], v[236:239]
    ds_read_b64_tr_b16 a[12:13], v12 offset:42752
    ds_read_b64_tr_b16 a[14:15], v12 offset:43008
    v_cvt_pk_bf16_f32 v192, v192, v193
    v_cvt_pk_bf16_f32 v193, v194, v195
    v_mfma_f32_16x16x32_bf16 v[228:231], a[52:55], v[104:107], v[228:231]
    ds_read_b64_tr_b16 a[16:17], v12 offset:33800
    v_cvt_pk_bf16_f32 v194, v196, v197
    v_cvt_pk_bf16_f32 v195, v198, v199
    v_cvt_pk_bf16_f32 v200, v200, v201
    v_mfma_f32_16x16x32_bf16 v[240:243], a[56:59], v[104:107], v[240:243]
    ds_read_b64_tr_b16 a[18:19], v12 offset:34056
    v_cvt_pk_bf16_f32 v201, v202, v203
    v_cvt_pk_bf16_f32 v202, v204, v205
    v_cvt_pk_bf16_f32 v203, v206, v207
    v_mfma_f32_16x16x32_bf16 v[248:251], a[56:59], v[108:111], v[248:251]
    ds_read_b64_tr_b16 a[20:21], v12 offset:34312
    v_mov_b32 v56, s7
    v_mfma_f32_16x16x32_bf16 v[252:255], a[60:63], v[108:111], v[252:255]
    ds_write_b32 v60, v56
    v_mfma_f32_16x16x32_bf16 v[244:247], a[60:63], v[104:107], v[244:247]
    v_rcp_f32 v48, v48
    v_cvt_pk_bf16_f32 v208, v208, v209
    v_cvt_pk_bf16_f32 v209, v210, v211
    v_mfma_f32_16x16x32_bf16 v[64:67], a[128:131], v[128:131], 0
    buffer_load_dwordx4 v24, s[20:23], s77 offen offset:1032 lds
    v_cvt_pk_bf16_f32 v210, v212, v213
    v_cvt_pk_bf16_f32 v211, v214, v215
    v_mfma_f32_16x16x32_bf16 v[64:67], a[132:135], v[144:147], v[64:67]
    ds_read_b64_tr_b16 a[22:23], v12 offset:34568
    ds_read_b64_tr_b16 a[24:25], v12 offset:42248
    v_cvt_pk_bf16_f32 v216, v216, v217
    v_cvt_pk_bf16_f32 v217, v218, v219
    v_mfma_f32_16x16x32_bf16 v[72:75], a[132:135], v[152:155], 0
    ds_read_b64_tr_b16 a[26:27], v12 offset:42504
    v_cvt_pk_bf16_f32 v218, v220, v221
    v_cvt_pk_bf16_f32 v219, v222, v223
    v_rcp_f32 v49, v49
    v_mfma_f32_16x16x32_bf16 v[72:75], a[128:131], v[136:139], v[72:75]
    s_lshl_b32 s3, s88, 12
    ds_read_b64_tr_b16 a[28:29], v12 offset:42760
    ds_read_b64_tr_b16 a[30:31], v12 offset:43016
    v_cvt_pk_bf16_f32 v224, v224, v225
    v_cvt_pk_bf16_f32 v225, v226, v227
    v_mfma_f32_16x16x32_bf16 v[68:71], a[136:139], v[128:131], 0
    s_add_u32 s4, s3, 135168
    buffer_load_dwordx4 v25, s[20:23], s77 offen offset:2112 lds
    v_cvt_pk_bf16_f32 v226, v228, v229
    v_cvt_pk_bf16_f32 v227, v230, v231
    v_mfma_f32_16x16x32_bf16 v[68:71], a[140:143], v[144:147], v[68:71]
    ds_read_b64_tr_b16 a[32:33], v8 offset:33792
    ds_read_b64_tr_b16 a[34:35], v8 offset:34048
    v_cvt_pk_bf16_f32 v232, v232, v233
    v_cvt_pk_bf16_f32 v233, v234, v235
    v_mfma_f32_16x16x32_bf16 v[76:79], a[140:143], v[152:155], 0
    ds_read_b64_tr_b16 a[36:37], v8 offset:34304
    v_cvt_pk_bf16_f32 v234, v236, v237
    v_cvt_pk_bf16_f32 v235, v238, v239
    v_cvt_pk_bf16_f32 v240, v240, v241
    v_mfma_f32_16x16x32_bf16 v[76:79], a[136:139], v[136:139], v[76:79]
    ds_read_b64_tr_b16 a[38:39], v8 offset:34560
    ds_read_b64_tr_b16 a[40:41], v8 offset:42240
    v_cvt_pk_bf16_f32 v241, v242, v243
    v_cvt_pk_bf16_f32 v242, v244, v245
    v_mfma_f32_16x16x32_bf16 v[80:83], a[144:147], v[128:131], 0
    buffer_load_dwordx4 v26, s[20:23], s77 offen offset:3144 lds
    v_cvt_pk_bf16_f32 v243, v246, v247
    v_cvt_pk_bf16_f32 v248, v248, v249
    v_mfma_f32_16x16x32_bf16 v[80:83], a[148:151], v[144:147], v[80:83]
    s_add_u32 s78, s76, 118528
    ds_read_b64_tr_b16 a[42:43], v8 offset:42496
    ds_read_b64_tr_b16 a[44:45], v8 offset:42752
    v_cvt_pk_bf16_f32 v249, v250, v251
    v_cvt_pk_bf16_f32 v250, v252, v253
    v_mfma_f32_16x16x32_bf16 v[88:91], a[148:151], v[152:155], 0
    s_add_u32 m0, s72, 71808
    ds_read_b64_tr_b16 a[46:47], v8 offset:43008
    v_cvt_pk_bf16_f32 v251, v254, v255
    v_add_u32 v50, s4, v27
    s_xor_b32 s3, s3, 0x2000
    v_mfma_f32_16x16x32_bf16 v[88:91], a[144:147], v[136:139], v[88:91]
    s_add_u32 s4, s3, 135168
    ds_read_b64_tr_b16 a[48:49], v8 offset:33800
    ds_read_b64_tr_b16 a[50:51], v8 offset:34056
    v_mfma_f32_16x16x32_bf16 v[84:87], a[152:155], v[128:131], 0
    ds_read_b64_tr_b16 a[52:53], v8 offset:34312
    ds_read_b64_tr_b16 a[54:55], v8 offset:34568
    v_mfma_f32_16x16x32_bf16 v[84:87], a[156:159], v[144:147], v[84:87]
    buffer_load_dwordx4 v23, s[20:23], s78 offen lds
    v_mfma_f32_16x16x32_bf16 v[92:95], a[156:159], v[152:155], 0
    ds_read_b64_tr_b16 a[56:57], v8 offset:42248
    ds_read_b64_tr_b16 a[58:59], v8 offset:42504
    v_add_u32 v51, s4, v27
    v_mov_b32 v54, 163328
    v_mfma_f32_16x16x32_bf16 v[92:95], a[152:155], v[136:139], v[92:95]
    ds_read_b64_tr_b16 a[60:61], v8 offset:42760
    ds_read_b64_tr_b16 a[62:63], v8 offset:43016
    v_mfma_f32_16x16x32_bf16 v[64:67], a[160:163], v[160:163], v[64:67]
    buffer_load_dwordx4 v24, s[20:23], s78 offen offset:1032 lds
    v_mfma_f32_16x16x32_bf16 v[64:67], a[164:167], v[176:179], v[64:67]
    buffer_load_dwordx4 v25, s[20:23], s78 offen offset:2112 lds
    v_mfma_f32_16x16x32_bf16 v[72:75], a[164:167], v[184:187], v[72:75]
    v_mfma_f32_16x16x32_bf16 v[72:75], a[160:163], v[168:171], v[72:75]
    s_waitcnt vmcnt(15) lgkmcnt(0)
    s_barrier
    ds_read_b64_tr_b16 a[128:129], v13 offset:33792
    v_mfma_f32_16x16x32_bf16 v[68:71], a[168:171], v[160:163], v[68:71]
    ds_read_b64_tr_b16 a[130:131], v13 offset:34048
    ds_read_b128 v[56:59], v54
    v_mfma_f32_16x16x32_bf16 v[68:71], a[172:175], v[176:179], v[68:71]
    ds_read_b64_tr_b16 a[132:133], v13 offset:34304
    v_mfma_f32_16x16x32_bf16 v[76:79], a[172:175], v[184:187], v[76:79]
    ds_read_b64_tr_b16 a[134:135], v13 offset:34560
    v_mfma_f32_16x16x32_bf16 v[76:79], a[168:171], v[168:171], v[76:79]
    buffer_load_dwordx4 v26, s[20:23], s78 offen offset:3144 lds
    v_mfma_f32_16x16x32_bf16 v[80:83], a[176:179], v[160:163], v[80:83]
    s_add_u32 s77, s76, 384
    ds_read_b64_tr_b16 a[136:137], v13 offset:42240
    ds_read_b64_tr_b16 a[138:139], v13 offset:42496
    v_mfma_f32_16x16x32_bf16 v[80:83], a[180:183], v[176:179], v[80:83]
    s_add_u32 m0, s72, 33792
    ds_read_b64_tr_b16 a[140:141], v13 offset:42752
    ds_read_b64_tr_b16 a[142:143], v13 offset:43008
    v_mfma_f32_16x16x32_bf16 v[88:91], a[180:183], v[184:187], v[88:91]
    ds_read_b64_tr_b16 a[144:145], v13 offset:33800
    v_mfma_f32_16x16x32_bf16 v[88:91], a[176:179], v[168:171], v[88:91]
    ds_read_b64_tr_b16 a[146:147], v13 offset:34056
    v_mfma_f32_16x16x32_bf16 v[84:87], a[184:187], v[160:163], v[84:87]
    ds_read_b64_tr_b16 a[148:149], v13 offset:34312
    ds_read_b64_tr_b16 a[150:151], v13 offset:34568
    v_mfma_f32_16x16x32_bf16 v[84:87], a[188:191], v[176:179], v[84:87]
    s_waitcnt lgkmcnt(9)
    v_or3_b32 v56, v56, v57, v58
    v_or_b32 v56, v56, v59
    v_mfma_f32_16x16x32_bf16 v[92:95], a[188:191], v[184:187], v[92:95]
    buffer_load_dwordx4 v23, s[20:23], s77 offen lds
    v_mfma_f32_16x16x32_bf16 v[92:95], a[184:187], v[168:171], v[92:95]
    ds_read_b64_tr_b16 a[152:153], v13 offset:42248
    v_readfirstlane_b32 s3, v56
    v_mfma_f32_16x16x32_bf16 v[64:67], v[32:35], v[192:195], v[64:67]
    ds_read_b64_tr_b16 a[154:155], v13 offset:42504
    ds_read_b64_tr_b16 a[156:157], v13 offset:42760
    v_mfma_f32_16x16x32_bf16 v[64:67], v[36:39], v[208:211], v[64:67]
    s_cmp_lg_u32 s3, 0
    s_cbranch_scc1 L_slow
    ds_read_b64_tr_b16 a[158:159], v13 offset:43016
    v_mfma_f32_16x16x32_bf16 v[72:75], v[36:39], v[216:219], v[72:75]
    buffer_load_dwordx4 v24, s[20:23], s77 offen offset:1032 lds
    v_mfma_f32_16x16x32_bf16 v[72:75], v[32:35], v[200:203], v[72:75]
    ds_read_b64_tr_b16 a[160:161], v9 offset:33792
    ds_read_b64_tr_b16 a[162:163], v9 offset:34048
    v_mfma_f32_16x16x32_bf16 v[68:71], v[40:43], v[192:195], v[68:71]
    ds_read_b64_tr_b16 a[164:165], v9 offset:34304
    ds_read_b64_tr_b16 a[166:167], v9 offset:34560
    v_mfma_f32_16x16x32_bf16 v[68:71], v[44:47], v[208:211], v[68:71]
    ds_read_b64_tr_b16 a[168:169], v9 offset:42240
    ds_read_b64_tr_b16 a[170:171], v9 offset:42496
    v_mfma_f32_16x16x32_bf16 v[76:79], v[44:47], v[216:219], v[76:79]
    ds_read_b64_tr_b16 a[172:173], v9 offset:42752
    ds_read_b64_tr_b16 a[174:175], v9 offset:43008
    v_mfma_f32_16x16x32_bf16 v[76:79], v[40:43], v[200:203], v[76:79]
    buffer_load_dwordx4 v25, s[20:23], s77 offen offset:2112 lds
    v_mfma_f32_16x16x32_bf16 v[80:83], a[192:195], v[192:195], v[80:83]
    ds_read_b64_tr_b16 a[176:177], v9 offset:33800
    ds_read_b64_tr_b16 a[178:179], v9 offset:34056
    v_mfma_f32_16x16x32_bf16 v[80:83], a[196:199], v[208:211], v[80:83]
    ds_read_b64_tr_b16 a[180:181], v9 offset:34312
    ds_read_b64_tr_b16 a[182:183], v9 offset:34568
    v_mfma_f32_16x16x32_bf16 v[88:91], a[196:199], v[216:219], v[88:91]
    buffer_load_dwordx4 v26, s[20:23], s77 offen offset:3144 lds
    v_mfma_f32_16x16x32_bf16 v[88:91], a[192:195], v[200:203], v[88:91]
    s_add_u32 s78, s76, 3968
    ds_read_b64_tr_b16 a[184:185], v9 offset:42248
    ds_read_b64_tr_b16 a[186:187], v9 offset:42504
    v_mfma_f32_16x16x32_bf16 v[84:87], a[200:203], v[192:195], v[84:87]
    s_add_u32 m0, s72, 38016
    ds_read_b64_tr_b16 a[188:189], v9 offset:42760
    v_mfma_f32_16x16x32_bf16 v[84:87], a[204:207], v[208:211], v[84:87]
    ds_read_b64_tr_b16 a[190:191], v9 offset:43016
    v_mfma_f32_16x16x32_bf16 v[92:95], a[204:207], v[216:219], v[92:95]
    buffer_load_dwordx4 v23, s[20:23], s78 offen lds
    v_mfma_f32_16x16x32_bf16 v[92:95], a[200:203], v[200:203], v[92:95]
    v_mfma_f32_16x16x32_bf16 v[64:67], a[208:211], v[224:227], v[64:67]
    v_mfma_f32_16x16x32_bf16 v[132:135], a[212:215], v[240:243], v[64:67]
    buffer_load_dwordx4 v24, s[20:23], s78 offen offset:1032 lds
    v_mfma_f32_16x16x32_bf16 v[72:75], a[212:215], v[248:251], v[72:75]
    v_mfma_f32_16x16x32_bf16 v[148:151], a[208:211], v[232:235], v[72:75]
    s_waitcnt vmcnt(14) lgkmcnt(0)
    s_barrier
    ds_read_b64_tr_b16 a[64:65], v12 offset:0
    v_mfma_f32_16x16x32_bf16 v[68:71], a[216:219], v[224:227], v[68:71]
    ds_read_b64_tr_b16 a[66:67], v12 offset:256
    v_bfe_u32 v43, v0, 3, 1
    v_mfma_f32_16x16x32_bf16 v[140:143], a[220:223], v[240:243], v[68:71]
    s_lshl_b32 s3, s90, 2
    ds_read_b64_tr_b16 a[68:69], v12 offset:512
    v_mfma_f32_16x16x32_bf16 v[76:79], a[220:223], v[248:251], v[76:79]
    s_and_b32 s4, s86, 5
    ds_read_b64_tr_b16 a[70:71], v12 offset:768
    v_mfma_f32_16x16x32_bf16 v[156:159], a[216:219], v[232:235], v[76:79]
    s_sub_u32 s3, s4, s3
    ds_read_b64_tr_b16 a[72:73], v12 offset:8448
    v_mfma_f32_16x16x32_bf16 v[80:83], a[224:227], v[224:227], v[80:83]
    buffer_load_dwordx4 v25, s[20:23], s78 offen offset:2112 lds
    v_mfma_f32_16x16x32_bf16 v[164:167], a[228:231], v[240:243], v[80:83]
    ds_read_b64_tr_b16 a[74:75], v12 offset:8704
    ds_read_b64_tr_b16 a[76:77], v12 offset:8960
    v_mfma_f32_16x16x32_bf16 v[88:91], a[228:231], v[248:251], v[88:91]
    ds_read_b64_tr_b16 a[78:79], v12 offset:9216
    ds_read_b64_tr_b16 a[192:193], v12 offset:8
    v_mfma_f32_16x16x32_bf16 v[180:183], a[224:227], v[232:235], v[88:91]
    ds_read_b64_tr_b16 a[194:195], v12 offset:264
    v_mul_f32 v132, v48, v132
    v_mfma_f32_16x16x32_bf16 v[84:87], a[232:235], v[224:227], v[84:87]
    buffer_load_dwordx4 v26, s[20:23], s78 offen offset:3144 lds
    v_mfma_f32_16x16x32_bf16 v[172:175], a[236:239], v[240:243], v[84:87]
    s_add_u32 s77, s76, 115072
    ds_read_b64_tr_b16 a[196:197], v12 offset:520
    ds_read_b64_tr_b16 a[198:199], v12 offset:776
    v_mfma_f32_16x16x32_bf16 v[92:95], a[236:239], v[248:251], v[92:95]
    s_add_u32 m0, s72, 101376
    ds_read_b64_tr_b16 a[200:201], v12 offset:8456
    ds_read_b64_tr_b16 a[202:203], v12 offset:8712
    v_mul_f32 v133, v48, v133
    v_mfma_f32_16x16x32_bf16 v[188:191], a[232:235], v[232:235], v[92:95]
    ds_read_b64_tr_b16 a[204:205], v12 offset:8968
    v_cmp_eq_u32 s[16:17], s3, v43
    v_mul_f32 v134, v48, v134
    v_mfma_f32_16x16x32_bf16 v[64:67], a[0:3], v[128:131], 0
    ds_read_b64_tr_b16 a[206:207], v12 offset:9224
    v_mul_f32 v135, v48, v135
    v_mfma_f32_16x16x32_bf16 v[64:67], a[4:7], v[144:147], v[64:67]
    ds_read_b64_tr_b16 a[208:209], v8 offset:0
    ds_read_b64_tr_b16 a[210:211], v8 offset:256
    v_mov_b32 v63, 1073741824
    v_cvt_pk_bf16_f32 v132, v132, v133
    v_mfma_f32_16x16x32_bf16 v[64:67], a[8:11], v[160:163], v[64:67]
    buffer_load_dwordx4 v23, s[20:23], s77 offen lds
    v_cvt_pk_bf16_f32 v133, v134, v135
    v_mul_f32 v140, v48, v140
    v_mfma_f32_16x16x32_bf16 v[64:67], a[12:15], v[176:179], v[64:67]
    ds_read_b64_tr_b16 a[212:213], v8 offset:512
    ds_read_b64_tr_b16 a[214:215], v8 offset:768
    v_cndmask_b32 v1, v27, v63, s[16:17]
    v_mul_f32 v141, v48, v141
    v_mfma_f32_16x16x32_bf16 v[72:75], a[12:15], v[184:187], 0
    ds_read_b64_tr_b16 a[216:217], v8 offset:8448
    v_mul_f32 v142, v48, v142
    v_mfma_f32_16x16x32_bf16 v[72:75], a[8:11], v[168:171], v[72:75]
    ds_read_b64_tr_b16 a[218:219], v8 offset:8704
    ds_read_b64_tr_b16 a[220:221], v8 offset:8960
    v_lshrrev_b32 v43, 4, v0
    v_mul_f32 v143, v48, v143
    v_mfma_f32_16x16x32_bf16 v[72:75], a[4:7], v[152:155], v[72:75]
    buffer_load_dwordx4 v24, s[20:23], s77 offen offset:1032 lds
    v_cvt_pk_bf16_f32 v134, v140, v141
    v_cvt_pk_bf16_f32 v135, v142, v143
    v_mfma_f32_16x16x32_bf16 v[72:75], a[0:3], v[136:139], v[72:75]
    ds_write_b128 v50, v[132:135] offset:0
    v_mfma_f32_16x16x32_bf16 v[68:71], a[16:19], v[128:131], 0
    ds_read_b64_tr_b16 a[222:223], v8 offset:9216
    v_lshlrev_b32 v43, 7, v43
    v_mul_f32 v148, v49, v148
    v_mfma_f32_16x16x32_bf16 v[68:71], a[20:23], v[144:147], v[68:71]
    ds_read_b64_tr_b16 a[224:225], v8 offset:8
    ds_read_b64_tr_b16 a[226:227], v8 offset:264
    v_and_b32 v53, 7, v0
    v_mul_f32 v149, v49, v149
    v_mfma_f32_16x16x32_bf16 v[68:71], a[24:27], v[160:163], v[68:71]
    ds_read_b64_tr_b16 a[228:229], v8 offset:520
    ds_read_b64_tr_b16 a[230:231], v8 offset:776
    v_mul_f32 v150, v49, v150
    v_mul_f32 v151, v49, v151
    v_mfma_f32_16x16x32_bf16 v[68:71], a[28:31], v[176:179], v[68:71]
    ds_read_b64_tr_b16 a[232:233], v8 offset:8456
    ds_read_b64_tr_b16 a[234:235], v8 offset:8712
    v_lshl_add_u32 v43, v53, 4, v43
    v_cvt_pk_bf16_f32 v148, v148, v149
L_hop0_9:
    s_cbranch_execz L_hopback0
    v_mfma_f32_16x16x32_bf16 v[76:79], a[28:31], v[184:187], 0
    s_lshl_b32 s3, s89, 9
    buffer_load_dwordx4 v25, s[20:23], s77 offen offset:2112 lds
    v_cvt_pk_bf16_f32 v149, v150, v151
    v_mfma_f32_16x16x32_bf16 v[76:79], a[24:27], v[168:171], v[76:79]
    s_add_u32 s3, s3, 151552
    ds_read_b64_tr_b16 a[236:237], v8 offset:8968
    ds_read_b64_tr_b16 a[238:239], v8 offset:9224
    v_mul_f32 v156, v49, v156
    v_mfma_f32_16x16x32_bf16 v[76:79], a[20:23], v[152:155], v[76:79]
    buffer_load_dwordx4 v26, s[20:23], s77 offen offset:3144 lds
    v_mul_f32 v157, v49, v157
    v_mul_f32 v158, v49, v158
    v_mfma_f32_16x16x32_bf16 v[76:79], a[16:19], v[136:139], v[76:79]
    s_add_u32 s78, s76, 118656
    v_mul_f32 v159, v49, v159
    v_cvt_pk_bf16_f32 v150, v156, v157
    v_mfma_f32_16x16x32_bf16 v[80:83], a[32:35], v[128:131], 0
    s_add_u32 m0, s72, 105600
    v_cvt_pk_bf16_f32 v151, v158, v159
    ds_write_b128 v50, v[148:151] offset:1024
    v_mfma_f32_16x16x32_bf16 v[80:83], a[36:39], v[144:147], v[80:83]
    v_add_u32 v52, s3, v43
    v_mfma_f32_16x16x32_bf16 v[80:83], a[40:43], v[160:163], v[80:83]
    s_lshl_b32 s3, s86, 4
    buffer_load_dwordx4 v23, s[20:23], s78 offen lds
    v_mfma_f32_16x16x32_bf16 v[80:83], a[44:47], v[176:179], v[80:83]
    s_waitcnt vmcnt(13) lgkmcnt(0)
    s_barrier
    ds_read_b64_tr_b16 a[0:1], v13 offset:0
    v_mfma_f32_16x16x32_bf16 v[88:91], a[44:47], v[184:187], 0
    s_add_u32 s3, s3, s34
    ds_read_b64_tr_b16 a[2:3], v13 offset:256
    ds_read_b128 v[96:99], v51 offset:0
    v_mfma_f32_16x16x32_bf16 v[88:91], a[40:43], v[168:171], v[88:91]
    s_add_u32 s98, s3, 251904
    ds_read_b64_tr_b16 a[4:5], v13 offset:512
    ds_read_b128 v[100:103], v51 offset:1024
    v_mfma_f32_16x16x32_bf16 v[88:91], a[36:39], v[152:155], v[88:91]
    s_add_u32 s3, s86, 1
    ds_read_b64_tr_b16 a[6:7], v13 offset:768
    v_mfma_f32_16x16x32_bf16 v[88:91], a[32:35], v[136:139], v[88:91]
    ds_read_b64_tr_b16 a[8:9], v13 offset:8448
    v_mfma_f32_16x16x32_bf16 v[84:87], a[48:51], v[128:131], 0
    s_and_b32 s3, s3, 7
    buffer_load_dwordx4 v24, s[20:23], s78 offen offset:1032 lds
    v_mfma_f32_16x16x32_bf16 v[84:87], a[52:55], v[144:147], v[84:87]
    s_and_b32 s4, s3, 4
    ds_read_b64_tr_b16 a[10:11], v13 offset:8704
    ds_read_b64_tr_b16 a[12:13], v13 offset:8960
    v_mfma_f32_16x16x32_bf16 v[84:87], a[56:59], v[160:163], v[84:87]
    ds_read_b64_tr_b16 a[14:15], v13 offset:9216
    ds_read_b64_tr_b16 a[16:17], v13 offset:8
    v_mfma_f32_16x16x32_bf16 v[84:87], a[60:63], v[176:179], v[84:87]
    s_add_u32 s3, s3, s4
    ds_read_b64_tr_b16 a[18:19], v13 offset:264
    s_waitcnt lgkmcnt(9)
    v_lshlrev_b32 v196, 16, v96
    v_mfma_f32_16x16x32_bf16 v[92:95], a[60:63], v[184:187], 0
    ds_read_b64_tr_b16 a[20:21], v13 offset:520
    ds_read_b64_tr_b16 a[22:23], v13 offset:776
    v_mfma_f32_16x16x32_bf16 v[92:95], a[56:59], v[168:171], v[92:95]
    s_lshl_b32 s8, s3, 11
    buffer_load_dwordx4 v25, s[20:23], s78 offen offset:2112 lds
    v_mfma_f32_16x16x32_bf16 v[92:95], a[52:55], v[152:155], v[92:95]
    ds_read_b64_tr_b16 a[24:25], v13 offset:8456
    ds_read_b64_tr_b16 a[26:27], v13 offset:8712
    v_and_b32 v197, s68, v96
    v_mfma_f32_16x16x32_bf16 v[92:95], a[48:51], v[136:139], v[92:95]
    s_add_u32 s3, s86, 2
    ds_read_b64_tr_b16 a[28:29], v13 offset:8968
    v_lshlrev_b32 v198, 16, v97
    v_and_b32 v199, s68, v97
    v_mfma_f32_16x16x32_bf16 v[64:67], a[128:131], v[192:195], v[64:67]
    s_and_b32 s3, s3, 7
    ds_read_b64_tr_b16 a[30:31], v13 offset:9224
    v_fmac_f32 v196, v48, v164
    v_fmac_f32 v197, v48, v165
    v_mfma_f32_16x16x32_bf16 v[64:67], a[132:135], v[208:211], v[64:67]
    buffer_load_dwordx4 v26, s[20:23], s78 offen offset:3144 lds
    v_fmac_f32 v198, v48, v166
    v_fmac_f32 v199, v48, v167
    v_mfma_f32_16x16x32_bf16 v[64:67], a[136:139], v[224:227], v[64:67]
    s_add_u32 s77, s76, 512
    ds_read_b64_tr_b16 a[32:33], v9 offset:0
    ds_read_b64_tr_b16 a[34:35], v9 offset:256
    v_cvt_pk_bf16_f32 v96, v196, v197
    v_cvt_pk_bf16_f32 v97, v198, v199
    v_mfma_f32_16x16x32_bf16 v[132:135], a[140:143], v[240:243], v[64:67]
    s_add_u32 m0, s72, 0
    ds_read_b64_tr_b16 a[36:37], v9 offset:512
    ds_read_b64_tr_b16 a[38:39], v9 offset:768
    v_lshlrev_b32 v204, 16, v98
    v_and_b32 v205, s68, v98
    v_mfma_f32_16x16x32_bf16 v[72:75], a[140:143], v[248:251], v[72:75]
    s_and_b32 s4, s3, 4
    ds_read_b64_tr_b16 a[40:41], v9 offset:8448
    v_lshlrev_b32 v206, 16, v99
    v_and_b32 v207, s68, v99
    v_mfma_f32_16x16x32_bf16 v[72:75], a[136:139], v[232:235], v[72:75]
    s_add_u32 s3, s3, s4
    ds_read_b64_tr_b16 a[42:43], v9 offset:8704
    ds_read_b64_tr_b16 a[44:45], v9 offset:8960
    v_fmac_f32 v204, v48, v172
    v_fmac_f32 v205, v48, v173
    v_mfma_f32_16x16x32_bf16 v[72:75], a[132:135], v[216:219], v[72:75]
    s_lshl_b32 s9, s3, 11
    ds_read_b64_tr_b16 a[46:47], v9 offset:9216
    v_fmac_f32 v206, v48, v174
    v_fmac_f32 v207, v48, v175
    v_mfma_f32_16x16x32_bf16 v[148:151], a[128:131], v[200:203], v[72:75]
    s_add_u32 s3, s86, 3
    buffer_load_dwordx4 v23, s[20:23], s77 offen lds
    v_cvt_pk_bf16_f32 v98, v204, v205
    v_cvt_pk_bf16_f32 v99, v206, v207
    v_mfma_f32_16x16x32_bf16 v[68:71], a[144:147], v[192:195], v[68:71]
    ds_read_b64_tr_b16 a[48:49], v9 offset:8
    ds_read_b64_tr_b16 a[50:51], v9 offset:264
    s_waitcnt lgkmcnt(10)
    v_lshlrev_b32 v212, 16, v100
    v_mfma_f32_16x16x32_bf16 v[68:71], a[148:151], v[208:211], v[68:71]
    s_and_b32 s3, s3, 7
    ds_read_b64_tr_b16 a[52:53], v9 offset:520
    v_and_b32 v213, s68, v100
    v_lshlrev_b32 v214, 16, v101
    v_and_b32 v215, s68, v101
    v_mfma_f32_16x16x32_bf16 v[68:71], a[152:155], v[224:227], v[68:71]
    ds_read_b64_tr_b16 a[54:55], v9 offset:776
    ds_read_b64_tr_b16 a[56:57], v9 offset:8456
    v_fmac_f32 v212, v49, v180
    v_fmac_f32 v213, v49, v181
    v_mfma_f32_16x16x32_bf16 v[140:143], a[156:159], v[240:243], v[68:71]
    s_and_b32 s4, s3, 4
    buffer_load_dwordx4 v24, s[20:23], s77 offen offset:1032 lds
    v_fmac_f32 v214, v49, v182
    v_fmac_f32 v215, v49, v183
    v_mfma_f32_16x16x32_bf16 v[76:79], a[156:159], v[248:251], v[76:79]
    ds_read_b64_tr_b16 a[58:59], v9 offset:8712
    ds_read_b64_tr_b16 a[60:61], v9 offset:8968
    v_cvt_pk_bf16_f32 v100, v212, v213
    v_cvt_pk_bf16_f32 v101, v214, v215
    v_mfma_f32_16x16x32_bf16 v[76:79], a[152:155], v[232:235], v[76:79]
    s_add_u32 s3, s3, s4
    ds_read_b64_tr_b16 a[62:63], v9 offset:9224
    v_lshlrev_b32 v220, 16, v102
    v_and_b32 v221, s68, v102
    v_mfma_f32_16x16x32_bf16 v[76:79], a[148:151], v[216:219], v[76:79]
    v_lshlrev_b32 v222, 16, v103
    v_and_b32 v223, s68, v103
    v_mfma_f32_16x16x32_bf16 v[156:159], a[144:147], v[200:203], v[76:79]
    s_lshl_b32 s10, s3, 11
    buffer_load_dwordx4 v25, s[20:23], s77 offen offset:2112 lds
    v_fmac_f32 v220, v49, v188
    v_fmac_f32 v221, v49, v189
    v_mfma_f32_16x16x32_bf16 v[80:83], a[160:163], v[192:195], v[80:83]
    s_add_u32 s3, s86, 4
    v_fmac_f32 v222, v49, v190
    v_fmac_f32 v223, v49, v191
    v_cvt_pk_bf16_f32 v102, v220, v221
    v_cvt_pk_bf16_f32 v103, v222, v223
    v_mfma_f32_16x16x32_bf16 v[80:83], a[164:167], v[208:211], v[80:83]
    s_add_u32 s80, s79, 0
    buffer_store_dwordx4 v[96:99], v1, s[28:31], s80 offen sc1
    v_mfma_f32_16x16x32_bf16 v[80:83], a[168:171], v[224:227], v[80:83]
    s_and_b32 s3, s3, 7
    buffer_load_dwordx4 v26, s[20:23], s77 offen offset:3144 lds
    v_mfma_f32_16x16x32_bf16 v[164:167], a[172:175], v[240:243], v[80:83]
    s_waitcnt vmcnt(13) lgkmcnt(0)
    s_barrier
    ds_read_b64_tr_b16 a[128:129], v12 offset:33792
    v_mfma_f32_16x16x32_bf16 v[88:91], a[172:175], v[248:251], v[88:91]
    s_add_u32 s78, s76, 4096
    ds_read_b64_tr_b16 a[130:131], v12 offset:34048
    v_mfma_f32_16x16x32_bf16 v[88:91], a[168:171], v[232:235], v[88:91]
    s_add_u32 m0, s72, 4224
    ds_read_b64_tr_b16 a[132:133], v12 offset:34304
    v_mfma_f32_16x16x32_bf16 v[88:91], a[164:167], v[216:219], v[88:91]
    s_and_b32 s4, s3, 4
    s_add_u32 s80, s81, 0
    buffer_store_dwordx4 v[100:103], v27, s[28:31], s80 offen sc1
    v_mfma_f32_16x16x32_bf16 v[180:183], a[160:163], v[200:203], v[88:91]
    s_add_u32 s3, s3, s4
    ds_read_b64_tr_b16 a[134:135], v12 offset:34560
    ds_read_b64_tr_b16 a[136:137], v12 offset:42240
    v_mfma_f32_16x16x32_bf16 v[84:87], a[176:179], v[192:195], v[84:87]
    s_lshl_b32 s11, s3, 11
    s_mov_b64 exec, s[16:17]
    ds_write_b128 v52, v[96:99] offset:0
    s_mov_b64 exec, -1
    v_mfma_f32_16x16x32_bf16 v[84:87], a[180:183], v[208:211], v[84:87]
    s_add_u32 s3, s86, 5
    v_mul_f32 v132, v48, v132
    v_mul_f32 v133, v48, v133
    v_mfma_f32_16x16x32_bf16 v[84:87], a[184:187], v[224:227], v[84:87]
    ds_read_b64_tr_b16 a[138:139], v12 offset:42496
    ds_read_b64_tr_b16 a[140:141], v12 offset:42752
    v_mfma_f32_16x16x32_bf16 v[172:175], a[188:191], v[240:243], v[84:87]
    s_and_b32 s3, s3, 7
    buffer_load_dwordx4 v23, s[20:23], s78 offen lds
    v_mfma_f32_16x16x32_bf16 v[92:95], a[188:191], v[248:251], v[92:95]
    ds_read_b64_tr_b16 a[142:143], v12 offset:43008
    ds_read_b64_tr_b16 a[144:145], v12 offset:33800
    v_mfma_f32_16x16x32_bf16 v[92:95], a[184:187], v[232:235], v[92:95]
    s_and_b32 s4, s3, 4
    ds_read_b64_tr_b16 a[146:147], v12 offset:34056
    ds_read_b64_tr_b16 a[148:149], v12 offset:34312
    v_mul_f32 v134, v48, v134
    v_mfma_f32_16x16x32_bf16 v[92:95], a[180:183], v[216:219], v[92:95]
    s_add_u32 s3, s3, s4
    ds_read_b64_tr_b16 a[150:151], v12 offset:34568
    ds_read_b64_tr_b16 a[152:153], v12 offset:42248
    v_mul_f32 v135, v48, v135
    v_cvt_pk_bf16_f32 v132, v132, v133
    v_mfma_f32_16x16x32_bf16 v[188:191], a[176:179], v[200:203], v[92:95]
    buffer_load_dwordx4 v24, s[20:23], s78 offen offset:1032 lds
    v_cvt_pk_bf16_f32 v133, v134, v135
    v_mfma_f32_16x16x32_bf16 v[64:67], a[64:67], v[128:131], 0
    s_lshl_b32 s12, s3, 11
    ds_read_b64_tr_b16 a[154:155], v12 offset:42504
    ds_read_b64_tr_b16 a[156:157], v12 offset:42760
    v_mul_f32 v140, v48, v140
    v_mfma_f32_16x16x32_bf16 v[64:67], a[68:71], v[144:147], v[64:67]
    ds_read_b64_tr_b16 a[158:159], v12 offset:43016
    ds_read_b64_tr_b16 a[160:161], v8 offset:33792
    v_mul_f32 v141, v48, v141
    v_mul_f32 v142, v48, v142
    v_mfma_f32_16x16x32_bf16 v[64:67], a[72:75], v[160:163], v[64:67]
    s_add_u32 s3, s86, 6
    ds_read_b64_tr_b16 a[162:163], v8 offset:34048
    ds_read_b64_tr_b16 a[164:165], v8 offset:34304
    v_mul_f32 v143, v48, v143
    v_mfma_f32_16x16x32_bf16 v[64:67], a[76:79], v[176:179], v[64:67]
    buffer_load_dwordx4 v25, s[20:23], s78 offen offset:2112 lds
    v_cvt_pk_bf16_f32 v134, v140, v141
    v_mfma_f32_16x16x32_bf16 v[72:75], a[76:79], v[184:187], 0
    s_and_b32 s3, s3, 7
    ds_read_b64_tr_b16 a[166:167], v8 offset:34560
    ds_read_b64_tr_b16 a[168:169], v8 offset:42240
    v_cvt_pk_bf16_f32 v135, v142, v143
    v_mfma_f32_16x16x32_bf16 v[72:75], a[72:75], v[168:171], v[72:75]
    s_and_b32 s4, s3, 4
    ds_write_b128 v50, v[132:135] offset:0
    v_mfma_f32_16x16x32_bf16 v[72:75], a[68:71], v[152:155], v[72:75]
    v_mul_f32 v148, v49, v148
    v_mul_f32 v149, v49, v149
    v_mul_f32 v150, v49, v150
    v_mfma_f32_16x16x32_bf16 v[72:75], a[64:67], v[136:139], v[72:75]
    s_add_u32 s3, s3, s4
    ds_read_b64_tr_b16 a[170:171], v8 offset:42496
    ds_read_b64_tr_b16 a[172:173], v8 offset:42752
    v_mul_f32 v151, v49, v151
    v_mfma_f32_16x16x32_bf16 v[68:71], a[192:195], v[128:131], 0
    buffer_load_dwordx4 v26, s[20:23], s78 offen offset:3144 lds
    v_cvt_pk_bf16_f32 v148, v148, v149
    v_mfma_f32_16x16x32_bf16 v[68:71], a[196:199], v[144:147], v[68:71]
    s_add_u32 s77, s76, 115200
    ds_read_b64_tr_b16 a[174:175], v8 offset:43008
    ds_read_b64_tr_b16 a[176:177], v8 offset:33800
    v_cvt_pk_bf16_f32 v149, v150, v151
    v_mul_f32 v156, v49, v156
    v_mfma_f32_16x16x32_bf16 v[68:71], a[200:203], v[160:163], v[68:71]
    s_add_u32 m0, s72, 67584
    ds_read_b64_tr_b16 a[178:179], v8 offset:34056
    ds_read_b64_tr_b16 a[180:181], v8 offset:34312
    v_mul_f32 v157, v49, v157
    v_mfma_f32_16x16x32_bf16 v[68:71], a[204:207], v[176:179], v[68:71]
    s_lshl_b32 s13, s3, 11
    ds_read_b64_tr_b16 a[182:183], v8 offset:34568
    ds_read_b64_tr_b16 a[184:185], v8 offset:42248
    v_mul_f32 v158, v49, v158
    v_mfma_f32_16x16x32_bf16 v[76:79], a[204:207], v[184:187], 0
    s_add_u32 s3, s86, 7
    ds_read_b64_tr_b16 a[186:187], v8 offset:42504
    v_mul_f32 v159, v49, v159
    v_cvt_pk_bf16_f32 v150, v156, v157
    v_cvt_pk_bf16_f32 v151, v158, v159
    ds_write_b128 v50, v[148:151] offset:1024
    v_mfma_f32_16x16x32_bf16 v[76:79], a[200:203], v[168:171], v[76:79]
    s_and_b32 s3, s3, 7
    buffer_load_dwordx4 v23, s[20:23], s77 offen lds
    v_mfma_f32_16x16x32_bf16 v[76:79], a[196:199], v[152:155], v[76:79]
    s_and_b32 s4, s3, 4
    ds_read_b64_tr_b16 a[188:189], v8 offset:42760
    ds_read_b64_tr_b16 a[190:191], v8 offset:43016
    v_mfma_f32_16x16x32_bf16 v[76:79], a[192:195], v[136:139], v[76:79]
    buffer_load_dwordx4 v24, s[20:23], s77 offen offset:1032 lds
    v_mfma_f32_16x16x32_bf16 v[80:83], a[208:211], v[128:131], 0
    s_add_u32 s3, s3, s4
    v_mfma_f32_16x16x32_bf16 v[80:83], a[212:215], v[144:147], v[80:83]
    v_mfma_f32_16x16x32_bf16 v[80:83], a[216:219], v[160:163], v[80:83]
    s_lshl_b32 s14, s3, 11
    v_mfma_f32_16x16x32_bf16 v[80:83], a[220:223], v[176:179], v[80:83]
    s_waitcnt vmcnt(12) lgkmcnt(0)
    s_barrier
    ds_read_b64_tr_b16 a[64:65], v13 offset:33792
    v_mfma_f32_16x16x32_bf16 v[88:91], a[220:223], v[184:187], 0
    ds_read_b64_tr_b16 a[66:67], v13 offset:34048
    ds_read_b128 v[96:99], v51 offset:0
    v_mfma_f32_16x16x32_bf16 v[88:91], a[216:219], v[168:171], v[88:91]
    buffer_load_dwordx4 v25, s[20:23], s77 offen offset:2112 lds
    v_mfma_f32_16x16x32_bf16 v[88:91], a[212:215], v[152:155], v[88:91]
    ds_read_b64_tr_b16 a[68:69], v13 offset:34304
    ds_read_b128 v[100:103], v51 offset:1024
    v_mfma_f32_16x16x32_bf16 v[88:91], a[208:211], v[136:139], v[88:91]
    ds_read_b64_tr_b16 a[70:71], v13 offset:34560
    ds_read_b64_tr_b16 a[72:73], v13 offset:42240
    v_mfma_f32_16x16x32_bf16 v[84:87], a[224:227], v[128:131], 0
    ds_read_b64_tr_b16 a[74:75], v13 offset:42496
    ds_read_b64_tr_b16 a[76:77], v13 offset:42752
    v_mfma_f32_16x16x32_bf16 v[84:87], a[228:231], v[144:147], v[84:87]
    buffer_load_dwordx4 v26, s[20:23], s77 offen offset:3144 lds
    v_mfma_f32_16x16x32_bf16 v[84:87], a[232:235], v[160:163], v[84:87]
    s_add_u32 s78, s76, 118784
    ds_read_b64_tr_b16 a[78:79], v13 offset:43008
    ds_read_b64_tr_b16 a[192:193], v13 offset:33800
    v_min_u32 v36, 55, v0
    v_mfma_f32_16x16x32_bf16 v[84:87], a[236:239], v[176:179], v[84:87]
    s_mul_i32 s4, s88, 896
    s_add_u32 s4, s4, 158720
    ds_read_b64_tr_b16 a[194:195], v13 offset:34056
    v_mfma_f32_16x16x32_bf16 v[92:95], a[236:239], v[184:187], 0
    s_add_u32 m0, s72, 71808
    ds_read_b64_tr_b16 a[196:197], v13 offset:34312
    ds_read_b64_tr_b16 a[198:199], v13 offset:34568
    v_mfma_f32_16x16x32_bf16 v[92:95], a[232:235], v[168:171], v[92:95]
    ds_read_b64_tr_b16 a[200:201], v13 offset:42248
    s_waitcnt lgkmcnt(12)
    v_lshlrev_b32 v196, 16, v96
    v_mfma_f32_16x16x32_bf16 v[92:95], a[228:231], v[152:155], v[92:95]
    buffer_load_dwordx4 v23, s[20:23], s78 offen lds
    v_and_b32 v197, s68, v96
    v_mfma_f32_16x16x32_bf16 v[92:95], a[224:227], v[136:139], v[92:95]
    ds_read_b64_tr_b16 a[202:203], v13 offset:42504
    ds_read_b64_tr_b16 a[204:205], v13 offset:42760
    v_lshl_add_u32 v34, v36, 4, s4
    v_lshlrev_b32 v198, 16, v97
    v_mfma_f32_16x16x32_bf16 v[64:67], a[0:3], v[192:195], v[64:67]
    ds_write_b64 v34, v[28:29]
    v_mfma_f32_16x16x32_bf16 v[64:67], a[4:7], v[208:211], v[64:67]
    ds_write_b64 v34, v[30:31] offset:8
    v_mfma_f32_16x16x32_bf16 v[64:67], a[8:11], v[224:227], v[64:67]
    ds_read_b64_tr_b16 a[206:207], v13 offset:43016
    v_and_b32 v199, s68, v97
    v_fmac_f32 v196, v48, v164
    v_fmac_f32 v197, v48, v165
    v_mfma_f32_16x16x32_bf16 v[132:135], a[12:15], v[240:243], v[64:67]
    ds_read_b64_tr_b16 a[208:209], v9 offset:33792
    ds_read_b64_tr_b16 a[210:211], v9 offset:34048
    v_fmac_f32 v198, v48, v166
    v_fmac_f32 v199, v48, v167
    v_mfma_f32_16x16x32_bf16 v[72:75], a[12:15], v[248:251], v[72:75]
    buffer_load_dwordx4 v24, s[20:23], s78 offen offset:1032 lds
    v_cvt_pk_bf16_f32 v96, v196, v197
    v_cvt_pk_bf16_f32 v97, v198, v199
    v_mfma_f32_16x16x32_bf16 v[72:75], a[8:11], v[232:235], v[72:75]
    ds_read_b64_tr_b16 a[212:213], v9 offset:34304
    ds_read_b64_tr_b16 a[214:215], v9 offset:34560
    v_lshlrev_b32 v204, 16, v98
    v_and_b32 v205, s68, v98
    v_mfma_f32_16x16x32_bf16 v[72:75], a[4:7], v[216:219], v[72:75]
    ds_read_b64_tr_b16 a[216:217], v9 offset:42240
    v_lshrrev_b32 v116, 3, v0
    v_lshlrev_b32 v206, 16, v99
    v_and_b32 v207, s68, v99
    v_mfma_f32_16x16x32_bf16 v[148:151], a[0:3], v[200:203], v[72:75]
    ds_read_b64_tr_b16 a[218:219], v9 offset:42496
    ds_read_b64_tr_b16 a[220:221], v9 offset:42752
    v_fmac_f32 v204, v48, v172
    v_fmac_f32 v205, v48, v173
    v_mfma_f32_16x16x32_bf16 v[68:71], a[16:19], v[192:195], v[68:71]
    ds_read_b64_tr_b16 a[222:223], v9 offset:43008
    v_fmac_f32 v206, v48, v174
    s_cmp_eq_u32 s88, 3
    s_cselect_b64 vcc, -1, 0
    s_cselect_b32 s15, 0, -1
    s_cselect_b32 s5, 3, 0
    v_mfma_f32_16x16x32_bf16 v[68:71], a[20:23], v[208:211], v[68:71]
    buffer_load_dwordx4 v25, s[20:23], s78 offen offset:2112 lds
    v_fmac_f32 v207, v48, v175
    v_cvt_pk_bf16_f32 v98, v204, v205
    v_mfma_f32_16x16x32_bf16 v[68:71], a[24:27], v[224:227], v[68:71]
    ds_read_b64_tr_b16 a[224:225], v9 offset:33800
    v_cvt_pk_bf16_f32 v99, v206, v207
    s_waitcnt lgkmcnt(9)
    v_lshlrev_b32 v212, 16, v100
    v_mfma_f32_16x16x32_bf16 v[140:143], a[28:31], v[240:243], v[68:71]
    ds_read_b64_tr_b16 a[226:227], v9 offset:34056
    v_and_b32 v213, s68, v100
    v_lshlrev_b32 v214, 16, v101
    v_and_b32 v215, s68, v101
    v_mfma_f32_16x16x32_bf16 v[76:79], a[28:31], v[248:251], v[76:79]
    ds_read_b64_tr_b16 a[228:229], v9 offset:34312
    ds_read_b64_tr_b16 a[230:231], v9 offset:34568
    v_fmac_f32 v212, v49, v180
    v_fmac_f32 v213, v49, v181
    v_mfma_f32_16x16x32_bf16 v[76:79], a[24:27], v[232:235], v[76:79]
    ds_read_b64_tr_b16 a[232:233], v9 offset:42248
    ds_read_b64_tr_b16 a[234:235], v9 offset:42504
    v_fmac_f32 v214, v49, v182
    v_fmac_f32 v215, v49, v183
    v_mfma_f32_16x16x32_bf16 v[76:79], a[20:23], v[216:219], v[76:79]
    buffer_load_dwordx4 v26, s[20:23], s78 offen offset:3144 lds
    v_cvt_pk_bf16_f32 v100, v212, v213
    v_cvt_pk_bf16_f32 v101, v214, v215
    v_mfma_f32_16x16x32_bf16 v[156:159], a[16:19], v[200:203], v[76:79]
    s_add_u32 s77, s76, 640
    ds_read_b64_tr_b16 a[236:237], v9 offset:42760
    ds_read_b64_tr_b16 a[238:239], v9 offset:43016
    v_mul_u32_u24 v105, 896, v53
    v_lshlrev_b32 v220, 16, v102
    v_mfma_f32_16x16x32_bf16 v[80:83], a[32:35], v[192:195], v[80:83]
    s_add_u32 m0, s72, 33792
    v_and_b32 v221, s68, v102
    v_lshlrev_b32 v222, 16, v103
    v_and_b32 v223, s68, v103
    v_fmac_f32 v220, v49, v188
    v_fmac_f32 v221, v49, v189
    v_fmac_f32 v222, v49, v190
    v_fmac_f32 v223, v49, v191
    v_cvt_pk_bf16_f32 v102, v220, v221
    v_cvt_pk_bf16_f32 v103, v222, v223
    v_lshl_add_u32 v105, v116, 4, v105
    v_mfma_f32_16x16x32_bf16 v[80:83], a[36:39], v[208:211], v[80:83]
    s_lshl_b32 s4, s88, 7
    buffer_load_dwordx4 v23, s[20:23], s77 offen lds
    v_mfma_f32_16x16x32_bf16 v[80:83], a[40:43], v[224:227], v[80:83]
    v_add_u32 v105, s4, v105
    v_cndmask_b32 v104, v105, v63, vcc
    v_mfma_f32_16x16x32_bf16 v[164:167], a[44:47], v[240:243], v[80:83]
    s_waitcnt vmcnt(9) lgkmcnt(0)
    s_barrier
    s_add_u32 s80, s79, 32768
    buffer_store_dwordx4 v[96:99], v1, s[28:31], s80 offen sc1
    v_mfma_f32_16x16x32_bf16 v[88:91], a[44:47], v[248:251], v[88:91]
    ds_read_b64_tr_b16 a[0:1], v12 offset:0
    v_cndmask_b32 v118, v14, v63, vcc
    v_mfma_f32_16x16x32_bf16 v[88:91], a[40:43], v[232:235], v[88:91]
    buffer_load_dwordx4 v24, s[20:23], s77 offen offset:1032 lds
    v_mfma_f32_16x16x32_bf16 v[88:91], a[36:39], v[216:219], v[88:91]
    s_add_u32 s80, s81, 32768
    buffer_store_dwordx4 v[100:103], v27, s[28:31], s80 offen sc1
    v_mfma_f32_16x16x32_bf16 v[180:183], a[32:35], v[200:203], v[88:91]
    ds_read_b64_tr_b16 a[2:3], v12 offset:256
    ds_read_b64_tr_b16 a[4:5], v12 offset:512
    v_mfma_f32_16x16x32_bf16 v[84:87], a[48:51], v[192:195], v[84:87]
    s_mov_b64 exec, s[16:17]
    ds_write_b128 v52, v[96:99] offset:1024
    s_mov_b64 exec, -1
    v_mfma_f32_16x16x32_bf16 v[84:87], a[52:55], v[208:211], v[84:87]
    v_lshlrev_b32 v119, 4, v53
    v_and_b32 v43, 15, v0
    v_mfma_f32_16x16x32_bf16 v[84:87], a[56:59], v[224:227], v[84:87]
    ds_read_b64_tr_b16 a[6:7], v12 offset:768
    v_lshlrev_b32 v43, 3, v43
    v_mfma_f32_16x16x32_bf16 v[172:175], a[60:63], v[240:243], v[84:87]
    buffer_load_dwordx4 v25, s[20:23], s77 offen offset:2112 lds
    v_mfma_f32_16x16x32_bf16 v[92:95], a[60:63], v[248:251], v[92:95]
    ds_read_b64_tr_b16 a[8:9], v12 offset:8448
    v_mul_f32 v132, v48, v132
    v_mul_f32 v133, v48, v133
    v_mfma_f32_16x16x32_bf16 v[92:95], a[56:59], v[232:235], v[92:95]
    ds_read_b64_tr_b16 a[10:11], v12 offset:8704
    v_add_u32 v43, 1024, v43
    v_mul_f32 v134, v48, v134
    v_mfma_f32_16x16x32_bf16 v[92:95], a[52:55], v[216:219], v[92:95]
    s_cmp_gt_u32 s88, 1
    s_cselect_b64 vcc, -1, 0
    ds_read_b64_tr_b16 a[12:13], v12 offset:8960
    v_mul_f32 v135, v48, v135
    v_cvt_pk_bf16_f32 v132, v132, v133
    v_mfma_f32_16x16x32_bf16 v[188:191], a[48:51], v[200:203], v[92:95]
    buffer_load_dwordx4 v26, s[20:23], s77 offen offset:3144 lds
    v_cvt_pk_bf16_f32 v133, v134, v135
    v_mfma_f32_16x16x32_bf16 v[64:67], a[128:131], v[128:131], 0
    s_add_u32 s78, s76, 4224
    ds_read_b64_tr_b16 a[14:15], v12 offset:9216
    v_mul_f32 v140, v48, v140
    v_mfma_f32_16x16x32_bf16 v[64:67], a[132:135], v[144:147], v[64:67]
    s_add_u32 m0, s72, 38016
    ds_read_b64_tr_b16 a[16:17], v12 offset:8
    v_mul_f32 v141, v48, v141
    v_mul_f32 v142, v48, v142
    v_mfma_f32_16x16x32_bf16 v[64:67], a[136:139], v[160:163], v[64:67]
    buffer_load_dwordx4 v23, s[20:23], s78 offen lds
    v_cndmask_b32 v125, v119, v43, vcc
    v_mul_f32 v143, v48, v143
    v_mfma_f32_16x16x32_bf16 v[64:67], a[140:143], v[176:179], v[64:67]
    s_add_u32 s64, s94, s88
    ds_read_b64_tr_b16 a[18:19], v12 offset:264
    v_cvt_pk_bf16_f32 v134, v140, v141
    v_mfma_f32_16x16x32_bf16 v[72:75], a[140:143], v[184:187], 0
    s_add_u32 s65, s64, 4
    ds_read_b64_tr_b16 a[20:21], v12 offset:520
    v_cvt_pk_bf16_f32 v135, v142, v143
    v_mfma_f32_16x16x32_bf16 v[72:75], a[136:139], v[168:171], v[72:75]
    s_add_u32 s64, s64, 1
    ds_write_b128 v50, v[132:135] offset:0
    v_mfma_f32_16x16x32_bf16 v[72:75], a[132:135], v[152:155], v[72:75]
    s_sub_u32 s64, s64, s5
    v_mul_f32 v148, v49, v148
    v_mul_f32 v149, v49, v149
    v_mul_f32 v150, v49, v150
    v_mfma_f32_16x16x32_bf16 v[72:75], a[128:131], v[136:139], v[72:75]
    s_lshl_b32 s60, s87, 3
    buffer_load_dwordx4 v24, s[20:23], s78 offen offset:1032 lds
    v_mul_f32 v151, v49, v151
    v_mfma_f32_16x16x32_bf16 v[68:71], a[144:147], v[128:131], 0
    s_add_u32 s60, s60, s86
    ds_read_b64_tr_b16 a[22:23], v12 offset:776
    v_cvt_pk_bf16_f32 v148, v148, v149
    v_mfma_f32_16x16x32_bf16 v[68:71], a[148:151], v[144:147], v[68:71]
    s_mul_i32 s96, s60, 7168
    ds_read_b64_tr_b16 a[24:25], v12 offset:8456
    v_cvt_pk_bf16_f32 v149, v150, v151
    v_mul_f32 v156, v49, v156
    v_mfma_f32_16x16x32_bf16 v[68:71], a[152:155], v[160:163], v[68:71]
    s_lshl_b32 s61, s86, 7
    ds_read_b64_tr_b16 a[26:27], v12 offset:8712
    v_mul_f32 v157, v49, v157
    v_mfma_f32_16x16x32_bf16 v[68:71], a[156:159], v[176:179], v[68:71]
    buffer_load_dwordx4 v25, s[20:23], s78 offen offset:2112 lds
    v_mul_f32 v158, v49, v158
    v_mfma_f32_16x16x32_bf16 v[76:79], a[156:159], v[184:187], 0
    s_add_u32 s61, s61, 251904
    ds_read_b64_tr_b16 a[28:29], v12 offset:8968
    v_mul_f32 v159, v49, v159
    v_cvt_pk_bf16_f32 v150, v156, v157
    v_cvt_pk_bf16_f32 v151, v158, v159
    ds_write_b128 v50, v[148:151] offset:1024
    v_mfma_f32_16x16x32_bf16 v[76:79], a[152:155], v[168:171], v[76:79]
    v_mfma_f32_16x16x32_bf16 v[76:79], a[148:151], v[152:155], v[76:79]
    s_add_u32 s61, s61, s34
    ds_read_b64_tr_b16 a[30:31], v12 offset:9224
    v_mfma_f32_16x16x32_bf16 v[76:79], a[144:147], v[136:139], v[76:79]
    buffer_load_dwordx4 v26, s[20:23], s78 offen offset:3144 lds
    v_mfma_f32_16x16x32_bf16 v[80:83], a[160:163], v[128:131], 0
    s_lshr_b32 s3, s86, 1
    ds_read_b64_tr_b16 a[32:33], v8 offset:0
    v_mfma_f32_16x16x32_bf16 v[80:83], a[164:167], v[144:147], v[80:83]
    s_add_u32 s77, s76, 115328
    ds_read_b64_tr_b16 a[34:35], v8 offset:256
    v_mfma_f32_16x16x32_bf16 v[80:83], a[168:171], v[160:163], v[80:83]
    s_add_u32 m0, s72, 101376
    v_mfma_f32_16x16x32_bf16 v[80:83], a[172:175], v[176:179], v[80:83]
    s_waitcnt lgkmcnt(3)
    s_barrier
    ds_read_b64_tr_b16 a[36:37], v8 offset:512
    v_mfma_f32_16x16x32_bf16 v[88:91], a[172:175], v[184:187], 0
    s_lshl_b32 s62, s3, 18
    ds_read_b128 v[96:99], v51 offset:0
    v_mfma_f32_16x16x32_bf16 v[88:91], a[168:171], v[168:171], v[88:91]
    s_lshl_b32 s3, s88, 15
    buffer_load_dwordx4 v23, s[20:23], s77 offen lds
    v_mfma_f32_16x16x32_bf16 v[88:91], a[164:167], v[152:155], v[88:91]
    s_add_u32 s62, s62, s3
    ds_read_b128 v[100:103], v51 offset:1024
    ds_read_b64_tr_b16 a[38:39], v8 offset:768
    v_mfma_f32_16x16x32_bf16 v[88:91], a[160:163], v[136:139], v[88:91]
    s_and_b32 s3, s86, 1
    ds_read_b64_tr_b16 a[40:41], v8 offset:8448
    v_mfma_f32_16x16x32_bf16 v[84:87], a[176:179], v[128:131], 0
    buffer_load_dwordx4 v24, s[20:23], s77 offen offset:1032 lds
    v_mfma_f32_16x16x32_bf16 v[84:87], a[180:183], v[144:147], v[84:87]
    s_lshl_b32 s3, s3, 7
    ds_read_b64_tr_b16 a[42:43], v8 offset:8704
    v_mfma_f32_16x16x32_bf16 v[84:87], a[184:187], v[160:163], v[84:87]
    s_add_u32 s62, s62, s3
    ds_read_b64_tr_b16 a[44:45], v8 offset:8960
    s_waitcnt lgkmcnt(5)
    v_lshlrev_b32 v196, 16, v96
    v_mfma_f32_16x16x32_bf16 v[84:87], a[188:191], v[176:179], v[84:87]
    ds_read_b64_tr_b16 a[46:47], v8 offset:9216
    v_and_b32 v197, s68, v96
    v_mfma_f32_16x16x32_bf16 v[92:95], a[188:191], v[184:187], 0
    s_xor_b32 s62, s62, s34
    v_lshlrev_b32 v198, 16, v97
    v_and_b32 v199, s68, v97
    v_mfma_f32_16x16x32_bf16 v[92:95], a[184:187], v[168:171], v[92:95]
    buffer_load_dwordx4 v25, s[20:23], s77 offen offset:2112 lds
    v_mfma_f32_16x16x32_bf16 v[92:95], a[180:183], v[152:155], v[92:95]
    s_mov_b32 s6, s62
    ds_read_b64_tr_b16 a[48:49], v8 offset:8
    v_fmac_f32 v196, v48, v164
    v_mfma_f32_16x16x32_bf16 v[92:95], a[176:179], v[136:139], v[92:95]
    ds_read_b64_tr_b16 a[50:51], v8 offset:264
    v_fmac_f32 v197, v48, v165
    v_mfma_f32_16x16x32_bf16 v[64:67], a[64:67], v[192:195], v[64:67]
    v_fmac_f32 v198, v48, v166
    v_fmac_f32 v199, v48, v167
    v_mfma_f32_16x16x32_bf16 v[64:67], a[68:71], v[208:211], v[64:67]
    buffer_load_dwordx4 v26, s[20:23], s77 offen offset:3144 lds
    v_mfma_f32_16x16x32_bf16 v[64:67], a[72:75], v[224:227], v[64:67]
    s_add_u32 s78, s76, 118912
    ds_read_b64_tr_b16 a[52:53], v8 offset:520
    v_cvt_pk_bf16_f32 v96, v196, v197
    v_cvt_pk_bf16_f32 v97, v198, v199
    v_mfma_f32_16x16x32_bf16 v[132:135], a[76:79], v[240:243], v[64:67]
    s_add_u32 m0, s72, 105600
    ds_read_b64_tr_b16 a[54:55], v8 offset:776
    v_lshlrev_b32 v204, 16, v98
    v_and_b32 v205, s68, v98
    v_mfma_f32_16x16x32_bf16 v[72:75], a[76:79], v[248:251], v[72:75]
    ds_read_b64_tr_b16 a[56:57], v8 offset:8456
    v_lshlrev_b32 v206, 16, v99
    v_and_b32 v207, s68, v99
    v_mfma_f32_16x16x32_bf16 v[72:75], a[72:75], v[232:235], v[72:75]
    v_fmac_f32 v204, v48, v172
    v_fmac_f32 v205, v48, v173
    v_mfma_f32_16x16x32_bf16 v[72:75], a[68:71], v[216:219], v[72:75]
    ds_read_b64_tr_b16 a[58:59], v8 offset:8712
    v_add_u32 v40, 114240, v27
    v_fmac_f32 v206, v48, v174
    v_fmac_f32 v207, v48, v175
    v_mfma_f32_16x16x32_bf16 v[148:151], a[64:67], v[200:203], v[72:75]
    buffer_load_dwordx4 v23, s[20:23], s78 offen lds
    v_cmp_gt_u32 vcc, 28, v0
    v_cvt_pk_bf16_f32 v98, v204, v205
L_hop0_10:
    s_cbranch_execz L_hopback0
    v_mfma_f32_16x16x32_bf16 v[68:71], a[192:195], v[192:195], v[68:71]
    ds_read_b64_tr_b16 a[60:61], v8 offset:8968
    v_cvt_pk_bf16_f32 v99, v206, v207
    s_waitcnt lgkmcnt(5)
    v_lshlrev_b32 v212, 16, v100
    v_mfma_f32_16x16x32_bf16 v[68:71], a[196:199], v[208:211], v[68:71]
    v_and_b32 v213, s68, v100
    v_cndmask_b32 v40, v40, v27, vcc
    v_lshlrev_b32 v214, 16, v101
    v_and_b32 v215, s68, v101
    v_mfma_f32_16x16x32_bf16 v[68:71], a[200:203], v[224:227], v[68:71]
    ds_read_b64_tr_b16 a[62:63], v8 offset:9224
    v_fmac_f32 v212, v49, v180
    v_fmac_f32 v213, v49, v181
    v_mfma_f32_16x16x32_bf16 v[140:143], a[204:207], v[240:243], v[68:71]
    buffer_load_dwordx4 v24, s[20:23], s78 offen offset:1032 lds
    v_cmp_gt_u32 vcc, 56, v0
    v_fmac_f32 v214, v49, v182
    v_mfma_f32_16x16x32_bf16 v[76:79], a[204:207], v[248:251], v[76:79]
    v_fmac_f32 v215, v49, v183
    v_cvt_pk_bf16_f32 v100, v212, v213
    v_cvt_pk_bf16_f32 v101, v214, v215
    v_mfma_f32_16x16x32_bf16 v[76:79], a[200:203], v[232:235], v[76:79]
    v_cndmask_b32 v40, v63, v40, vcc
    v_lshlrev_b32 v220, 16, v102
    v_and_b32 v221, s68, v102
    v_mfma_f32_16x16x32_bf16 v[76:79], a[196:199], v[216:219], v[76:79]
    v_add_u32 v15, 0, v40
    v_lshlrev_b32 v222, 16, v103
    v_and_b32 v223, s68, v103
    v_mfma_f32_16x16x32_bf16 v[156:159], a[192:195], v[200:203], v[76:79]
    v_fmac_f32 v220, v49, v188
    v_fmac_f32 v221, v49, v189
    v_mfma_f32_16x16x32_bf16 v[80:83], a[208:211], v[192:195], v[80:83]
    v_fmac_f32 v222, v49, v190
    v_fmac_f32 v223, v49, v191
    v_cvt_pk_bf16_f32 v102, v220, v221
    v_cvt_pk_bf16_f32 v103, v222, v223
    v_add_u32 v16, 2528, v40
    v_mfma_f32_16x16x32_bf16 v[80:83], a[212:215], v[208:211], v[80:83]
    buffer_load_dwordx4 v25, s[20:23], s78 offen offset:2112 lds
    v_add_u32 v122, 2, v122
    v_mfma_f32_16x16x32_bf16 v[80:83], a[216:219], v[224:227], v[80:83]
    v_add_u32 v17, 5056, v40
    v_add_u32 v18, 7584, v40
    v_mfma_f32_16x16x32_bf16 v[164:167], a[220:223], v[240:243], v[80:83]
    s_waitcnt vmcnt(13) lgkmcnt(0)
    s_barrier
    s_add_u32 s80, s79, 65536
    buffer_store_dwordx4 v[96:99], v1, s[28:31], s80 offen sc1
    v_mfma_f32_16x16x32_bf16 v[88:91], a[220:223], v[248:251], v[88:91]
    s_lshl_b32 s3, s90, 2
    ds_read_b64_tr_b16 a[128:129], v13 offset:0
    ds_read_b64_tr_b16 a[130:131], v13 offset:256
    v_mfma_f32_16x16x32_bf16 v[88:91], a[216:219], v[232:235], v[88:91]
    s_lshl_b32 s4, s89, 4
    buffer_load_dwordx4 v26, s[20:23], s78 offen offset:3144 lds
    v_mfma_f32_16x16x32_bf16 v[88:91], a[212:215], v[216:219], v[88:91]
    s_add_u32 s3, s3, s4
    s_add_u32 s80, s81, 65536
    buffer_store_dwordx4 v[100:103], v27, s[28:31], s80 offen sc1
    buffer_store_dwordx2 v[122:123], v55, s[28:31], s98 offen sc1
    v_mfma_f32_16x16x32_bf16 v[180:183], a[208:211], v[200:203], v[88:91]
    s_add_u32 s77, s76, 768
    ds_read_b64_tr_b16 a[132:133], v13 offset:512
    ds_read_b64_tr_b16 a[134:135], v13 offset:768
    v_mfma_f32_16x16x32_bf16 v[84:87], a[224:227], v[192:195], v[84:87]
    s_mul_i32 s74, s3, 3584
    s_mov_b64 exec, s[16:17]
    ds_write_b128 v52, v[96:99] offset:2048
    s_mov_b64 exec, -1
    v_mfma_f32_16x16x32_bf16 v[84:87], a[228:231], v[208:211], v[84:87]
    s_add_u32 m0, s72, 0
    ds_read_b64_tr_b16 a[136:137], v13 offset:8448
    v_mul_f32 v132, v48, v132
    v_mfma_f32_16x16x32_bf16 v[84:87], a[232:235], v[224:227], v[84:87]
    s_mul_i32 s4, s86, 448
    ds_read_b64_tr_b16 a[138:139], v13 offset:8704
    ds_read_b64_tr_b16 a[140:141], v13 offset:8960
    v_mfma_f32_16x16x32_bf16 v[172:175], a[236:239], v[240:243], v[84:87]
    s_add_u32 s74, s74, s4
    ds_read_b64_tr_b16 a[142:143], v13 offset:9216
    ds_read_b64_tr_b16 a[144:145], v13 offset:8
    v_mfma_f32_16x16x32_bf16 v[92:95], a[236:239], v[248:251], v[92:95]
    s_mul_i32 s3, s86, 200704
    buffer_load_dwordx4 v23, s[20:23], s77 offen lds
    v_mul_f32 v133, v48, v133
    v_mfma_f32_16x16x32_bf16 v[92:95], a[232:235], v[232:235], v[92:95]
    ds_read_b64_tr_b16 a[146:147], v13 offset:264
    ds_read_b64_tr_b16 a[148:149], v13 offset:520
    v_mul_f32 v134, v48, v134
    v_mfma_f32_16x16x32_bf16 v[92:95], a[228:231], v[216:219], v[92:95]
    ds_read_b64_tr_b16 a[150:151], v13 offset:776
    ds_read_b64_tr_b16 a[152:153], v13 offset:8456
    v_mul_f32 v135, v48, v135
    v_cvt_pk_bf16_f32 v132, v132, v133
    v_mfma_f32_16x16x32_bf16 v[188:191], a[224:227], v[200:203], v[92:95]
    ds_read_b64_tr_b16 a[154:155], v13 offset:8712
    ds_read_b64_tr_b16 a[156:157], v13 offset:8968
    v_cvt_pk_bf16_f32 v133, v134, v135
    v_mfma_f32_16x16x32_bf16 v[64:67], a[0:3], v[128:131], 0
    buffer_load_dwordx4 v24, s[20:23], s77 offen offset:1032 lds
    v_mul_f32 v140, v48, v140
    v_mfma_f32_16x16x32_bf16 v[64:67], a[4:7], v[144:147], v[64:67]
    s_add_u32 s52, s38, s3
    s_addc_u32 s53, s39, 0
    ds_read_b64_tr_b16 a[158:159], v13 offset:9224
    v_mul_f32 v141, v48, v141
    v_mul_f32 v142, v48, v142
    v_mfma_f32_16x16x32_bf16 v[64:67], a[8:11], v[160:163], v[64:67]
    ds_read_b64_tr_b16 a[160:161], v9 offset:0
    ds_read_b64_tr_b16 a[162:163], v9 offset:256
    v_mul_f32 v143, v48, v143
    v_mfma_f32_16x16x32_bf16 v[64:67], a[12:15], v[176:179], v[64:67]
    ds_read_b64_tr_b16 a[164:165], v9 offset:512
    ds_read_b64_tr_b16 a[166:167], v9 offset:768
    v_cvt_pk_bf16_f32 v134, v140, v141
    v_mfma_f32_16x16x32_bf16 v[72:75], a[12:15], v[184:187], 0
    s_sub_u32 s52, s52, 512
    s_subb_u32 s53, s53, 0
    ds_read_b64_tr_b16 a[168:169], v9 offset:8448
    v_cvt_pk_bf16_f32 v135, v142, v143
    v_mfma_f32_16x16x32_bf16 v[72:75], a[8:11], v[168:171], v[72:75]
    s_mov_b32 s54, 201216
    ds_write_b128 v50, v[132:135] offset:0
    v_mfma_f32_16x16x32_bf16 v[72:75], a[4:7], v[152:155], v[72:75]
    s_mov_b32 s55, 0x20000
    buffer_load_dwordx4 v25, s[20:23], s77 offen offset:2112 lds
    v_mul_f32 v148, v49, v148
    v_mul_f32 v149, v49, v149
    v_mfma_f32_16x16x32_bf16 v[72:75], a[0:3], v[136:139], v[72:75]
    s_mov_b32 s56, s50
    ds_read_b64_tr_b16 a[170:171], v9 offset:8704
    ds_read_b64_tr_b16 a[172:173], v9 offset:8960
    v_mul_f32 v150, v49, v150
    v_mul_f32 v151, v49, v151
    v_mfma_f32_16x16x32_bf16 v[68:71], a[16:19], v[128:131], 0
    s_mov_b32 s57, s51
    ds_read_b64_tr_b16 a[174:175], v9 offset:9216
    ds_read_b64_tr_b16 a[176:177], v9 offset:8
    v_cvt_pk_bf16_f32 v148, v148, v149
    v_mfma_f32_16x16x32_bf16 v[68:71], a[20:23], v[144:147], v[68:71]
    buffer_load_dwordx4 v26, s[20:23], s77 offen offset:3144 lds
    v_cvt_pk_bf16_f32 v149, v150, v151
    v_mul_f32 v156, v49, v156
    v_mfma_f32_16x16x32_bf16 v[68:71], a[24:27], v[160:163], v[68:71]
    s_add_u32 s78, s76, 4352
    ds_read_b64_tr_b16 a[178:179], v9 offset:264
    ds_read_b64_tr_b16 a[180:181], v9 offset:520
    v_mul_f32 v157, v49, v157
    v_mfma_f32_16x16x32_bf16 v[68:71], a[28:31], v[176:179], v[68:71]
    s_add_u32 m0, s72, 4224
    ds_read_b64_tr_b16 a[182:183], v9 offset:776
    ds_read_b64_tr_b16 a[184:185], v9 offset:8456
    v_mul_f32 v158, v49, v158
    v_mfma_f32_16x16x32_bf16 v[76:79], a[28:31], v[184:187], 0
    s_mov_b32 s58, 1835008
    ds_read_b64_tr_b16 a[186:187], v9 offset:8712
    v_mul_f32 v159, v49, v159
    v_cvt_pk_bf16_f32 v150, v156, v157
    v_cvt_pk_bf16_f32 v151, v158, v159
    ds_write_b128 v50, v[148:151] offset:1024
    v_mfma_f32_16x16x32_bf16 v[76:79], a[24:27], v[168:171], v[76:79]
    s_mov_b32 s59, 0x20000
    v_mfma_f32_16x16x32_bf16 v[76:79], a[20:23], v[152:155], v[76:79]
    ds_read_b64_tr_b16 a[188:189], v9 offset:8968
    ds_read_b64_tr_b16 a[190:191], v9 offset:9224
    v_mfma_f32_16x16x32_bf16 v[76:79], a[16:19], v[136:139], v[76:79]
    buffer_load_dwordx4 v23, s[20:23], s78 offen lds
    v_mfma_f32_16x16x32_bf16 v[80:83], a[32:35], v[128:131], 0
    buffer_load_dwordx4 v24, s[20:23], s78 offen offset:1032 lds
    v_mfma_f32_16x16x32_bf16 v[80:83], a[36:39], v[144:147], v[80:83]
    v_mfma_f32_16x16x32_bf16 v[80:83], a[40:43], v[160:163], v[80:83]
    v_mfma_f32_16x16x32_bf16 v[80:83], a[44:47], v[176:179], v[80:83]
    s_waitcnt vmcnt(17) lgkmcnt(0)
    s_barrier
    ds_read_b64_tr_b16 a[64:65], v12 offset:33792
    v_mfma_f32_16x16x32_bf16 v[88:91], a[44:47], v[184:187], 0
    ds_read_b64_tr_b16 a[66:67], v12 offset:34048
    ds_read_b128 v[96:99], v51 offset:0
    v_mfma_f32_16x16x32_bf16 v[88:91], a[40:43], v[168:171], v[88:91]
    ds_read_b64_tr_b16 a[68:69], v12 offset:34304
    ds_read_b128 v[100:103], v51 offset:1024
    v_mfma_f32_16x16x32_bf16 v[88:91], a[36:39], v[152:155], v[88:91]
    buffer_load_dwordx4 v25, s[20:23], s78 offen offset:2112 lds
    v_mfma_f32_16x16x32_bf16 v[88:91], a[32:35], v[136:139], v[88:91]
    ds_read_b64_tr_b16 a[70:71], v12 offset:34560
    ds_read_b64_tr_b16 a[72:73], v12 offset:42240
    v_mfma_f32_16x16x32_bf16 v[84:87], a[48:51], v[128:131], 0
    ds_read_b64_tr_b16 a[74:75], v12 offset:42496
    ds_read_b64_tr_b16 a[76:77], v12 offset:42752
    v_mfma_f32_16x16x32_bf16 v[84:87], a[52:55], v[144:147], v[84:87]
    ds_read_b64_tr_b16 a[78:79], v12 offset:43008
    v_mfma_f32_16x16x32_bf16 v[84:87], a[56:59], v[160:163], v[84:87]
    buffer_load_dwordx4 v26, s[20:23], s78 offen offset:3144 lds
    v_mfma_f32_16x16x32_bf16 v[84:87], a[60:63], v[176:179], v[84:87]
    s_add_u32 s77, s76, 115456
    ds_read_b64_tr_b16 a[192:193], v12 offset:33800
    ds_read_b64_tr_b16 a[194:195], v12 offset:34056
    v_mfma_f32_16x16x32_bf16 v[92:95], a[60:63], v[184:187], 0
    s_add_u32 m0, s72, 67584
    ds_read_b64_tr_b16 a[196:197], v12 offset:34312
    ds_read_b64_tr_b16 a[198:199], v12 offset:34568
    v_mfma_f32_16x16x32_bf16 v[92:95], a[56:59], v[168:171], v[92:95]
    ds_read_b64_tr_b16 a[200:201], v12 offset:42248
    s_waitcnt lgkmcnt(10)
    v_lshlrev_b32 v196, 16, v96
    v_mfma_f32_16x16x32_bf16 v[92:95], a[52:55], v[152:155], v[92:95]
    ds_read_b64_tr_b16 a[202:203], v12 offset:42504
    v_and_b32 v197, s68, v96
    v_mfma_f32_16x16x32_bf16 v[92:95], a[48:51], v[136:139], v[92:95]
    ds_read_b64_tr_b16 a[204:205], v12 offset:42760
    v_lshlrev_b32 v198, 16, v97
    v_and_b32 v199, s68, v97
    v_mfma_f32_16x16x32_bf16 v[64:67], a[128:131], v[192:195], v[64:67]
    buffer_load_dwordx4 v23, s[20:23], s77 offen lds
    v_fmac_f32 v196, v48, v164
    v_fmac_f32 v197, v48, v165
    v_mfma_f32_16x16x32_bf16 v[64:67], a[132:135], v[208:211], v[64:67]
    ds_read_b64_tr_b16 a[206:207], v12 offset:43016
    ds_read_b64_tr_b16 a[208:209], v8 offset:33792
    v_fmac_f32 v198, v48, v166
    v_fmac_f32 v199, v48, v167
    v_mfma_f32_16x16x32_bf16 v[64:67], a[136:139], v[224:227], v[64:67]
    ds_read_b64_tr_b16 a[210:211], v8 offset:34048
    ds_read_b64_tr_b16 a[212:213], v8 offset:34304
    v_cvt_pk_bf16_f32 v96, v196, v197
    v_cvt_pk_bf16_f32 v97, v198, v199
    v_mfma_f32_16x16x32_bf16 v[132:135], a[140:143], v[240:243], v[64:67]
    ds_read_b64_tr_b16 a[214:215], v8 offset:34560
    v_lshlrev_b32 v204, 16, v98
    v_and_b32 v205, s68, v98
    v_mfma_f32_16x16x32_bf16 v[72:75], a[140:143], v[248:251], v[72:75]
    buffer_load_dwordx4 v24, s[20:23], s77 offen offset:1032 lds
    v_lshlrev_b32 v206, 16, v99
    v_and_b32 v207, s68, v99
    v_mfma_f32_16x16x32_bf16 v[72:75], a[136:139], v[232:235], v[72:75]
    ds_read_b64_tr_b16 a[216:217], v8 offset:42240
    ds_read_b64_tr_b16 a[218:219], v8 offset:42496
    v_fmac_f32 v204, v48, v172
    v_fmac_f32 v205, v48, v173
    v_mfma_f32_16x16x32_bf16 v[72:75], a[132:135], v[216:219], v[72:75]
    ds_read_b64_tr_b16 a[220:221], v8 offset:42752
    ds_read_b64_tr_b16 a[222:223], v8 offset:43008
    v_fmac_f32 v206, v48, v174
    v_fmac_f32 v207, v48, v175
    v_mfma_f32_16x16x32_bf16 v[148:151], a[128:131], v[200:203], v[72:75]
    ds_read_b64_tr_b16 a[224:225], v8 offset:33800
    v_cvt_pk_bf16_f32 v98, v204, v205
    v_cvt_pk_bf16_f32 v99, v206, v207
    v_mfma_f32_16x16x32_bf16 v[68:71], a[144:147], v[192:195], v[68:71]
    ds_read_b64_tr_b16 a[226:227], v8 offset:34056
    v_lshlrev_b32 v212, 16, v100
    v_and_b32 v213, s68, v100
    v_mfma_f32_16x16x32_bf16 v[68:71], a[148:151], v[208:211], v[68:71]
    buffer_load_dwordx4 v25, s[20:23], s77 offen offset:2112 lds
    v_lshlrev_b32 v214, 16, v101
    v_and_b32 v215, s68, v101
    v_mfma_f32_16x16x32_bf16 v[68:71], a[152:155], v[224:227], v[68:71]
    ds_read_b64_tr_b16 a[228:229], v8 offset:34312
    ds_read_b64_tr_b16 a[230:231], v8 offset:34568
    v_fmac_f32 v212, v49, v180
    v_fmac_f32 v213, v49, v181
    v_mfma_f32_16x16x32_bf16 v[140:143], a[156:159], v[240:243], v[68:71]
    ds_read_b64_tr_b16 a[232:233], v8 offset:42248
    ds_read_b64_tr_b16 a[234:235], v8 offset:42504
    v_fmac_f32 v214, v49, v182
    v_fmac_f32 v215, v49, v183
    v_mfma_f32_16x16x32_bf16 v[76:79], a[156:159], v[248:251], v[76:79]
    ds_read_b64_tr_b16 a[236:237], v8 offset:42760
    v_cvt_pk_bf16_f32 v100, v212, v213
    v_cvt_pk_bf16_f32 v101, v214, v215
    v_mfma_f32_16x16x32_bf16 v[76:79], a[152:155], v[232:235], v[76:79]
    buffer_load_dwordx4 v26, s[20:23], s77 offen offset:3144 lds
    v_lshlrev_b32 v220, 16, v102
    v_and_b32 v221, s68, v102
    v_mfma_f32_16x16x32_bf16 v[76:79], a[148:151], v[216:219], v[76:79]
    s_add_u32 s78, s76, 119040
    ds_read_b64_tr_b16 a[238:239], v8 offset:43016
    v_lshlrev_b32 v222, 16, v103
    v_and_b32 v223, s68, v103
    v_mfma_f32_16x16x32_bf16 v[156:159], a[144:147], v[200:203], v[76:79]
    s_add_u32 m0, s72, 71808
    v_fmac_f32 v220, v49, v188
    v_fmac_f32 v221, v49, v189
    v_mfma_f32_16x16x32_bf16 v[80:83], a[160:163], v[192:195], v[80:83]
    v_fmac_f32 v222, v49, v190
    v_fmac_f32 v223, v49, v191
    v_cvt_pk_bf16_f32 v102, v220, v221
    v_cvt_pk_bf16_f32 v103, v222, v223
    v_mfma_f32_16x16x32_bf16 v[80:83], a[164:167], v[208:211], v[80:83]
    buffer_load_dwordx4 v[108:111], v104, s[24:27], s96 offen
    v_add_u32 v122, 1, v122
    v_mfma_f32_16x16x32_bf16 v[80:83], a[168:171], v[224:227], v[80:83]
    buffer_load_dwordx4 v[112:115], v105, s[24:27], s96 offen offset:384
    v_mfma_f32_16x16x32_bf16 v[164:167], a[172:175], v[240:243], v[80:83]
    s_waitcnt vmcnt(15) lgkmcnt(0)
    s_barrier
    s_add_u32 s80, s79, 98304
    buffer_store_dwordx4 v[96:99], v1, s[28:31], s80 offen sc1
    v_mfma_f32_16x16x32_bf16 v[88:91], a[172:175], v[248:251], v[88:91]
    buffer_load_dwordx4 v23, s[20:23], s78 offen lds
    v_mfma_f32_16x16x32_bf16 v[88:91], a[168:171], v[232:235], v[88:91]
    ds_read_b64_tr_b16 a[0:1], v13 offset:33792
    ds_read_b64_tr_b16 a[2:3], v13 offset:34048
    v_mfma_f32_16x16x32_bf16 v[88:91], a[164:167], v[216:219], v[88:91]
    s_add_u32 s80, s81, 98304
    buffer_store_dwordx4 v[100:103], v27, s[28:31], s80 offen sc1
    buffer_store_dwordx2 v[122:123], v55, s[28:31], s98 offen sc1
    v_mfma_f32_16x16x32_bf16 v[180:183], a[160:163], v[200:203], v[88:91]
    ds_read_b64_tr_b16 a[4:5], v13 offset:34304
    ds_read_b64_tr_b16 a[6:7], v13 offset:34560
    v_mfma_f32_16x16x32_bf16 v[84:87], a[176:179], v[192:195], v[84:87]
    s_mov_b64 exec, s[16:17]
    ds_write_b128 v52, v[96:99] offset:3072
    s_mov_b64 exec, -1
    v_mfma_f32_16x16x32_bf16 v[84:87], a[180:183], v[208:211], v[84:87]
    buffer_load_dwordx4 v24, s[20:23], s78 offen offset:1032 lds
    v_mfma_f32_16x16x32_bf16 v[84:87], a[184:187], v[224:227], v[84:87]
    ds_read_b64_tr_b16 a[8:9], v13 offset:42240
    ds_read_b64_tr_b16 a[10:11], v13 offset:42496
    v_mfma_f32_16x16x32_bf16 v[172:175], a[188:191], v[240:243], v[84:87]
    ds_read_b64_tr_b16 a[12:13], v13 offset:42752
    ds_read_b64_tr_b16 a[14:15], v13 offset:43008
    v_mfma_f32_16x16x32_bf16 v[92:95], a[188:191], v[248:251], v[92:95]
    ds_read_b64_tr_b16 a[16:17], v13 offset:33800
    ds_read_b64_tr_b16 a[18:19], v13 offset:34056
    v_mul_f32 v132, v48, v132
    v_mul_f32 v133, v48, v133
    v_mfma_f32_16x16x32_bf16 v[92:95], a[184:187], v[232:235], v[92:95]
    buffer_load_dwordx4 v25, s[20:23], s78 offen offset:2112 lds
    v_mul_f32 v134, v48, v134
    v_mfma_f32_16x16x32_bf16 v[92:95], a[180:183], v[216:219], v[92:95]
    ds_read_b64_tr_b16 a[20:21], v13 offset:34312
    ds_read_b64_tr_b16 a[22:23], v13 offset:34568
    v_mul_f32 v135, v48, v135
    v_cvt_pk_bf16_f32 v132, v132, v133
    v_mfma_f32_16x16x32_bf16 v[188:191], a[176:179], v[200:203], v[92:95]
    ds_read_b64_tr_b16 a[24:25], v13 offset:42248
    ds_read_b64_tr_b16 a[26:27], v13 offset:42504
    v_cvt_pk_bf16_f32 v133, v134, v135
    v_mfma_f32_16x16x32_bf16 v[64:67], a[64:67], v[128:131], 0
    buffer_load_dwordx4 v26, s[20:23], s78 offen offset:3144 lds
    v_mul_f32 v140, v48, v140
    v_mfma_f32_16x16x32_bf16 v[64:67], a[68:71], v[144:147], v[64:67]
    s_add_u32 s77, s74, 0
    ds_read_b64_tr_b16 a[28:29], v13 offset:42760
    ds_read_b64_tr_b16 a[30:31], v13 offset:43016
    v_mul_f32 v141, v48, v141
    v_mul_f32 v142, v48, v142
    v_mfma_f32_16x16x32_bf16 v[64:67], a[72:75], v[160:163], v[64:67]
    s_add_u32 m0, s72, 33792
    ds_read_b64_tr_b16 a[32:33], v9 offset:33792
    ds_read_b64_tr_b16 a[34:35], v9 offset:34048
    v_mul_f32 v143, v48, v143
    v_mfma_f32_16x16x32_bf16 v[64:67], a[76:79], v[176:179], v[64:67]
    ds_read_b64_tr_b16 a[36:37], v9 offset:34304
    ds_read_b64_tr_b16 a[38:39], v9 offset:34560
    v_cvt_pk_bf16_f32 v134, v140, v141
    v_mfma_f32_16x16x32_bf16 v[72:75], a[76:79], v[184:187], 0
    ds_read_b64_tr_b16 a[40:41], v9 offset:42240
    v_cvt_pk_bf16_f32 v135, v142, v143
    v_mfma_f32_16x16x32_bf16 v[72:75], a[72:75], v[168:171], v[72:75]
    ds_write_b128 v50, v[132:135] offset:0
    v_mfma_f32_16x16x32_bf16 v[72:75], a[68:71], v[152:155], v[72:75]
    buffer_load_dwordx4 v15, s[40:43], s77 offen lds
    v_mul_f32 v148, v49, v148
    v_mul_f32 v149, v49, v149
    v_mfma_f32_16x16x32_bf16 v[72:75], a[64:67], v[136:139], v[72:75]
    ds_read_b64_tr_b16 a[42:43], v9 offset:42496
    ds_read_b64_tr_b16 a[44:45], v9 offset:42752
    v_mul_f32 v150, v49, v150
    v_mul_f32 v151, v49, v151
    v_mfma_f32_16x16x32_bf16 v[68:71], a[192:195], v[128:131], 0
    ds_read_b64_tr_b16 a[46:47], v9 offset:43008
    ds_read_b64_tr_b16 a[48:49], v9 offset:33800
    v_cvt_pk_bf16_f32 v148, v148, v149
    v_mfma_f32_16x16x32_bf16 v[68:71], a[196:199], v[144:147], v[68:71]
    ds_read_b64_tr_b16 a[50:51], v9 offset:34056
    ds_read_b64_tr_b16 a[52:53], v9 offset:34312
    v_cvt_pk_bf16_f32 v149, v150, v151
    v_mul_f32 v156, v49, v156
    v_mfma_f32_16x16x32_bf16 v[68:71], a[200:203], v[160:163], v[68:71]
    buffer_load_dwordx4 v16, s[40:43], s77 offen offset:1056 lds
    v_mul_f32 v157, v49, v157
    v_mfma_f32_16x16x32_bf16 v[68:71], a[204:207], v[176:179], v[68:71]
    ds_read_b64_tr_b16 a[54:55], v9 offset:34568
    ds_read_b64_tr_b16 a[56:57], v9 offset:42248
    v_mul_f32 v158, v49, v158
    v_mfma_f32_16x16x32_bf16 v[76:79], a[204:207], v[184:187], 0
    ds_read_b64_tr_b16 a[58:59], v9 offset:42504
    v_mul_f32 v159, v49, v159
    v_cvt_pk_bf16_f32 v150, v156, v157
    v_cvt_pk_bf16_f32 v151, v158, v159
    ds_write_b128 v50, v[148:151] offset:1024
    v_mfma_f32_16x16x32_bf16 v[76:79], a[200:203], v[168:171], v[76:79]
    v_mfma_f32_16x16x32_bf16 v[76:79], a[196:199], v[152:155], v[76:79]
    ds_read_b64_tr_b16 a[60:61], v9 offset:42760
    ds_read_b64_tr_b16 a[62:63], v9 offset:43016
    v_mfma_f32_16x16x32_bf16 v[76:79], a[192:195], v[136:139], v[76:79]
    buffer_load_dwordx4 v17, s[40:43], s77 offen offset:2112 lds
    v_mfma_f32_16x16x32_bf16 v[80:83], a[208:211], v[128:131], 0
    buffer_load_dwordx4 v18, s[40:43], s77 offen offset:3168 lds
    v_mfma_f32_16x16x32_bf16 v[80:83], a[212:215], v[144:147], v[80:83]
    s_add_u32 s78, s74, 28672
    v_mfma_f32_16x16x32_bf16 v[80:83], a[216:219], v[160:163], v[80:83]
    s_add_u32 m0, s72, 38016
    v_mfma_f32_16x16x32_bf16 v[80:83], a[220:223], v[176:179], v[80:83]
    s_waitcnt vmcnt(17) lgkmcnt(0)
    s_barrier
    ds_read_b64_tr_b16 a[128:129], v12 offset:0
    v_mfma_f32_16x16x32_bf16 v[88:91], a[220:223], v[184:187], 0
    ds_read_b128 v[96:99], v51 offset:0
    v_mfma_f32_16x16x32_bf16 v[88:91], a[216:219], v[168:171], v[88:91]
    ds_read_b64_tr_b16 a[130:131], v12 offset:256
    ds_read_b128 v[100:103], v51 offset:1024
    v_mfma_f32_16x16x32_bf16 v[88:91], a[212:215], v[152:155], v[88:91]
    buffer_load_dwordx4 v15, s[40:43], s78 offen lds
    v_mfma_f32_16x16x32_bf16 v[88:91], a[208:211], v[136:139], v[88:91]
    ds_read_b64_tr_b16 a[132:133], v12 offset:512
    v_mfma_f32_16x16x32_bf16 v[84:87], a[224:227], v[128:131], 0
    ds_read_b64_tr_b16 a[134:135], v12 offset:768
    v_mfma_f32_16x16x32_bf16 v[84:87], a[228:231], v[144:147], v[84:87]
    buffer_load_dwordx4 v16, s[40:43], s78 offen offset:1056 lds
    v_mfma_f32_16x16x32_bf16 v[84:87], a[232:235], v[160:163], v[84:87]
    buffer_load_dwordx2 v[120:121], v119, s[28:31], s61 offen sc1
    v_mfma_f32_16x16x32_bf16 v[84:87], a[236:239], v[176:179], v[84:87]
    ds_read_b64_tr_b16 a[136:137], v12 offset:8448
    s_waitcnt lgkmcnt(5)
    v_lshlrev_b32 v196, 16, v96
    v_mfma_f32_16x16x32_bf16 v[92:95], a[236:239], v[184:187], 0
    ds_read_b64_tr_b16 a[138:139], v12 offset:8704
    v_and_b32 v197, s68, v96
    v_mfma_f32_16x16x32_bf16 v[92:95], a[232:235], v[168:171], v[92:95]
    ds_read_b64_tr_b16 a[140:141], v12 offset:8960
    v_lshlrev_b32 v198, 16, v97
    v_mfma_f32_16x16x32_bf16 v[92:95], a[228:231], v[152:155], v[92:95]
    buffer_load_dwordx4 v17, s[40:43], s78 offen offset:2112 lds
    v_mfma_f32_16x16x32_bf16 v[92:95], a[224:227], v[136:139], v[92:95]
    ds_read_b64_tr_b16 a[142:143], v12 offset:9216
    v_and_b32 v199, s68, v97
    v_mfma_f32_16x16x32_bf16 v[64:67], a[0:3], v[192:195], v[64:67]
    ds_read_b64_tr_b16 a[144:145], v12 offset:8
    v_fmac_f32 v196, v48, v164
    v_fmac_f32 v197, v48, v165
    v_mfma_f32_16x16x32_bf16 v[64:67], a[4:7], v[208:211], v[64:67]
    v_fmac_f32 v198, v48, v166
    v_fmac_f32 v199, v48, v167
    v_mfma_f32_16x16x32_bf16 v[64:67], a[8:11], v[224:227], v[64:67]
    ds_read_b64_tr_b16 a[146:147], v12 offset:264
    v_cvt_pk_bf16_f32 v96, v196, v197
    v_cvt_pk_bf16_f32 v97, v198, v199
    v_mfma_f32_16x16x32_bf16 v[132:135], a[12:15], v[240:243], v[64:67]
    buffer_load_dwordx4 v18, s[40:43], s78 offen offset:3168 lds
    v_lshlrev_b32 v204, 16, v98
    v_and_b32 v205, s68, v98
    v_mfma_f32_16x16x32_bf16 v[72:75], a[12:15], v[248:251], v[72:75]
    ds_read_b64_tr_b16 a[148:149], v12 offset:520
    v_lshlrev_b32 v206, 16, v99
    v_and_b32 v207, s68, v99
    v_mfma_f32_16x16x32_bf16 v[72:75], a[8:11], v[232:235], v[72:75]
    s_add_u32 s77, s74, 229376
    ds_read_b64_tr_b16 a[150:151], v12 offset:776
    v_fmac_f32 v204, v48, v172
    v_fmac_f32 v205, v48, v173
    v_mfma_f32_16x16x32_bf16 v[72:75], a[4:7], v[216:219], v[72:75]
    s_add_u32 m0, s72, 101376
    v_fmac_f32 v206, v48, v174
    v_fmac_f32 v207, v48, v175
    v_mfma_f32_16x16x32_bf16 v[148:151], a[0:3], v[200:203], v[72:75]
    ds_read_b64_tr_b16 a[152:153], v12 offset:8456
    v_cvt_pk_bf16_f32 v98, v204, v205
    v_cvt_pk_bf16_f32 v99, v206, v207
    v_mfma_f32_16x16x32_bf16 v[68:71], a[16:19], v[192:195], v[68:71]
    s_waitcnt lgkmcnt(4)
    v_lshlrev_b32 v212, 16, v100
    v_and_b32 v213, s68, v100
    v_mfma_f32_16x16x32_bf16 v[68:71], a[20:23], v[208:211], v[68:71]
    buffer_load_dwordx4 v15, s[40:43], s77 offen lds
    v_lshlrev_b32 v214, 16, v101
    v_and_b32 v215, s68, v101
    v_mfma_f32_16x16x32_bf16 v[68:71], a[24:27], v[224:227], v[68:71]
    ds_read_b64_tr_b16 a[154:155], v12 offset:8712
    v_fmac_f32 v212, v49, v180
    v_fmac_f32 v213, v49, v181
    v_mfma_f32_16x16x32_bf16 v[140:143], a[28:31], v[240:243], v[68:71]
    ds_read_b64_tr_b16 a[156:157], v12 offset:8968
    v_fmac_f32 v214, v49, v182
    v_fmac_f32 v215, v49, v183
    v_mfma_f32_16x16x32_bf16 v[76:79], a[28:31], v[248:251], v[76:79]
    v_cvt_pk_bf16_f32 v100, v212, v213
    v_cvt_pk_bf16_f32 v101, v214, v215
    v_mfma_f32_16x16x32_bf16 v[76:79], a[24:27], v[232:235], v[76:79]
    buffer_load_dwordx4 v16, s[40:43], s77 offen offset:1056 lds
    v_lshlrev_b32 v220, 16, v102
    v_and_b32 v221, s68, v102
    v_mfma_f32_16x16x32_bf16 v[76:79], a[20:23], v[216:219], v[76:79]
    ds_read_b64_tr_b16 a[158:159], v12 offset:9224
    v_lshlrev_b32 v222, 16, v103
    v_and_b32 v223, s68, v103
    v_mfma_f32_16x16x32_bf16 v[156:159], a[16:19], v[200:203], v[76:79]
    ds_read_b64_tr_b16 a[160:161], v8 offset:0
    v_fmac_f32 v220, v49, v188
    v_fmac_f32 v221, v49, v189
    v_mfma_f32_16x16x32_bf16 v[80:83], a[32:35], v[192:195], v[80:83]
    ds_read_b64_tr_b16 a[162:163], v8 offset:256
    v_fmac_f32 v222, v49, v190
    v_fmac_f32 v223, v49, v191
    v_cvt_pk_bf16_f32 v102, v220, v221
    v_cvt_pk_bf16_f32 v103, v222, v223
    v_mfma_f32_16x16x32_bf16 v[80:83], a[36:39], v[208:211], v[80:83]
    v_add_u32 v122, 1, v122
    v_mfma_f32_16x16x32_bf16 v[80:83], a[40:43], v[224:227], v[80:83]
    buffer_load_dwordx4 v17, s[40:43], s77 offen offset:2112 lds
    v_mfma_f32_16x16x32_bf16 v[164:167], a[44:47], v[240:243], v[80:83]
    s_waitcnt vmcnt(16)
    s_barrier
    s_add_u32 s80, s79, 131072
    buffer_store_dwordx4 v[96:99], v1, s[28:31], s80 offen sc1
    v_mfma_f32_16x16x32_bf16 v[88:91], a[44:47], v[248:251], v[88:91]
    ds_read_b64_tr_b16 a[164:165], v8 offset:512
    v_mfma_f32_16x16x32_bf16 v[88:91], a[40:43], v[232:235], v[88:91]
    s_waitcnt vmcnt(6)
    v_subrev_u32 v56, s64, v120
    v_cmp_ne_u32 s[4:5], s95, v121
    v_cmp_lt_u32 vcc, 7, v56
    v_mfma_f32_16x16x32_bf16 v[88:91], a[36:39], v[216:219], v[88:91]
    s_add_u32 s80, s81, 131072
    buffer_store_dwordx4 v[100:103], v27, s[28:31], s80 offen sc1
    buffer_store_dwordx2 v[122:123], v55, s[28:31], s98 offen sc1
    v_mfma_f32_16x16x32_bf16 v[180:183], a[32:35], v[200:203], v[88:91]
    s_or_b64 vcc, vcc, s[4:5]
    s_cselect_b32 s67, 0, 1
    s_cselect_b64 vcc, -1, 0
    v_mfma_f32_16x16x32_bf16 v[84:87], a[48:51], v[192:195], v[84:87]
    s_mov_b64 exec, s[16:17]
    ds_write_b128 v52, v[96:99] offset:4096
    s_mov_b64 exec, -1
    v_cndmask_b32 v57, v118, v63, vcc
    v_mfma_f32_16x16x32_bf16 v[84:87], a[52:55], v[208:211], v[84:87]
    ds_read_b64_tr_b16 a[166:167], v8 offset:768
    v_mul_f32 v132, v48, v132
    v_mfma_f32_16x16x32_bf16 v[84:87], a[56:59], v[224:227], v[84:87]
    buffer_load_dwordx4 v18, s[40:43], s77 offen offset:3168 lds
    v_mfma_f32_16x16x32_bf16 v[172:175], a[60:63], v[240:243], v[84:87]
    s_add_u32 s78, s74, 258048
    ds_read_b64_tr_b16 a[168:169], v8 offset:8448
    ds_read_b64_tr_b16 a[170:171], v8 offset:8704
    v_mfma_f32_16x16x32_bf16 v[92:95], a[60:63], v[248:251], v[92:95]
    s_add_u32 m0, s72, 105600
    s_add_u32 s7, s6, s8
    buffer_load_dwordx4 v[236:239], v57, s[28:31], s7 offen sc1
    v_mul_f32 v133, v48, v133
    v_mfma_f32_16x16x32_bf16 v[92:95], a[56:59], v[232:235], v[92:95]
    ds_read_b64_tr_b16 a[172:173], v8 offset:8960
    ds_read_b64_tr_b16 a[174:175], v8 offset:9216
    v_mul_f32 v134, v48, v134
    v_mfma_f32_16x16x32_bf16 v[92:95], a[52:55], v[216:219], v[92:95]
    buffer_load_dwordx4 v15, s[40:43], s78 offen lds
    v_mul_f32 v135, v48, v135
    v_cvt_pk_bf16_f32 v132, v132, v133
    v_mfma_f32_16x16x32_bf16 v[188:191], a[48:51], v[200:203], v[92:95]
    ds_read_b64_tr_b16 a[176:177], v8 offset:8
    v_cvt_pk_bf16_f32 v133, v134, v135
    v_mfma_f32_16x16x32_bf16 v[64:67], a[128:131], v[128:131], 0
    buffer_load_dwordx4 v16, s[40:43], s78 offen offset:1056 lds
    v_mul_f32 v140, v48, v140
    v_mfma_f32_16x16x32_bf16 v[64:67], a[132:135], v[144:147], v[64:67]
    s_add_u32 s7, s6, s9
    buffer_load_dwordx4 v[244:247], v57, s[28:31], s7 offen sc1
    v_mul_f32 v141, v48, v141
    v_mul_f32 v142, v48, v142
    v_mfma_f32_16x16x32_bf16 v[64:67], a[136:139], v[160:163], v[64:67]
    ds_read_b64_tr_b16 a[178:179], v8 offset:264
    v_mul_f32 v143, v48, v143
    v_mfma_f32_16x16x32_bf16 v[64:67], a[140:143], v[176:179], v[64:67]
    ds_read_b64_tr_b16 a[180:181], v8 offset:520
    v_cvt_pk_bf16_f32 v134, v140, v141
    v_mfma_f32_16x16x32_bf16 v[72:75], a[140:143], v[184:187], 0
    ds_read_b64_tr_b16 a[182:183], v8 offset:776
    v_cvt_pk_bf16_f32 v135, v142, v143
    v_mfma_f32_16x16x32_bf16 v[72:75], a[136:139], v[168:171], v[72:75]
    ds_write_b128 v50, v[132:135] offset:0
    v_mfma_f32_16x16x32_bf16 v[72:75], a[132:135], v[152:155], v[72:75]
    s_add_u32 s7, s6, s10
    buffer_load_dwordx4 v[252:255], v57, s[28:31], s7 offen sc1
    v_mul_f32 v148, v49, v148
    v_mul_f32 v149, v49, v149
    v_mfma_f32_16x16x32_bf16 v[72:75], a[128:131], v[136:139], v[72:75]
    s_waitcnt lgkmcnt(4)
    buffer_load_dwordx4 v17, s[40:43], s78 offen offset:2112 lds
    v_mul_f32 v150, v49, v150
    v_mul_f32 v151, v49, v151
    v_mfma_f32_16x16x32_bf16 v[68:71], a[144:147], v[128:131], 0
    ds_read_b64_tr_b16 a[184:185], v8 offset:8456
    ds_read_b64_tr_b16 a[186:187], v8 offset:8712
    v_cvt_pk_bf16_f32 v148, v148, v149
    v_mfma_f32_16x16x32_bf16 v[68:71], a[148:151], v[144:147], v[68:71]
L_hop0_11:
    s_cbranch_execz L_hopback0
    buffer_load_dwordx4 v18, s[40:43], s78 offen offset:3168 lds
    v_cvt_pk_bf16_f32 v149, v150, v151
    v_mul_f32 v156, v49, v156
    v_mfma_f32_16x16x32_bf16 v[68:71], a[152:155], v[160:163], v[68:71]
    s_add_u32 s7, s6, s11
    buffer_load_dwordx4 v[32:35], v57, s[28:31], s7 offen sc1
    v_mul_f32 v157, v49, v157
    v_mfma_f32_16x16x32_bf16 v[68:71], a[156:159], v[176:179], v[68:71]
    ds_read_b64_tr_b16 a[188:189], v8 offset:8968
    v_mul_f32 v158, v49, v158
    v_mfma_f32_16x16x32_bf16 v[76:79], a[156:159], v[184:187], 0
    ds_read_b64_tr_b16 a[190:191], v8 offset:9224
    v_mul_f32 v159, v49, v159
    v_cvt_pk_bf16_f32 v150, v156, v157
    v_cvt_pk_bf16_f32 v151, v158, v159
    ds_write_b128 v50, v[148:151] offset:1024
    v_mfma_f32_16x16x32_bf16 v[76:79], a[152:155], v[168:171], v[76:79]
    v_mfma_f32_16x16x32_bf16 v[76:79], a[148:151], v[152:155], v[76:79]
    s_add_u32 s7, s6, s12
    buffer_load_dwordx4 v[36:39], v57, s[28:31], s7 offen sc1
    v_mfma_f32_16x16x32_bf16 v[76:79], a[144:147], v[136:139], v[76:79]
    v_mfma_f32_16x16x32_bf16 v[80:83], a[160:163], v[128:131], 0
    v_mfma_f32_16x16x32_bf16 v[80:83], a[164:167], v[144:147], v[80:83]
    v_mfma_f32_16x16x32_bf16 v[80:83], a[168:171], v[160:163], v[80:83]
    s_add_u32 s7, s6, s13
    buffer_load_dwordx4 v[40:43], v57, s[28:31], s7 offen sc1
    v_mfma_f32_16x16x32_bf16 v[80:83], a[172:175], v[176:179], v[80:83]
    s_waitcnt lgkmcnt(0)
    s_barrier
    ds_read_b64_tr_b16 a[64:65], v13 offset:0
    v_mfma_f32_16x16x32_bf16 v[88:91], a[172:175], v[184:187], 0
    ds_read_b128 v[96:99], v51 offset:0
    v_mfma_f32_16x16x32_bf16 v[88:91], a[168:171], v[168:171], v[88:91]
    ds_read_b64_tr_b16 a[66:67], v13 offset:256
    ds_read_b128 v[100:103], v51 offset:1024
    v_mfma_f32_16x16x32_bf16 v[88:91], a[164:167], v[152:155], v[88:91]
    ds_read_b64_tr_b16 a[68:69], v13 offset:512
    v_mfma_f32_16x16x32_bf16 v[88:91], a[160:163], v[136:139], v[88:91]
    ds_read_b64_tr_b16 a[70:71], v13 offset:768
    v_mfma_f32_16x16x32_bf16 v[84:87], a[176:179], v[128:131], 0
    ds_read_b64_tr_b16 a[72:73], v13 offset:8448
    v_mfma_f32_16x16x32_bf16 v[84:87], a[180:183], v[144:147], v[84:87]
    s_add_u32 s7, s6, s14
    buffer_load_dwordx4 v[44:47], v57, s[28:31], s7 offen sc1
    v_mfma_f32_16x16x32_bf16 v[84:87], a[184:187], v[160:163], v[84:87]
    ds_read_b64_tr_b16 a[74:75], v13 offset:8704
    ds_read_b64_tr_b16 a[76:77], v13 offset:8960
    v_mfma_f32_16x16x32_bf16 v[84:87], a[188:191], v[176:179], v[84:87]
    ds_read_b64_tr_b16 a[78:79], v13 offset:9216
    s_waitcnt lgkmcnt(8)
    v_lshlrev_b32 v196, 16, v96
    v_mfma_f32_16x16x32_bf16 v[92:95], a[188:191], v[184:187], 0
    ds_read_b64_tr_b16 a[192:193], v13 offset:8
    v_and_b32 v197, s68, v96
    v_mfma_f32_16x16x32_bf16 v[92:95], a[184:187], v[168:171], v[92:95]
    ds_read_b64_tr_b16 a[194:195], v13 offset:264
    v_lshlrev_b32 v198, 16, v97
    v_mfma_f32_16x16x32_bf16 v[92:95], a[180:183], v[152:155], v[92:95]
    ds_read_b64_tr_b16 a[196:197], v13 offset:520
    v_and_b32 v199, s68, v97
    v_mfma_f32_16x16x32_bf16 v[92:95], a[176:179], v[136:139], v[92:95]
    s_waitcnt lgkmcnt(7)
    ds_read_b64_tr_b16 a[198:199], v13 offset:776
    v_fmac_f32 v196, v48, v164
    v_fmac_f32 v197, v48, v165
    v_mfma_f32_16x16x32_bf16 v[64:67], a[64:67], v[192:195], v[64:67]
    ds_read_b64_tr_b16 a[200:201], v13 offset:8456
    v_fmac_f32 v198, v48, v166
    v_fmac_f32 v199, v48, v167
    v_cvt_pk_bf16_f32 v96, v196, v197
    v_mfma_f32_16x16x32_bf16 v[64:67], a[68:71], v[208:211], v[64:67]
    s_waitcnt lgkmcnt(7)
    ds_read_b64_tr_b16 a[202:203], v13 offset:8712
    v_cvt_pk_bf16_f32 v97, v198, v199
    v_lshlrev_b32 v204, 16, v98
    v_and_b32 v205, s68, v98
    v_mfma_f32_16x16x32_bf16 v[64:67], a[72:75], v[224:227], v[64:67]
    s_waitcnt lgkmcnt(6)
    ds_read_b64_tr_b16 a[204:205], v13 offset:8968
    v_lshlrev_b32 v206, 16, v99
    v_and_b32 v207, s68, v99
    v_fmac_f32 v204, v48, v172
    v_mfma_f32_16x16x32_bf16 v[132:135], a[76:79], v[240:243], v[64:67]
    ds_read_b64_tr_b16 a[206:207], v13 offset:9224
    v_fmac_f32 v205, v48, v173
    v_fmac_f32 v206, v48, v174
    v_fmac_f32 v207, v48, v175
    v_mfma_f32_16x16x32_bf16 v[72:75], a[76:79], v[248:251], v[72:75]
    ds_read_b64_tr_b16 a[208:209], v9 offset:0
    v_cvt_pk_bf16_f32 v98, v204, v205
    v_cvt_pk_bf16_f32 v99, v206, v207
    v_mfma_f32_16x16x32_bf16 v[72:75], a[72:75], v[232:235], v[72:75]
    ds_read_b64_tr_b16 a[210:211], v9 offset:256
    v_lshlrev_b32 v212, 16, v100
    v_and_b32 v213, s68, v100
    v_lshlrev_b32 v214, 16, v101
    v_mfma_f32_16x16x32_bf16 v[72:75], a[68:71], v[216:219], v[72:75]
    ds_read_b64_tr_b16 a[212:213], v9 offset:512
    v_and_b32 v215, s68, v101
    v_fmac_f32 v212, v49, v180
    v_fmac_f32 v213, v49, v181
    v_mfma_f32_16x16x32_bf16 v[148:151], a[64:67], v[200:203], v[72:75]
    s_waitcnt lgkmcnt(7)
    ds_read_b64_tr_b16 a[214:215], v9 offset:768
    v_fmac_f32 v214, v49, v182
    v_fmac_f32 v215, v49, v183
    v_cvt_pk_bf16_f32 v100, v212, v213
    v_mfma_f32_16x16x32_bf16 v[68:71], a[192:195], v[192:195], v[68:71]
    ds_read_b64_tr_b16 a[216:217], v9 offset:8448
    v_cvt_pk_bf16_f32 v101, v214, v215
    v_lshlrev_b32 v220, 16, v102
    v_and_b32 v221, s68, v102
    v_mfma_f32_16x16x32_bf16 v[68:71], a[196:199], v[208:211], v[68:71]
    s_waitcnt lgkmcnt(7)
    ds_read_b64_tr_b16 a[218:219], v9 offset:8704
    v_lshlrev_b32 v222, 16, v103
    v_and_b32 v223, s68, v103
    v_fmac_f32 v220, v49, v188
    v_mfma_f32_16x16x32_bf16 v[68:71], a[200:203], v[224:227], v[68:71]
    s_waitcnt lgkmcnt(6)
    ds_read_b64_tr_b16 a[220:221], v9 offset:8960
    v_fmac_f32 v221, v49, v189
    v_fmac_f32 v222, v49, v190
    v_fmac_f32 v223, v49, v191
    v_cvt_pk_bf16_f32 v102, v220, v221
    v_cvt_pk_bf16_f32 v103, v222, v223
    v_mfma_f32_16x16x32_bf16 v[140:143], a[204:207], v[240:243], v[68:71]
    ds_read_b64_tr_b16 a[222:223], v9 offset:9216
    v_mfma_f32_16x16x32_bf16 v[76:79], a[204:207], v[248:251], v[76:79]
    ds_read_b64_tr_b16 a[224:225], v9 offset:8
    v_mfma_f32_16x16x32_bf16 v[76:79], a[200:203], v[232:235], v[76:79]
    s_add_u32 s80, s79, 163840
    buffer_store_dwordx4 v[96:99], v1, s[28:31], s80 offen sc1
    v_mfma_f32_16x16x32_bf16 v[76:79], a[196:199], v[216:219], v[76:79]
    ds_read_b64_tr_b16 a[226:227], v9 offset:264
    ds_read_b64_tr_b16 a[228:229], v9 offset:520
    v_mfma_f32_16x16x32_bf16 v[156:159], a[192:195], v[200:203], v[76:79]
    s_waitcnt lgkmcnt(7)
    ds_read_b64_tr_b16 a[230:231], v9 offset:776
    v_mfma_f32_16x16x32_bf16 v[80:83], a[208:211], v[192:195], v[80:83]
    s_add_u32 s80, s81, 163840
    buffer_store_dwordx4 v[100:103], v27, s[28:31], s80 offen sc1
    v_mfma_f32_16x16x32_bf16 v[80:83], a[212:215], v[208:211], v[80:83]
    s_waitcnt lgkmcnt(6)
    ds_read_b64_tr_b16 a[232:233], v9 offset:8456
    ds_read_b64_tr_b16 a[234:235], v9 offset:8712
    v_mfma_f32_16x16x32_bf16 v[80:83], a[216:219], v[224:227], v[80:83]
    s_waitcnt lgkmcnt(6)
    s_mov_b64 exec, s[16:17]
    ds_write_b128 v52, v[96:99] offset:5120
    s_mov_b64 exec, -1
    v_mfma_f32_16x16x32_bf16 v[164:167], a[220:223], v[240:243], v[80:83]
    v_subrev_u32 v50, 135168, v50
    v_subrev_u32 v51, 135168, v51
    v_mfma_f32_16x16x32_bf16 v[88:91], a[220:223], v[248:251], v[88:91]
    ds_read_b64_tr_b16 a[236:237], v9 offset:8968
    ds_read_b64_tr_b16 a[238:239], v9 offset:9224
    v_mfma_f32_16x16x32_bf16 v[88:91], a[216:219], v[232:235], v[88:91]
    v_mul_f32 v132, v48, v132
    v_mul_f32 v133, v48, v133
    v_mfma_f32_16x16x32_bf16 v[88:91], a[212:215], v[216:219], v[88:91]
    v_mul_f32 v134, v48, v134
    v_mul_f32 v135, v48, v135
    v_mfma_f32_16x16x32_bf16 v[180:183], a[208:211], v[200:203], v[88:91]
    s_waitcnt lgkmcnt(4)
    v_cvt_pk_bf16_f32 v132, v132, v133
    v_cvt_pk_bf16_f32 v133, v134, v135
    v_mfma_f32_16x16x32_bf16 v[84:87], a[224:227], v[192:195], v[84:87]
    v_mul_f32 v140, v48, v140
    v_mul_f32 v141, v48, v141
    v_mfma_f32_16x16x32_bf16 v[84:87], a[228:231], v[208:211], v[84:87]
    s_waitcnt lgkmcnt(2)
    v_mul_f32 v142, v48, v142
    v_mul_f32 v143, v48, v143
    v_mfma_f32_16x16x32_bf16 v[84:87], a[232:235], v[224:227], v[84:87]
    s_waitcnt lgkmcnt(0)
    v_cvt_pk_bf16_f32 v134, v140, v141
    v_cvt_pk_bf16_f32 v135, v142, v143
    v_mfma_f32_16x16x32_bf16 v[172:175], a[236:239], v[240:243], v[84:87]
    ds_write_b128 v50, v[132:135] offset:0
    v_mfma_f32_16x16x32_bf16 v[92:95], a[236:239], v[248:251], v[92:95]
    v_mul_f32 v148, v49, v148
    v_mul_f32 v149, v49, v149
    v_mfma_f32_16x16x32_bf16 v[92:95], a[232:235], v[232:235], v[92:95]
    v_mul_f32 v150, v49, v150
    v_mul_f32 v151, v49, v151
    v_mfma_f32_16x16x32_bf16 v[92:95], a[228:231], v[216:219], v[92:95]
    v_cvt_pk_bf16_f32 v148, v148, v149
    v_cvt_pk_bf16_f32 v149, v150, v151
    v_mfma_f32_16x16x32_bf16 v[188:191], a[224:227], v[200:203], v[92:95]
    v_mul_f32 v156, v49, v156
    v_mul_f32 v157, v49, v157
    v_mul_f32 v158, v49, v158
    v_mul_f32 v159, v49, v159
    v_cvt_pk_bf16_f32 v150, v156, v157
    v_cvt_pk_bf16_f32 v151, v158, v159
    ds_write_b128 v50, v[148:151] offset:1024
    v_add_u32 v122, 1, v122
    s_waitcnt vmcnt(6) lgkmcnt(0)
    s_barrier
    ds_read_b128 v[96:99], v51 offset:0
    ds_read_b128 v[100:103], v51 offset:1024
    buffer_store_dwordx2 v[122:123], v55, s[28:31], s98 offen sc1
    buffer_load_dwordx2 v[120:121], v125, s[28:31], s61 offen sc1
    s_waitcnt lgkmcnt(1)
    v_lshlrev_b32 v196, 16, v96
    v_and_b32 v197, s68, v96
    v_lshlrev_b32 v198, 16, v97
    v_and_b32 v199, s68, v97
    v_fmac_f32 v196, v48, v164
    v_fmac_f32 v197, v48, v165
    v_fmac_f32 v198, v48, v166
    v_fmac_f32 v199, v48, v167
    v_cvt_pk_bf16_f32 v96, v196, v197
    v_cvt_pk_bf16_f32 v97, v198, v199
    v_lshlrev_b32 v204, 16, v98
    v_and_b32 v205, s68, v98
    v_lshlrev_b32 v206, 16, v99
    v_and_b32 v207, s68, v99
    v_fmac_f32 v204, v48, v172
    v_fmac_f32 v205, v48, v173
    v_fmac_f32 v206, v48, v174
    v_fmac_f32 v207, v48, v175
    v_cvt_pk_bf16_f32 v98, v204, v205
    v_cvt_pk_bf16_f32 v99, v206, v207
    s_add_u32 s80, s79, 196608
    buffer_store_dwordx4 v[96:99], v1, s[28:31], s80 offen sc1
    s_waitcnt lgkmcnt(0)
    v_lshlrev_b32 v212, 16, v100
    v_and_b32 v213, s68, v100
    v_lshlrev_b32 v214, 16, v101
    v_and_b32 v215, s68, v101
    v_fmac_f32 v212, v49, v180
    v_fmac_f32 v213, v49, v181
    v_fmac_f32 v214, v49, v182
    v_fmac_f32 v215, v49, v183
    v_cvt_pk_bf16_f32 v100, v212, v213
    v_cvt_pk_bf16_f32 v101, v214, v215
    v_lshlrev_b32 v220, 16, v102
    v_and_b32 v221, s68, v102
    v_lshlrev_b32 v222, 16, v103
    v_and_b32 v223, s68, v103
    v_fmac_f32 v220, v49, v188
    v_fmac_f32 v221, v49, v189
    v_fmac_f32 v222, v49, v190
    v_fmac_f32 v223, v49, v191
    v_cvt_pk_bf16_f32 v102, v220, v221
    v_cvt_pk_bf16_f32 v103, v222, v223
    s_add_u32 s80, s81, 196608
    buffer_store_dwordx4 v[100:103], v27, s[28:31], s80 offen sc1
    s_mov_b64 exec, s[16:17]
    ds_write_b128 v52, v[96:99] offset:6144
    s_mov_b64 exec, -1
L_tail:
    s_add_u32 s7, s6, 98304
    s_lshl_b32 s4, s88, 7
    s_add_u32 s4, s4, 158720
    v_lshl_add_u32 v124, v116, 4, s4
    s_lshl_b32 s3, s88, 10
    s_add_u32 s3, s3, 151552
    v_add_u32 v60, s3, v27
    v_lshrrev_b32 v56, 5, v0
    v_and_b32 v57, 3, v0
    v_bfe_u32 v58, v0, 2, 3
    v_lshl_add_u32 v58, v56, 4, v58
    v_mul_u32_u24 v2, 1056, v58
    v_lshl_add_u32 v2, v57, 3, v2
    s_mul_i32 s3, s89, 224
    v_add_u32 v2, s3, v2
    v_add_u32 v3, 67584, v2
    ds_read_b128 v[128:131], v124 offset:0
    ds_read_b128 v[132:135], v124 offset:384
    ds_read_b128 v[136:139], v124 offset:896
    ds_read_b128 v[140:143], v124 offset:1280
    ds_read_b128 v[144:147], v124 offset:1792
    ds_read_b128 v[148:151], v124 offset:2176
    ds_read_b128 v[152:155], v124 offset:2688
    ds_read_b128 v[156:159], v124 offset:3072
    ds_read_b64_tr_b16 a[0:1], v2 offset:33792
    ds_read_b64_tr_b16 a[2:3], v2 offset:42240
    ds_read_b64_tr_b16 a[4:5], v2 offset:33824
    ds_read_b64_tr_b16 a[6:7], v2 offset:42272
    ds_read_b64_tr_b16 a[8:9], v2 offset:33856
    ds_read_b64_tr_b16 a[10:11], v2 offset:42304
    ds_read_b64_tr_b16 a[12:13], v2 offset:33888
    ds_read_b64_tr_b16 a[14:15], v2 offset:42336
    ds_read_b64_tr_b16 a[16:17], v2 offset:33920
    ds_read_b64_tr_b16 a[18:19], v2 offset:42368
    ds_read_b64_tr_b16 a[20:21], v2 offset:33952
    ds_read_b64_tr_b16 a[22:23], v2 offset:42400
    ds_read_b64_tr_b16 a[24:25], v2 offset:33984
    ds_read_b64_tr_b16 a[26:27], v2 offset:42432
    ds_read_b64_tr_b16 a[28:29], v2 offset:34240
    ds_read_b64_tr_b16 a[30:31], v2 offset:42688
    ds_read_b64_tr_b16 a[32:33], v2 offset:34272
    ds_read_b64_tr_b16 a[34:35], v2 offset:42720
    ds_read_b64_tr_b16 a[36:37], v2 offset:34304
    ds_read_b64_tr_b16 a[38:39], v2 offset:42752
    ds_read_b64_tr_b16 a[40:41], v2 offset:34336
    ds_read_b64_tr_b16 a[42:43], v2 offset:42784
    ds_read_b64_tr_b16 a[44:45], v2 offset:34368
    ds_read_b64_tr_b16 a[46:47], v2 offset:42816
    ds_read_b64_tr_b16 a[48:49], v2 offset:34400
    ds_read_b64_tr_b16 a[50:51], v2 offset:42848
    ds_read_b64_tr_b16 a[52:53], v2 offset:34432
    ds_read_b64_tr_b16 a[54:55], v2 offset:42880
    ds_read_b64_tr_b16 a[56:57], v3 offset:33792
    ds_read_b64_tr_b16 a[58:59], v3 offset:42240
    ds_read_b64_tr_b16 a[196:197], v3 offset:34240
    ds_read_b64_tr_b16 a[198:199], v3 offset:42688
    ds_read_b64_tr_b16 a[60:61], v3 offset:33824
    ds_read_b64_tr_b16 a[62:63], v3 offset:42272
    ds_read_b64_tr_b16 a[200:201], v3 offset:34272
    ds_read_b64_tr_b16 a[202:203], v3 offset:42720
    ds_read_b64_tr_b16 a[176:177], v3 offset:33856
    ds_read_b64_tr_b16 a[178:179], v3 offset:42304
    ds_read_b64_tr_b16 a[204:205], v3 offset:34304
    ds_read_b64_tr_b16 a[206:207], v3 offset:42752
    ds_read_b64_tr_b16 a[180:181], v3 offset:33888
    ds_read_b64_tr_b16 a[182:183], v3 offset:42336
    ds_read_b64_tr_b16 a[208:209], v3 offset:34336
    ds_read_b64_tr_b16 a[210:211], v3 offset:42784
    ds_read_b64_tr_b16 a[184:185], v3 offset:33920
    ds_read_b64_tr_b16 a[186:187], v3 offset:42368
    ds_read_b64_tr_b16 a[212:213], v3 offset:34368
    ds_read_b64_tr_b16 a[214:215], v3 offset:42816
    ds_read_b64_tr_b16 a[188:189], v3 offset:33952
    ds_read_b64_tr_b16 a[190:191], v3 offset:42400
    ds_read_b64_tr_b16 a[216:217], v3 offset:34400
    ds_read_b64_tr_b16 a[218:219], v3 offset:42848
    ds_read_b64_tr_b16 a[192:193], v3 offset:33984
    ds_read_b64_tr_b16 a[194:195], v3 offset:42432
    ds_read_b64_tr_b16 a[220:221], v3 offset:34432
    ds_read_b64_tr_b16 a[222:223], v3 offset:42880
    s_waitcnt lgkmcnt(0)
    s_barrier
    ds_read_b128 v[228:231], v60
    ds_read_b128 v[64:67], v60 offset:3072
    v_cmp_gt_u32 vcc, 4, v0
    s_lshl_b32 s3, s90, 9
    s_lshl_b32 s4, s89, 3
    s_add_u32 s3, s3, s4
    s_add_u32 s3, s3, 1024
    v_lshl_add_u32 v58, v0, 7, s3
    v_cndmask_b32 v54, v63, v58, vcc
    s_add_u32 s3, s94, 7
    v_mov_b32 v126, s3
    v_mov_b32 v127, s95
    s_cmp_eq_u32 s88, 3
    s_cselect_b64 vcc, -1, 0
    v_lshlrev_b32 v107, 8, v116
    v_lshl_add_u32 v107, v53, 4, v107
    s_lshl_b32 s3, s88, 11
    v_add_u32 v107, s3, v107
    v_cndmask_b32 v106, v107, v63, vcc
    v_add_u32 v107, s69, v107
    v_lshrrev_b32 v56, 4, v0
    s_lshl_b32 s3, s88, 2
    v_add_u32 v56, s3, v56
    v_lshlrev_b32 v116, 7, v53
    v_add_u32 v116, 162304, v116
    v_lshl_add_u32 v117, v56, 3, v116
    s_waitcnt vmcnt(0)
    buffer_store_dwordx2 v[126:127], v54, s[28:31], s98 offen sc1
    s_cmp_eq_u32 s67, 0
    s_cbranch_scc1 L_e_late
L_e_done:
    v_subrev_u32 v56, s65, v120
    v_cmp_ne_u32 s[4:5], s95, v121
    v_cmp_lt_u32 vcc, 7, v56
    s_nop 0
    s_or_b64 vcc, vcc, s[4:5]
    s_cselect_b32 s67, 0, 1
    s_cbranch_scc1 L_late_skip
    s_add_u32 s78, s7, s8
    buffer_load_dwordx4 v[68:71], v14, s[28:31], s78 offen sc1
    s_add_u32 s77, s7, s9
    buffer_load_dwordx4 v[72:75], v14, s[28:31], s77 offen sc1
    s_add_u32 s78, s7, s10
    buffer_load_dwordx4 v[76:79], v14, s[28:31], s78 offen sc1
    s_add_u32 s77, s7, s11
    buffer_load_dwordx4 v[80:83], v14, s[28:31], s77 offen sc1
    s_add_u32 s78, s7, s12
    buffer_load_dwordx4 v[84:87], v14, s[28:31], s78 offen sc1
    s_add_u32 s77, s7, s13
    buffer_load_dwordx4 v[88:91], v14, s[28:31], s77 offen sc1
    s_add_u32 s78, s7, s14
    buffer_load_dwordx4 v[92:95], v14, s[28:31], s78 offen sc1
L_late_skip:
    s_add_u32 s77, s74, 458752
    s_add_u32 m0, s72, 0
    s_nop 0
    buffer_load_dwordx4 v15, s[40:43], s77 offen lds
    s_mul_i32 s75, s88, 28672
    s_mul_i32 s3, s90, 14336
    s_add_u32 s4, s3, 135168
    v_add_u32 v5, s4, v27
    s_lshl_b32 s3, s90, 11
    s_add_u32 s3, s3, 101376
    v_add_u32 v6, s3, v27
    s_lshl_b32 s3, s89, 3
    v_add_u32 v4, s3, v5
    v_lshrrev_b32 v56, 5, v0
    buffer_load_dwordx4 v16, s[40:43], s77 offen offset:1056 lds
    v_bfe_u32 v57, v0, 4, 1
    v_mul_u32_u24 v58, 112, v57
    v_lshl_add_u32 v58, v56, 4, v58
    v_bfe_u32 v57, v0, 3, 1
    v_lshl_add_u32 v58, v57, 3, v58
    v_mul_u32_u24 v58, 896, v58
    v_lshl_add_u32 v58, v53, 4, v58
    s_cmp_eq_u32 s88, 3
    s_cselect_b32 s3, 32, 64
    v_cmp_gt_u32 vcc, s3, v0
    buffer_load_dwordx4 v17, s[40:43], s77 offen offset:2112 lds
    s_nop 1
    v_cndmask_b32 v58, v63, v58, vcc
    v_add_u32 v19, 512, v58
    v_add_u32 v20, 376, v58
    v_add_u32 v21, 192, v58
    v_add_u32 v22, 56, v58
    s_xor_b32 s79, s79, 1048576
    s_xor_b32 s81, s81, 1048576
    s_mov_b32 s70, 0x3f80
    s_mov_b32 s71, 0x3f800000
    buffer_load_dwordx4 v18, s[40:43], s77 offen offset:3168 lds
    s_mul_i32 s3, s89, 16896
    v_subrev_u32 v8, s3, v8
    v_subrev_u32 v9, s3, v9
    s_waitcnt lgkmcnt(0)
    v_lshlrev_b32 v160, 16, v128
    v_and_b32 v161, s68, v128
    v_lshlrev_b32 v162, 16, v129
    v_and_b32 v163, s68, v129
    v_lshlrev_b32 v164, 16, v130
    v_and_b32 v165, s68, v130
    s_add_u32 s78, s74, 487424
    s_add_u32 m0, s72, 4224
    s_nop 0
    buffer_load_dwordx4 v15, s[40:43], s78 offen lds
    v_lshlrev_b32 v166, 16, v131
    v_and_b32 v167, s68, v131
    v_lshlrev_b32 v168, 16, v132
    v_and_b32 v169, s68, v132
    v_lshlrev_b32 v170, 16, v133
    v_and_b32 v171, s68, v133
    v_lshlrev_b32 v172, 16, v134
    v_and_b32 v173, s68, v134
    v_lshlrev_b32 v174, 16, v135
    v_and_b32 v175, s68, v135
    buffer_load_dwordx4 v16, s[40:43], s78 offen offset:1056 lds
    v_lshlrev_b32 v176, 16, v136
    v_and_b32 v177, s68, v136
    v_lshlrev_b32 v178, 16, v137
    v_and_b32 v179, s68, v137
    v_lshlrev_b32 v180, 16, v138
    v_and_b32 v181, s68, v138
    v_lshlrev_b32 v182, 16, v139
    v_and_b32 v183, s68, v139
    v_lshlrev_b32 v184, 16, v140
    v_and_b32 v185, s68, v140
    buffer_load_dwordx4 v17, s[40:43], s78 offen offset:2112 lds
    v_lshlrev_b32 v186, 16, v141
    v_and_b32 v187, s68, v141
    v_lshlrev_b32 v188, 16, v142
    v_and_b32 v189, s68, v142
    v_lshlrev_b32 v190, 16, v143
    v_and_b32 v191, s68, v143
    v_lshlrev_b32 v192, 16, v144
    v_and_b32 v193, s68, v144
    v_lshlrev_b32 v194, 16, v145
    v_and_b32 v195, s68, v145
    buffer_load_dwordx4 v18, s[40:43], s78 offen offset:3168 lds
    v_lshlrev_b32 v196, 16, v146
    v_and_b32 v197, s68, v146
    v_lshlrev_b32 v198, 16, v147
    v_and_b32 v199, s68, v147
    v_lshlrev_b32 v200, 16, v148
    v_and_b32 v201, s68, v148
    v_lshlrev_b32 v202, 16, v149
    v_and_b32 v203, s68, v149
    v_lshlrev_b32 v204, 16, v150
    v_and_b32 v205, s68, v150
    s_add_u32 s77, s74, 688128
    s_add_u32 m0, s72, 67584
    s_nop 0
    buffer_load_dwordx4 v15, s[40:43], s77 offen lds
    v_lshlrev_b32 v206, 16, v151
    v_and_b32 v207, s68, v151
    v_lshlrev_b32 v208, 16, v108
    v_and_b32 v209, s68, v108
    v_lshlrev_b32 v210, 16, v109
    v_and_b32 v211, s68, v109
    v_lshlrev_b32 v212, 16, v110
    v_and_b32 v213, s68, v110
    v_lshlrev_b32 v214, 16, v111
    v_and_b32 v215, s68, v111
    buffer_load_dwordx4 v16, s[40:43], s77 offen offset:1056 lds
    v_lshlrev_b32 v216, 16, v112
    v_and_b32 v217, s68, v112
    v_lshlrev_b32 v218, 16, v113
    v_and_b32 v219, s68, v113
    v_lshlrev_b32 v220, 16, v114
    v_and_b32 v221, s68, v114
    v_lshlrev_b32 v222, 16, v115
    v_and_b32 v223, s68, v115
    v_lshlrev_b32 v136, 16, v64
    v_and_b32 v137, s68, v64
    buffer_load_dwordx4 v17, s[40:43], s77 offen offset:2112 lds
    v_lshlrev_b32 v138, 16, v65
    v_and_b32 v139, s68, v65
    v_lshlrev_b32 v140, 16, v66
    v_and_b32 v141, s68, v66
    v_lshlrev_b32 v142, 16, v67
    v_and_b32 v143, s68, v67
    v_and_b32 v228, s15, v228
    v_and_b32 v229, s15, v229
    v_and_b32 v230, s15, v230
    v_and_b32 v231, s15, v231
    buffer_load_dwordx4 v18, s[40:43], s77 offen offset:3168 lds
    v_lshlrev_b32 v128, 16, v228
    v_and_b32 v129, s68, v228
    v_lshlrev_b32 v130, 16, v229
    v_and_b32 v131, s68, v229
    v_lshlrev_b32 v132, 16, v230
    v_and_b32 v133, s68, v230
    v_lshlrev_b32 v134, 16, v231
    v_and_b32 v135, s68, v231
    v_dot2c_f32_bf16 v128, s70, v236
    v_dot2c_f32_bf16 v129, s71, v236
    s_add_u32 s78, s74, 716800
    s_add_u32 m0, s72, 71808
    s_nop 0
    buffer_load_dwordx4 v15, s[40:43], s78 offen lds
    v_dot2c_f32_bf16 v130, s70, v237
    v_dot2c_f32_bf16 v131, s71, v237
    v_dot2c_f32_bf16 v132, s70, v238
    v_dot2c_f32_bf16 v133, s71, v238
    v_dot2c_f32_bf16 v134, s70, v239
    v_dot2c_f32_bf16 v135, s71, v239
    v_dot2c_f32_bf16 v128, s70, v244
    v_dot2c_f32_bf16 v129, s71, v244
    v_dot2c_f32_bf16 v130, s70, v245
    v_dot2c_f32_bf16 v131, s71, v245
    buffer_load_dwordx4 v16, s[40:43], s78 offen offset:1056 lds
    v_dot2c_f32_bf16 v132, s70, v246
    v_dot2c_f32_bf16 v133, s71, v246
    v_dot2c_f32_bf16 v134, s70, v247
    v_dot2c_f32_bf16 v135, s71, v247
    v_dot2c_f32_bf16 v128, s70, v252
    v_dot2c_f32_bf16 v129, s71, v252
    v_dot2c_f32_bf16 v130, s70, v253
    v_dot2c_f32_bf16 v131, s71, v253
    v_dot2c_f32_bf16 v132, s70, v254
    v_dot2c_f32_bf16 v133, s71, v254
    buffer_load_dwordx4 v17, s[40:43], s78 offen offset:2112 lds
    v_dot2c_f32_bf16 v134, s70, v255
    v_dot2c_f32_bf16 v135, s71, v255
    v_dot2c_f32_bf16 v128, s70, v32
    v_dot2c_f32_bf16 v129, s71, v32
    v_dot2c_f32_bf16 v130, s70, v33
    v_dot2c_f32_bf16 v131, s71, v33
    v_dot2c_f32_bf16 v132, s70, v34
    v_dot2c_f32_bf16 v133, s71, v34
    v_dot2c_f32_bf16 v134, s70, v35
    v_dot2c_f32_bf16 v135, s71, v35
    buffer_load_dwordx4 v18, s[40:43], s78 offen offset:3168 lds
    v_dot2c_f32_bf16 v128, s70, v36
    v_dot2c_f32_bf16 v129, s71, v36
    v_dot2c_f32_bf16 v130, s70, v37
    v_dot2c_f32_bf16 v131, s71, v37
    v_dot2c_f32_bf16 v132, s70, v38
    v_dot2c_f32_bf16 v133, s71, v38
    v_dot2c_f32_bf16 v134, s70, v39
    v_dot2c_f32_bf16 v135, s71, v39
    v_dot2c_f32_bf16 v128, s70, v40
    v_dot2c_f32_bf16 v129, s71, v40
    v_dot2c_f32_bf16 v130, s70, v41
    v_dot2c_f32_bf16 v131, s71, v41
    v_dot2c_f32_bf16 v132, s70, v42
    v_dot2c_f32_bf16 v133, s71, v42
    v_dot2c_f32_bf16 v134, s70, v43
    v_dot2c_f32_bf16 v135, s71, v43
    v_dot2c_f32_bf16 v128, s70, v44
    v_dot2c_f32_bf16 v129, s71, v44
    v_dot2c_f32_bf16 v130, s70, v45
    v_dot2c_f32_bf16 v131, s71, v45
    v_dot2c_f32_bf16 v132, s70, v46
    v_dot2c_f32_bf16 v133, s71, v46
    v_dot2c_f32_bf16 v134, s70, v47
    v_dot2c_f32_bf16 v135, s71, v47
    v_pk_fma_f32 v[208:209], v[128:129], v[160:161], v[208:209]
    v_pk_fma_f32 v[210:211], v[130:131], v[162:163], v[210:211]
    v_pk_fma_f32 v[212:213], v[132:133], v[164:165], v[212:213]
    v_pk_fma_f32 v[214:215], v[134:135], v[166:167], v[214:215]
    v_pk_mul_f32 v[50:51], v[208:209], v[208:209]
    v_pk_fma_f32 v[50:51], v[210:211], v[210:211], v[50:51]
    v_pk_add_f32 v[48:49], v[208:209], v[210:211]
    v_pk_fma_f32 v[50:51], v[212:213], v[212:213], v[50:51]
    v_pk_add_f32 v[48:49], v[48:49], v[212:213]
    v_pk_fma_f32 v[50:51], v[214:215], v[214:215], v[50:51]
    v_pk_add_f32 v[48:49], v[48:49], v[214:215]
    s_mov_b64 exec, 0
    s_cmp_eq_u32 s88, 0
    s_cbranch_scc1 L_hop1_0
    s_cmp_eq_u32 s88, 1
    s_cbranch_scc1 L_hop1_1
    s_cmp_eq_u32 s88, 2
    s_cbranch_scc1 L_hop1_2
    s_branch L_hop1_3
L_hop1_3:
L_hopback1:
    s_mov_b64 exec, -1
    s_cmp_eq_u32 s67, 1
    s_cbranch_scc1 L_late_done
    s_mov_b32 s93, 60000
L_sw4:
    v_subrev_u32 v56, s65, v120
    v_cmp_ne_u32 s[4:5], s95, v121
    v_cmp_lt_u32 vcc, 7, v56
    s_nop 0
    s_or_b64 vcc, vcc, s[4:5]
    s_cbranch_scc1 L_sw4_retry
L_sw4_done:
    s_add_u32 s78, s7, s8
    buffer_load_dwordx4 v[68:71], v14, s[28:31], s78 offen sc1
    s_add_u32 s77, s7, s9
    buffer_load_dwordx4 v[72:75], v14, s[28:31], s77 offen sc1
    s_add_u32 s78, s7, s10
    buffer_load_dwordx4 v[76:79], v14, s[28:31], s78 offen sc1
    s_add_u32 s77, s7, s11
    buffer_load_dwordx4 v[80:83], v14, s[28:31], s77 offen sc1
    s_add_u32 s78, s7, s12
    buffer_load_dwordx4 v[84:87], v14, s[28:31], s78 offen sc1
    s_add_u32 s77, s7, s13
    buffer_load_dwordx4 v[88:91], v14, s[28:31], s77 offen sc1
    s_add_u32 s78, s7, s14
    buffer_load_dwordx4 v[92:95], v14, s[28:31], s78 offen sc1
L_late_done:
    s_xor_b32 s98, s98, 1048576
    s_xor_b32 s61, s61, 1048576
    s_cmp_ge_u32 s88, 0
    s_cselect_b64 vcc, -1, 0
    v_and_b32 v56, 15, v0
    v_lshlrev_b32 v56, 3, v56
    v_add_u32 v56, 1024, v56
    v_cndmask_b32 v125, v119, v56, vcc
    s_mov_b32 s66, 0x3b124925
    s_lshl_b32 s5, s88, 18
    s_add_u32 s5, s5, 229376
    s_xor_b32 s5, s5, s34
    s_mov_b32 s101, s5
    s_lshl_b32 s6, s91, 10
    s_add_u32 s6, s6, 101376
    v_add_u32 v7, s6, v27
    v_mov_b32 v122, s94
    s_waitcnt vmcnt(5)
    v_dot2c_f32_bf16 v136, s70, v68
    v_dot2c_f32_bf16 v137, s71, v68
    v_dot2c_f32_bf16 v138, s70, v69
    v_dot2c_f32_bf16 v139, s71, v69
    v_dot2c_f32_bf16 v140, s70, v70
    v_dot2c_f32_bf16 v141, s71, v70
    v_dot2c_f32_bf16 v142, s70, v71
    v_dot2c_f32_bf16 v143, s71, v71
    s_add_u32 s77, s74, 917504
    s_add_u32 m0, s72, 33792
    s_nop 0
    buffer_load_dwordx4 v15, s[40:43], s77 offen lds
    v_dot2c_f32_bf16 v136, s70, v72
    v_dot2c_f32_bf16 v137, s71, v72
    v_dot2c_f32_bf16 v138, s70, v73
    v_dot2c_f32_bf16 v139, s71, v73
    v_dot2c_f32_bf16 v140, s70, v74
    v_dot2c_f32_bf16 v141, s71, v74
    v_dot2c_f32_bf16 v142, s70, v75
    v_dot2c_f32_bf16 v143, s71, v75
    s_waitcnt vmcnt(4)
    v_dot2c_f32_bf16 v136, s70, v76
    v_dot2c_f32_bf16 v137, s71, v76
    v_dot2c_f32_bf16 v138, s70, v77
    v_dot2c_f32_bf16 v139, s71, v77
    v_dot2c_f32_bf16 v140, s70, v78
    v_dot2c_f32_bf16 v141, s71, v78
    v_dot2c_f32_bf16 v142, s70, v79
    v_dot2c_f32_bf16 v143, s71, v79
    buffer_load_dwordx4 v16, s[40:43], s77 offen offset:1056 lds
    v_dot2c_f32_bf16 v136, s70, v80
    v_dot2c_f32_bf16 v137, s71, v80
    v_dot2c_f32_bf16 v138, s70, v81
    v_dot2c_f32_bf16 v139, s71, v81
    v_dot2c_f32_bf16 v140, s70, v82
    v_dot2c_f32_bf16 v141, s71, v82
    v_dot2c_f32_bf16 v142, s70, v83
    v_dot2c_f32_bf16 v143, s71, v83
    s_waitcnt vmcnt(3)
    buffer_load_dwordx4 v17, s[40:43], s77 offen offset:2112 lds
    v_dot2c_f32_bf16 v136, s70, v84
    v_dot2c_f32_bf16 v137, s71, v84
    v_dot2c_f32_bf16 v138, s70, v85
    v_dot2c_f32_bf16 v139, s71, v85
    v_dot2c_f32_bf16 v140, s70, v86
    v_dot2c_f32_bf16 v141, s71, v86
    v_dot2c_f32_bf16 v142, s70, v87
    v_dot2c_f32_bf16 v143, s71, v87
    buffer_load_dwordx4 v18, s[40:43], s77 offen offset:3168 lds
    v_dot2c_f32_bf16 v136, s70, v88
    v_dot2c_f32_bf16 v137, s71, v88
    v_dot2c_f32_bf16 v138, s70, v89
    v_dot2c_f32_bf16 v139, s71, v89
    v_dot2c_f32_bf16 v140, s70, v90
    v_dot2c_f32_bf16 v141, s71, v90
    v_dot2c_f32_bf16 v142, s70, v91
    v_dot2c_f32_bf16 v143, s71, v91
    s_waitcnt vmcnt(4)
    s_add_u32 s78, s74, 946176
    s_add_u32 m0, s72, 38016
    s_nop 0
    buffer_load_dwordx4 v15, s[40:43], s78 offen lds
    v_dot2c_f32_bf16 v136, s70, v92
    v_dot2c_f32_bf16 v137, s71, v92
    v_dot2c_f32_bf16 v138, s70, v93
    v_dot2c_f32_bf16 v139, s71, v93
L_hop1_0:
    s_cbranch_execz L_hopback1
    v_dot2c_f32_bf16 v140, s70, v94
    v_dot2c_f32_bf16 v141, s71, v94
    v_dot2c_f32_bf16 v142, s70, v95
    v_dot2c_f32_bf16 v143, s71, v95
    buffer_load_dwordx4 v16, s[40:43], s78 offen offset:1056 lds
    v_pk_fma_f32 v[216:217], v[136:137], v[168:169], v[216:217]
    v_pk_fma_f32 v[218:219], v[138:139], v[170:171], v[218:219]
    v_pk_fma_f32 v[220:221], v[140:141], v[172:173], v[220:221]
    v_pk_fma_f32 v[222:223], v[142:143], v[174:175], v[222:223]
    v_pk_fma_f32 v[50:51], v[216:217], v[216:217], v[50:51]
    v_pk_add_f32 v[48:49], v[48:49], v[216:217]
    v_pk_fma_f32 v[50:51], v[218:219], v[218:219], v[50:51]
    v_pk_add_f32 v[48:49], v[48:49], v[218:219]
    v_pk_fma_f32 v[50:51], v[220:221], v[220:221], v[50:51]
    v_pk_add_f32 v[48:49], v[48:49], v[220:221]
    v_pk_fma_f32 v[50:51], v[222:223], v[222:223], v[50:51]
    v_pk_add_f32 v[48:49], v[48:49], v[222:223]
    v_add_f32 v48, v48, v49
    v_add_f32 v49, v50, v51
    s_nop 0
    v_add_f32_dpp v48, v48, v48 row_ror:8 row_mask:0xf bank_mask:0xf
    v_add_f32_dpp v49, v49, v49 row_ror:8 row_mask:0xf bank_mask:0xf
    ds_write_b64 v117, v[48:49]
    buffer_load_dwordx4 v17, s[40:43], s78 offen offset:2112 lds
    s_waitcnt lgkmcnt(0)
    s_barrier
    ds_read_b128 v[64:67], v116 offset:0
    ds_read_b128 v[68:71], v116 offset:16
    ds_read_b128 v[72:75], v116 offset:32
    ds_read_b128 v[76:79], v116 offset:48
    ds_read_b128 v[80:83], v116 offset:64
    ds_read_b128 v[84:87], v116 offset:80
    ds_read_b128 v[88:91], v116 offset:96
    ds_read_b128 v[92:95], v116 offset:112
    buffer_load_dwordx4 v18, s[40:43], s78 offen offset:3168 lds
    s_waitcnt lgkmcnt(0)
    v_pk_add_f32 v[64:65], v[64:65], v[80:81]
    v_pk_add_f32 v[66:67], v[66:67], v[82:83]
    v_pk_add_f32 v[68:69], v[68:69], v[84:85]
    v_pk_add_f32 v[70:71], v[70:71], v[86:87]
    v_pk_add_f32 v[72:73], v[72:73], v[88:89]
    v_pk_add_f32 v[74:75], v[74:75], v[90:91]
    v_pk_add_f32 v[76:77], v[76:77], v[92:93]
    v_pk_add_f32 v[78:79], v[78:79], v[94:95]
    v_pk_add_f32 v[64:65], v[64:65], v[72:73]
    v_pk_add_f32 v[66:67], v[66:67], v[74:75]
    v_pk_add_f32 v[68:69], v[68:69], v[76:77]
    v_pk_add_f32 v[70:71], v[70:71], v[78:79]
    v_pk_add_f32 v[64:65], v[64:65], v[68:69]
    v_pk_add_f32 v[66:67], v[66:67], v[70:71]
    v_pk_add_f32 v[64:65], v[64:65], v[66:67]
    v_pk_mul_f32 v[64:65], v[64:65], s[66:67] op_sel:[0,0] op_sel_hi:[1,0]
    v_fma_f32 v65, -v64, v64, v65
    v_max_f32 v65, 0, v65
    v_add_f32 v65, 0x3727c5ac, v65
    v_rsq_f32 v66, v65
    s_nop 0
    v_mul_f32 v67, -v64, v66
    v_pk_fma_f32 v[128:129], v[208:209], v[66:67], v[66:67] op_sel:[0,0,1] op_sel_hi:[1,0,1]
    v_pk_fma_f32 v[130:131], v[210:211], v[66:67], v[66:67] op_sel:[0,0,1] op_sel_hi:[1,0,1]
    v_pk_fma_f32 v[132:133], v[212:213], v[66:67], v[66:67] op_sel:[0,0,1] op_sel_hi:[1,0,1]
    v_pk_fma_f32 v[134:135], v[214:215], v[66:67], v[66:67] op_sel:[0,0,1] op_sel_hi:[1,0,1]
    v_pk_fma_f32 v[128:129], v[128:129], v[192:193], v[176:177]
    v_pk_fma_f32 v[130:131], v[130:131], v[194:195], v[178:179]
    v_pk_fma_f32 v[132:133], v[132:133], v[196:197], v[180:181]
    v_pk_fma_f32 v[134:135], v[134:135], v[198:199], v[182:183]
    v_cvt_pk_bf16_f32 v248, v128, v129
    v_cvt_pk_bf16_f32 v249, v130, v131
    v_cvt_pk_bf16_f32 v250, v132, v133
    v_cvt_pk_bf16_f32 v251, v134, v135
    buffer_store_dwordx4 v[248:251], v106, s[28:31], s63 offen sc1
    v_pk_fma_f32 v[136:137], v[216:217], v[66:67], v[66:67] op_sel:[0,0,1] op_sel_hi:[1,0,1]
    v_pk_fma_f32 v[138:139], v[218:219], v[66:67], v[66:67] op_sel:[0,0,1] op_sel_hi:[1,0,1]
    v_pk_fma_f32 v[140:141], v[220:221], v[66:67], v[66:67] op_sel:[0,0,1] op_sel_hi:[1,0,1]
    v_pk_fma_f32 v[142:143], v[222:223], v[66:67], v[66:67] op_sel:[0,0,1] op_sel_hi:[1,0,1]
    v_pk_fma_f32 v[136:137], v[136:137], v[200:201], v[184:185]
    v_pk_fma_f32 v[138:139], v[138:139], v[202:203], v[186:187]
    v_pk_fma_f32 v[140:141], v[140:141], v[204:205], v[188:189]
    v_pk_fma_f32 v[142:143], v[142:143], v[206:207], v[190:191]
    v_cvt_pk_bf16_f32 v252, v136, v137
    v_cvt_pk_bf16_f32 v253, v138, v139
    v_cvt_pk_bf16_f32 v254, v140, v141
    v_cvt_pk_bf16_f32 v255, v142, v143
    buffer_store_dwordx4 v[252:255], v107, s[28:31], s63 offen sc1
    v_mov_b64 v[176:177], v[208:209]
    v_mov_b64 v[178:179], v[210:211]
    v_mov_b64 v[180:181], v[212:213]
    v_mov_b64 v[182:183], v[214:215]
    v_mov_b64 v[184:185], v[216:217]
    v_mov_b64 v[186:187], v[218:219]
    v_mov_b64 v[188:189], v[220:221]
    v_mov_b64 v[190:191], v[222:223]
    ds_read_b64_tr_b16 a[224:225], v2 offset:0
    ds_read_b64_tr_b16 a[226:227], v2 offset:8448
    ds_read_b64_tr_b16 a[252:253], v2 offset:448
    ds_read_b64_tr_b16 a[254:255], v2 offset:8896
    ds_read_b64_tr_b16 a[228:229], v2 offset:32
    ds_read_b64_tr_b16 a[230:231], v2 offset:8480
    ds_read_b64_tr_b16 v[64:65], v2 offset:480
    ds_read_b64_tr_b16 v[66:67], v2 offset:8928
    ds_read_b64_tr_b16 a[232:233], v2 offset:64
    ds_read_b64_tr_b16 a[234:235], v2 offset:8512
    ds_read_b64_tr_b16 v[68:69], v2 offset:512
    ds_read_b64_tr_b16 v[70:71], v2 offset:8960
    ds_read_b64_tr_b16 a[236:237], v2 offset:96
    ds_read_b64_tr_b16 a[238:239], v2 offset:8544
    ds_read_b64_tr_b16 v[72:73], v2 offset:544
    ds_read_b64_tr_b16 v[74:75], v2 offset:8992
    ds_read_b64_tr_b16 a[240:241], v2 offset:128
    ds_read_b64_tr_b16 a[242:243], v2 offset:8576
    ds_read_b64_tr_b16 v[76:77], v2 offset:576
    ds_read_b64_tr_b16 v[78:79], v2 offset:9024
    ds_read_b64_tr_b16 a[244:245], v2 offset:160
    ds_read_b64_tr_b16 a[246:247], v2 offset:8608
    ds_read_b64_tr_b16 v[80:81], v2 offset:608
    ds_read_b64_tr_b16 v[82:83], v2 offset:9056
    ds_read_b64_tr_b16 a[248:249], v2 offset:192
    ds_read_b64_tr_b16 a[250:251], v2 offset:8640
    ds_read_b64_tr_b16 v[84:85], v2 offset:640
    ds_read_b64_tr_b16 v[86:87], v2 offset:9088
    ds_read_b64_tr_b16 v[88:89], v3 offset:0
    ds_read_b64_tr_b16 v[90:91], v3 offset:8448
    ds_read_b64_tr_b16 v[140:141], v3 offset:448
    ds_read_b64_tr_b16 v[142:143], v3 offset:8896
    ds_read_b64_tr_b16 v[92:93], v3 offset:32
    ds_read_b64_tr_b16 v[94:95], v3 offset:8480
    ds_read_b64_tr_b16 v[144:145], v3 offset:480
    ds_read_b64_tr_b16 v[146:147], v3 offset:8928
    ds_read_b64_tr_b16 v[96:97], v3 offset:64
    ds_read_b64_tr_b16 v[98:99], v3 offset:8512
    ds_read_b64_tr_b16 v[148:149], v3 offset:512
    ds_read_b64_tr_b16 v[150:151], v3 offset:8960
    ds_read_b64_tr_b16 v[100:101], v3 offset:96
    ds_read_b64_tr_b16 v[102:103], v3 offset:8544
    ds_read_b64_tr_b16 v[160:161], v3 offset:544
    ds_read_b64_tr_b16 v[162:163], v3 offset:8992
    ds_read_b64_tr_b16 v[128:129], v3 offset:128
    ds_read_b64_tr_b16 v[130:131], v3 offset:8576
    ds_read_b64_tr_b16 v[164:165], v3 offset:576
    ds_read_b64_tr_b16 v[166:167], v3 offset:9024
    ds_read_b64_tr_b16 v[132:133], v3 offset:160
    ds_read_b64_tr_b16 v[134:135], v3 offset:8608
    ds_read_b64_tr_b16 v[168:169], v3 offset:608
    ds_read_b64_tr_b16 v[170:171], v3 offset:9056
    ds_read_b64_tr_b16 v[136:137], v3 offset:192
    ds_read_b64_tr_b16 v[138:139], v3 offset:8640
    ds_read_b64_tr_b16 v[172:173], v3 offset:640
    ds_read_b64_tr_b16 v[174:175], v3 offset:9088
    s_waitcnt lgkmcnt(0)
    s_barrier
    s_add_u32 s77, s74, 1146880
    s_add_u32 m0, s72, 0
    s_nop 0
    buffer_load_dwordx4 v15, s[40:43], s77 offen lds
    buffer_load_dwordx4 v16, s[40:43], s77 offen offset:1056 lds
    buffer_load_dwordx4 v17, s[40:43], s77 offen offset:2112 lds
    buffer_load_dwordx4 v18, s[40:43], s77 offen offset:3168 lds
    s_add_u32 s78, s74, 1175552
    s_add_u32 m0, s72, 4224
    s_nop 0
    buffer_load_dwordx4 v15, s[40:43], s78 offen lds
    buffer_load_dwordx4 v16, s[40:43], s78 offen offset:1056 lds
    buffer_load_dwordx4 v17, s[40:43], s78 offen offset:2112 lds
    buffer_load_dwordx4 v18, s[40:43], s78 offen offset:3168 lds
    s_add_u32 m0, s6, 0
    s_nop 0
    buffer_load_dwordx4 v27, s[28:31], s5 offen sc1 lds
    s_add_u32 m0, s6, 3072
    s_nop 0
    buffer_load_dwordx4 v27, s[28:31], s5 offen offset:1024 sc1 lds
    s_add_u32 m0, s6, 6144
    s_nop 0
    buffer_load_dwordx4 v27, s[28:31], s5 offen offset:2048 sc1 lds
    s_add_u32 m0, s6, 9216
    s_nop 0
    buffer_load_dwordx4 v27, s[28:31], s5 offen offset:3072 sc1 lds
    s_add_u32 s77, s74, 1376256
    s_add_u32 m0, s72, 67584
    s_nop 0
    buffer_load_dwordx4 v15, s[40:43], s77 offen lds
    buffer_load_dwordx4 v16, s[40:43], s77 offen offset:1056 lds
    buffer_load_dwordx4 v17, s[40:43], s77 offen offset:2112 lds
    buffer_load_dwordx4 v18, s[40:43], s77 offen offset:3168 lds
    s_add_u32 s78, s74, 1404928
    s_add_u32 m0, s72, 71808
    s_nop 0
    buffer_load_dwordx4 v15, s[40:43], s78 offen lds
    buffer_load_dwordx4 v16, s[40:43], s78 offen offset:1056 lds
    buffer_load_dwordx4 v17, s[40:43], s78 offen offset:2112 lds
    buffer_load_dwordx4 v18, s[40:43], s78 offen offset:3168 lds
    s_waitcnt vmcnt(8)
    ds_read_b128 v[32:35], v7 offset:0
    ds_read_b128 v[36:39], v7 offset:4096
    ds_read_b128 v[40:43], v7 offset:8192
    ds_read_b128 v[44:47], v7 offset:12288
    s_waitcnt lgkmcnt(0)
    v_max3_u32 v32, v32, v33, v34
    v_max3_u32 v32, v32, v35, v36
    v_max3_u32 v32, v32, v37, v38
    v_max3_u32 v32, v32, v39, v40
    v_max3_u32 v32, v32, v41, v42
    v_max3_u32 v32, v32, v43, v44
    v_max3_u32 v32, v32, v45, v46
    v_max_u32 v32, v32, v47
    v_cmp_eq_u32 vcc, -1, v32
    s_cbranch_vccnz L_hc_c0_retry
L_hc_c0_done:
    s_barrier
    s_add_u32 s5, s5, 4096
    ds_read_b128 a[64:67], v6 offset:0
    ds_read_b128 a[68:71], v6 offset:1024
    s_waitcnt lgkmcnt(1)
    v_mfma_f32_16x16x32_bf16 v[192:195], a[0:3], a[64:67], 0
    s_waitcnt lgkmcnt(0)
    ds_read_b128 a[72:75], v6 offset:4096
    v_mfma_f32_16x16x32_bf16 v[196:199], a[0:3], a[68:71], 0
    s_add_u32 m0, s6, 16384
    ds_read_b128 a[76:79], v6 offset:5120
    v_mfma_f32_16x16x32_bf16 v[200:203], a[4:7], a[64:67], 0
    buffer_load_dwordx4 v27, s[28:31], s5 offen sc1 lds
    v_mfma_f32_16x16x32_bf16 v[204:207], a[4:7], a[68:71], 0
    s_add_u32 m0, s6, 19456
    ds_read_b128 a[80:83], v6 offset:8192
    v_mfma_f32_16x16x32_bf16 v[208:211], a[8:11], a[64:67], 0
    ds_read_b128 a[84:87], v6 offset:9216
    v_mfma_f32_16x16x32_bf16 v[212:215], a[8:11], a[68:71], 0
    buffer_load_dwordx4 v27, s[28:31], s5 offen offset:1024 sc1 lds
    v_mfma_f32_16x16x32_bf16 v[216:219], a[12:15], a[64:67], 0
    s_add_u32 m0, s6, 22528
    ds_read_b128 a[88:91], v6 offset:12288
    ds_read_b128 a[92:95], v6 offset:13312
    v_mfma_f32_16x16x32_bf16 v[220:223], a[12:15], a[68:71], 0
    buffer_load_dwordx4 v27, s[28:31], s5 offen offset:2048 sc1 lds
    v_mfma_f32_16x16x32_bf16 v[224:227], a[16:19], a[64:67], 0
    s_add_u32 m0, s6, 25600
    ds_read_b64_tr_b16 a[0:1], v2 offset:33792
    v_mfma_f32_16x16x32_bf16 v[228:231], a[16:19], a[68:71], 0
    ds_read_b64_tr_b16 a[2:3], v2 offset:42240
    v_mfma_f32_16x16x32_bf16 v[232:235], a[20:23], a[64:67], 0
    buffer_load_dwordx4 v27, s[28:31], s5 offen offset:3072 sc1 lds
    v_mfma_f32_16x16x32_bf16 v[236:239], a[20:23], a[68:71], 0
    s_add_u32 s5, s5, 12288
    ds_read_b64_tr_b16 a[4:5], v2 offset:33824
    v_mfma_f32_16x16x32_bf16 v[240:243], a[24:27], a[64:67], 0
    s_add_u32 m0, s6, 32768
    ds_read_b64_tr_b16 a[6:7], v2 offset:42272
    v_mfma_f32_16x16x32_bf16 v[244:247], a[24:27], a[68:71], 0
    s_waitcnt lgkmcnt(6)
    ds_read_b64_tr_b16 a[8:9], v2 offset:33856
    v_mfma_f32_16x16x32_bf16 v[192:195], a[28:31], a[72:75], v[192:195]
    buffer_load_dwordx4 v27, s[28:31], s5 offen sc1 lds
    v_mfma_f32_16x16x32_bf16 v[196:199], a[28:31], a[76:79], v[196:199]
    s_add_u32 m0, s6, 35840
    ds_read_b64_tr_b16 a[10:11], v2 offset:42304
    v_mfma_f32_16x16x32_bf16 v[200:203], a[32:35], a[72:75], v[200:203]
    ds_read_b64_tr_b16 a[12:13], v2 offset:33888
    v_mfma_f32_16x16x32_bf16 v[204:207], a[32:35], a[76:79], v[204:207]
    buffer_load_dwordx4 v27, s[28:31], s5 offen offset:1024 sc1 lds
    v_mfma_f32_16x16x32_bf16 v[208:211], a[36:39], a[72:75], v[208:211]
    s_add_u32 m0, s6, 38912
    ds_read_b64_tr_b16 a[14:15], v2 offset:42336
    ds_read_b64_tr_b16 a[16:17], v2 offset:33920
    v_mfma_f32_16x16x32_bf16 v[212:215], a[36:39], a[76:79], v[212:215]
    ds_read_b64_tr_b16 a[18:19], v2 offset:42368
    v_mfma_f32_16x16x32_bf16 v[216:219], a[40:43], a[72:75], v[216:219]
    buffer_load_dwordx4 v27, s[28:31], s5 offen offset:2048 sc1 lds
    v_mfma_f32_16x16x32_bf16 v[220:223], a[40:43], a[76:79], v[220:223]
    s_add_u32 m0, s6, 41984
    ds_read_b64_tr_b16 a[20:21], v2 offset:33952
    ds_read_b64_tr_b16 a[22:23], v2 offset:42400
    v_mfma_f32_16x16x32_bf16 v[224:227], a[44:47], a[72:75], v[224:227]
    buffer_load_dwordx4 v27, s[28:31], s5 offen offset:3072 sc1 lds
    v_mfma_f32_16x16x32_bf16 v[228:231], a[44:47], a[76:79], v[228:231]
    s_add_u32 s5, s5, 4096
    ds_read_b64_tr_b16 a[24:25], v2 offset:33984
    v_mfma_f32_16x16x32_bf16 v[232:235], a[48:51], a[72:75], v[232:235]
    s_add_u32 m0, s6, 49152
    ds_read_b64_tr_b16 a[26:27], v2 offset:42432
    v_mfma_f32_16x16x32_bf16 v[236:239], a[48:51], a[76:79], v[236:239]
    ds_read_b64_tr_b16 a[28:29], v2 offset:34240
    v_mfma_f32_16x16x32_bf16 v[240:243], a[52:55], a[72:75], v[240:243]
    buffer_load_dwordx4 v27, s[28:31], s5 offen sc1 lds
    v_mfma_f32_16x16x32_bf16 v[244:247], a[52:55], a[76:79], v[244:247]
    s_add_u32 m0, s6, 52224
    ds_read_b64_tr_b16 a[30:31], v2 offset:42688
    ds_read_b64_tr_b16 a[32:33], v2 offset:34272
    v_mfma_f32_16x16x32_bf16 v[192:195], a[56:59], a[80:83], v[192:195]
    s_waitcnt lgkmcnt(7)
    buffer_load_dwordx4 v27, s[28:31], s5 offen offset:1024 sc1 lds
    v_mfma_f32_16x16x32_bf16 v[192:195], a[196:199], a[88:91], v[192:195]
    ds_read_b64_tr_b16 a[34:35], v2 offset:42720
    v_mfma_f32_16x16x32_bf16 v[196:199], a[196:199], a[92:95], v[196:199]
    s_waitcnt vmcnt(5)
    ds_read_b128 v[32:35], v7 offset:16384
    v_mfma_f32_16x16x32_bf16 v[196:199], a[56:59], a[84:87], v[196:199]
    ds_read_b128 v[36:39], v7 offset:20480
    ds_read_b64_tr_b16 a[36:37], v2 offset:34304
    v_mfma_f32_16x16x32_bf16 v[200:203], a[60:63], a[80:83], v[200:203]
    ds_read_b128 v[40:43], v7 offset:24576
    ds_read_b64_tr_b16 a[38:39], v2 offset:42752
    v_mfma_f32_16x16x32_bf16 v[200:203], a[200:203], a[88:91], v[200:203]
    ds_read_b128 v[44:47], v7 offset:28672
    ds_read_b64_tr_b16 a[40:41], v2 offset:34336
    v_mfma_f32_16x16x32_bf16 v[204:207], a[200:203], a[92:95], v[204:207]
    ds_read_b128 v[48:51], v7 offset:32768
    ds_read_b64_tr_b16 a[42:43], v2 offset:42784
    v_mfma_f32_16x16x32_bf16 v[204:207], a[60:63], a[84:87], v[204:207]
    ds_read_b64_tr_b16 a[44:45], v2 offset:34368
    v_mfma_f32_16x16x32_bf16 v[208:211], a[176:179], a[80:83], v[208:211]
    ds_read_b64_tr_b16 a[46:47], v2 offset:42816
    v_mfma_f32_16x16x32_bf16 v[208:211], a[204:207], a[88:91], v[208:211]
    ds_read_b64_tr_b16 a[48:49], v2 offset:34400
    s_waitcnt lgkmcnt(4)
    v_max3_u32 v32, v32, v33, v34
    v_mfma_f32_16x16x32_bf16 v[212:215], a[204:207], a[92:95], v[212:215]
    ds_read_b64_tr_b16 a[50:51], v2 offset:42848
    v_max3_u32 v32, v32, v35, v36
    v_mfma_f32_16x16x32_bf16 v[212:215], a[176:179], a[84:87], v[212:215]
    ds_read_b64_tr_b16 a[52:53], v2 offset:34432
    v_max3_u32 v32, v32, v37, v38
    v_max3_u32 v32, v32, v39, v40
    v_mfma_f32_16x16x32_bf16 v[216:219], a[180:183], a[80:83], v[216:219]
    ds_read_b64_tr_b16 a[54:55], v2 offset:42880
    v_max3_u32 v32, v32, v41, v42
    v_max3_u32 v32, v32, v43, v44
    v_mfma_f32_16x16x32_bf16 v[216:219], a[208:211], a[88:91], v[216:219]
    v_max3_u32 v32, v32, v45, v46
    v_max3_u32 v32, v32, v47, v48
    v_max3_u32 v32, v32, v49, v50
    v_max_u32 v32, v32, v51
    v_mfma_f32_16x16x32_bf16 v[220:223], a[208:211], a[92:95], v[220:223]
    v_cmp_eq_u32 vcc, -1, v32
    s_cbranch_vccnz L_hc_c1_retry
L_hc_c1_done:
    v_mfma_f32_16x16x32_bf16 v[220:223], a[180:183], a[84:87], v[220:223]
    s_waitcnt lgkmcnt(0)
    s_barrier
    ds_read_b128 a[96:99], v6 offset:16384
    v_mfma_f32_16x16x32_bf16 v[224:227], a[184:187], a[80:83], v[224:227]
    s_add_u32 s77, s75, 0
    ds_read_b128 a[100:103], v6 offset:17408
    v_mfma_f32_16x16x32_bf16 v[224:227], a[212:215], a[88:91], v[224:227]
    s_add_u32 m0, s72, 33792
    ds_read_b128 a[104:107], v6 offset:20480
    v_mfma_f32_16x16x32_bf16 v[228:231], a[212:215], a[92:95], v[228:231]
    ds_read_b128 a[108:111], v6 offset:21504
    v_mfma_f32_16x16x32_bf16 v[228:231], a[184:187], a[84:87], v[228:231]
    buffer_load_dwordx4 v19, s[52:55], s77 offen lds
    v_mfma_f32_16x16x32_bf16 v[232:235], a[188:191], a[80:83], v[232:235]
    ds_read_b128 a[112:115], v6 offset:24576
    v_mfma_f32_16x16x32_bf16 v[232:235], a[216:219], a[88:91], v[232:235]
    ds_read_b128 a[116:119], v6 offset:25600
    v_mfma_f32_16x16x32_bf16 v[236:239], a[216:219], a[92:95], v[236:239]
    ds_read_b128 a[120:123], v6 offset:28672
    v_mfma_f32_16x16x32_bf16 v[236:239], a[188:191], a[84:87], v[236:239]
    buffer_load_dwordx4 v20, s[52:55], s77 offen offset:1032 lds
    v_mfma_f32_16x16x32_bf16 v[240:243], a[192:195], a[80:83], v[240:243]
    ds_read_b128 a[124:127], v6 offset:29696
    v_mfma_f32_16x16x32_bf16 v[240:243], a[220:223], a[88:91], v[240:243]
    ds_read_b128 a[128:131], v6 offset:32768
    v_mfma_f32_16x16x32_bf16 v[244:247], a[220:223], a[92:95], v[244:247]
    ds_read_b128 a[132:135], v6 offset:33792
    v_mfma_f32_16x16x32_bf16 v[244:247], a[192:195], a[84:87], v[244:247]
    s_waitcnt lgkmcnt(6)
    buffer_load_dwordx4 v21, s[52:55], s77 offen offset:2112 lds
    v_mfma_f32_16x16x32_bf16 v[192:195], a[224:227], a[96:99], v[192:195]
    v_mfma_f32_16x16x32_bf16 v[192:195], a[252:255], a[104:107], v[192:195]
    ds_read_b64_tr_b16 a[56:57], v2 offset:0
    v_mfma_f32_16x16x32_bf16 v[196:199], a[252:255], a[108:111], v[196:199]
    ds_read_b64_tr_b16 a[58:59], v2 offset:8448
    v_mfma_f32_16x16x32_bf16 v[196:199], a[224:227], a[100:103], v[196:199]
    buffer_load_dwordx4 v22, s[52:55], s77 offen offset:3144 lds
    v_mfma_f32_16x16x32_bf16 v[200:203], a[228:231], a[96:99], v[200:203]
    s_add_u32 s78, s75, 3584
    ds_read_b64_tr_b16 a[196:197], v2 offset:448
    v_mfma_f32_16x16x32_bf16 v[200:203], v[64:67], a[104:107], v[200:203]
    s_waitcnt lgkmcnt(3)
    s_barrier
    ds_read_b64_tr_b16 a[198:199], v2 offset:8896
    v_mfma_f32_16x16x32_bf16 v[204:207], v[64:67], a[108:111], v[204:207]
    s_add_u32 m0, s72, 38016
    ds_read_b64_tr_b16 a[60:61], v2 offset:32
    v_mfma_f32_16x16x32_bf16 v[204:207], a[228:231], a[100:103], v[204:207]
    ds_read_b64_tr_b16 a[62:63], v2 offset:8480
    v_mfma_f32_16x16x32_bf16 v[208:211], a[232:235], a[96:99], v[208:211]
    buffer_load_dwordx4 v19, s[52:55], s78 offen lds
    v_mfma_f32_16x16x32_bf16 v[208:211], v[68:71], a[104:107], v[208:211]
    ds_read_b64_tr_b16 a[200:201], v2 offset:480
    ds_read_b64_tr_b16 a[202:203], v2 offset:8928
    v_mfma_f32_16x16x32_bf16 v[212:215], v[68:71], a[108:111], v[212:215]
    ds_read_b64_tr_b16 a[176:177], v2 offset:64
    v_mfma_f32_16x16x32_bf16 v[212:215], a[232:235], a[100:103], v[212:215]
    ds_read_b64_tr_b16 a[178:179], v2 offset:8512
    v_mfma_f32_16x16x32_bf16 v[216:219], a[236:239], a[96:99], v[216:219]
    buffer_load_dwordx4 v20, s[52:55], s78 offen offset:1032 lds
    v_mfma_f32_16x16x32_bf16 v[216:219], v[72:75], a[104:107], v[216:219]
    ds_read_b64_tr_b16 a[204:205], v2 offset:512
    ds_read_b64_tr_b16 a[206:207], v2 offset:8960
    v_mfma_f32_16x16x32_bf16 v[220:223], v[72:75], a[108:111], v[220:223]
    ds_read_b64_tr_b16 a[180:181], v2 offset:96
    v_mfma_f32_16x16x32_bf16 v[220:223], a[236:239], a[100:103], v[220:223]
    ds_read_b64_tr_b16 a[182:183], v2 offset:8544
    v_mfma_f32_16x16x32_bf16 v[224:227], a[240:243], a[96:99], v[224:227]
    buffer_load_dwordx4 v21, s[52:55], s78 offen offset:2112 lds
    v_mfma_f32_16x16x32_bf16 v[224:227], v[76:79], a[104:107], v[224:227]
    ds_read_b64_tr_b16 a[208:209], v2 offset:544
    ds_read_b64_tr_b16 a[210:211], v2 offset:8992
    v_mfma_f32_16x16x32_bf16 v[228:231], v[76:79], a[108:111], v[228:231]
    ds_read_b64_tr_b16 a[184:185], v2 offset:128
    v_mfma_f32_16x16x32_bf16 v[228:231], a[240:243], a[100:103], v[228:231]
    ds_read_b64_tr_b16 a[186:187], v2 offset:8576
    v_mfma_f32_16x16x32_bf16 v[232:235], a[244:247], a[96:99], v[232:235]
    buffer_load_dwordx4 v22, s[52:55], s78 offen offset:3144 lds
    v_mfma_f32_16x16x32_bf16 v[232:235], v[80:83], a[104:107], v[232:235]
    s_add_u32 s77, s75, 128
    ds_read_b64_tr_b16 a[212:213], v2 offset:576
    ds_read_b64_tr_b16 a[214:215], v2 offset:9024
    v_mfma_f32_16x16x32_bf16 v[236:239], v[80:83], a[108:111], v[236:239]
    s_add_u32 m0, s72, 101376
    ds_read_b64_tr_b16 a[188:189], v2 offset:160
    v_mfma_f32_16x16x32_bf16 v[236:239], a[244:247], a[100:103], v[236:239]
    ds_read_b64_tr_b16 a[190:191], v2 offset:8608
    v_mfma_f32_16x16x32_bf16 v[240:243], a[248:251], a[96:99], v[240:243]
    ds_read_b64_tr_b16 a[216:217], v2 offset:608
    v_mfma_f32_16x16x32_bf16 v[240:243], v[84:87], a[104:107], v[240:243]
    buffer_load_dwordx4 v19, s[52:55], s77 offen lds
    v_mfma_f32_16x16x32_bf16 v[244:247], v[84:87], a[108:111], v[244:247]
    ds_read_b64_tr_b16 a[218:219], v2 offset:9056
    ds_read_b64_tr_b16 a[192:193], v2 offset:192
    v_mfma_f32_16x16x32_bf16 v[244:247], a[248:251], a[100:103], v[244:247]
    ds_read_b64_tr_b16 a[194:195], v2 offset:8640
    v_mfma_f32_16x16x32_bf16 v[192:195], v[88:91], a[112:115], v[192:195]
    ds_read_b64_tr_b16 a[220:221], v2 offset:640
    ds_read_b64_tr_b16 a[222:223], v2 offset:9088
    v_mfma_f32_16x16x32_bf16 v[192:195], v[140:143], a[120:123], v[192:195]
    buffer_load_dwordx4 v20, s[52:55], s77 offen offset:1032 lds
    v_mfma_f32_16x16x32_bf16 v[196:199], v[140:143], a[124:127], v[196:199]
    s_waitcnt lgkmcnt(0)
    s_barrier
    ds_read_b64_tr_b16 a[224:225], v3 offset:0
    v_mfma_f32_16x16x32_bf16 v[196:199], v[88:91], a[116:119], v[196:199]
    ds_read_b64_tr_b16 a[226:227], v3 offset:8448
    v_mfma_f32_16x16x32_bf16 v[200:203], v[92:95], a[112:115], v[200:203]
    ds_read_b64_tr_b16 a[252:253], v3 offset:448
    v_mfma_f32_16x16x32_bf16 v[200:203], v[144:147], a[120:123], v[200:203]
    buffer_load_dwordx4 v21, s[52:55], s77 offen offset:2112 lds
    v_mfma_f32_16x16x32_bf16 v[204:207], v[144:147], a[124:127], v[204:207]
    ds_read_b64_tr_b16 a[254:255], v3 offset:8896
    ds_read_b64_tr_b16 a[228:229], v3 offset:32
    v_mfma_f32_16x16x32_bf16 v[204:207], v[92:95], a[116:119], v[204:207]
    ds_read_b64_tr_b16 a[230:231], v3 offset:8480
    ds_read_b64_tr_b16 v[64:65], v3 offset:480
    v_mfma_f32_16x16x32_bf16 v[208:211], v[96:99], a[112:115], v[208:211]
    ds_read_b64_tr_b16 v[66:67], v3 offset:8928
    v_mfma_f32_16x16x32_bf16 v[208:211], v[148:151], a[120:123], v[208:211]
    buffer_load_dwordx4 v22, s[52:55], s77 offen offset:3144 lds
    v_mfma_f32_16x16x32_bf16 v[212:215], v[148:151], a[124:127], v[212:215]
    s_add_u32 s78, s75, 3712
    ds_read_b64_tr_b16 a[232:233], v3 offset:64
    ds_read_b64_tr_b16 a[234:235], v3 offset:8512
    v_mfma_f32_16x16x32_bf16 v[212:215], v[96:99], a[116:119], v[212:215]
    s_add_u32 m0, s72, 105600
    ds_read_b64_tr_b16 v[68:69], v3 offset:512
    ds_read_b64_tr_b16 v[70:71], v3 offset:8960
    v_mfma_f32_16x16x32_bf16 v[216:219], v[100:103], a[112:115], v[216:219]
    ds_read_b64_tr_b16 a[236:237], v3 offset:96
    v_mfma_f32_16x16x32_bf16 v[216:219], v[160:163], a[120:123], v[216:219]
    buffer_load_dwordx4 v19, s[52:55], s78 offen lds
    v_mfma_f32_16x16x32_bf16 v[220:223], v[160:163], a[124:127], v[220:223]
    ds_read_b64_tr_b16 a[238:239], v3 offset:8544
    ds_read_b64_tr_b16 v[72:73], v3 offset:544
    v_mfma_f32_16x16x32_bf16 v[220:223], v[100:103], a[116:119], v[220:223]
    ds_read_b64_tr_b16 v[74:75], v3 offset:8992
    ds_read_b64_tr_b16 a[240:241], v3 offset:128
    v_mfma_f32_16x16x32_bf16 v[224:227], v[128:131], a[112:115], v[224:227]
    s_waitcnt vmcnt(13)
    ds_read_b128 v[32:35], v7 offset:36864
    v_mfma_f32_16x16x32_bf16 v[224:227], v[164:167], a[120:123], v[224:227]
    ds_read_b128 v[36:39], v7 offset:40960
    ds_read_b64_tr_b16 a[242:243], v3 offset:8576
    v_mfma_f32_16x16x32_bf16 v[228:231], v[164:167], a[124:127], v[228:231]
    ds_read_b128 v[40:43], v7 offset:45056
    ds_read_b64_tr_b16 v[76:77], v3 offset:576
    v_mfma_f32_16x16x32_bf16 v[228:231], v[128:131], a[116:119], v[228:231]
    ds_read_b128 v[44:47], v7 offset:49152
    ds_read_b64_tr_b16 v[78:79], v3 offset:9024
    v_mfma_f32_16x16x32_bf16 v[232:235], v[132:135], a[112:115], v[232:235]
    ds_read_b128 v[48:51], v7 offset:53248
    ds_read_b64_tr_b16 a[244:245], v3 offset:160
    v_mfma_f32_16x16x32_bf16 v[232:235], v[168:171], a[120:123], v[232:235]
    buffer_load_dwordx4 v20, s[52:55], s78 offen offset:1032 lds
    v_mfma_f32_16x16x32_bf16 v[236:239], v[168:171], a[124:127], v[236:239]
    ds_read_b64_tr_b16 a[246:247], v3 offset:8608
    ds_read_b64_tr_b16 v[80:81], v3 offset:608
    v_mfma_f32_16x16x32_bf16 v[236:239], v[132:135], a[116:119], v[236:239]
    buffer_load_dwordx4 v21, s[52:55], s78 offen offset:2112 lds
    v_mfma_f32_16x16x32_bf16 v[240:243], v[136:139], a[112:115], v[240:243]
    buffer_load_dwordx4 v22, s[52:55], s78 offen offset:3144 lds
    s_waitcnt lgkmcnt(3)
    v_max3_u32 v32, v32, v33, v34
    v_mfma_f32_16x16x32_bf16 v[240:243], v[172:175], a[120:123], v[240:243]
    s_add_u32 s77, s75, 256
    ds_read_b64_tr_b16 v[82:83], v3 offset:9056
    ds_read_b64_tr_b16 a[248:249], v3 offset:192
    v_max3_u32 v32, v32, v35, v36
    v_max3_u32 v32, v32, v37, v38
    v_mfma_f32_16x16x32_bf16 v[244:247], v[172:175], a[124:127], v[244:247]
    s_add_u32 m0, s72, 0
    ds_read_b64_tr_b16 a[250:251], v3 offset:8640
    ds_read_b64_tr_b16 v[84:85], v3 offset:640
    ds_read_b64_tr_b16 v[86:87], v3 offset:9088
    v_max3_u32 v32, v32, v39, v40
    v_max3_u32 v32, v32, v41, v42
    v_mfma_f32_16x16x32_bf16 v[244:247], v[136:139], a[116:119], v[244:247]
    v_max3_u32 v32, v32, v43, v44
    v_max3_u32 v32, v32, v45, v46
    v_max3_u32 v32, v32, v47, v48
    v_max3_u32 v32, v32, v49, v50
    v_max_u32 v32, v32, v51
    v_mfma_f32_16x16x32_bf16 v[192:195], a[0:3], a[128:131], v[192:195]
    v_cmp_eq_u32 vcc, -1, v32
    s_cbranch_vccnz L_hc_c2_retry
L_hc_c2_done:
    v_mfma_f32_16x16x32_bf16 v[196:199], a[0:3], a[132:135], v[196:199]
    s_waitcnt vmcnt(8) lgkmcnt(0)
    s_barrier
    ds_read_b128 a[136:139], v6 offset:36864
    v_mfma_f32_16x16x32_bf16 v[200:203], a[4:7], a[128:131], v[200:203]
    buffer_load_dwordx4 v19, s[52:55], s77 offen lds
    v_mfma_f32_16x16x32_bf16 v[204:207], a[4:7], a[132:135], v[204:207]
    ds_read_b128 a[140:143], v6 offset:37888
    v_mfma_f32_16x16x32_bf16 v[208:211], a[8:11], a[128:131], v[208:211]
    buffer_load_dwordx4 v20, s[52:55], s77 offen offset:1032 lds
    v_mfma_f32_16x16x32_bf16 v[212:215], a[8:11], a[132:135], v[212:215]
    ds_read_b128 a[144:147], v6 offset:40960
    v_mfma_f32_16x16x32_bf16 v[216:219], a[12:15], a[128:131], v[216:219]
    ds_read_b128 a[148:151], v6 offset:41984
    v_mfma_f32_16x16x32_bf16 v[220:223], a[12:15], a[132:135], v[220:223]
    ds_read_b128 a[152:155], v6 offset:45056
    v_mfma_f32_16x16x32_bf16 v[224:227], a[16:19], a[128:131], v[224:227]
    buffer_load_dwordx4 v21, s[52:55], s77 offen offset:2112 lds
    v_mfma_f32_16x16x32_bf16 v[228:231], a[16:19], a[132:135], v[228:231]
    ds_read_b128 a[156:159], v6 offset:46080
    v_mfma_f32_16x16x32_bf16 v[232:235], a[20:23], a[128:131], v[232:235]
    ds_read_b64_tr_b16 a[64:65], v8 offset:33792
    ds_read_b64_tr_b16 a[66:67], v8 offset:34048
    v_mfma_f32_16x16x32_bf16 v[236:239], a[20:23], a[132:135], v[236:239]
L_hop1_1:
    s_cbranch_execz L_hopback1
    ds_read_b128 a[160:163], v6 offset:49152
    ds_read_b64_tr_b16 a[68:69], v8 offset:33800
    v_mfma_f32_16x16x32_bf16 v[240:243], a[24:27], a[128:131], v[240:243]
    ds_read_b128 a[164:167], v6 offset:50176
    ds_read_b64_tr_b16 a[70:71], v8 offset:34056
    v_mfma_f32_16x16x32_bf16 v[244:247], a[24:27], a[132:135], v[244:247]
    s_waitcnt lgkmcnt(9)
    buffer_load_dwordx4 v22, s[52:55], s77 offen offset:3144 lds
    v_mfma_f32_16x16x32_bf16 v[192:195], a[28:31], a[136:139], v[192:195]
    s_add_u32 s78, s75, 3840
    ds_read_b64_tr_b16 a[72:73], v8 offset:34304
    ds_read_b128 a[168:171], v6 offset:53248
    v_mfma_f32_16x16x32_bf16 v[196:199], a[28:31], a[140:143], v[196:199]
    s_add_u32 m0, s72, 4224
    ds_read_b64_tr_b16 a[74:75], v8 offset:34560
    ds_read_b128 a[172:175], v6 offset:54272
    v_mfma_f32_16x16x32_bf16 v[200:203], a[32:35], a[136:139], v[200:203]
    ds_read_b64_tr_b16 a[76:77], v8 offset:42240
    ds_read_b64_tr_b16 a[78:79], v8 offset:42496
    v_mfma_f32_16x16x32_bf16 v[204:207], a[32:35], a[140:143], v[204:207]
    buffer_load_dwordx4 v19, s[52:55], s78 offen lds
    v_mfma_f32_16x16x32_bf16 v[208:211], a[36:39], a[136:139], v[208:211]
    ds_read_b64_tr_b16 a[80:81], v8 offset:34312
    ds_read_b64_tr_b16 a[82:83], v8 offset:34568
    v_mfma_f32_16x16x32_bf16 v[212:215], a[36:39], a[140:143], v[212:215]
    ds_read_b64_tr_b16 a[84:85], v8 offset:42248
    ds_read_b64_tr_b16 a[86:87], v8 offset:42504
    v_mfma_f32_16x16x32_bf16 v[216:219], a[40:43], a[136:139], v[216:219]
    ds_read_b64_tr_b16 a[88:89], v8 offset:42752
    v_mfma_f32_16x16x32_bf16 v[220:223], a[40:43], a[140:143], v[220:223]
    buffer_load_dwordx4 v20, s[52:55], s78 offen offset:1032 lds
    v_mfma_f32_16x16x32_bf16 v[224:227], a[44:47], a[136:139], v[224:227]
    ds_read_b64_tr_b16 a[90:91], v8 offset:43008
    ds_read_b64_tr_b16 a[92:93], v8 offset:50688
    v_mfma_f32_16x16x32_bf16 v[228:231], a[44:47], a[140:143], v[228:231]
    ds_read_b64_tr_b16 a[94:95], v8 offset:50944
    v_mfma_f32_16x16x32_bf16 v[232:235], a[48:51], a[136:139], v[232:235]
    ds_read_b64_tr_b16 a[96:97], v8 offset:42760
    v_mfma_f32_16x16x32_bf16 v[236:239], a[48:51], a[140:143], v[236:239]
    buffer_load_dwordx4 v21, s[52:55], s78 offen offset:2112 lds
    v_mfma_f32_16x16x32_bf16 v[240:243], a[52:55], a[136:139], v[240:243]
    ds_read_b64_tr_b16 a[98:99], v8 offset:43016
    ds_read_b64_tr_b16 a[100:101], v8 offset:50696
    v_mfma_f32_16x16x32_bf16 v[244:247], a[52:55], a[140:143], v[244:247]
    ds_read_b64_tr_b16 a[102:103], v8 offset:50952
    ds_read_b64_tr_b16 a[104:105], v8 offset:51200
    v_mfma_f32_16x16x32_bf16 v[192:195], a[56:59], a[144:147], v[192:195]
    s_waitcnt lgkmcnt(8)
    buffer_load_dwordx4 v22, s[52:55], s78 offen offset:3144 lds
    v_mfma_f32_16x16x32_bf16 v[192:195], a[196:199], a[152:155], v[192:195]
    s_add_u32 s77, s75, 384
    ds_read_b64_tr_b16 a[106:107], v8 offset:51456
    ds_read_b64_tr_b16 a[108:109], v8 offset:59136
    v_mfma_f32_16x16x32_bf16 v[192:195], a[224:227], a[160:163], v[192:195]
    s_add_u32 m0, s72, 67584
    ds_read_b64_tr_b16 a[110:111], v8 offset:59392
    v_mfma_f32_16x16x32_bf16 v[192:195], a[252:255], a[168:171], v[192:195]
    ds_read_b64_tr_b16 a[112:113], v8 offset:51208
    v_mfma_f32_16x16x32_bf16 v[196:199], a[252:255], a[172:175], v[196:199]
    ds_read_b64_tr_b16 a[114:115], v8 offset:51464
    v_mfma_f32_16x16x32_bf16 v[196:199], a[224:227], a[164:167], v[196:199]
    buffer_load_dwordx4 v19, s[52:55], s77 offen lds
    v_mfma_f32_16x16x32_bf16 v[196:199], a[196:199], a[156:159], v[196:199]
    s_waitcnt vmcnt(9)
    s_barrier
    ds_read_b64_tr_b16 a[116:117], v8 offset:59144
    v_mfma_f32_16x16x32_bf16 v[196:199], a[56:59], a[148:151], v[196:199]
    ds_read_b64_tr_b16 a[118:119], v8 offset:59400
    ds_read_b64_tr_b16 a[120:121], v9 offset:33792
    v_mfma_f32_16x16x32_bf16 v[200:203], a[60:63], a[144:147], v[200:203]
    ds_read_b64_tr_b16 a[122:123], v9 offset:34048
    ds_read_b64_tr_b16 a[124:125], v9 offset:34304
    v_mfma_f32_16x16x32_bf16 v[200:203], a[200:203], a[152:155], v[200:203]
    buffer_load_dwordx4 v20, s[52:55], s77 offen offset:1032 lds
    v_mfma_f32_16x16x32_bf16 v[200:203], a[228:231], a[160:163], v[200:203]
    ds_read_b64_tr_b16 a[126:127], v9 offset:34560
    ds_read_b64_tr_b16 a[128:129], v9 offset:42240
    v_mfma_f32_16x16x32_bf16 v[200:203], v[64:67], a[168:171], v[200:203]
    ds_read_b64_tr_b16 a[130:131], v9 offset:42496
    v_cvt_pk_bf16_f32 v32, v192, v193
    v_cvt_pk_bf16_f32 v33, v194, v195
    v_pk_max_i16 v32, v32, 0
    v_mfma_f32_16x16x32_bf16 v[204:207], v[64:67], a[172:175], v[204:207]
    ds_read_b64_tr_b16 a[132:133], v9 offset:42752
    v_pk_max_i16 v33, v33, 0
    v_mfma_f32_16x16x32_bf16 v[204:207], a[228:231], a[164:167], v[204:207]
    ds_write_b64 v4, v[32:33] offset:0
    v_mfma_f32_16x16x32_bf16 v[204:207], a[200:203], a[156:159], v[204:207]
    buffer_load_dwordx4 v21, s[52:55], s77 offen offset:2112 lds
    v_cvt_pk_bf16_f32 v34, v196, v197
    v_cvt_pk_bf16_f32 v35, v198, v199
    v_mfma_f32_16x16x32_bf16 v[204:207], a[60:63], a[148:151], v[204:207]
    ds_read_b64_tr_b16 a[134:135], v9 offset:43008
    ds_read_b64_tr_b16 a[136:137], v9 offset:50688
    v_pk_max_i16 v34, v34, 0
    v_pk_max_i16 v35, v35, 0
    v_mfma_f32_16x16x32_bf16 v[208:211], a[176:179], a[144:147], v[208:211]
    ds_write_b64 v4, v[34:35] offset:1024
    v_mfma_f32_16x16x32_bf16 v[208:211], a[204:207], a[152:155], v[208:211]
    ds_read_b64_tr_b16 a[138:139], v9 offset:50944
    ds_read_b64_tr_b16 a[140:141], v9 offset:51200
    v_mfma_f32_16x16x32_bf16 v[208:211], a[232:235], a[160:163], v[208:211]
    buffer_load_dwordx4 v22, s[52:55], s77 offen offset:3144 lds
    s_add_u32 s78, s75, 3968
    v_mfma_f32_16x16x32_bf16 v[208:211], v[68:71], a[168:171], v[208:211]
    s_add_u32 m0, s72, 71808
    ds_read_b64_tr_b16 a[142:143], v9 offset:51456
    ds_read_b64_tr_b16 a[0:1], v9 offset:59136
    v_cvt_pk_bf16_f32 v36, v200, v201
    v_cvt_pk_bf16_f32 v37, v202, v203
    v_mfma_f32_16x16x32_bf16 v[212:215], v[68:71], a[172:175], v[212:215]
    ds_read_b64_tr_b16 a[2:3], v9 offset:59392
    ds_read_b64_tr_b16 a[4:5], v9 offset:33800
    v_pk_max_i16 v36, v36, 0
    v_pk_max_i16 v37, v37, 0
    v_mfma_f32_16x16x32_bf16 v[212:215], a[232:235], a[164:167], v[212:215]
    ds_write_b64 v4, v[36:37] offset:2048
    v_mfma_f32_16x16x32_bf16 v[212:215], a[204:207], a[156:159], v[212:215]
    ds_read_b64_tr_b16 a[6:7], v9 offset:34056
    ds_read_b64_tr_b16 a[8:9], v9 offset:34312
    v_cvt_pk_bf16_f32 v38, v204, v205
    v_cvt_pk_bf16_f32 v39, v206, v207
    v_mfma_f32_16x16x32_bf16 v[212:215], a[176:179], a[148:151], v[212:215]
    buffer_load_dwordx4 v19, s[52:55], s78 offen lds
    v_pk_max_i16 v38, v38, 0
    v_pk_max_i16 v39, v39, 0
    v_mfma_f32_16x16x32_bf16 v[216:219], a[180:183], a[144:147], v[216:219]
    ds_write_b64 v4, v[38:39] offset:3072
    v_mfma_f32_16x16x32_bf16 v[216:219], a[208:211], a[152:155], v[216:219]
    ds_read_b64_tr_b16 a[10:11], v9 offset:34568
    ds_read_b64_tr_b16 a[12:13], v9 offset:42248
    v_mfma_f32_16x16x32_bf16 v[216:219], a[236:239], a[160:163], v[216:219]
    ds_read_b64_tr_b16 a[14:15], v9 offset:42504
    ds_read_b64_tr_b16 a[16:17], v9 offset:42760
    v_mfma_f32_16x16x32_bf16 v[216:219], v[72:75], a[168:171], v[216:219]
    buffer_load_dwordx4 v20, s[52:55], s78 offen offset:1032 lds
    v_cvt_pk_bf16_f32 v40, v208, v209
    v_cvt_pk_bf16_f32 v41, v210, v211
    v_mfma_f32_16x16x32_bf16 v[220:223], v[72:75], a[172:175], v[220:223]
    ds_read_b64_tr_b16 a[18:19], v9 offset:43016
    ds_read_b64_tr_b16 a[20:21], v9 offset:50696
    v_pk_max_i16 v40, v40, 0
    v_pk_max_i16 v41, v41, 0
    v_mfma_f32_16x16x32_bf16 v[220:223], a[236:239], a[164:167], v[220:223]
    ds_write_b64 v4, v[40:41] offset:4096
    v_mfma_f32_16x16x32_bf16 v[220:223], a[208:211], a[156:159], v[220:223]
    ds_read_b64_tr_b16 a[22:23], v9 offset:50952
    ds_read_b64_tr_b16 a[24:25], v9 offset:51208
    v_cvt_pk_bf16_f32 v42, v212, v213
    v_cvt_pk_bf16_f32 v43, v214, v215
    v_mfma_f32_16x16x32_bf16 v[220:223], a[180:183], a[148:151], v[220:223]
    buffer_load_dwordx4 v21, s[52:55], s78 offen offset:2112 lds
    v_pk_max_i16 v42, v42, 0
    v_pk_max_i16 v43, v43, 0
    v_mfma_f32_16x16x32_bf16 v[224:227], a[184:187], a[144:147], v[224:227]
    s_waitcnt lgkmcnt(15)
    s_barrier
    buffer_load_dwordx4 v22, s[52:55], s78 offen offset:3144 lds
    v_mfma_f32_16x16x32_bf16 v[224:227], a[212:215], a[152:155], v[224:227]
    s_add_u32 s77, s75, 512
    ds_write_b64 v4, v[42:43] offset:5120
    v_mfma_f32_16x16x32_bf16 v[224:227], a[240:243], a[160:163], v[224:227]
    s_add_u32 m0, s72, 33792
    ds_read_b64_tr_b16 a[26:27], v9 offset:51464
    ds_read_b64_tr_b16 a[28:29], v9 offset:59144
    v_mfma_f32_16x16x32_bf16 v[224:227], v[76:79], a[168:171], v[224:227]
    ds_read_b64_tr_b16 a[30:31], v9 offset:59400
    v_cvt_pk_bf16_f32 v44, v216, v217
    v_cvt_pk_bf16_f32 v45, v218, v219
    v_pk_max_i16 v44, v44, 0
    v_mfma_f32_16x16x32_bf16 v[228:231], v[76:79], a[172:175], v[228:231]
    buffer_load_dwordx4 v19, s[52:55], s77 offen lds
    v_pk_max_i16 v45, v45, 0
    v_mfma_f32_16x16x32_bf16 v[228:231], a[240:243], a[164:167], v[228:231]
    ds_write_b64 v4, v[44:45] offset:6144
    v_mfma_f32_16x16x32_bf16 v[228:231], a[212:215], a[156:159], v[228:231]
    buffer_load_dwordx4 v20, s[52:55], s77 offen offset:1032 lds
    v_cvt_pk_bf16_f32 v46, v220, v221
    v_cvt_pk_bf16_f32 v47, v222, v223
    v_mfma_f32_16x16x32_bf16 v[228:231], a[184:187], a[148:151], v[228:231]
    v_pk_max_i16 v46, v46, 0
    v_pk_max_i16 v47, v47, 0
    v_mfma_f32_16x16x32_bf16 v[232:235], a[188:191], a[144:147], v[232:235]
    ds_write_b64 v4, v[46:47] offset:7168
    v_mfma_f32_16x16x32_bf16 v[232:235], a[216:219], a[152:155], v[232:235]
    buffer_load_dwordx4 v21, s[52:55], s77 offen offset:2112 lds
    v_mfma_f32_16x16x32_bf16 v[232:235], a[244:247], a[160:163], v[232:235]
    v_cvt_pk_bf16_f32 v32, v224, v225
    v_cvt_pk_bf16_f32 v33, v226, v227
    v_mfma_f32_16x16x32_bf16 v[232:235], v[80:83], a[168:171], v[232:235]
    buffer_load_dwordx4 v22, s[52:55], s77 offen offset:3144 lds
    v_pk_max_i16 v32, v32, 0
    v_pk_max_i16 v33, v33, 0
    v_mfma_f32_16x16x32_bf16 v[236:239], v[80:83], a[172:175], v[236:239]
    s_add_u32 s78, s75, 4096
    ds_write_b64 v4, v[32:33] offset:8192
    v_mfma_f32_16x16x32_bf16 v[236:239], a[244:247], a[164:167], v[236:239]
    s_add_u32 m0, s72, 38016
    s_nop 0
    buffer_load_dwordx4 v19, s[52:55], s78 offen lds
    v_cvt_pk_bf16_f32 v34, v228, v229
    v_cvt_pk_bf16_f32 v35, v230, v231
    v_mfma_f32_16x16x32_bf16 v[236:239], a[216:219], a[156:159], v[236:239]
    v_pk_max_i16 v34, v34, 0
    v_pk_max_i16 v35, v35, 0
    v_mfma_f32_16x16x32_bf16 v[236:239], a[188:191], a[148:151], v[236:239]
    ds_write_b64 v4, v[34:35] offset:9216
    v_mfma_f32_16x16x32_bf16 v[240:243], a[192:195], a[144:147], v[240:243]
    buffer_load_dwordx4 v20, s[52:55], s78 offen offset:1032 lds
    v_mfma_f32_16x16x32_bf16 v[240:243], a[220:223], a[152:155], v[240:243]
    v_mfma_f32_16x16x32_bf16 v[240:243], a[248:251], a[160:163], v[240:243]
    v_cvt_pk_bf16_f32 v36, v232, v233
    v_cvt_pk_bf16_f32 v37, v234, v235
    v_mfma_f32_16x16x32_bf16 v[240:243], v[84:87], a[168:171], v[240:243]
    buffer_load_dwordx4 v21, s[52:55], s78 offen offset:2112 lds
    v_pk_max_i16 v36, v36, 0
    v_pk_max_i16 v37, v37, 0
    v_mfma_f32_16x16x32_bf16 v[244:247], v[84:87], a[172:175], v[244:247]
    ds_write_b64 v4, v[36:37] offset:10240
    v_mfma_f32_16x16x32_bf16 v[244:247], a[248:251], a[164:167], v[244:247]
    buffer_load_dwordx4 v22, s[52:55], s78 offen offset:3144 lds
    v_cvt_pk_bf16_f32 v38, v236, v237
    v_cvt_pk_bf16_f32 v39, v238, v239
    v_mfma_f32_16x16x32_bf16 v[244:247], a[220:223], a[156:159], v[244:247]
    v_pk_max_i16 v38, v38, 0
    v_pk_max_i16 v39, v39, 0
    v_mfma_f32_16x16x32_bf16 v[244:247], a[192:195], a[148:151], v[244:247]
    ds_write_b64 v4, v[38:39] offset:11264
    v_cvt_pk_bf16_f32 v40, v240, v241
    v_cvt_pk_bf16_f32 v41, v242, v243
    v_pk_max_i16 v40, v40, 0
    v_pk_max_i16 v41, v41, 0
    ds_write_b64 v4, v[40:41] offset:12288
    s_nop 1
    v_cvt_pk_bf16_f32 v42, v244, v245
    v_cvt_pk_bf16_f32 v43, v246, v247
    v_pk_max_i16 v42, v42, 0
    v_pk_max_i16 v43, v43, 0
    ds_write_b64 v4, v[42:43] offset:13312
    s_waitcnt lgkmcnt(0)
    s_barrier
    ds_read_b128 a[176:179], v5 offset:0
    ds_read_b128 a[180:183], v5 offset:1024
    s_waitcnt lgkmcnt(1)
    v_mfma_f32_16x16x32_bf16 v[64:67], a[64:67], a[176:179], 0
    s_waitcnt lgkmcnt(0)
    ds_read_b128 a[184:187], v5 offset:2048
    ds_read_b128 a[188:191], v5 offset:3072
    v_mfma_f32_16x16x32_bf16 v[72:75], a[64:67], a[180:183], 0
    ds_read_b128 a[192:195], v5 offset:4096
    ds_read_b128 a[196:199], v5 offset:5120
    v_mfma_f32_16x16x32_bf16 v[68:71], a[68:71], a[176:179], 0
    s_add_u32 s77, s75, 640
    ds_read_b128 a[200:203], v5 offset:6144
    ds_read_b128 a[204:207], v5 offset:7168
    v_mfma_f32_16x16x32_bf16 v[76:79], a[68:71], a[180:183], 0
    s_waitcnt lgkmcnt(5)
    ds_read_b128 a[208:211], v5 offset:8192
    ds_read_b128 a[212:215], v5 offset:9216
    v_mfma_f32_16x16x32_bf16 v[64:67], a[72:75], a[184:187], v[64:67]
    s_waitcnt lgkmcnt(5)
    s_add_u32 m0, s72, 101376
    v_mfma_f32_16x16x32_bf16 v[64:67], a[76:79], a[192:195], v[64:67]
    s_waitcnt lgkmcnt(4)
    buffer_load_dwordx4 v19, s[52:55], s77 offen lds
    v_mfma_f32_16x16x32_bf16 v[72:75], a[76:79], a[196:199], v[72:75]
    v_mfma_f32_16x16x32_bf16 v[72:75], a[72:75], a[188:191], v[72:75]
    v_mfma_f32_16x16x32_bf16 v[68:71], a[80:83], a[184:187], v[68:71]
    buffer_load_dwordx4 v20, s[52:55], s77 offen offset:1032 lds
    v_mfma_f32_16x16x32_bf16 v[68:71], a[84:87], a[192:195], v[68:71]
    ds_read_b128 a[216:219], v5 offset:10240
    v_mfma_f32_16x16x32_bf16 v[76:79], a[84:87], a[196:199], v[76:79]
    ds_read_b128 a[220:223], v5 offset:11264
    v_mfma_f32_16x16x32_bf16 v[76:79], a[80:83], a[188:191], v[76:79]
    s_waitcnt lgkmcnt(2)
    ds_read_b128 a[224:227], v5 offset:12288
    ds_read_b128 a[228:231], v5 offset:13312
    v_mfma_f32_16x16x32_bf16 v[64:67], a[88:91], a[200:203], v[64:67]
    buffer_load_dwordx4 v21, s[52:55], s77 offen offset:2112 lds
    v_mfma_f32_16x16x32_bf16 v[64:67], a[92:95], a[208:211], v[64:67]
    v_mfma_f32_16x16x32_bf16 v[72:75], a[92:95], a[212:215], v[72:75]
    v_mfma_f32_16x16x32_bf16 v[72:75], a[88:91], a[204:207], v[72:75]
    v_mfma_f32_16x16x32_bf16 v[68:71], a[96:99], a[200:203], v[68:71]
    buffer_load_dwordx4 v22, s[52:55], s77 offen offset:3144 lds
    v_mfma_f32_16x16x32_bf16 v[68:71], a[100:103], a[208:211], v[68:71]
    s_add_u32 s78, s75, 4224
    v_mfma_f32_16x16x32_bf16 v[76:79], a[100:103], a[212:215], v[76:79]
    s_add_u32 m0, s72, 105600
    v_mfma_f32_16x16x32_bf16 v[76:79], a[96:99], a[204:207], v[76:79]
    s_waitcnt lgkmcnt(0)
    buffer_load_dwordx4 v19, s[52:55], s78 offen lds
    v_mfma_f32_16x16x32_bf16 v[64:67], a[104:107], a[216:219], v[64:67]
    v_mfma_f32_16x16x32_bf16 v[80:83], a[108:111], a[224:227], v[64:67]
    v_mfma_f32_16x16x32_bf16 v[72:75], a[108:111], a[228:231], v[72:75]
    v_mfma_f32_16x16x32_bf16 v[88:91], a[104:107], a[220:223], v[72:75]
    buffer_load_dwordx4 v20, s[52:55], s78 offen offset:1032 lds
    v_mfma_f32_16x16x32_bf16 v[68:71], a[112:115], a[216:219], v[68:71]
    v_mfma_f32_16x16x32_bf16 v[84:87], a[116:119], a[224:227], v[68:71]
    v_mfma_f32_16x16x32_bf16 v[76:79], a[116:119], a[228:231], v[76:79]
    s_waitcnt vmcnt(22)
    s_barrier
    ds_read_b64_tr_b16 a[32:33], v8 offset:0
    v_mfma_f32_16x16x32_bf16 v[92:95], a[112:115], a[220:223], v[76:79]
    ds_read_b64_tr_b16 a[34:35], v8 offset:256
    v_mfma_f32_16x16x32_bf16 v[64:67], a[120:123], a[176:179], 0
    buffer_load_dwordx4 v21, s[52:55], s78 offen offset:2112 lds
    v_mfma_f32_16x16x32_bf16 v[64:67], a[124:127], a[184:187], v[64:67]
    ds_read_b64_tr_b16 a[36:37], v8 offset:512
    v_mfma_f32_16x16x32_bf16 v[64:67], a[128:131], a[192:195], v[64:67]
    ds_read_b64_tr_b16 a[38:39], v8 offset:768
    v_cvt_pk_bf16_f32 v96, v80, v81
    v_mfma_f32_16x16x32_bf16 v[64:67], a[132:135], a[200:203], v[64:67]
    ds_read_b64_tr_b16 a[40:41], v8 offset:8448
    v_cvt_pk_bf16_f32 v97, v82, v83
    v_mfma_f32_16x16x32_bf16 v[72:75], a[132:135], a[204:207], 0
    buffer_load_dwordx4 v22, s[52:55], s78 offen offset:3144 lds
    v_mfma_f32_16x16x32_bf16 v[72:75], a[128:131], a[196:199], v[72:75]
    ds_read_b64_tr_b16 a[42:43], v8 offset:8704
    ds_read_b64_tr_b16 a[44:45], v8 offset:8960
    v_cvt_pk_bf16_f32 v98, v84, v85
    v_mfma_f32_16x16x32_bf16 v[72:75], a[124:127], a[188:191], v[72:75]
    ds_read_b64_tr_b16 a[46:47], v8 offset:9216
    v_cvt_pk_bf16_f32 v99, v86, v87
    v_mfma_f32_16x16x32_bf16 v[72:75], a[120:123], a[180:183], v[72:75]
    ds_read_b64_tr_b16 a[48:49], v8 offset:16896
    v_cvt_pk_bf16_f32 v100, v88, v89
    v_mfma_f32_16x16x32_bf16 v[72:75], a[136:139], a[212:215], v[72:75]
    ds_read_b64_tr_b16 a[50:51], v8 offset:17152
    v_cvt_pk_bf16_f32 v101, v90, v91
    v_mfma_f32_16x16x32_bf16 v[72:75], a[140:143], a[220:223], v[72:75]
    ds_read_b64_tr_b16 a[52:53], v8 offset:17408
    v_cvt_pk_bf16_f32 v102, v92, v93
    v_cvt_pk_bf16_f32 v103, v94, v95
    v_mfma_f32_16x16x32_bf16 v[88:91], a[0:3], a[228:231], v[72:75]
    ds_read_b64_tr_b16 a[54:55], v8 offset:17664
    v_mfma_f32_16x16x32_bf16 v[64:67], a[0:3], a[224:227], v[64:67]
    ds_read_b64_tr_b16 a[56:57], v8 offset:25344
    v_mfma_f32_16x16x32_bf16 v[64:67], a[140:143], a[216:219], v[64:67]
    ds_read_b64_tr_b16 a[58:59], v8 offset:25600
    v_mfma_f32_16x16x32_bf16 v[80:83], a[136:139], a[208:211], v[64:67]
    s_add_u32 s80, s79, 0
    buffer_store_dwordx4 v[96:99], v1, s[28:31], s80 offen sc1
    v_mfma_f32_16x16x32_bf16 v[68:71], a[4:7], a[176:179], 0
    ds_read_b64_tr_b16 a[60:61], v8 offset:8
    ds_read_b64_tr_b16 a[62:63], v8 offset:264
    v_mfma_f32_16x16x32_bf16 v[68:71], a[8:11], a[184:187], v[68:71]
    ds_read_b64_tr_b16 a[64:65], v8 offset:520
    v_mfma_f32_16x16x32_bf16 v[68:71], a[12:15], a[192:195], v[68:71]
    s_add_u32 s80, s81, 0
    buffer_store_dwordx4 v[100:103], v27, s[28:31], s80 offen sc1
    v_mfma_f32_16x16x32_bf16 v[68:71], a[16:19], a[200:203], v[68:71]
    ds_read_b64_tr_b16 a[66:67], v8 offset:776
    ds_read_b64_tr_b16 a[68:69], v8 offset:8456
    v_mfma_f32_16x16x32_bf16 v[76:79], a[16:19], a[204:207], 0
    ds_read_b64_tr_b16 a[70:71], v8 offset:8712
    v_mfma_f32_16x16x32_bf16 v[76:79], a[12:15], a[196:199], v[76:79]
    s_mov_b64 exec, s[16:17]
    ds_write_b128 v52, v[96:99] offset:0
    s_mov_b64 exec, -1
    v_mfma_f32_16x16x32_bf16 v[76:79], a[8:11], a[188:191], v[76:79]
    v_mfma_f32_16x16x32_bf16 v[76:79], a[4:7], a[180:183], v[76:79]
    ds_read_b64_tr_b16 a[72:73], v8 offset:8968
    ds_read_b64_tr_b16 a[74:75], v8 offset:9224
    v_mfma_f32_16x16x32_bf16 v[76:79], a[20:23], a[212:215], v[76:79]
    ds_read_b64_tr_b16 a[76:77], v8 offset:16904
    ds_read_b64_tr_b16 a[78:79], v8 offset:17160
    v_mfma_f32_16x16x32_bf16 v[76:79], a[24:27], a[220:223], v[76:79]
    ds_read_b64_tr_b16 a[80:81], v8 offset:17416
    v_mfma_f32_16x16x32_bf16 v[92:95], a[28:31], a[228:231], v[76:79]
    ds_read_b64_tr_b16 a[82:83], v8 offset:17672
    v_mfma_f32_16x16x32_bf16 v[68:71], a[28:31], a[224:227], v[68:71]
    ds_read_b64_tr_b16 a[84:85], v8 offset:25352
    v_mfma_f32_16x16x32_bf16 v[68:71], a[24:27], a[216:219], v[68:71]
    ds_read_b64_tr_b16 a[86:87], v8 offset:25608
    v_mfma_f32_16x16x32_bf16 v[84:87], a[20:23], a[208:211], v[68:71]
    s_waitcnt lgkmcnt(8)
    v_mfma_f32_16x16x32_bf16 v[64:67], a[32:35], a[176:179], 0
    v_mfma_f32_16x16x32_bf16 v[64:67], a[36:39], a[184:187], v[64:67]
    v_mfma_f32_16x16x32_bf16 v[64:67], a[40:43], a[192:195], v[64:67]
    v_cvt_pk_bf16_f32 v96, v80, v81
    v_mfma_f32_16x16x32_bf16 v[64:67], a[44:47], a[200:203], v[64:67]
    s_waitcnt vmcnt(10) lgkmcnt(0)
    s_barrier
    ds_read_b64_tr_b16 a[88:89], v9 offset:0
    v_mfma_f32_16x16x32_bf16 v[72:75], a[44:47], a[204:207], 0
    s_add_u32 s77, s75, 768
    ds_read_b64_tr_b16 a[90:91], v9 offset:256
    v_cvt_pk_bf16_f32 v97, v82, v83
    v_mfma_f32_16x16x32_bf16 v[72:75], a[40:43], a[196:199], v[72:75]
    s_add_u32 m0, s72, 0
    ds_read_b64_tr_b16 a[92:93], v9 offset:512
    v_cvt_pk_bf16_f32 v98, v84, v85
    v_mfma_f32_16x16x32_bf16 v[72:75], a[36:39], a[188:191], v[72:75]
    ds_read_b64_tr_b16 a[94:95], v9 offset:768
    v_cvt_pk_bf16_f32 v99, v86, v87
    v_mfma_f32_16x16x32_bf16 v[72:75], a[32:35], a[180:183], v[72:75]
    buffer_load_dwordx4 v19, s[52:55], s77 offen lds
    v_cvt_pk_bf16_f32 v100, v88, v89
    v_mfma_f32_16x16x32_bf16 v[72:75], a[48:51], a[212:215], v[72:75]
    ds_read_b64_tr_b16 a[96:97], v9 offset:8448
    v_cvt_pk_bf16_f32 v101, v90, v91
    v_mfma_f32_16x16x32_bf16 v[72:75], a[52:55], a[220:223], v[72:75]
    ds_read_b64_tr_b16 a[98:99], v9 offset:8704
    v_cvt_pk_bf16_f32 v102, v92, v93
    v_cvt_pk_bf16_f32 v103, v94, v95
    v_mfma_f32_16x16x32_bf16 v[88:91], a[56:59], a[228:231], v[72:75]
    ds_read_b64_tr_b16 a[100:101], v9 offset:8960
    v_mfma_f32_16x16x32_bf16 v[64:67], a[56:59], a[224:227], v[64:67]
    buffer_load_dwordx4 v20, s[52:55], s77 offen offset:1032 lds
    v_mfma_f32_16x16x32_bf16 v[64:67], a[52:55], a[216:219], v[64:67]
    ds_read_b64_tr_b16 a[102:103], v9 offset:9216
    v_mfma_f32_16x16x32_bf16 v[80:83], a[48:51], a[208:211], v[64:67]
    s_add_u32 s80, s79, 32768
    buffer_store_dwordx4 v[96:99], v1, s[28:31], s80 offen sc1
    v_mfma_f32_16x16x32_bf16 v[68:71], a[60:63], a[176:179], 0
    ds_read_b64_tr_b16 a[104:105], v9 offset:16896
    v_mfma_f32_16x16x32_bf16 v[68:71], a[64:67], a[184:187], v[68:71]
    ds_read_b64_tr_b16 a[106:107], v9 offset:17152
    v_mfma_f32_16x16x32_bf16 v[68:71], a[68:71], a[192:195], v[68:71]
    buffer_load_dwordx4 v21, s[52:55], s77 offen offset:2112 lds
    v_mfma_f32_16x16x32_bf16 v[68:71], a[72:75], a[200:203], v[68:71]
    s_add_u32 s80, s81, 32768
    buffer_store_dwordx4 v[100:103], v27, s[28:31], s80 offen sc1
    v_mfma_f32_16x16x32_bf16 v[76:79], a[72:75], a[204:207], 0
    ds_read_b64_tr_b16 a[108:109], v9 offset:17408
    ds_read_b64_tr_b16 a[110:111], v9 offset:17664
    v_mfma_f32_16x16x32_bf16 v[76:79], a[68:71], a[196:199], v[76:79]
    s_mov_b64 exec, s[16:17]
    ds_write_b128 v52, v[96:99] offset:1024
    s_mov_b64 exec, -1
    v_mfma_f32_16x16x32_bf16 v[76:79], a[64:67], a[188:191], v[76:79]
    v_mfma_f32_16x16x32_bf16 v[76:79], a[60:63], a[180:183], v[76:79]
    ds_read_b64_tr_b16 a[112:113], v9 offset:25344
    ds_read_b64_tr_b16 a[114:115], v9 offset:25600
    v_mfma_f32_16x16x32_bf16 v[76:79], a[76:79], a[212:215], v[76:79]
    buffer_load_dwordx4 v22, s[52:55], s77 offen offset:3144 lds
    s_add_u32 s78, s75, 4352
    v_mfma_f32_16x16x32_bf16 v[76:79], a[80:83], a[220:223], v[76:79]
    s_add_u32 m0, s72, 4224
    ds_read_b64_tr_b16 a[116:117], v9 offset:8
    ds_read_b64_tr_b16 a[118:119], v9 offset:264
    v_mfma_f32_16x16x32_bf16 v[92:95], a[84:87], a[228:231], v[76:79]
    ds_read_b64_tr_b16 a[120:121], v9 offset:520
    v_mfma_f32_16x16x32_bf16 v[68:71], a[84:87], a[224:227], v[68:71]
    buffer_load_dwordx4 v19, s[52:55], s78 offen lds
    v_mfma_f32_16x16x32_bf16 v[68:71], a[80:83], a[216:219], v[68:71]
    ds_read_b64_tr_b16 a[122:123], v9 offset:776
    ds_read_b64_tr_b16 a[124:125], v9 offset:8456
    v_mfma_f32_16x16x32_bf16 v[84:87], a[76:79], a[208:211], v[68:71]
    s_waitcnt lgkmcnt(7)
    ds_read_b64_tr_b16 a[126:127], v9 offset:8712
    v_mfma_f32_16x16x32_bf16 v[64:67], a[88:91], a[176:179], 0
    ds_read_b64_tr_b16 a[128:129], v9 offset:8968
    v_mfma_f32_16x16x32_bf16 v[64:67], a[92:95], a[184:187], v[64:67]
    buffer_load_dwordx4 v20, s[52:55], s78 offen offset:1032 lds
    v_mfma_f32_16x16x32_bf16 v[64:67], a[96:99], a[192:195], v[64:67]
    ds_read_b64_tr_b16 a[130:131], v9 offset:9224
    v_cvt_pk_bf16_f32 v96, v80, v81
    v_mfma_f32_16x16x32_bf16 v[64:67], a[100:103], a[200:203], v[64:67]
    ds_read_b64_tr_b16 a[132:133], v9 offset:16904
    v_cvt_pk_bf16_f32 v97, v82, v83
    v_mfma_f32_16x16x32_bf16 v[72:75], a[100:103], a[204:207], 0
    ds_read_b64_tr_b16 a[134:135], v9 offset:17160
    v_cvt_pk_bf16_f32 v98, v84, v85
    v_mfma_f32_16x16x32_bf16 v[72:75], a[96:99], a[196:199], v[72:75]
    buffer_load_dwordx4 v21, s[52:55], s78 offen offset:2112 lds
    v_mfma_f32_16x16x32_bf16 v[72:75], a[92:95], a[188:191], v[72:75]
    ds_read_b64_tr_b16 a[136:137], v9 offset:17416
    v_cvt_pk_bf16_f32 v99, v86, v87
    v_mfma_f32_16x16x32_bf16 v[72:75], a[88:91], a[180:183], v[72:75]
    ds_read_b64_tr_b16 a[138:139], v9 offset:17672
    v_cvt_pk_bf16_f32 v100, v88, v89
    v_mfma_f32_16x16x32_bf16 v[72:75], a[104:107], a[212:215], v[72:75]
    ds_read_b64_tr_b16 a[140:141], v9 offset:25352
    v_cvt_pk_bf16_f32 v101, v90, v91
    v_mfma_f32_16x16x32_bf16 v[72:75], a[108:111], a[220:223], v[72:75]
    s_waitcnt lgkmcnt(6)
    ds_read_b64_tr_b16 a[142:143], v9 offset:25608
    v_cvt_pk_bf16_f32 v102, v92, v93
    v_cvt_pk_bf16_f32 v103, v94, v95
    v_mfma_f32_16x16x32_bf16 v[88:91], a[112:115], a[228:231], v[72:75]
    buffer_load_dwordx4 v22, s[52:55], s78 offen offset:3144 lds
    v_mfma_f32_16x16x32_bf16 v[64:67], a[112:115], a[224:227], v[64:67]
    ds_read_b64_tr_b16 a[0:1], v8 offset:33792
    v_mfma_f32_16x16x32_bf16 v[64:67], a[108:111], a[216:219], v[64:67]
    ds_read_b64_tr_b16 a[2:3], v8 offset:34048
    v_mfma_f32_16x16x32_bf16 v[80:83], a[104:107], a[208:211], v[64:67]
    s_add_u32 s80, s79, 65536
    buffer_store_dwordx4 v[96:99], v1, s[28:31], s80 offen sc1
    v_mfma_f32_16x16x32_bf16 v[68:71], a[116:119], a[176:179], 0
    ds_read_b64_tr_b16 a[4:5], v8 offset:34304
    ds_read_b64_tr_b16 a[6:7], v8 offset:34560
    v_mfma_f32_16x16x32_bf16 v[68:71], a[120:123], a[184:187], v[68:71]
    ds_read_b64_tr_b16 a[8:9], v8 offset:42240
    v_mfma_f32_16x16x32_bf16 v[68:71], a[124:127], a[192:195], v[68:71]
    s_waitcnt lgkmcnt(6)
    ds_read_b64_tr_b16 a[10:11], v8 offset:42496
    v_mfma_f32_16x16x32_bf16 v[68:71], a[128:131], a[200:203], v[68:71]
    s_add_u32 s80, s81, 65536
    buffer_store_dwordx4 v[100:103], v27, s[28:31], s80 offen sc1
    v_mfma_f32_16x16x32_bf16 v[76:79], a[128:131], a[204:207], 0
    ds_read_b64_tr_b16 a[12:13], v8 offset:42752
    ds_read_b64_tr_b16 a[14:15], v8 offset:43008
    v_mfma_f32_16x16x32_bf16 v[76:79], a[124:127], a[196:199], v[76:79]
    s_mov_b64 exec, s[16:17]
    ds_write_b128 v52, v[96:99] offset:2048
    s_mov_b64 exec, -1
    v_mfma_f32_16x16x32_bf16 v[76:79], a[120:123], a[188:191], v[76:79]
    v_mfma_f32_16x16x32_bf16 v[76:79], a[116:119], a[180:183], v[76:79]
    ds_read_b64_tr_b16 a[16:17], v8 offset:50688
    ds_read_b64_tr_b16 a[18:19], v8 offset:50944
    v_mfma_f32_16x16x32_bf16 v[76:79], a[132:135], a[212:215], v[76:79]
    ds_read_b64_tr_b16 a[20:21], v8 offset:51200
    v_mfma_f32_16x16x32_bf16 v[76:79], a[136:139], a[220:223], v[76:79]
    s_waitcnt lgkmcnt(6)
    ds_read_b64_tr_b16 a[22:23], v8 offset:51456
    v_mfma_f32_16x16x32_bf16 v[92:95], a[140:143], a[228:231], v[76:79]
    ds_read_b64_tr_b16 a[24:25], v8 offset:59136
    v_mfma_f32_16x16x32_bf16 v[68:71], a[140:143], a[224:227], v[68:71]
    ds_read_b64_tr_b16 a[26:27], v8 offset:59392
    v_mfma_f32_16x16x32_bf16 v[68:71], a[136:139], a[216:219], v[68:71]
    ds_read_b64_tr_b16 a[28:29], v8 offset:33800
    v_mfma_f32_16x16x32_bf16 v[84:87], a[132:135], a[208:211], v[68:71]
    ds_read_b64_tr_b16 a[30:31], v8 offset:34056
    v_mfma_f32_16x16x32_bf16 v[64:67], a[0:3], a[176:179], 0
    ds_read_b64_tr_b16 a[32:33], v8 offset:34312
    v_mfma_f32_16x16x32_bf16 v[64:67], a[4:7], a[184:187], v[64:67]
    s_waitcnt lgkmcnt(7)
    ds_read_b64_tr_b16 a[34:35], v8 offset:34568
L_hop1_2:
    s_cbranch_execz L_hopback1
    v_mfma_f32_16x16x32_bf16 v[64:67], a[8:11], a[192:195], v[64:67]
    ds_read_b64_tr_b16 a[36:37], v8 offset:42248
    v_cvt_pk_bf16_f32 v96, v80, v81
    v_mfma_f32_16x16x32_bf16 v[64:67], a[12:15], a[200:203], v[64:67]
    ds_read_b64_tr_b16 a[38:39], v8 offset:42504
    v_cvt_pk_bf16_f32 v97, v82, v83
    v_mfma_f32_16x16x32_bf16 v[72:75], a[12:15], a[204:207], 0
    ds_read_b64_tr_b16 a[40:41], v8 offset:42760
    v_cvt_pk_bf16_f32 v98, v84, v85
    v_mfma_f32_16x16x32_bf16 v[72:75], a[8:11], a[196:199], v[72:75]
    ds_read_b64_tr_b16 a[42:43], v8 offset:43016
    v_cvt_pk_bf16_f32 v99, v86, v87
    v_mfma_f32_16x16x32_bf16 v[72:75], a[4:7], a[188:191], v[72:75]
    ds_read_b64_tr_b16 a[44:45], v8 offset:50696
    v_cvt_pk_bf16_f32 v100, v88, v89
    v_mfma_f32_16x16x32_bf16 v[72:75], a[0:3], a[180:183], v[72:75]
    ds_read_b64_tr_b16 a[46:47], v8 offset:50952
    v_cvt_pk_bf16_f32 v101, v90, v91
    v_mfma_f32_16x16x32_bf16 v[72:75], a[16:19], a[212:215], v[72:75]
    s_waitcnt lgkmcnt(7)
    ds_read_b64_tr_b16 a[48:49], v8 offset:51208
    v_cvt_pk_bf16_f32 v102, v92, v93
    v_mfma_f32_16x16x32_bf16 v[72:75], a[20:23], a[220:223], v[72:75]
    ds_read_b64_tr_b16 a[50:51], v8 offset:51464
    v_cvt_pk_bf16_f32 v103, v94, v95
    v_mfma_f32_16x16x32_bf16 v[88:91], a[24:27], a[228:231], v[72:75]
    ds_read_b64_tr_b16 a[52:53], v8 offset:59144
    v_mfma_f32_16x16x32_bf16 v[64:67], a[24:27], a[224:227], v[64:67]
    ds_read_b64_tr_b16 a[54:55], v8 offset:59400
    v_mfma_f32_16x16x32_bf16 v[64:67], a[20:23], a[216:219], v[64:67]
    s_add_u32 s80, s79, 98304
    buffer_store_dwordx4 v[96:99], v1, s[28:31], s80 offen sc1
    v_mfma_f32_16x16x32_bf16 v[80:83], a[16:19], a[208:211], v[64:67]
    s_waitcnt vmcnt(3)
    s_barrier
    ds_read_b64_tr_b16 a[56:57], v9 offset:33792
    v_mfma_f32_16x16x32_bf16 v[68:71], a[28:31], a[176:179], 0
    s_waitcnt lgkmcnt(6)
    ds_read_b64_tr_b16 a[58:59], v9 offset:34048
    v_mfma_f32_16x16x32_bf16 v[68:71], a[32:35], a[184:187], v[68:71]
    s_add_u32 s80, s81, 98304
    buffer_store_dwordx4 v[100:103], v27, s[28:31], s80 offen sc1
    v_mfma_f32_16x16x32_bf16 v[68:71], a[36:39], a[192:195], v[68:71]
    ds_read_b64_tr_b16 a[60:61], v9 offset:34304
    v_mfma_f32_16x16x32_bf16 v[68:71], a[40:43], a[200:203], v[68:71]
    ds_read_b64_tr_b16 a[62:63], v9 offset:34560
    v_mfma_f32_16x16x32_bf16 v[76:79], a[40:43], a[204:207], 0
    ds_read_b64_tr_b16 a[64:65], v9 offset:42240
    v_mfma_f32_16x16x32_bf16 v[76:79], a[36:39], a[196:199], v[76:79]
    s_mov_b64 exec, s[16:17]
    ds_write_b128 v52, v[96:99] offset:3072
    s_mov_b64 exec, -1
    v_mfma_f32_16x16x32_bf16 v[76:79], a[32:35], a[188:191], v[76:79]
    v_mfma_f32_16x16x32_bf16 v[76:79], a[28:31], a[180:183], v[76:79]
    s_waitcnt lgkmcnt(4)
    ds_read_b64_tr_b16 a[66:67], v9 offset:42496
    ds_read_b64_tr_b16 a[68:69], v9 offset:42752
    v_mfma_f32_16x16x32_bf16 v[76:79], a[44:47], a[212:215], v[76:79]
    ds_read_b64_tr_b16 a[70:71], v9 offset:43008
    ds_read_b64_tr_b16 a[72:73], v9 offset:50688
    v_mfma_f32_16x16x32_bf16 v[76:79], a[48:51], a[220:223], v[76:79]
    ds_read_b64_tr_b16 a[74:75], v9 offset:50944
    v_mfma_f32_16x16x32_bf16 v[92:95], a[52:55], a[228:231], v[76:79]
    ds_read_b64_tr_b16 a[76:77], v9 offset:51200
    v_mfma_f32_16x16x32_bf16 v[68:71], a[52:55], a[224:227], v[68:71]
    ds_read_b64_tr_b16 a[78:79], v9 offset:51456
    v_mfma_f32_16x16x32_bf16 v[68:71], a[48:51], a[216:219], v[68:71]
    ds_read_b64_tr_b16 a[80:81], v9 offset:59136
    v_mfma_f32_16x16x32_bf16 v[84:87], a[44:47], a[208:211], v[68:71]
    s_waitcnt lgkmcnt(8)
    ds_read_b64_tr_b16 a[82:83], v9 offset:59392
    v_mfma_f32_16x16x32_bf16 v[64:67], a[56:59], a[176:179], 0
    ds_read_b64_tr_b16 a[84:85], v9 offset:33800
    v_mfma_f32_16x16x32_bf16 v[64:67], a[60:63], a[184:187], v[64:67]
    s_waitcnt lgkmcnt(8)
    ds_read_b64_tr_b16 a[86:87], v9 offset:34056
    v_mfma_f32_16x16x32_bf16 v[64:67], a[64:67], a[192:195], v[64:67]
    s_waitcnt lgkmcnt(7)
    ds_read_b64_tr_b16 a[88:89], v9 offset:34312
    v_cvt_pk_bf16_f32 v96, v80, v81
    v_mfma_f32_16x16x32_bf16 v[64:67], a[68:71], a[200:203], v[64:67]
    ds_read_b64_tr_b16 a[90:91], v9 offset:34568
    v_cvt_pk_bf16_f32 v97, v82, v83
    v_mfma_f32_16x16x32_bf16 v[72:75], a[68:71], a[204:207], 0
    ds_read_b64_tr_b16 a[92:93], v9 offset:42248
    v_cvt_pk_bf16_f32 v98, v84, v85
    v_mfma_f32_16x16x32_bf16 v[72:75], a[64:67], a[196:199], v[72:75]
    ds_read_b64_tr_b16 a[94:95], v9 offset:42504
    v_cvt_pk_bf16_f32 v99, v86, v87
    v_mfma_f32_16x16x32_bf16 v[72:75], a[60:63], a[188:191], v[72:75]
    ds_read_b64_tr_b16 a[96:97], v9 offset:42760
    v_cvt_pk_bf16_f32 v100, v88, v89
    v_mfma_f32_16x16x32_bf16 v[72:75], a[56:59], a[180:183], v[72:75]
    s_waitcnt lgkmcnt(7)
    ds_read_b64_tr_b16 a[98:99], v9 offset:43016
    v_cvt_pk_bf16_f32 v101, v90, v91
    v_mfma_f32_16x16x32_bf16 v[72:75], a[72:75], a[212:215], v[72:75]
    ds_read_b64_tr_b16 a[100:101], v9 offset:50696
    v_cvt_pk_bf16_f32 v102, v92, v93
    v_mfma_f32_16x16x32_bf16 v[72:75], a[76:79], a[220:223], v[72:75]
    ds_read_b64_tr_b16 a[102:103], v9 offset:50952
    v_cvt_pk_bf16_f32 v103, v94, v95
    v_mfma_f32_16x16x32_bf16 v[88:91], a[80:83], a[228:231], v[72:75]
    ds_read_b64_tr_b16 a[104:105], v9 offset:51208
    v_mfma_f32_16x16x32_bf16 v[64:67], a[80:83], a[224:227], v[64:67]
    ds_read_b64_tr_b16 a[106:107], v9 offset:51464
    v_mfma_f32_16x16x32_bf16 v[64:67], a[76:79], a[216:219], v[64:67]
    s_add_u32 s80, s79, 131072
    buffer_store_dwordx4 v[96:99], v1, s[28:31], s80 offen sc1
    v_mfma_f32_16x16x32_bf16 v[80:83], a[72:75], a[208:211], v[64:67]
    s_waitcnt lgkmcnt(6)
    ds_read_b64_tr_b16 a[108:109], v9 offset:59144
    v_mfma_f32_16x16x32_bf16 v[68:71], a[84:87], a[176:179], 0
    ds_read_b64_tr_b16 a[110:111], v9 offset:59400
    v_mfma_f32_16x16x32_bf16 v[68:71], a[88:91], a[184:187], v[68:71]
    s_add_u32 s80, s81, 131072
    buffer_store_dwordx4 v[100:103], v27, s[28:31], s80 offen sc1
    v_mfma_f32_16x16x32_bf16 v[68:71], a[92:95], a[192:195], v[68:71]
    s_waitcnt lgkmcnt(5)
    ds_read_b64_tr_b16 a[112:113], v8 offset:0
    v_mfma_f32_16x16x32_bf16 v[68:71], a[96:99], a[200:203], v[68:71]
    ds_read_b64_tr_b16 a[114:115], v8 offset:256
    v_mfma_f32_16x16x32_bf16 v[76:79], a[96:99], a[204:207], 0
    ds_read_b64_tr_b16 a[116:117], v8 offset:512
    v_mfma_f32_16x16x32_bf16 v[76:79], a[92:95], a[196:199], v[76:79]
    s_mov_b64 exec, s[16:17]
    ds_write_b128 v52, v[96:99] offset:4096
    s_mov_b64 exec, -1
    v_mfma_f32_16x16x32_bf16 v[76:79], a[88:91], a[188:191], v[76:79]
    v_mfma_f32_16x16x32_bf16 v[76:79], a[84:87], a[180:183], v[76:79]
    s_waitcnt lgkmcnt(4)
    ds_read_b64_tr_b16 a[118:119], v8 offset:768
    ds_read_b64_tr_b16 a[120:121], v8 offset:8448
    v_mfma_f32_16x16x32_bf16 v[76:79], a[100:103], a[212:215], v[76:79]
    ds_read_b64_tr_b16 a[122:123], v8 offset:8704
    ds_read_b64_tr_b16 a[124:125], v8 offset:8960
    v_mfma_f32_16x16x32_bf16 v[76:79], a[104:107], a[220:223], v[76:79]
    s_waitcnt lgkmcnt(7)
    ds_read_b64_tr_b16 a[126:127], v8 offset:9216
    v_mfma_f32_16x16x32_bf16 v[92:95], a[108:111], a[228:231], v[76:79]
    ds_read_b64_tr_b16 a[128:129], v8 offset:16896
    v_mfma_f32_16x16x32_bf16 v[68:71], a[108:111], a[224:227], v[68:71]
    ds_read_b64_tr_b16 a[130:131], v8 offset:17152
    v_mfma_f32_16x16x32_bf16 v[68:71], a[104:107], a[216:219], v[68:71]
    ds_read_b64_tr_b16 a[132:133], v8 offset:17408
    v_mfma_f32_16x16x32_bf16 v[84:87], a[100:103], a[208:211], v[68:71]
    s_waitcnt lgkmcnt(8)
    ds_read_b64_tr_b16 a[134:135], v8 offset:17664
    v_mfma_f32_16x16x32_bf16 v[64:67], a[112:115], a[176:179], 0
    s_waitcnt lgkmcnt(8)
    ds_read_b64_tr_b16 a[136:137], v8 offset:25344
    v_mfma_f32_16x16x32_bf16 v[64:67], a[116:119], a[184:187], v[64:67]
    s_waitcnt lgkmcnt(7)
    ds_read_b64_tr_b16 a[138:139], v8 offset:25600
    v_mfma_f32_16x16x32_bf16 v[64:67], a[120:123], a[192:195], v[64:67]
    s_waitcnt lgkmcnt(6)
    ds_read_b64_tr_b16 a[140:141], v8 offset:8
    v_cvt_pk_bf16_f32 v96, v80, v81
    v_mfma_f32_16x16x32_bf16 v[64:67], a[124:127], a[200:203], v[64:67]
    ds_read_b64_tr_b16 a[142:143], v8 offset:264
    v_add_u32 v122, 3, v122
    v_mfma_f32_16x16x32_bf16 v[72:75], a[124:127], a[204:207], 0
    ds_read_b64_tr_b16 a[0:1], v8 offset:520
    v_cvt_pk_bf16_f32 v97, v82, v83
    v_mfma_f32_16x16x32_bf16 v[72:75], a[120:123], a[196:199], v[72:75]
    ds_read_b64_tr_b16 a[2:3], v8 offset:776
    v_cvt_pk_bf16_f32 v98, v84, v85
    v_mfma_f32_16x16x32_bf16 v[72:75], a[116:119], a[188:191], v[72:75]
    ds_read_b64_tr_b16 a[4:5], v8 offset:8456
    v_cvt_pk_bf16_f32 v99, v86, v87
    v_mfma_f32_16x16x32_bf16 v[72:75], a[112:115], a[180:183], v[72:75]
    s_waitcnt lgkmcnt(7)
    ds_read_b64_tr_b16 a[6:7], v8 offset:8712
    v_cvt_pk_bf16_f32 v100, v88, v89
    v_mfma_f32_16x16x32_bf16 v[72:75], a[128:131], a[212:215], v[72:75]
    s_waitcnt vmcnt(4)
    s_barrier
    ds_read_b64_tr_b16 a[8:9], v8 offset:8968
    v_cvt_pk_bf16_f32 v101, v90, v91
    v_mfma_f32_16x16x32_bf16 v[72:75], a[132:135], a[220:223], v[72:75]
    s_waitcnt lgkmcnt(7)
    ds_read_b64_tr_b16 a[10:11], v8 offset:9224
    v_cvt_pk_bf16_f32 v102, v92, v93
    v_cvt_pk_bf16_f32 v103, v94, v95
    v_mfma_f32_16x16x32_bf16 v[88:91], a[136:139], a[228:231], v[72:75]
    ds_read_b64_tr_b16 a[12:13], v8 offset:16904
    v_mfma_f32_16x16x32_bf16 v[64:67], a[136:139], a[224:227], v[64:67]
    buffer_store_dwordx2 v[122:123], v55, s[28:31], s98 offen sc1
    v_mfma_f32_16x16x32_bf16 v[64:67], a[132:135], a[216:219], v[64:67]
    ds_read_b64_tr_b16 a[14:15], v8 offset:17160
    ds_read_b64_tr_b16 a[16:17], v8 offset:17416
    v_mfma_f32_16x16x32_bf16 v[80:83], a[128:131], a[208:211], v[64:67]
    s_waitcnt lgkmcnt(7)
    ds_read_b64_tr_b16 a[18:19], v8 offset:17672
    v_mfma_f32_16x16x32_bf16 v[68:71], a[140:143], a[176:179], 0
    s_add_u32 s80, s79, 163840
    buffer_store_dwordx4 v[96:99], v1, s[28:31], s80 offen sc1
    v_mfma_f32_16x16x32_bf16 v[68:71], a[0:3], a[184:187], v[68:71]
    s_waitcnt lgkmcnt(6)
    ds_read_b64_tr_b16 a[20:21], v8 offset:25352
    ds_read_b64_tr_b16 a[22:23], v8 offset:25608
    v_mfma_f32_16x16x32_bf16 v[68:71], a[4:7], a[192:195], v[68:71]
    s_waitcnt lgkmcnt(6)
    v_mfma_f32_16x16x32_bf16 v[68:71], a[8:11], a[200:203], v[68:71]
    s_add_u32 s80, s81, 163840
    buffer_store_dwordx4 v[100:103], v27, s[28:31], s80 offen sc1
    v_mfma_f32_16x16x32_bf16 v[76:79], a[8:11], a[204:207], 0
    v_mfma_f32_16x16x32_bf16 v[76:79], a[4:7], a[196:199], v[76:79]
    s_mov_b64 exec, s[16:17]
    ds_write_b128 v52, v[96:99] offset:5120
    s_mov_b64 exec, -1
    v_mfma_f32_16x16x32_bf16 v[76:79], a[0:3], a[188:191], v[76:79]
    v_mfma_f32_16x16x32_bf16 v[76:79], a[140:143], a[180:183], v[76:79]
    s_waitcnt lgkmcnt(2)
    v_mfma_f32_16x16x32_bf16 v[76:79], a[12:15], a[212:215], v[76:79]
    v_mfma_f32_16x16x32_bf16 v[76:79], a[16:19], a[220:223], v[76:79]
    s_waitcnt lgkmcnt(0)
    v_mfma_f32_16x16x32_bf16 v[92:95], a[20:23], a[228:231], v[76:79]
    v_mfma_f32_16x16x32_bf16 v[68:71], a[20:23], a[224:227], v[68:71]
    buffer_load_dwordx2 v[120:121], v119, s[28:31], s61 offen sc1
    v_mfma_f32_16x16x32_bf16 v[68:71], a[16:19], a[216:219], v[68:71]
    v_mfma_f32_16x16x32_bf16 v[84:87], a[12:15], a[208:211], v[68:71]
    v_cvt_pk_bf16_f32 v96, v80, v81
    v_cvt_pk_bf16_f32 v97, v82, v83
    s_nop 5
    v_cvt_pk_bf16_f32 v98, v84, v85
    v_cvt_pk_bf16_f32 v99, v86, v87
    s_add_u32 s80, s79, 196608
    buffer_store_dwordx4 v[96:99], v1, s[28:31], s80 offen sc1
    v_cvt_pk_bf16_f32 v100, v88, v89
    v_cvt_pk_bf16_f32 v101, v90, v91
    v_cvt_pk_bf16_f32 v102, v92, v93
    v_cvt_pk_bf16_f32 v103, v94, v95
    s_add_u32 s80, s81, 196608
    buffer_store_dwordx4 v[100:103], v27, s[28:31], s80 offen sc1
    s_mov_b64 exec, s[16:17]
    ds_write_b128 v52, v[96:99] offset:6144
    s_mov_b64 exec, -1
    s_xor_b32 s6, s62, 1048576
    s_add_u32 s7, s6, 98304
    s_waitcnt lgkmcnt(0)
    s_barrier
    ds_read_b128 v[208:211], v60
    ds_read_b128 v[64:67], v60 offset:3072
    v_lshlrev_b32 v160, 16, v152
    v_and_b32 v161, s68, v152
    v_lshlrev_b32 v162, 16, v153
    v_and_b32 v163, s68, v153
    v_lshlrev_b32 v164, 16, v154
    v_and_b32 v165, s68, v154
    v_lshlrev_b32 v166, 16, v155
    v_and_b32 v167, s68, v155
    v_lshlrev_b32 v168, 16, v156
    v_and_b32 v169, s68, v156
    v_lshlrev_b32 v170, 16, v157
    v_and_b32 v171, s68, v157
    v_lshlrev_b32 v172, 16, v158
    v_and_b32 v173, s68, v158
    v_lshlrev_b32 v174, 16, v159
    v_and_b32 v175, s68, v159
    s_waitcnt lgkmcnt(0)
    v_lshlrev_b32 v128, 16, v208
    v_and_b32 v129, s68, v208
    v_lshlrev_b32 v130, 16, v209
    v_and_b32 v131, s68, v209
    v_lshlrev_b32 v132, 16, v210
    v_and_b32 v133, s68, v210
    v_lshlrev_b32 v134, 16, v211
    v_and_b32 v135, s68, v211
    v_lshlrev_b32 v136, 16, v64
    v_and_b32 v137, s68, v64
    v_lshlrev_b32 v138, 16, v65
    v_and_b32 v139, s68, v65
    v_lshlrev_b32 v140, 16, v66
    v_and_b32 v141, s68, v66
    v_lshlrev_b32 v142, 16, v67
    v_and_b32 v143, s68, v67
    s_waitcnt vmcnt(0)
    buffer_store_dwordx2 v[126:127], v54, s[28:31], s98 offen sc1
    s_mov_b32 s93, 60000
L_sw5:
    v_subrev_u32 v56, s64, v120
    v_cmp_ne_u32 s[4:5], s95, v121
    v_cmp_lt_u32 vcc, 7, v56
    s_nop 0
    s_or_b64 vcc, vcc, s[4:5]
    s_cbranch_scc1 L_sw5_retry
L_sw5_done:
    s_add_u32 s78, s6, s8
    buffer_load_dwordx4 v[212:215], v118, s[28:31], s78 offen sc1
    s_add_u32 s77, s6, s9
    buffer_load_dwordx4 v[216:219], v118, s[28:31], s77 offen sc1
    s_add_u32 s78, s6, s10
    buffer_load_dwordx4 v[220:223], v118, s[28:31], s78 offen sc1
    s_add_u32 s77, s6, s11
    buffer_load_dwordx4 v[224:227], v118, s[28:31], s77 offen sc1
    s_add_u32 s78, s6, s12
    buffer_load_dwordx4 v[228:231], v118, s[28:31], s78 offen sc1
    s_add_u32 s77, s6, s13
    buffer_load_dwordx4 v[232:235], v118, s[28:31], s77 offen sc1
    s_add_u32 s78, s6, s14
    buffer_load_dwordx4 v[236:239], v118, s[28:31], s78 offen sc1
L_e3_done:
    s_mov_b32 s93, 60000
L_sw6:
    v_subrev_u32 v56, s65, v120
    v_cmp_ne_u32 s[4:5], s95, v121
    v_cmp_lt_u32 vcc, 7, v56
    s_nop 0
    s_or_b64 vcc, vcc, s[4:5]
    s_cbranch_scc1 L_sw6_retry
L_sw6_done:
    s_add_u32 s78, s7, s8
    buffer_load_dwordx4 v[68:71], v14, s[28:31], s78 offen sc1
    s_add_u32 s77, s7, s9
    buffer_load_dwordx4 v[72:75], v14, s[28:31], s77 offen sc1
    s_add_u32 s78, s7, s10
    buffer_load_dwordx4 v[76:79], v14, s[28:31], s78 offen sc1
    s_add_u32 s77, s7, s11
    buffer_load_dwordx4 v[80:83], v14, s[28:31], s77 offen sc1
    s_add_u32 s78, s7, s12
    buffer_load_dwordx4 v[84:87], v14, s[28:31], s78 offen sc1
    s_add_u32 s77, s7, s13
    buffer_load_dwordx4 v[88:91], v14, s[28:31], s77 offen sc1
    s_add_u32 s78, s7, s14
    buffer_load_dwordx4 v[92:95], v14, s[28:31], s78 offen sc1
    s_waitcnt vmcnt(12)
    v_dot2c_f32_bf16 v128, s70, v212
    v_dot2c_f32_bf16 v129, s71, v212
    v_dot2c_f32_bf16 v130, s70, v213
    v_dot2c_f32_bf16 v131, s71, v213
    v_dot2c_f32_bf16 v132, s70, v214
    v_dot2c_f32_bf16 v133, s71, v214
    v_dot2c_f32_bf16 v134, s70, v215
    v_dot2c_f32_bf16 v135, s71, v215
    v_dot2c_f32_bf16 v128, s70, v216
    v_dot2c_f32_bf16 v129, s71, v216
    v_dot2c_f32_bf16 v130, s70, v217
    v_dot2c_f32_bf16 v131, s71, v217
    v_dot2c_f32_bf16 v132, s70, v218
    v_dot2c_f32_bf16 v133, s71, v218
    v_dot2c_f32_bf16 v134, s70, v219
    v_dot2c_f32_bf16 v135, s71, v219
    s_waitcnt vmcnt(10)
    v_dot2c_f32_bf16 v128, s70, v220
    v_dot2c_f32_bf16 v129, s71, v220
    v_dot2c_f32_bf16 v130, s70, v221
    v_dot2c_f32_bf16 v131, s71, v221
    v_dot2c_f32_bf16 v132, s70, v222
    v_dot2c_f32_bf16 v133, s71, v222
    v_dot2c_f32_bf16 v134, s70, v223
    v_dot2c_f32_bf16 v135, s71, v223
    v_dot2c_f32_bf16 v128, s70, v224
    v_dot2c_f32_bf16 v129, s71, v224
    v_dot2c_f32_bf16 v130, s70, v225
    v_dot2c_f32_bf16 v131, s71, v225
    v_dot2c_f32_bf16 v132, s70, v226
    v_dot2c_f32_bf16 v133, s71, v226
    v_dot2c_f32_bf16 v134, s70, v227
    v_dot2c_f32_bf16 v135, s71, v227
    s_waitcnt vmcnt(8)
    v_dot2c_f32_bf16 v128, s70, v228
    v_dot2c_f32_bf16 v129, s71, v228
    v_dot2c_f32_bf16 v130, s70, v229
    v_dot2c_f32_bf16 v131, s71, v229
    v_dot2c_f32_bf16 v132, s70, v230
    v_dot2c_f32_bf16 v133, s71, v230
    v_dot2c_f32_bf16 v134, s70, v231
    v_dot2c_f32_bf16 v135, s71, v231
    v_dot2c_f32_bf16 v128, s70, v232
    v_dot2c_f32_bf16 v129, s71, v232
    v_dot2c_f32_bf16 v130, s70, v233
    v_dot2c_f32_bf16 v131, s71, v233
    v_dot2c_f32_bf16 v132, s70, v234
    v_dot2c_f32_bf16 v133, s71, v234
    v_dot2c_f32_bf16 v134, s70, v235
    v_dot2c_f32_bf16 v135, s71, v235
    s_waitcnt vmcnt(7)
    v_dot2c_f32_bf16 v128, s70, v236
    v_dot2c_f32_bf16 v129, s71, v236
    v_dot2c_f32_bf16 v130, s70, v237
    v_dot2c_f32_bf16 v131, s71, v237
    v_dot2c_f32_bf16 v132, s70, v238
    v_dot2c_f32_bf16 v133, s71, v238
    v_dot2c_f32_bf16 v134, s70, v239
    v_dot2c_f32_bf16 v135, s71, v239
    v_pk_fma_f32 v[128:129], v[128:129], v[160:161], v[176:177]
    v_pk_fma_f32 v[130:131], v[130:131], v[162:163], v[178:179]
    v_pk_fma_f32 v[132:133], v[132:133], v[164:165], v[180:181]
    v_pk_fma_f32 v[134:135], v[134:135], v[166:167], v[182:183]
    v_cvt_pk_bf16_f32 v48, v128, v129
    v_cvt_pk_bf16_f32 v49, v130, v131
    v_cvt_pk_bf16_f32 v50, v132, v133
    v_cvt_pk_bf16_f32 v51, v134, v135
    buffer_store_dwordx4 v[48:51], v104, s[56:59], s96 offen
    s_waitcnt vmcnt(6)
    v_dot2c_f32_bf16 v136, s70, v68
    v_dot2c_f32_bf16 v137, s71, v68
    v_dot2c_f32_bf16 v138, s70, v69
    v_dot2c_f32_bf16 v139, s71, v69
    v_dot2c_f32_bf16 v140, s70, v70
    v_dot2c_f32_bf16 v141, s71, v70
    v_dot2c_f32_bf16 v142, s70, v71
    v_dot2c_f32_bf16 v143, s71, v71
    v_dot2c_f32_bf16 v136, s70, v72
    v_dot2c_f32_bf16 v137, s71, v72
    v_dot2c_f32_bf16 v138, s70, v73
    v_dot2c_f32_bf16 v139, s71, v73
    v_dot2c_f32_bf16 v140, s70, v74
    v_dot2c_f32_bf16 v141, s71, v74
    v_dot2c_f32_bf16 v142, s70, v75
    v_dot2c_f32_bf16 v143, s71, v75
    s_waitcnt vmcnt(4)
    v_dot2c_f32_bf16 v136, s70, v76
    v_dot2c_f32_bf16 v137, s71, v76
    v_dot2c_f32_bf16 v138, s70, v77
    v_dot2c_f32_bf16 v139, s71, v77
    v_dot2c_f32_bf16 v140, s70, v78
    v_dot2c_f32_bf16 v141, s71, v78
    v_dot2c_f32_bf16 v142, s70, v79
    v_dot2c_f32_bf16 v143, s71, v79
    v_dot2c_f32_bf16 v136, s70, v80
    v_dot2c_f32_bf16 v137, s71, v80
    v_dot2c_f32_bf16 v138, s70, v81
    v_dot2c_f32_bf16 v139, s71, v81
    v_dot2c_f32_bf16 v140, s70, v82
    v_dot2c_f32_bf16 v141, s71, v82
    v_dot2c_f32_bf16 v142, s70, v83
    v_dot2c_f32_bf16 v143, s71, v83
    s_waitcnt vmcnt(2)
    v_dot2c_f32_bf16 v136, s70, v84
    v_dot2c_f32_bf16 v137, s71, v84
    v_dot2c_f32_bf16 v138, s70, v85
    v_dot2c_f32_bf16 v139, s71, v85
    v_dot2c_f32_bf16 v140, s70, v86
    v_dot2c_f32_bf16 v141, s71, v86
    v_dot2c_f32_bf16 v142, s70, v87
    v_dot2c_f32_bf16 v143, s71, v87
    v_dot2c_f32_bf16 v136, s70, v88
    v_dot2c_f32_bf16 v137, s71, v88
    v_dot2c_f32_bf16 v138, s70, v89
    v_dot2c_f32_bf16 v139, s71, v89
    v_dot2c_f32_bf16 v140, s70, v90
    v_dot2c_f32_bf16 v141, s71, v90
    v_dot2c_f32_bf16 v142, s70, v91
    v_dot2c_f32_bf16 v143, s71, v91
    s_waitcnt vmcnt(1)
    v_dot2c_f32_bf16 v136, s70, v92
    v_dot2c_f32_bf16 v137, s71, v92
    v_dot2c_f32_bf16 v138, s70, v93
    v_dot2c_f32_bf16 v139, s71, v93
    v_dot2c_f32_bf16 v140, s70, v94
    v_dot2c_f32_bf16 v141, s71, v94
    v_dot2c_f32_bf16 v142, s70, v95
    v_dot2c_f32_bf16 v143, s71, v95
    v_pk_fma_f32 v[136:137], v[136:137], v[168:169], v[184:185]
    v_pk_fma_f32 v[138:139], v[138:139], v[170:171], v[186:187]
    v_pk_fma_f32 v[140:141], v[140:141], v[172:173], v[188:189]
    v_pk_fma_f32 v[142:143], v[142:143], v[174:175], v[190:191]
    v_cvt_pk_bf16_f32 v52, v136, v137
    v_cvt_pk_bf16_f32 v53, v138, v139
    v_cvt_pk_bf16_f32 v54, v140, v141
    v_cvt_pk_bf16_f32 v55, v142, v143
    buffer_store_dwordx4 v[52:55], v105, s[56:59], s96 offen offset:384
L_end:
    s_endpgm
L_non1_retry:
    s_mov_b32 s93, 60000
L_non1:
    buffer_load_dwordx2 v[56:57], v59, s[32:35], 0 offen sc1
    s_waitcnt vmcnt(0)
    v_readfirstlane_b32 s94, v56
    v_readfirstlane_b32 s95, v57
    s_cmp_lg_u32 s94, 0
    s_cbranch_scc1 L_non1_done
    s_sub_u32 s93, s93, 1
    s_cbranch_scc0 L_non1
    s_branch L_non1_done
L_non2_retry:
    s_mov_b32 s93, 60000
L_non2:
    buffer_load_dwordx2 v[56:57], v59, s[32:35], 0 offen sc1
    s_waitcnt vmcnt(0)
    v_readfirstlane_b32 s94, v56
    v_readfirstlane_b32 s95, v57
    s_cmp_lg_u32 s94, 0
    s_cbranch_scc1 L_non2_done
    s_sub_u32 s93, s93, 1
    s_cbranch_scc0 L_non2
    s_branch L_non2_done
L_gran_retry:
    s_sub_u32 s93, s93, 1
    s_cbranch_scc1 L_gran_done
    buffer_load_dwordx4 v[32:35], v52, s[28:31], s96 offen sc1
    s_waitcnt vmcnt(0)
    s_branch L_gran
L_tg_retry:
    s_sub_u32 s93, s93, 1
    s_cbranch_scc1 L_tg_done
    buffer_load_dwordx4 v[28:31], v52, s[28:31], s64 offen sc1
    buffer_load_dwordx4 v[124:127], v52, s[28:31], s64 offen offset:16 sc1
    buffer_load_dwordx4 v[32:35], off, s[28:31], s67 sc1
    s_waitcnt vmcnt(0)
    s_branch L_tg
L_hc_c1_retry:
    s_mov_b32 s93, 60000
    s_mov_b32 s67, m0
L_hc_c1_loop:
    s_add_u32 s4, s101, 4096
    s_add_u32 m0, s6, 16384
    s_nop 0
    buffer_load_dwordx4 v27, s[28:31], s4 offen sc1 lds
    s_add_u32 s4, s101, 5120
    s_add_u32 m0, s6, 20480
    s_nop 0
    buffer_load_dwordx4 v27, s[28:31], s4 offen sc1 lds
    s_add_u32 s4, s101, 6144
    s_add_u32 m0, s6, 24576
    s_nop 0
    buffer_load_dwordx4 v27, s[28:31], s4 offen sc1 lds
    s_add_u32 s4, s101, 7168
    s_add_u32 m0, s6, 28672
    s_nop 0
    buffer_load_dwordx4 v27, s[28:31], s4 offen sc1 lds
    s_add_u32 s4, s101, 16384
    s_add_u32 m0, s6, 32768
    s_nop 0
    buffer_load_dwordx4 v27, s[28:31], s4 offen sc1 lds
    s_waitcnt vmcnt(0)
    ds_read_b128 v[32:35], v7 offset:16384
    ds_read_b128 v[36:39], v7 offset:20480
    ds_read_b128 v[40:43], v7 offset:24576
    ds_read_b128 v[44:47], v7 offset:28672
    ds_read_b128 v[48:51], v7 offset:32768
    s_waitcnt lgkmcnt(0)
    v_max3_u32 v32, v32, v33, v34
    v_max3_u32 v32, v32, v35, v36
    v_max3_u32 v32, v32, v37, v38
    v_max3_u32 v32, v32, v39, v40
    v_max3_u32 v32, v32, v41, v42
    v_max3_u32 v32, v32, v43, v44
    v_max3_u32 v32, v32, v45, v46
    v_max3_u32 v32, v32, v47, v48
    v_max3_u32 v32, v32, v49, v50
    v_max_u32 v32, v32, v51
    v_cmp_eq_u32 vcc, -1, v32
    s_mov_b32 m0, s67
    s_cbranch_vccz L_hc_c1_done
    s_sub_u32 s93, s93, 1
    s_cbranch_scc0 L_hc_c1_loop
    s_branch L_hc_c1_done
L_hc_c2_retry:
    s_mov_b32 s93, 60000
    s_mov_b32 s67, m0
L_hc_c2_loop:
    s_add_u32 s4, s101, 17408
    s_add_u32 m0, s6, 36864
    s_nop 0
    buffer_load_dwordx4 v27, s[28:31], s4 offen sc1 lds
    s_add_u32 s4, s101, 18432
    s_add_u32 m0, s6, 40960
    s_nop 0
    buffer_load_dwordx4 v27, s[28:31], s4 offen sc1 lds
    s_add_u32 s4, s101, 19456
    s_add_u32 m0, s6, 45056
    s_nop 0
    buffer_load_dwordx4 v27, s[28:31], s4 offen sc1 lds
    s_add_u32 s4, s101, 20480
    s_add_u32 m0, s6, 49152
    s_nop 0
    buffer_load_dwordx4 v27, s[28:31], s4 offen sc1 lds
    s_add_u32 s4, s101, 21504
    s_add_u32 m0, s6, 53248
    s_nop 0
    buffer_load_dwordx4 v27, s[28:31], s4 offen sc1 lds
    s_waitcnt vmcnt(0)
    ds_read_b128 v[32:35], v7 offset:36864
    ds_read_b128 v[36:39], v7 offset:40960
    ds_read_b128 v[40:43], v7 offset:45056
    ds_read_b128 v[44:47], v7 offset:49152
    ds_read_b128 v[48:51], v7 offset:53248
    s_waitcnt lgkmcnt(0)
    v_max3_u32 v32, v32, v33, v34
    v_max3_u32 v32, v32, v35, v36
    v_max3_u32 v32, v32, v37, v38
    v_max3_u32 v32, v32, v39, v40
    v_max3_u32 v32, v32, v41, v42
    v_max3_u32 v32, v32, v43, v44
    v_max3_u32 v32, v32, v45, v46
    v_max3_u32 v32, v32, v47, v48
    v_max3_u32 v32, v32, v49, v50
    v_max_u32 v32, v32, v51
    v_cmp_eq_u32 vcc, -1, v32
    s_mov_b32 m0, s67
    s_cbranch_vccz L_hc_c2_done
    s_sub_u32 s93, s93, 1
    s_cbranch_scc0 L_hc_c2_loop
    s_branch L_hc_c2_done
L_e_late:
    buffer_load_dwordx2 v[120:121], v119, s[28:31], s61 offen sc1
    s_waitcnt vmcnt(0)
    s_mov_b32 s93, 60000
L_sw3:
    v_subrev_u32 v56, s64, v120
    v_cmp_ne_u32 s[4:5], s95, v121
    v_cmp_lt_u32 vcc, 7, v56
    s_nop 0
    s_or_b64 vcc, vcc, s[4:5]
    s_cbranch_scc1 L_sw3_retry
L_sw3_done:
    s_add_u32 s78, s6, s8
    buffer_load_dwordx4 v[236:239], v118, s[28:31], s78 offen sc1
    s_add_u32 s77, s6, s9
    buffer_load_dwordx4 v[244:247], v118, s[28:31], s77 offen sc1
    s_add_u32 s78, s6, s10
    buffer_load_dwordx4 v[252:255], v118, s[28:31], s78 offen sc1
    s_add_u32 s77, s6, s11
    buffer_load_dwordx4 v[32:35], v118, s[28:31], s77 offen sc1
    s_add_u32 s78, s6, s12
    buffer_load_dwordx4 v[36:39], v118, s[28:31], s78 offen sc1
    s_add_u32 s77, s6, s13
    buffer_load_dwordx4 v[40:43], v118, s[28:31], s77 offen sc1
    s_add_u32 s78, s6, s14
    buffer_load_dwordx4 v[44:47], v118, s[28:31], s78 offen sc1
    buffer_load_dwordx2 v[120:121], v125, s[28:31], s61 offen sc1
    s_waitcnt vmcnt(0)
    s_branch L_e_done
L_sw3_retry:
    s_sub_u32 s93, s93, 1
    s_cbranch_scc1 L_sw3_done
    buffer_load_dwordx2 v[120:121], v119, s[28:31], s61 offen sc1
    s_waitcnt vmcnt(0)
    s_branch L_sw3
L_sw4_retry:
    s_sub_u32 s93, s93, 1
    s_cbranch_scc1 L_sw4_done
    buffer_load_dwordx2 v[120:121], v125, s[28:31], s61 offen sc1
    s_waitcnt vmcnt(0)
    s_branch L_sw4
L_hc_c0_retry:
    s_mov_b32 s93, 60000
    s_mov_b32 s67, m0
L_hc_c0_loop:
    s_add_u32 s4, s101, 0
    s_add_u32 m0, s6, 0
    s_nop 0
    buffer_load_dwordx4 v27, s[28:31], s4 offen sc1 lds
    s_add_u32 s4, s101, 1024
    s_add_u32 m0, s6, 4096
    s_nop 0
    buffer_load_dwordx4 v27, s[28:31], s4 offen sc1 lds
    s_add_u32 s4, s101, 2048
    s_add_u32 m0, s6, 8192
    s_nop 0
    buffer_load_dwordx4 v27, s[28:31], s4 offen sc1 lds
    s_add_u32 s4, s101, 3072
    s_add_u32 m0, s6, 12288
    s_nop 0
    buffer_load_dwordx4 v27, s[28:31], s4 offen sc1 lds
    s_waitcnt vmcnt(0)
    ds_read_b128 v[32:35], v7 offset:0
    ds_read_b128 v[36:39], v7 offset:4096
    ds_read_b128 v[40:43], v7 offset:8192
    ds_read_b128 v[44:47], v7 offset:12288
    s_waitcnt lgkmcnt(0)
    v_max3_u32 v32, v32, v33, v34
    v_max3_u32 v32, v32, v35, v36
    v_max3_u32 v32, v32, v37, v38
    v_max3_u32 v32, v32, v39, v40
    v_max3_u32 v32, v32, v41, v42
    v_max3_u32 v32, v32, v43, v44
    v_max3_u32 v32, v32, v45, v46
    v_max_u32 v32, v32, v47
    v_cmp_eq_u32 vcc, -1, v32
    s_mov_b32 m0, s67
    s_cbranch_vccz L_hc_c0_done
    s_sub_u32 s93, s93, 1
    s_cbranch_scc0 L_hc_c0_loop
    s_branch L_hc_c0_done
L_sw5_retry:
    s_sub_u32 s93, s93, 1
    s_cbranch_scc1 L_sw5_done
    buffer_load_dwordx2 v[120:121], v119, s[28:31], s61 offen sc1
    s_waitcnt vmcnt(0)
    s_branch L_sw5
L_sw6_retry:
    s_sub_u32 s93, s93, 1
    s_cbranch_scc1 L_sw6_done
    buffer_load_dwordx2 v[120:121], v125, s[28:31], s61 offen sc1
    s_waitcnt vmcnt(0)
    s_branch L_sw6
L_fast_end:
L_slow:
    s_waitcnt vmcnt(0) lgkmcnt(0)
    s_barrier
    s_nop 7
    s_add_u32 s77, s75, 0
    s_add_u32 m0, s73, 67584
    s_nop 0
    buffer_load_dwordx4 v19, s[12:15], s77 offen lds
    buffer_load_dwordx4 v20, s[12:15], s77 offen offset:1056 lds
    buffer_load_dwordx4 v21, s[12:15], s77 offen offset:2112 lds
    buffer_load_dwordx4 v22, s[12:15], s77 offen offset:3168 lds
    s_add_u32 s78, s75, 16384
    s_add_u32 m0, s73, 84480
    s_nop 0
    buffer_load_dwordx4 v19, s[12:15], s78 offen lds
    buffer_load_dwordx4 v20, s[12:15], s78 offen offset:1056 lds
    buffer_load_dwordx4 v21, s[12:15], s78 offen offset:2112 lds
    buffer_load_dwordx4 v22, s[12:15], s78 offen offset:3168 lds
    s_add_u32 s77, s75, 32768
    s_add_u32 m0, s73, 101376
    s_nop 0
    buffer_load_dwordx4 v19, s[12:15], s77 offen lds
    buffer_load_dwordx4 v20, s[12:15], s77 offen offset:1056 lds
    buffer_load_dwordx4 v21, s[12:15], s77 offen offset:2112 lds
    buffer_load_dwordx4 v22, s[12:15], s77 offen offset:3168 lds
    s_add_u32 s78, s75, 0
    s_add_u32 m0, s73, 118272
    s_nop 0
    buffer_load_dwordx4 v19, s[16:19], s78 offen lds
    buffer_load_dwordx4 v20, s[16:19], s78 offen offset:1056 lds
    buffer_load_dwordx4 v21, s[16:19], s78 offen offset:2112 lds
    buffer_load_dwordx4 v22, s[16:19], s78 offen offset:3168 lds
    v_and_b32 v48, 15, v0
    v_lshrrev_b32 v49, 4, v0
    v_lshlrev_b32 v48, 9, v48
    v_lshl_add_u32 v48, v49, 4, v48
    v_add_u32 v48, 2048, v48
    v_mov_b32 v50, 0xff800000
    v_mov_b32 v51, 0xff800000
    s_mov_b32 s3, 0
L_maxloop:
    buffer_load_dwordx4 v[128:131], v48, s[12:15], s3 offen offset:0
    buffer_load_dwordx4 v[132:135], v48, s[12:15], s3 offen offset:64
    buffer_load_dwordx4 v[136:139], v48, s[12:15], s3 offen offset:128
    buffer_load_dwordx4 v[140:143], v48, s[12:15], s3 offen offset:192
    buffer_load_dwordx4 v[144:147], v48, s[12:15], s3 offen offset:256
    buffer_load_dwordx4 v[148:151], v48, s[12:15], s3 offen offset:320
    buffer_load_dwordx4 v[152:155], v48, s[12:15], s3 offen offset:384
    buffer_load_dwordx4 v[156:159], v48, s[12:15], s3 offen offset:448
    s_waitcnt vmcnt(0)
    v_mfma_f32_16x16x32_bf16 v[64:67], v[128:131], a[64:67], 0
    v_mfma_f32_16x16x32_bf16 v[68:71], v[128:131], a[68:71], 0
    v_mfma_f32_16x16x32_bf16 v[64:67], v[132:135], a[72:75], v[64:67]
    v_mfma_f32_16x16x32_bf16 v[68:71], v[132:135], a[76:79], v[68:71]
    v_mfma_f32_16x16x32_bf16 v[64:67], v[136:139], a[80:83], v[64:67]
    v_mfma_f32_16x16x32_bf16 v[68:71], v[136:139], a[84:87], v[68:71]
    v_mfma_f32_16x16x32_bf16 v[64:67], v[140:143], a[88:91], v[64:67]
    v_mfma_f32_16x16x32_bf16 v[68:71], v[140:143], a[92:95], v[68:71]
    v_mfma_f32_16x16x32_bf16 v[64:67], v[144:147], a[96:99], v[64:67]
    v_mfma_f32_16x16x32_bf16 v[68:71], v[144:147], a[100:103], v[68:71]
    v_mfma_f32_16x16x32_bf16 v[64:67], v[148:151], a[104:107], v[64:67]
    v_mfma_f32_16x16x32_bf16 v[68:71], v[148:151], a[108:111], v[68:71]
    v_mfma_f32_16x16x32_bf16 v[64:67], v[152:155], a[112:115], v[64:67]
    v_mfma_f32_16x16x32_bf16 v[68:71], v[152:155], a[116:119], v[68:71]
    v_mfma_f32_16x16x32_bf16 v[64:67], v[156:159], a[120:123], v[64:67]
    v_mfma_f32_16x16x32_bf16 v[68:71], v[156:159], a[124:127], v[68:71]
    s_nop 7
    v_max3_f32 v50, v50, v64, v65
    v_max3_f32 v50, v50, v66, v67
    v_max3_f32 v51, v51, v68, v69
    v_max3_f32 v51, v51, v70, v71
    s_add_u32 s3, s3, 8192
    s_cmp_lt_u32 s3, 262144
    s_cbranch_scc1 L_maxloop
    v_mov_b32 v52, v50
    v_mov_b32 v53, v51
    s_nop 0
    v_permlane16_swap_b32 v50, v52
    v_permlane16_swap_b32 v51, v53
    v_max_f32 v50, v50, v52
    v_max_f32 v51, v51, v53
    v_mov_b32 v52, v50
    v_mov_b32 v53, v51
    s_nop 0
    v_permlane32_swap_b32 v50, v52
    v_permlane32_swap_b32 v51, v53
    v_max_f32 v50, v50, v52
    v_max_f32 v51, v51, v53
    v_sub_f32 v112, 0xc2400000, v50
    v_sub_f32 v113, 0xc2400000, v50
    v_sub_f32 v114, 0xc2400000, v50
    v_sub_f32 v115, 0xc2400000, v50
    v_sub_f32 v116, 0xc2400000, v51
    v_sub_f32 v117, 0xc2400000, v51
    v_sub_f32 v118, 0xc2400000, v51
    v_sub_f32 v119, 0xc2400000, v51
    s_barrier
    ds_read_b128 a[0:3], v5 offset:0
    ds_read_b128 a[4:7], v5 offset:64
    s_waitcnt lgkmcnt(1)
    v_mfma_f32_16x16x32_bf16 v[64:67], a[0:3], a[64:67], v[112:115]
    s_waitcnt lgkmcnt(0)
    ds_read_b128 a[8:11], v5 offset:128
    ds_read_b128 a[12:15], v5 offset:192
    v_mfma_f32_16x16x32_bf16 v[64:67], a[4:7], a[72:75], v[64:67]
    s_waitcnt lgkmcnt(1)
    ds_read_b128 a[16:19], v5 offset:256
    ds_read_b128 a[20:23], v5 offset:320
    v_mfma_f32_16x16x32_bf16 v[64:67], a[8:11], a[80:83], v[64:67]
    s_waitcnt lgkmcnt(2)
    ds_read_b128 a[24:27], v5 offset:384
    v_mfma_f32_16x16x32_bf16 v[64:67], a[12:15], a[88:91], v[64:67]
    s_add_u32 s77, s75, 49152
    ds_read_b128 a[28:31], v5 offset:448
    v_mfma_f32_16x16x32_bf16 v[72:75], a[12:15], a[92:95], v[116:119]
    s_add_u32 m0, s73, 0
    s_nop 0
    buffer_load_dwordx4 v19, s[12:15], s77 offen lds
    v_mfma_f32_16x16x32_bf16 v[72:75], a[8:11], a[84:87], v[72:75]
    v_mfma_f32_16x16x32_bf16 v[72:75], a[4:7], a[76:79], v[72:75]
    v_mfma_f32_16x16x32_bf16 v[72:75], a[0:3], a[68:71], v[72:75]
    s_waitcnt lgkmcnt(3)
    ds_read_b128 a[32:35], v5 offset:512
    v_mfma_f32_16x16x32_bf16 v[72:75], a[16:19], a[100:103], v[72:75]
    s_waitcnt lgkmcnt(3)
    ds_read_b128 a[36:39], v5 offset:576
    v_mfma_f32_16x16x32_bf16 v[72:75], a[20:23], a[108:111], v[72:75]
    s_waitcnt lgkmcnt(3)
    ds_read_b128 a[40:43], v5 offset:640
    v_mfma_f32_16x16x32_bf16 v[72:75], a[24:27], a[116:119], v[72:75]
    s_waitcnt lgkmcnt(3)
    buffer_load_dwordx4 v20, s[12:15], s77 offen offset:1056 lds
    v_mfma_f32_16x16x32_bf16 v[72:75], a[28:31], a[124:127], v[72:75]
    ds_read_b128 a[44:47], v5 offset:704
    v_mfma_f32_16x16x32_bf16 v[64:67], a[28:31], a[120:123], v[64:67]
    v_mfma_f32_16x16x32_bf16 v[64:67], a[24:27], a[112:115], v[64:67]
    v_mfma_f32_16x16x32_bf16 v[64:67], a[20:23], a[104:107], v[64:67]
    v_mfma_f32_16x16x32_bf16 v[64:67], a[16:19], a[96:99], v[64:67]
    s_waitcnt lgkmcnt(3)
    ds_read_b128 a[48:51], v5 offset:768
    v_mfma_f32_16x16x32_bf16 v[68:71], a[32:35], a[64:67], v[112:115]
    s_waitcnt lgkmcnt(3)
    buffer_load_dwordx4 v21, s[12:15], s77 offen offset:2112 lds
    v_mfma_f32_16x16x32_bf16 v[68:71], a[36:39], a[72:75], v[68:71]
    s_waitcnt lgkmcnt(2)
    ds_read_b128 a[52:55], v5 offset:832
    v_mfma_f32_16x16x32_bf16 v[68:71], a[40:43], a[80:83], v[68:71]
    s_waitcnt lgkmcnt(2)
    ds_read_b128 a[56:59], v5 offset:896
    v_mfma_f32_16x16x32_bf16 v[68:71], a[44:47], a[88:91], v[68:71]
    ds_read_b128 a[60:63], v5 offset:960
    v_mfma_f32_16x16x32_bf16 v[76:79], a[44:47], a[92:95], v[116:119]
    v_exp_f32 v64, v64
    v_mfma_f32_16x16x32_bf16 v[76:79], a[40:43], a[84:87], v[76:79]
    v_exp_f32 v65, v65
    v_mfma_f32_16x16x32_bf16 v[76:79], a[36:39], a[76:79], v[76:79]
    ds_read_b128 a[0:3], v5 offset:16896
    v_mfma_f32_16x16x32_bf16 v[76:79], a[32:35], a[68:71], v[76:79]
    s_waitcnt lgkmcnt(4)
    buffer_load_dwordx4 v22, s[12:15], s77 offen offset:3168 lds
    v_mfma_f32_16x16x32_bf16 v[76:79], a[48:51], a[100:103], v[76:79]
    s_waitcnt lgkmcnt(3)
    v_exp_f32 v66, v66
    v_mfma_f32_16x16x32_bf16 v[76:79], a[52:55], a[108:111], v[76:79]
    s_waitcnt lgkmcnt(2)
    ds_read_b128 a[4:7], v5 offset:16960
    ds_read_b128 a[8:11], v5 offset:17024
    v_mfma_f32_16x16x32_bf16 v[76:79], a[56:59], a[116:119], v[76:79]
    s_waitcnt lgkmcnt(3)
    v_exp_f32 v67, v67
    v_mfma_f32_16x16x32_bf16 v[76:79], a[60:63], a[124:127], v[76:79]
    s_add_u32 s78, s75, 16384
    ds_read_b128 a[12:15], v5 offset:17088
    v_cvt_pk_bf16_f32 v96, v64, v65
    v_mfma_f32_16x16x32_bf16 v[68:71], a[60:63], a[120:123], v[68:71]
    s_add_u32 m0, s73, 16896
    ds_read_b128 a[16:19], v5 offset:17152
    v_cvt_pk_bf16_f32 v97, v66, v67
    v_mfma_f32_16x16x32_bf16 v[68:71], a[56:59], a[112:115], v[68:71]
    buffer_load_dwordx4 v19, s[16:19], s78 offen lds
    v_mfma_f32_16x16x32_bf16 v[68:71], a[52:55], a[104:107], v[68:71]
    ds_read_b128 a[20:23], v5 offset:17216
    v_mfma_f32_16x16x32_bf16 v[68:71], a[48:51], a[96:99], v[68:71]
    s_waitcnt lgkmcnt(5)
    v_exp_f32 v72, v72
    v_mfma_f32_16x16x32_bf16 v[80:83], a[0:3], a[64:67], v[112:115]
    s_waitcnt lgkmcnt(4)
    ds_read_b128 a[24:27], v5 offset:17280
    v_mfma_f32_16x16x32_bf16 v[80:83], a[4:7], a[72:75], v[80:83]
    s_waitcnt lgkmcnt(4)
    v_exp_f32 v73, v73
    v_mfma_f32_16x16x32_bf16 v[80:83], a[8:11], a[80:83], v[80:83]
    s_waitcnt lgkmcnt(3)
    ds_read_b128 a[28:31], v5 offset:17344
    ds_read_b128 a[32:35], v5 offset:17408
    v_mfma_f32_16x16x32_bf16 v[80:83], a[12:15], a[88:91], v[80:83]
    v_exp_f32 v74, v74
    v_mfma_f32_16x16x32_bf16 v[88:91], a[12:15], a[92:95], v[116:119]
    ds_read_b128 a[36:39], v5 offset:17472
    v_mfma_f32_16x16x32_bf16 v[88:91], a[8:11], a[84:87], v[88:91]
    buffer_load_dwordx4 v20, s[16:19], s78 offen offset:1056 lds
    v_exp_f32 v75, v75
    v_mfma_f32_16x16x32_bf16 v[88:91], a[4:7], a[76:79], v[88:91]
    ds_read_b128 a[40:43], v5 offset:17536
    ds_read_b128 a[44:47], v5 offset:17600
    v_mfma_f32_16x16x32_bf16 v[88:91], a[0:3], a[68:71], v[88:91]
    s_waitcnt lgkmcnt(6)
    ds_read_b128 a[48:51], v5 offset:17664
    v_cvt_pk_bf16_f32 v100, v72, v73
    v_mfma_f32_16x16x32_bf16 v[88:91], a[16:19], a[100:103], v[88:91]
    ds_read_b128 a[52:55], v5 offset:17728
    v_cvt_pk_bf16_f32 v101, v74, v75
    v_mfma_f32_16x16x32_bf16 v[88:91], a[20:23], a[108:111], v[88:91]
    s_waitcnt lgkmcnt(7)
    v_exp_f32 v68, v68
    v_mfma_f32_16x16x32_bf16 v[88:91], a[24:27], a[116:119], v[88:91]
    s_waitcnt lgkmcnt(5)
    buffer_load_dwordx4 v21, s[16:19], s78 offen offset:2112 lds
    v_mfma_f32_16x16x32_bf16 v[88:91], a[28:31], a[124:127], v[88:91]
    ds_read_b128 a[56:59], v5 offset:17792
    v_mfma_f32_16x16x32_bf16 v[80:83], a[28:31], a[120:123], v[80:83]
    v_exp_f32 v69, v69
    v_mfma_f32_16x16x32_bf16 v[80:83], a[24:27], a[112:115], v[80:83]
    ds_read_b128 a[60:63], v5 offset:17856
    v_mfma_f32_16x16x32_bf16 v[80:83], a[20:23], a[104:107], v[80:83]
    v_exp_f32 v70, v70
    v_mfma_f32_16x16x32_bf16 v[80:83], a[16:19], a[96:99], v[80:83]
    v_exp_f32 v71, v71
    v_mfma_f32_16x16x32_bf16 v[84:87], a[32:35], a[64:67], v[112:115]
    s_waitcnt lgkmcnt(2)
    buffer_load_dwordx4 v22, s[16:19], s78 offen offset:3168 lds
    v_mfma_f32_16x16x32_bf16 v[84:87], a[36:39], a[72:75], v[84:87]
    v_cvt_pk_bf16_f32 v98, v68, v69
    v_cvt_pk_bf16_f32 v99, v70, v71
    v_mfma_f32_16x16x32_bf16 v[84:87], a[40:43], a[80:83], v[84:87]
    v_mfma_f32_16x16x32_bf16 v[84:87], a[44:47], a[88:91], v[84:87]
    s_waitcnt lgkmcnt(0)
    s_barrier
    ds_read_b128 a[0:3], v5 offset:33792
    v_mfma_f32_16x16x32_bf16 v[92:95], a[44:47], a[92:95], v[116:119]
    s_add_u32 s77, s75, 65536
    v_exp_f32 v76, v76
    v_mfma_f32_16x16x32_bf16 v[92:95], a[40:43], a[84:87], v[92:95]
    s_add_u32 m0, s73, 67584
    ds_read_b128 a[4:7], v5 offset:33856
    v_mfma_f32_16x16x32_bf16 v[92:95], a[36:39], a[76:79], v[92:95]
    ds_read_b128 a[8:11], v5 offset:33920
    v_mfma_f32_16x16x32_bf16 v[92:95], a[32:35], a[68:71], v[92:95]
    v_exp_f32 v77, v77
    v_mfma_f32_16x16x32_bf16 v[92:95], a[48:51], a[100:103], v[92:95]
    ds_read_b128 a[12:15], v5 offset:33984
    v_mfma_f32_16x16x32_bf16 v[92:95], a[52:55], a[108:111], v[92:95]
    v_exp_f32 v78, v78
    v_mfma_f32_16x16x32_bf16 v[92:95], a[56:59], a[116:119], v[92:95]
    ds_read_b128 a[16:19], v5 offset:34048
    ds_read_b128 a[20:23], v5 offset:34112
    v_mfma_f32_16x16x32_bf16 v[92:95], a[60:63], a[124:127], v[92:95]
    buffer_load_dwordx4 v19, s[12:15], s77 offen lds
    v_exp_f32 v79, v79
    v_mfma_f32_16x16x32_bf16 v[84:87], a[60:63], a[120:123], v[84:87]
    ds_read_b128 a[24:27], v5 offset:34176
    ds_read_b128 a[28:31], v5 offset:34240
    v_mfma_f32_16x16x32_bf16 v[84:87], a[56:59], a[112:115], v[84:87]
    ds_read_b64_tr_b16 a[32:33], v7 offset:50688
    v_cvt_pk_bf16_f32 v102, v76, v77
    v_mfma_f32_16x16x32_bf16 v[84:87], a[52:55], a[104:107], v[84:87]
    ds_read_b64_tr_b16 a[34:35], v7 offset:51200
    v_cvt_pk_bf16_f32 v103, v78, v79
    v_mfma_f32_16x16x32_bf16 v[84:87], a[48:51], a[96:99], v[84:87]
    s_waitcnt lgkmcnt(7)
    ds_read_b64_tr_b16 a[36:37], v7 offset:50720
    v_mfma_f32_16x16x32_bf16 v[64:67], a[0:3], a[64:67], v[112:115]
    ds_read_b64_tr_b16 a[38:39], v7 offset:51232
    v_mfma_f32_16x16x32_bf16 v[64:67], a[4:7], a[72:75], v[64:67]
    buffer_load_dwordx4 v20, s[12:15], s77 offen offset:1056 lds
    v_mfma_f32_16x16x32_bf16 v[64:67], a[8:11], a[80:83], v[64:67]
    s_waitcnt lgkmcnt(6)
    ds_read_b64_tr_b16 a[40:41], v7 offset:50752
    v_mfma_f32_16x16x32_bf16 v[64:67], a[12:15], a[88:91], v[64:67]
    ds_read_b64_tr_b16 a[42:43], v7 offset:51264
    v_mfma_f32_16x16x32_bf16 v[72:75], a[12:15], a[92:95], v[116:119]
    ds_read_b64_tr_b16 a[44:45], v7 offset:50784
    v_mfma_f32_16x16x32_bf16 v[72:75], a[8:11], a[84:87], v[72:75]
    ds_read_b64_tr_b16 a[46:47], v7 offset:51296
    v_mfma_f32_16x16x32_bf16 v[72:75], a[4:7], a[76:79], v[72:75]
    v_mfma_f32_16x16x32_bf16 v[72:75], a[0:3], a[68:71], v[72:75]
    ds_read_b64_tr_b16 a[48:49], v7 offset:50816
    v_mfma_f32_16x16x32_bf16 v[72:75], a[16:19], a[100:103], v[72:75]
    ds_read_b64_tr_b16 a[50:51], v7 offset:51328
    v_mfma_f32_16x16x32_bf16 v[72:75], a[20:23], a[108:111], v[72:75]
    s_waitcnt lgkmcnt(6)
    buffer_load_dwordx4 v21, s[12:15], s77 offen offset:2112 lds
    v_mfma_f32_16x16x32_bf16 v[72:75], a[24:27], a[116:119], v[72:75]
    ds_read_b64_tr_b16 a[52:53], v7 offset:50848
    v_mfma_f32_16x16x32_bf16 v[72:75], a[28:31], a[124:127], v[72:75]
    ds_read_b64_tr_b16 a[54:55], v7 offset:51360
    v_mfma_f32_16x16x32_bf16 v[64:67], a[28:31], a[120:123], v[64:67]
    ds_read_b64_tr_b16 a[56:57], v7 offset:50880
    v_mfma_f32_16x16x32_bf16 v[64:67], a[24:27], a[112:115], v[64:67]
    ds_read_b64_tr_b16 a[58:59], v7 offset:51392
    v_mfma_f32_16x16x32_bf16 v[64:67], a[20:23], a[104:107], v[64:67]
    ds_read_b64_tr_b16 a[60:61], v7 offset:50912
    v_mfma_f32_16x16x32_bf16 v[64:67], a[16:19], a[96:99], v[64:67]
    v_exp_f32 v80, v80
    v_mfma_f32_16x16x32_bf16 v[128:131], a[32:35], v[96:99], 0
    ds_read_b64_tr_b16 a[62:63], v7 offset:51424
    v_mfma_f32_16x16x32_bf16 v[136:139], a[32:35], v[100:103], 0
    buffer_load_dwordx4 v22, s[12:15], s77 offen offset:3168 lds
    v_mfma_f32_16x16x32_bf16 v[140:143], a[36:39], v[100:103], 0
    v_exp_f32 v81, v81
    v_mfma_f32_16x16x32_bf16 v[132:135], a[36:39], v[96:99], 0
    s_waitcnt lgkmcnt(4)
    ds_read_b128 a[0:3], v5 offset:34304
    ds_read_b128 a[4:7], v5 offset:34368
    v_mfma_f32_16x16x32_bf16 v[144:147], a[40:43], v[96:99], 0
    s_add_u32 s78, s75, 32768
    ds_read_b128 a[8:11], v5 offset:34432
    v_mfma_f32_16x16x32_bf16 v[152:155], a[40:43], v[100:103], 0
    s_add_u32 m0, s73, 84480
    v_exp_f32 v82, v82
    v_mfma_f32_16x16x32_bf16 v[156:159], a[44:47], v[100:103], 0
    ds_read_b128 a[12:15], v5 offset:34496
    v_mfma_f32_16x16x32_bf16 v[148:151], a[44:47], v[96:99], 0
    v_exp_f32 v83, v83
    v_mfma_f32_16x16x32_bf16 v[160:163], a[48:51], v[96:99], 0
    ds_read_b128 a[16:19], v5 offset:34560
    ds_read_b128 a[20:23], v5 offset:34624
    v_mfma_f32_16x16x32_bf16 v[168:171], a[48:51], v[100:103], 0
    ds_read_b128 a[24:27], v5 offset:34688
    v_cvt_pk_bf16_f32 v104, v80, v81
    v_mfma_f32_16x16x32_bf16 v[172:175], a[52:55], v[100:103], 0
    buffer_load_dwordx4 v19, s[16:19], s78 offen lds
    v_mfma_f32_16x16x32_bf16 v[164:167], a[52:55], v[96:99], 0
    s_waitcnt lgkmcnt(5)
    ds_read_b128 a[28:31], v5 offset:34752
    v_cvt_pk_bf16_f32 v105, v82, v83
    v_mfma_f32_16x16x32_bf16 v[176:179], a[56:59], v[96:99], 0
    v_exp_f32 v88, v88
    v_mfma_f32_16x16x32_bf16 v[184:187], a[56:59], v[100:103], 0
    ds_read_b64_tr_b16 a[32:33], v7 offset:50944
    ds_read_b64_tr_b16 a[34:35], v7 offset:51456
    v_mfma_f32_16x16x32_bf16 v[188:191], a[60:63], v[100:103], 0
    ds_read_b64_tr_b16 a[36:37], v7 offset:50976
    v_mfma_f32_16x16x32_bf16 v[180:183], a[60:63], v[96:99], 0
    v_exp_f32 v89, v89
    v_mfma_f32_16x16x32_bf16 a[240:243], a[248:251], v[96:99], 0
    ds_read_b64_tr_b16 a[38:39], v7 offset:51488
    v_mfma_f32_16x16x32_bf16 a[244:247], a[248:251], v[100:103], 0
    v_exp_f32 v90, v90
    v_mfma_f32_16x16x32_bf16 v[68:71], a[0:3], a[64:67], v[112:115]
    ds_read_b64_tr_b16 a[40:41], v7 offset:51008
    ds_read_b64_tr_b16 a[42:43], v7 offset:51520
    v_mfma_f32_16x16x32_bf16 v[68:71], a[4:7], a[72:75], v[68:71]
    s_waitcnt lgkmcnt(6)
    buffer_load_dwordx4 v20, s[16:19], s78 offen offset:1056 lds
    v_mfma_f32_16x16x32_bf16 v[68:71], a[8:11], a[80:83], v[68:71]
    ds_read_b64_tr_b16 a[44:45], v7 offset:51040
    ds_read_b64_tr_b16 a[46:47], v7 offset:51552
    v_exp_f32 v91, v91
    v_mfma_f32_16x16x32_bf16 v[68:71], a[12:15], a[88:91], v[68:71]
    ds_read_b64_tr_b16 a[48:49], v7 offset:51072
    v_cvt_pk_bf16_f32 v108, v88, v89
    v_mfma_f32_16x16x32_bf16 v[76:79], a[12:15], a[92:95], v[116:119]
    ds_read_b64_tr_b16 a[50:51], v7 offset:51584
    v_cvt_pk_bf16_f32 v109, v90, v91
    v_mfma_f32_16x16x32_bf16 v[76:79], a[8:11], a[84:87], v[76:79]
    ds_read_b64_tr_b16 a[52:53], v7 offset:51104
    v_mfma_f32_16x16x32_bf16 v[76:79], a[4:7], a[76:79], v[76:79]
    v_exp_f32 v84, v84
    v_mfma_f32_16x16x32_bf16 v[76:79], a[0:3], a[68:71], v[76:79]
    ds_read_b64_tr_b16 a[54:55], v7 offset:51616
    v_mfma_f32_16x16x32_bf16 v[76:79], a[16:19], a[100:103], v[76:79]
    buffer_load_dwordx4 v21, s[16:19], s78 offen offset:2112 lds
    v_mfma_f32_16x16x32_bf16 v[76:79], a[20:23], a[108:111], v[76:79]
    v_exp_f32 v85, v85
    v_mfma_f32_16x16x32_bf16 v[76:79], a[24:27], a[116:119], v[76:79]
    ds_read_b64_tr_b16 a[56:57], v7 offset:51136
    ds_read_b64_tr_b16 a[58:59], v7 offset:51648
    v_mfma_f32_16x16x32_bf16 v[76:79], a[28:31], a[124:127], v[76:79]
    ds_read_b64_tr_b16 a[60:61], v7 offset:51168
    v_mfma_f32_16x16x32_bf16 v[68:71], a[28:31], a[120:123], v[68:71]
    v_exp_f32 v86, v86
    v_mfma_f32_16x16x32_bf16 v[68:71], a[24:27], a[112:115], v[68:71]
    ds_read_b64_tr_b16 a[62:63], v7 offset:51680
    v_mfma_f32_16x16x32_bf16 v[68:71], a[20:23], a[104:107], v[68:71]
    v_exp_f32 v87, v87
    v_mfma_f32_16x16x32_bf16 v[68:71], a[16:19], a[96:99], v[68:71]
    s_waitcnt lgkmcnt(4)
    buffer_load_dwordx4 v22, s[16:19], s78 offen offset:3168 lds
    v_mfma_f32_16x16x32_bf16 v[192:195], a[32:35], v[96:99], 0
    v_cvt_pk_bf16_f32 v106, v84, v85
    v_cvt_pk_bf16_f32 v107, v86, v87
    v_mfma_f32_16x16x32_bf16 v[200:203], a[32:35], v[100:103], 0
    v_exp_f32 v92, v92
    v_mfma_f32_16x16x32_bf16 v[204:207], a[36:39], v[100:103], 0
    v_mfma_f32_16x16x32_bf16 v[196:199], a[36:39], v[96:99], 0
    s_waitcnt vmcnt(8) lgkmcnt(0)
    s_barrier
    ds_read_b128 a[0:3], v4 offset:0
    v_mfma_f32_16x16x32_bf16 v[208:211], a[40:43], v[96:99], 0
    s_add_u32 s77, s75, 81920
    ds_read_b128 a[4:7], v4 offset:64
    v_mfma_f32_16x16x32_bf16 v[216:219], a[40:43], v[100:103], 0
    s_add_u32 m0, s73, 101376
    v_exp_f32 v93, v93
    v_mfma_f32_16x16x32_bf16 v[220:223], a[44:47], v[100:103], 0
    ds_read_b128 a[8:11], v4 offset:128
    v_mfma_f32_16x16x32_bf16 v[212:215], a[44:47], v[96:99], 0
    ds_read_b128 a[12:15], v4 offset:192
    v_mfma_f32_16x16x32_bf16 v[224:227], a[48:51], v[96:99], 0
    v_exp_f32 v94, v94
    v_mfma_f32_16x16x32_bf16 v[232:235], a[48:51], v[100:103], 0
    ds_read_b128 a[16:19], v4 offset:256
    v_mfma_f32_16x16x32_bf16 v[236:239], a[52:55], v[100:103], 0
    buffer_load_dwordx4 v19, s[12:15], s77 offen lds
    v_mfma_f32_16x16x32_bf16 v[228:231], a[52:55], v[96:99], 0
    ds_read_b128 a[20:23], v4 offset:320
    ds_read_b128 a[24:27], v4 offset:384
    v_exp_f32 v95, v95
    v_mfma_f32_16x16x32_bf16 v[240:243], a[56:59], v[96:99], 0
    ds_read_b128 a[28:31], v4 offset:448
    v_cvt_pk_bf16_f32 v110, v92, v93
    v_mfma_f32_16x16x32_bf16 v[248:251], a[56:59], v[100:103], 0
    ds_read_b64_tr_b16 a[32:33], v6 offset:16896
    v_cvt_pk_bf16_f32 v111, v94, v95
    v_mfma_f32_16x16x32_bf16 v[252:255], a[60:63], v[100:103], 0
    ds_read_b64_tr_b16 a[34:35], v6 offset:17408
    v_mfma_f32_16x16x32_bf16 v[244:247], a[60:63], v[96:99], 0
    s_waitcnt lgkmcnt(6)
    ds_read_b64_tr_b16 a[36:37], v6 offset:16928
    v_mfma_f32_16x16x32_bf16 v[80:83], a[0:3], a[64:67], v[112:115]
    ds_read_b64_tr_b16 a[38:39], v6 offset:17440
    v_mfma_f32_16x16x32_bf16 v[80:83], a[4:7], a[72:75], v[80:83]
    buffer_load_dwordx4 v20, s[12:15], s77 offen offset:1056 lds
    v_mfma_f32_16x16x32_bf16 v[80:83], a[8:11], a[80:83], v[80:83]
    ds_read_b64_tr_b16 a[40:41], v6 offset:16960
    v_mfma_f32_16x16x32_bf16 v[80:83], a[12:15], a[88:91], v[80:83]
    ds_read_b64_tr_b16 a[42:43], v6 offset:17472
    v_mfma_f32_16x16x32_bf16 v[88:91], a[12:15], a[92:95], v[116:119]
    ds_read_b64_tr_b16 a[44:45], v6 offset:16992
    v_mfma_f32_16x16x32_bf16 v[88:91], a[8:11], a[84:87], v[88:91]
    ds_read_b64_tr_b16 a[46:47], v6 offset:17504
    v_mfma_f32_16x16x32_bf16 v[88:91], a[4:7], a[76:79], v[88:91]
    v_mfma_f32_16x16x32_bf16 v[88:91], a[0:3], a[68:71], v[88:91]
    s_waitcnt lgkmcnt(5)
    ds_read_b64_tr_b16 a[48:49], v6 offset:17024
    v_mfma_f32_16x16x32_bf16 v[88:91], a[16:19], a[100:103], v[88:91]
    ds_read_b64_tr_b16 a[50:51], v6 offset:17536
    v_mfma_f32_16x16x32_bf16 v[88:91], a[20:23], a[108:111], v[88:91]
    buffer_load_dwordx4 v21, s[12:15], s77 offen offset:2112 lds
    v_mfma_f32_16x16x32_bf16 v[88:91], a[24:27], a[116:119], v[88:91]
    ds_read_b64_tr_b16 a[52:53], v6 offset:17056
    v_mfma_f32_16x16x32_bf16 v[88:91], a[28:31], a[124:127], v[88:91]
    ds_read_b64_tr_b16 a[54:55], v6 offset:17568
    v_mfma_f32_16x16x32_bf16 v[80:83], a[28:31], a[120:123], v[80:83]
    ds_read_b64_tr_b16 a[56:57], v6 offset:17088
    v_mfma_f32_16x16x32_bf16 v[80:83], a[24:27], a[112:115], v[80:83]
    ds_read_b64_tr_b16 a[58:59], v6 offset:17600
    v_mfma_f32_16x16x32_bf16 v[80:83], a[20:23], a[104:107], v[80:83]
    ds_read_b64_tr_b16 a[60:61], v6 offset:17120
    v_mfma_f32_16x16x32_bf16 v[80:83], a[16:19], a[96:99], v[80:83]
    v_exp_f32 v64, v64
    v_mfma_f32_16x16x32_bf16 v[128:131], a[32:35], v[104:107], v[128:131]
    ds_read_b64_tr_b16 a[62:63], v6 offset:17632
    v_mfma_f32_16x16x32_bf16 v[136:139], a[32:35], v[108:111], v[136:139]
    s_waitcnt lgkmcnt(6)
    buffer_load_dwordx4 v22, s[12:15], s77 offen offset:3168 lds
    v_mfma_f32_16x16x32_bf16 v[140:143], a[36:39], v[108:111], v[140:143]
    v_exp_f32 v65, v65
    v_mfma_f32_16x16x32_bf16 v[132:135], a[36:39], v[104:107], v[132:135]
    ds_read_b128 a[0:3], v4 offset:512
    ds_read_b128 a[4:7], v4 offset:576
    v_mfma_f32_16x16x32_bf16 v[144:147], a[40:43], v[104:107], v[144:147]
    s_add_u32 s78, s75, 49152
    ds_read_b128 a[8:11], v4 offset:640
    v_mfma_f32_16x16x32_bf16 v[152:155], a[40:43], v[108:111], v[152:155]
    s_add_u32 m0, s73, 118272
    v_exp_f32 v66, v66
    v_mfma_f32_16x16x32_bf16 v[156:159], a[44:47], v[108:111], v[156:159]
    ds_read_b128 a[12:15], v4 offset:704
    v_mfma_f32_16x16x32_bf16 v[148:151], a[44:47], v[104:107], v[148:151]
    v_exp_f32 v67, v67
    v_mfma_f32_16x16x32_bf16 v[160:163], a[48:51], v[104:107], v[160:163]
    ds_read_b128 a[16:19], v4 offset:768
    ds_read_b128 a[20:23], v4 offset:832
    v_mfma_f32_16x16x32_bf16 v[168:171], a[48:51], v[108:111], v[168:171]
    s_waitcnt lgkmcnt(6)
    ds_read_b128 a[24:27], v4 offset:896
    v_cvt_pk_bf16_f32 v96, v64, v65
    v_mfma_f32_16x16x32_bf16 v[172:175], a[52:55], v[108:111], v[172:175]
    buffer_load_dwordx4 v19, s[16:19], s78 offen lds
    v_mfma_f32_16x16x32_bf16 v[164:167], a[52:55], v[104:107], v[164:167]
    ds_read_b128 a[28:31], v4 offset:960
    v_cvt_pk_bf16_f32 v97, v66, v67
    v_mfma_f32_16x16x32_bf16 v[176:179], a[56:59], v[104:107], v[176:179]
    v_exp_f32 v72, v72
    v_mfma_f32_16x16x32_bf16 v[184:187], a[56:59], v[108:111], v[184:187]
    ds_read_b64_tr_b16 a[32:33], v6 offset:17152
    ds_read_b64_tr_b16 a[34:35], v6 offset:17664
    v_mfma_f32_16x16x32_bf16 v[188:191], a[60:63], v[108:111], v[188:191]
    ds_read_b64_tr_b16 a[36:37], v6 offset:17184
    v_mfma_f32_16x16x32_bf16 v[180:183], a[60:63], v[104:107], v[180:183]
    v_exp_f32 v73, v73
    v_mfma_f32_16x16x32_bf16 a[240:243], a[248:251], v[104:107], a[240:243]
    ds_read_b64_tr_b16 a[38:39], v6 offset:17696
    v_mfma_f32_16x16x32_bf16 a[244:247], a[248:251], v[108:111], a[244:247]
    s_waitcnt lgkmcnt(5)
    v_exp_f32 v74, v74
    v_mfma_f32_16x16x32_bf16 v[84:87], a[0:3], a[64:67], v[112:115]
    ds_read_b64_tr_b16 a[40:41], v6 offset:17216
    ds_read_b64_tr_b16 a[42:43], v6 offset:17728
    v_mfma_f32_16x16x32_bf16 v[84:87], a[4:7], a[72:75], v[84:87]
    buffer_load_dwordx4 v20, s[16:19], s78 offen offset:1056 lds
    v_mfma_f32_16x16x32_bf16 v[84:87], a[8:11], a[80:83], v[84:87]
    ds_read_b64_tr_b16 a[44:45], v6 offset:17248
    ds_read_b64_tr_b16 a[46:47], v6 offset:17760
    v_exp_f32 v75, v75
    v_mfma_f32_16x16x32_bf16 v[84:87], a[12:15], a[88:91], v[84:87]
    ds_read_b64_tr_b16 a[48:49], v6 offset:17280
    v_cvt_pk_bf16_f32 v100, v72, v73
    v_mfma_f32_16x16x32_bf16 v[92:95], a[12:15], a[92:95], v[116:119]
    ds_read_b64_tr_b16 a[50:51], v6 offset:17792
    v_cvt_pk_bf16_f32 v101, v74, v75
    v_mfma_f32_16x16x32_bf16 v[92:95], a[8:11], a[84:87], v[92:95]
    ds_read_b64_tr_b16 a[52:53], v6 offset:17312
    v_mfma_f32_16x16x32_bf16 v[92:95], a[4:7], a[76:79], v[92:95]
    v_exp_f32 v68, v68
    v_mfma_f32_16x16x32_bf16 v[92:95], a[0:3], a[68:71], v[92:95]
    ds_read_b64_tr_b16 a[54:55], v6 offset:17824
    v_mfma_f32_16x16x32_bf16 v[92:95], a[16:19], a[100:103], v[92:95]
    buffer_load_dwordx4 v21, s[16:19], s78 offen offset:2112 lds
    v_mfma_f32_16x16x32_bf16 v[92:95], a[20:23], a[108:111], v[92:95]
    v_exp_f32 v69, v69
    v_mfma_f32_16x16x32_bf16 v[92:95], a[24:27], a[116:119], v[92:95]
    s_waitcnt lgkmcnt(4)
    ds_read_b64_tr_b16 a[56:57], v6 offset:17344
    ds_read_b64_tr_b16 a[58:59], v6 offset:17856
    v_mfma_f32_16x16x32_bf16 v[92:95], a[28:31], a[124:127], v[92:95]
    ds_read_b64_tr_b16 a[60:61], v6 offset:17376
    v_mfma_f32_16x16x32_bf16 v[84:87], a[28:31], a[120:123], v[84:87]
    v_exp_f32 v70, v70
    v_mfma_f32_16x16x32_bf16 v[84:87], a[24:27], a[112:115], v[84:87]
    ds_read_b64_tr_b16 a[62:63], v6 offset:17888
    v_mfma_f32_16x16x32_bf16 v[84:87], a[20:23], a[104:107], v[84:87]
    v_exp_f32 v71, v71
    v_mfma_f32_16x16x32_bf16 v[84:87], a[16:19], a[96:99], v[84:87]
    buffer_load_dwordx4 v22, s[16:19], s78 offen offset:3168 lds
    v_mfma_f32_16x16x32_bf16 v[192:195], a[32:35], v[104:107], v[192:195]
    v_cvt_pk_bf16_f32 v98, v68, v69
    v_cvt_pk_bf16_f32 v99, v70, v71
    v_mfma_f32_16x16x32_bf16 v[200:203], a[32:35], v[108:111], v[200:203]
    v_exp_f32 v76, v76
    v_mfma_f32_16x16x32_bf16 v[204:207], a[36:39], v[108:111], v[204:207]
    v_mfma_f32_16x16x32_bf16 v[196:199], a[36:39], v[104:107], v[196:199]
    s_waitcnt vmcnt(8) lgkmcnt(0)
    s_barrier
    ds_read_b128 a[0:3], v5 offset:0
    v_mfma_f32_16x16x32_bf16 v[208:211], a[40:43], v[104:107], v[208:211]
    s_add_u32 s77, s75, 98304
    ds_read_b128 a[4:7], v5 offset:64
    v_mfma_f32_16x16x32_bf16 v[216:219], a[40:43], v[108:111], v[216:219]
    s_add_u32 m0, s73, 0
    v_exp_f32 v77, v77
    v_mfma_f32_16x16x32_bf16 v[220:223], a[44:47], v[108:111], v[220:223]
    ds_read_b128 a[8:11], v5 offset:128
    v_mfma_f32_16x16x32_bf16 v[212:215], a[44:47], v[104:107], v[212:215]
    ds_read_b128 a[12:15], v5 offset:192
    v_mfma_f32_16x16x32_bf16 v[224:227], a[48:51], v[104:107], v[224:227]
    v_exp_f32 v78, v78
    v_mfma_f32_16x16x32_bf16 v[232:235], a[48:51], v[108:111], v[232:235]
    ds_read_b128 a[16:19], v5 offset:256
    v_mfma_f32_16x16x32_bf16 v[236:239], a[52:55], v[108:111], v[236:239]
    buffer_load_dwordx4 v19, s[12:15], s77 offen lds
    v_mfma_f32_16x16x32_bf16 v[228:231], a[52:55], v[104:107], v[228:231]
    ds_read_b128 a[20:23], v5 offset:320
    ds_read_b128 a[24:27], v5 offset:384
    v_exp_f32 v79, v79
    v_mfma_f32_16x16x32_bf16 v[240:243], a[56:59], v[104:107], v[240:243]
    ds_read_b128 a[28:31], v5 offset:448
    v_cvt_pk_bf16_f32 v102, v76, v77
    v_mfma_f32_16x16x32_bf16 v[248:251], a[56:59], v[108:111], v[248:251]
    ds_read_b64_tr_b16 a[32:33], v7 offset:16896
    v_cvt_pk_bf16_f32 v103, v78, v79
    v_mfma_f32_16x16x32_bf16 v[252:255], a[60:63], v[108:111], v[252:255]
    ds_read_b64_tr_b16 a[34:35], v7 offset:17408
    v_mfma_f32_16x16x32_bf16 v[244:247], a[60:63], v[104:107], v[244:247]
    s_waitcnt lgkmcnt(6)
    ds_read_b64_tr_b16 a[36:37], v7 offset:16928
    v_mfma_f32_16x16x32_bf16 v[64:67], a[0:3], a[64:67], v[112:115]
    ds_read_b64_tr_b16 a[38:39], v7 offset:17440
    v_mfma_f32_16x16x32_bf16 v[64:67], a[4:7], a[72:75], v[64:67]
    buffer_load_dwordx4 v20, s[12:15], s77 offen offset:1056 lds
    v_mfma_f32_16x16x32_bf16 v[64:67], a[8:11], a[80:83], v[64:67]
    ds_read_b64_tr_b16 a[40:41], v7 offset:16960
    v_mfma_f32_16x16x32_bf16 v[64:67], a[12:15], a[88:91], v[64:67]
    ds_read_b64_tr_b16 a[42:43], v7 offset:17472
    v_mfma_f32_16x16x32_bf16 v[72:75], a[12:15], a[92:95], v[116:119]
    ds_read_b64_tr_b16 a[44:45], v7 offset:16992
    v_mfma_f32_16x16x32_bf16 v[72:75], a[8:11], a[84:87], v[72:75]
    ds_read_b64_tr_b16 a[46:47], v7 offset:17504
    v_mfma_f32_16x16x32_bf16 v[72:75], a[4:7], a[76:79], v[72:75]
    v_mfma_f32_16x16x32_bf16 v[72:75], a[0:3], a[68:71], v[72:75]
    s_waitcnt lgkmcnt(5)
    ds_read_b64_tr_b16 a[48:49], v7 offset:17024
    v_mfma_f32_16x16x32_bf16 v[72:75], a[16:19], a[100:103], v[72:75]
    ds_read_b64_tr_b16 a[50:51], v7 offset:17536
    v_mfma_f32_16x16x32_bf16 v[72:75], a[20:23], a[108:111], v[72:75]
    buffer_load_dwordx4 v21, s[12:15], s77 offen offset:2112 lds
    v_mfma_f32_16x16x32_bf16 v[72:75], a[24:27], a[116:119], v[72:75]
    ds_read_b64_tr_b16 a[52:53], v7 offset:17056
    v_mfma_f32_16x16x32_bf16 v[72:75], a[28:31], a[124:127], v[72:75]
    ds_read_b64_tr_b16 a[54:55], v7 offset:17568
    v_mfma_f32_16x16x32_bf16 v[64:67], a[28:31], a[120:123], v[64:67]
    ds_read_b64_tr_b16 a[56:57], v7 offset:17088
    v_mfma_f32_16x16x32_bf16 v[64:67], a[24:27], a[112:115], v[64:67]
    ds_read_b64_tr_b16 a[58:59], v7 offset:17600
    v_mfma_f32_16x16x32_bf16 v[64:67], a[20:23], a[104:107], v[64:67]
    ds_read_b64_tr_b16 a[60:61], v7 offset:17120
    v_mfma_f32_16x16x32_bf16 v[64:67], a[16:19], a[96:99], v[64:67]
    v_exp_f32 v80, v80
    v_mfma_f32_16x16x32_bf16 v[128:131], a[32:35], v[96:99], v[128:131]
    ds_read_b64_tr_b16 a[62:63], v7 offset:17632
    v_mfma_f32_16x16x32_bf16 v[136:139], a[32:35], v[100:103], v[136:139]
    s_waitcnt lgkmcnt(6)
    buffer_load_dwordx4 v22, s[12:15], s77 offen offset:3168 lds
    v_mfma_f32_16x16x32_bf16 v[140:143], a[36:39], v[100:103], v[140:143]
    v_exp_f32 v81, v81
    v_mfma_f32_16x16x32_bf16 v[132:135], a[36:39], v[96:99], v[132:135]
    ds_read_b128 a[0:3], v5 offset:512
    ds_read_b128 a[4:7], v5 offset:576
    v_mfma_f32_16x16x32_bf16 v[144:147], a[40:43], v[96:99], v[144:147]
    s_add_u32 s78, s75, 65536
    ds_read_b128 a[8:11], v5 offset:640
    v_mfma_f32_16x16x32_bf16 v[152:155], a[40:43], v[100:103], v[152:155]
    s_add_u32 m0, s73, 16896
    v_exp_f32 v82, v82
    v_mfma_f32_16x16x32_bf16 v[156:159], a[44:47], v[100:103], v[156:159]
    ds_read_b128 a[12:15], v5 offset:704
    v_mfma_f32_16x16x32_bf16 v[148:151], a[44:47], v[96:99], v[148:151]
    v_exp_f32 v83, v83
    v_mfma_f32_16x16x32_bf16 v[160:163], a[48:51], v[96:99], v[160:163]
    ds_read_b128 a[16:19], v5 offset:768
    ds_read_b128 a[20:23], v5 offset:832
    v_mfma_f32_16x16x32_bf16 v[168:171], a[48:51], v[100:103], v[168:171]
    s_waitcnt lgkmcnt(6)
    ds_read_b128 a[24:27], v5 offset:896
    v_cvt_pk_bf16_f32 v104, v80, v81
    v_mfma_f32_16x16x32_bf16 v[172:175], a[52:55], v[100:103], v[172:175]
    buffer_load_dwordx4 v19, s[16:19], s78 offen lds
    v_mfma_f32_16x16x32_bf16 v[164:167], a[52:55], v[96:99], v[164:167]
    ds_read_b128 a[28:31], v5 offset:960
    v_cvt_pk_bf16_f32 v105, v82, v83
    v_mfma_f32_16x16x32_bf16 v[176:179], a[56:59], v[96:99], v[176:179]
    v_exp_f32 v88, v88
    v_mfma_f32_16x16x32_bf16 v[184:187], a[56:59], v[100:103], v[184:187]
    ds_read_b64_tr_b16 a[32:33], v7 offset:17152
    ds_read_b64_tr_b16 a[34:35], v7 offset:17664
    v_mfma_f32_16x16x32_bf16 v[188:191], a[60:63], v[100:103], v[188:191]
    ds_read_b64_tr_b16 a[36:37], v7 offset:17184
    v_mfma_f32_16x16x32_bf16 v[180:183], a[60:63], v[96:99], v[180:183]
    v_exp_f32 v89, v89
    v_mfma_f32_16x16x32_bf16 a[240:243], a[248:251], v[96:99], a[240:243]
    ds_read_b64_tr_b16 a[38:39], v7 offset:17696
    v_mfma_f32_16x16x32_bf16 a[244:247], a[248:251], v[100:103], a[244:247]
    s_waitcnt lgkmcnt(5)
    v_exp_f32 v90, v90
    v_mfma_f32_16x16x32_bf16 v[68:71], a[0:3], a[64:67], v[112:115]
    ds_read_b64_tr_b16 a[40:41], v7 offset:17216
    ds_read_b64_tr_b16 a[42:43], v7 offset:17728
    v_mfma_f32_16x16x32_bf16 v[68:71], a[4:7], a[72:75], v[68:71]
    buffer_load_dwordx4 v20, s[16:19], s78 offen offset:1056 lds
    v_mfma_f32_16x16x32_bf16 v[68:71], a[8:11], a[80:83], v[68:71]
    ds_read_b64_tr_b16 a[44:45], v7 offset:17248
    ds_read_b64_tr_b16 a[46:47], v7 offset:17760
    v_exp_f32 v91, v91
    v_mfma_f32_16x16x32_bf16 v[68:71], a[12:15], a[88:91], v[68:71]
    ds_read_b64_tr_b16 a[48:49], v7 offset:17280
    v_cvt_pk_bf16_f32 v108, v88, v89
    v_mfma_f32_16x16x32_bf16 v[76:79], a[12:15], a[92:95], v[116:119]
    ds_read_b64_tr_b16 a[50:51], v7 offset:17792
    v_cvt_pk_bf16_f32 v109, v90, v91
    v_mfma_f32_16x16x32_bf16 v[76:79], a[8:11], a[84:87], v[76:79]
    ds_read_b64_tr_b16 a[52:53], v7 offset:17312
    v_mfma_f32_16x16x32_bf16 v[76:79], a[4:7], a[76:79], v[76:79]
    v_exp_f32 v84, v84
    v_mfma_f32_16x16x32_bf16 v[76:79], a[0:3], a[68:71], v[76:79]
    ds_read_b64_tr_b16 a[54:55], v7 offset:17824
    v_mfma_f32_16x16x32_bf16 v[76:79], a[16:19], a[100:103], v[76:79]
    buffer_load_dwordx4 v21, s[16:19], s78 offen offset:2112 lds
    v_mfma_f32_16x16x32_bf16 v[76:79], a[20:23], a[108:111], v[76:79]
    v_exp_f32 v85, v85
    v_mfma_f32_16x16x32_bf16 v[76:79], a[24:27], a[116:119], v[76:79]
    s_waitcnt lgkmcnt(4)
    ds_read_b64_tr_b16 a[56:57], v7 offset:17344
    ds_read_b64_tr_b16 a[58:59], v7 offset:17856
    v_mfma_f32_16x16x32_bf16 v[76:79], a[28:31], a[124:127], v[76:79]
    ds_read_b64_tr_b16 a[60:61], v7 offset:17376
    v_mfma_f32_16x16x32_bf16 v[68:71], a[28:31], a[120:123], v[68:71]
    v_exp_f32 v86, v86
    v_mfma_f32_16x16x32_bf16 v[68:71], a[24:27], a[112:115], v[68:71]
    ds_read_b64_tr_b16 a[62:63], v7 offset:17888
    v_mfma_f32_16x16x32_bf16 v[68:71], a[20:23], a[104:107], v[68:71]
    v_exp_f32 v87, v87
    v_mfma_f32_16x16x32_bf16 v[68:71], a[16:19], a[96:99], v[68:71]
    buffer_load_dwordx4 v22, s[16:19], s78 offen offset:3168 lds
    v_mfma_f32_16x16x32_bf16 v[192:195], a[32:35], v[96:99], v[192:195]
    v_cvt_pk_bf16_f32 v106, v84, v85
    v_cvt_pk_bf16_f32 v107, v86, v87
    v_mfma_f32_16x16x32_bf16 v[200:203], a[32:35], v[100:103], v[200:203]
    v_exp_f32 v92, v92
    v_mfma_f32_16x16x32_bf16 v[204:207], a[36:39], v[100:103], v[204:207]
    v_mfma_f32_16x16x32_bf16 v[196:199], a[36:39], v[96:99], v[196:199]
    s_waitcnt vmcnt(8) lgkmcnt(0)
    s_barrier
    ds_read_b128 a[0:3], v5 offset:33792
    v_mfma_f32_16x16x32_bf16 v[208:211], a[40:43], v[96:99], v[208:211]
    s_add_u32 s77, s75, 114688
    ds_read_b128 a[4:7], v5 offset:33856
    v_mfma_f32_16x16x32_bf16 v[216:219], a[40:43], v[100:103], v[216:219]
    s_add_u32 m0, s73, 67584
    v_exp_f32 v93, v93
    v_mfma_f32_16x16x32_bf16 v[220:223], a[44:47], v[100:103], v[220:223]
    ds_read_b128 a[8:11], v5 offset:33920
    v_mfma_f32_16x16x32_bf16 v[212:215], a[44:47], v[96:99], v[212:215]
    ds_read_b128 a[12:15], v5 offset:33984
    v_mfma_f32_16x16x32_bf16 v[224:227], a[48:51], v[96:99], v[224:227]
    buffer_load_dwordx4 v19, s[12:15], s77 offen lds
    v_exp_f32 v94, v94
    v_mfma_f32_16x16x32_bf16 v[232:235], a[48:51], v[100:103], v[232:235]
    ds_read_b128 a[16:19], v5 offset:34048
    v_mfma_f32_16x16x32_bf16 v[236:239], a[52:55], v[100:103], v[236:239]
    ds_read_b128 a[20:23], v5 offset:34112
    v_mfma_f32_16x16x32_bf16 v[228:231], a[52:55], v[96:99], v[228:231]
    v_exp_f32 v95, v95
    v_mfma_f32_16x16x32_bf16 v[240:243], a[56:59], v[96:99], v[240:243]
    ds_read_b128 a[24:27], v5 offset:34176
    ds_read_b128 a[28:31], v5 offset:34240
    v_mfma_f32_16x16x32_bf16 v[248:251], a[56:59], v[100:103], v[248:251]
    buffer_load_dwordx4 v20, s[12:15], s77 offen offset:1056 lds
    v_cvt_pk_bf16_f32 v110, v92, v93
    v_mfma_f32_16x16x32_bf16 v[252:255], a[60:63], v[100:103], v[252:255]
    ds_read_b64_tr_b16 a[32:33], v7 offset:50688
    v_cvt_pk_bf16_f32 v111, v94, v95
    v_mfma_f32_16x16x32_bf16 v[244:247], a[60:63], v[96:99], v[244:247]
    s_waitcnt lgkmcnt(5)
    ds_read_b64_tr_b16 a[34:35], v7 offset:51200
    v_mfma_f32_16x16x32_bf16 v[80:83], a[0:3], a[64:67], v[112:115]
    ds_read_b64_tr_b16 a[36:37], v7 offset:50720
    v_mfma_f32_16x16x32_bf16 v[80:83], a[4:7], a[72:75], v[80:83]
    ds_read_b64_tr_b16 a[38:39], v7 offset:51232
    v_mfma_f32_16x16x32_bf16 v[80:83], a[8:11], a[80:83], v[80:83]
    buffer_load_dwordx4 v21, s[12:15], s77 offen offset:2112 lds
    v_mfma_f32_16x16x32_bf16 v[80:83], a[12:15], a[88:91], v[80:83]
    ds_read_b64_tr_b16 a[40:41], v7 offset:50752
    v_mfma_f32_16x16x32_bf16 v[88:91], a[12:15], a[92:95], v[116:119]
    ds_read_b64_tr_b16 a[42:43], v7 offset:51264
    v_mfma_f32_16x16x32_bf16 v[88:91], a[8:11], a[84:87], v[88:91]
    ds_read_b64_tr_b16 a[44:45], v7 offset:50784
    v_mfma_f32_16x16x32_bf16 v[88:91], a[4:7], a[76:79], v[88:91]
    ds_read_b64_tr_b16 a[46:47], v7 offset:51296
    v_mfma_f32_16x16x32_bf16 v[88:91], a[0:3], a[68:71], v[88:91]
    s_waitcnt lgkmcnt(6)
    buffer_load_dwordx4 v22, s[12:15], s77 offen offset:3168 lds
    v_mfma_f32_16x16x32_bf16 v[88:91], a[16:19], a[100:103], v[88:91]
    s_add_u32 s78, s75, 81920
    ds_read_b64_tr_b16 a[48:49], v7 offset:50816
    v_mfma_f32_16x16x32_bf16 v[88:91], a[20:23], a[108:111], v[88:91]
    s_add_u32 m0, s73, 84480
    ds_read_b64_tr_b16 a[50:51], v7 offset:51328
    v_mfma_f32_16x16x32_bf16 v[88:91], a[24:27], a[116:119], v[88:91]
    ds_read_b64_tr_b16 a[52:53], v7 offset:50848
    v_mfma_f32_16x16x32_bf16 v[88:91], a[28:31], a[124:127], v[88:91]
    ds_read_b64_tr_b16 a[54:55], v7 offset:51360
    v_mfma_f32_16x16x32_bf16 v[80:83], a[28:31], a[120:123], v[80:83]
    ds_read_b64_tr_b16 a[56:57], v7 offset:50880
    v_mfma_f32_16x16x32_bf16 v[80:83], a[24:27], a[112:115], v[80:83]
    buffer_load_dwordx4 v19, s[16:19], s78 offen lds
    v_mfma_f32_16x16x32_bf16 v[80:83], a[20:23], a[104:107], v[80:83]
    ds_read_b64_tr_b16 a[58:59], v7 offset:51392
    v_mfma_f32_16x16x32_bf16 v[80:83], a[16:19], a[96:99], v[80:83]
    ds_read_b64_tr_b16 a[60:61], v7 offset:50912
    v_mfma_f32_16x16x32_bf16 v[128:131], a[32:35], v[104:107], v[128:131]
    v_exp_f32 v64, v64
    v_mfma_f32_16x16x32_bf16 v[136:139], a[32:35], v[108:111], v[136:139]
    s_waitcnt lgkmcnt(5)
    ds_read_b64_tr_b16 a[62:63], v7 offset:51424
    v_mfma_f32_16x16x32_bf16 v[140:143], a[36:39], v[108:111], v[140:143]
    v_exp_f32 v65, v65
    v_mfma_f32_16x16x32_bf16 v[132:135], a[36:39], v[104:107], v[132:135]
    ds_read_b128 a[0:3], v5 offset:34304
    ds_read_b128 a[4:7], v5 offset:34368
    v_mfma_f32_16x16x32_bf16 v[144:147], a[40:43], v[104:107], v[144:147]
    buffer_load_dwordx4 v20, s[16:19], s78 offen offset:1056 lds
    v_mfma_f32_16x16x32_bf16 v[152:155], a[40:43], v[108:111], v[152:155]
    ds_read_b128 a[8:11], v5 offset:34432
    ds_read_b128 a[12:15], v5 offset:34496
    v_exp_f32 v66, v66
    v_mfma_f32_16x16x32_bf16 v[156:159], a[44:47], v[108:111], v[156:159]
    v_exp_f32 v67, v67
    v_mfma_f32_16x16x32_bf16 v[148:151], a[44:47], v[104:107], v[148:151]
    ds_read_b128 a[16:19], v5 offset:34560
    v_mfma_f32_16x16x32_bf16 v[160:163], a[48:51], v[104:107], v[160:163]
    ds_read_b128 a[20:23], v5 offset:34624
    v_cvt_pk_bf16_f32 v96, v64, v65
    v_mfma_f32_16x16x32_bf16 v[168:171], a[48:51], v[108:111], v[168:171]
    s_waitcnt lgkmcnt(6)
    buffer_load_dwordx4 v21, s[16:19], s78 offen offset:2112 lds
    v_mfma_f32_16x16x32_bf16 v[172:175], a[52:55], v[108:111], v[172:175]
    ds_read_b128 a[24:27], v5 offset:34688
    ds_read_b128 a[28:31], v5 offset:34752
    v_mfma_f32_16x16x32_bf16 v[164:167], a[52:55], v[104:107], v[164:167]
    ds_read_b64_tr_b16 a[32:33], v7 offset:50944
    v_cvt_pk_bf16_f32 v97, v66, v67
    v_mfma_f32_16x16x32_bf16 v[176:179], a[56:59], v[104:107], v[176:179]
    v_exp_f32 v72, v72
    v_mfma_f32_16x16x32_bf16 v[184:187], a[56:59], v[108:111], v[184:187]
    ds_read_b64_tr_b16 a[34:35], v7 offset:51456
    v_mfma_f32_16x16x32_bf16 v[188:191], a[60:63], v[108:111], v[188:191]
    buffer_load_dwordx4 v22, s[16:19], s78 offen offset:3168 lds
    v_mfma_f32_16x16x32_bf16 v[180:183], a[60:63], v[104:107], v[180:183]
    s_add_u32 s77, s76, 0
    ds_read_b64_tr_b16 a[36:37], v7 offset:50976
    ds_read_b64_tr_b16 a[38:39], v7 offset:51488
    v_exp_f32 v73, v73
    v_mfma_f32_16x16x32_bf16 a[240:243], a[248:251], v[104:107], a[240:243]
    s_add_u32 m0, s72, 33792
    v_exp_f32 v74, v74
    v_mfma_f32_16x16x32_bf16 a[244:247], a[248:251], v[108:111], a[244:247]
    s_waitcnt lgkmcnt(6)
    ds_read_b64_tr_b16 a[40:41], v7 offset:51008
    v_mfma_f32_16x16x32_bf16 v[84:87], a[0:3], a[64:67], v[112:115]
    ds_read_b64_tr_b16 a[42:43], v7 offset:51520
    v_mfma_f32_16x16x32_bf16 v[84:87], a[4:7], a[72:75], v[84:87]
    ds_read_b64_tr_b16 a[44:45], v7 offset:51040
    v_mfma_f32_16x16x32_bf16 v[84:87], a[8:11], a[80:83], v[84:87]
    buffer_load_dwordx4 v23, s[20:23], s77 offen lds
    v_exp_f32 v75, v75
    v_mfma_f32_16x16x32_bf16 v[84:87], a[12:15], a[88:91], v[84:87]
    ds_read_b64_tr_b16 a[46:47], v7 offset:51552
    v_cvt_pk_bf16_f32 v100, v72, v73
    v_mfma_f32_16x16x32_bf16 v[92:95], a[12:15], a[92:95], v[116:119]
    ds_read_b64_tr_b16 a[48:49], v7 offset:51072
    v_cvt_pk_bf16_f32 v101, v74, v75
    v_mfma_f32_16x16x32_bf16 v[92:95], a[8:11], a[84:87], v[92:95]
    ds_read_b64_tr_b16 a[50:51], v7 offset:51584
    v_mfma_f32_16x16x32_bf16 v[92:95], a[4:7], a[76:79], v[92:95]
    ds_read_b64_tr_b16 a[52:53], v7 offset:51104
    v_mfma_f32_16x16x32_bf16 v[92:95], a[0:3], a[68:71], v[92:95]
    buffer_load_dwordx4 v24, s[20:23], s77 offen offset:1032 lds
    v_exp_f32 v68, v68
    v_mfma_f32_16x16x32_bf16 v[92:95], a[16:19], a[100:103], v[92:95]
    ds_read_b64_tr_b16 a[54:55], v7 offset:51616
    v_mfma_f32_16x16x32_bf16 v[92:95], a[20:23], a[108:111], v[92:95]
    s_waitcnt lgkmcnt(5)
    v_exp_f32 v69, v69
    v_mfma_f32_16x16x32_bf16 v[92:95], a[24:27], a[116:119], v[92:95]
    ds_read_b64_tr_b16 a[56:57], v7 offset:51136
    ds_read_b64_tr_b16 a[58:59], v7 offset:51648
    v_mfma_f32_16x16x32_bf16 v[92:95], a[28:31], a[124:127], v[92:95]
    ds_read_b64_tr_b16 a[60:61], v7 offset:51168
    v_mfma_f32_16x16x32_bf16 v[84:87], a[28:31], a[120:123], v[84:87]
    buffer_load_dwordx4 v25, s[20:23], s77 offen offset:2112 lds
    v_exp_f32 v70, v70
    v_mfma_f32_16x16x32_bf16 v[84:87], a[24:27], a[112:115], v[84:87]
    ds_read_b64_tr_b16 a[62:63], v7 offset:51680
    v_mfma_f32_16x16x32_bf16 v[84:87], a[20:23], a[104:107], v[84:87]
    v_exp_f32 v71, v71
    v_mfma_f32_16x16x32_bf16 v[84:87], a[16:19], a[96:99], v[84:87]
    v_cvt_pk_bf16_f32 v98, v68, v69
    v_mfma_f32_16x16x32_bf16 v[192:195], a[32:35], v[104:107], v[192:195]
    buffer_load_dwordx4 v26, s[20:23], s77 offen offset:3144 lds
    v_mfma_f32_16x16x32_bf16 v[200:203], a[32:35], v[108:111], v[200:203]
    v_cvt_pk_bf16_f32 v99, v70, v71
    v_mfma_f32_16x16x32_bf16 v[204:207], a[36:39], v[108:111], v[204:207]
    v_exp_f32 v76, v76
    v_mfma_f32_16x16x32_bf16 v[196:199], a[36:39], v[104:107], v[196:199]
    s_waitcnt vmcnt(12) lgkmcnt(0)
    s_barrier
    ds_read_b128 a[0:3], v4 offset:0
    v_mfma_f32_16x16x32_bf16 v[208:211], a[40:43], v[104:107], v[208:211]
    s_add_u32 s77, s75, 131072
    ds_read_b128 a[4:7], v4 offset:64
    v_mfma_f32_16x16x32_bf16 v[216:219], a[40:43], v[108:111], v[216:219]
    s_add_u32 m0, s73, 101376
    v_exp_f32 v77, v77
    v_mfma_f32_16x16x32_bf16 v[220:223], a[44:47], v[108:111], v[220:223]
    ds_read_b128 a[8:11], v4 offset:128
    v_mfma_f32_16x16x32_bf16 v[212:215], a[44:47], v[104:107], v[212:215]
    ds_read_b128 a[12:15], v4 offset:192
    v_mfma_f32_16x16x32_bf16 v[224:227], a[48:51], v[104:107], v[224:227]
    buffer_load_dwordx4 v19, s[12:15], s77 offen lds
    v_exp_f32 v78, v78
    v_mfma_f32_16x16x32_bf16 v[232:235], a[48:51], v[108:111], v[232:235]
    ds_read_b128 a[16:19], v4 offset:256
    v_mfma_f32_16x16x32_bf16 v[236:239], a[52:55], v[108:111], v[236:239]
    ds_read_b128 a[20:23], v4 offset:320
    v_mfma_f32_16x16x32_bf16 v[228:231], a[52:55], v[104:107], v[228:231]
    v_exp_f32 v79, v79
    v_mfma_f32_16x16x32_bf16 v[240:243], a[56:59], v[104:107], v[240:243]
    ds_read_b128 a[24:27], v4 offset:384
    ds_read_b128 a[28:31], v4 offset:448
    v_mfma_f32_16x16x32_bf16 v[248:251], a[56:59], v[108:111], v[248:251]
    buffer_load_dwordx4 v20, s[12:15], s77 offen offset:1056 lds
    v_cvt_pk_bf16_f32 v102, v76, v77
    v_mfma_f32_16x16x32_bf16 v[252:255], a[60:63], v[108:111], v[252:255]
    ds_read_b64_tr_b16 a[32:33], v6 offset:16896
    v_cvt_pk_bf16_f32 v103, v78, v79
    v_mfma_f32_16x16x32_bf16 v[244:247], a[60:63], v[104:107], v[244:247]
    s_waitcnt lgkmcnt(5)
    ds_read_b64_tr_b16 a[34:35], v6 offset:17408
    v_mfma_f32_16x16x32_bf16 v[64:67], a[0:3], a[64:67], v[112:115]
    ds_read_b64_tr_b16 a[36:37], v6 offset:16928
    v_mfma_f32_16x16x32_bf16 v[64:67], a[4:7], a[72:75], v[64:67]
    ds_read_b64_tr_b16 a[38:39], v6 offset:17440
    v_mfma_f32_16x16x32_bf16 v[64:67], a[8:11], a[80:83], v[64:67]
    buffer_load_dwordx4 v21, s[12:15], s77 offen offset:2112 lds
    v_mfma_f32_16x16x32_bf16 v[64:67], a[12:15], a[88:91], v[64:67]
    ds_read_b64_tr_b16 a[40:41], v6 offset:16960
    v_mfma_f32_16x16x32_bf16 v[72:75], a[12:15], a[92:95], v[116:119]
    ds_read_b64_tr_b16 a[42:43], v6 offset:17472
    v_mfma_f32_16x16x32_bf16 v[72:75], a[8:11], a[84:87], v[72:75]
    ds_read_b64_tr_b16 a[44:45], v6 offset:16992
    v_mfma_f32_16x16x32_bf16 v[72:75], a[4:7], a[76:79], v[72:75]
    ds_read_b64_tr_b16 a[46:47], v6 offset:17504
    v_mfma_f32_16x16x32_bf16 v[72:75], a[0:3], a[68:71], v[72:75]
    s_waitcnt lgkmcnt(6)
    buffer_load_dwordx4 v22, s[12:15], s77 offen offset:3168 lds
    v_mfma_f32_16x16x32_bf16 v[72:75], a[16:19], a[100:103], v[72:75]
    s_add_u32 s78, s75, 98304
    ds_read_b64_tr_b16 a[48:49], v6 offset:17024
    v_mfma_f32_16x16x32_bf16 v[72:75], a[20:23], a[108:111], v[72:75]
    s_add_u32 m0, s73, 118272
    ds_read_b64_tr_b16 a[50:51], v6 offset:17536
    v_mfma_f32_16x16x32_bf16 v[72:75], a[24:27], a[116:119], v[72:75]
    ds_read_b64_tr_b16 a[52:53], v6 offset:17056
    v_mfma_f32_16x16x32_bf16 v[72:75], a[28:31], a[124:127], v[72:75]
    ds_read_b64_tr_b16 a[54:55], v6 offset:17568
    v_mfma_f32_16x16x32_bf16 v[64:67], a[28:31], a[120:123], v[64:67]
    ds_read_b64_tr_b16 a[56:57], v6 offset:17088
    v_mfma_f32_16x16x32_bf16 v[64:67], a[24:27], a[112:115], v[64:67]
    buffer_load_dwordx4 v19, s[16:19], s78 offen lds
    v_mfma_f32_16x16x32_bf16 v[64:67], a[20:23], a[104:107], v[64:67]
    ds_read_b64_tr_b16 a[58:59], v6 offset:17600
    v_mfma_f32_16x16x32_bf16 v[64:67], a[16:19], a[96:99], v[64:67]
    ds_read_b64_tr_b16 a[60:61], v6 offset:17120
    v_mfma_f32_16x16x32_bf16 v[128:131], a[32:35], v[96:99], v[128:131]
    v_exp_f32 v80, v80
    v_mfma_f32_16x16x32_bf16 v[136:139], a[32:35], v[100:103], v[136:139]
    s_waitcnt lgkmcnt(5)
    ds_read_b64_tr_b16 a[62:63], v6 offset:17632
    v_mfma_f32_16x16x32_bf16 v[140:143], a[36:39], v[100:103], v[140:143]
    v_exp_f32 v81, v81
    v_mfma_f32_16x16x32_bf16 v[132:135], a[36:39], v[96:99], v[132:135]
    ds_read_b128 a[0:3], v4 offset:512
    ds_read_b128 a[4:7], v4 offset:576
    v_mfma_f32_16x16x32_bf16 v[144:147], a[40:43], v[96:99], v[144:147]
    buffer_load_dwordx4 v20, s[16:19], s78 offen offset:1056 lds
    v_mfma_f32_16x16x32_bf16 v[152:155], a[40:43], v[100:103], v[152:155]
    ds_read_b128 a[8:11], v4 offset:640
    ds_read_b128 a[12:15], v4 offset:704
    v_exp_f32 v82, v82
    v_mfma_f32_16x16x32_bf16 v[156:159], a[44:47], v[100:103], v[156:159]
    v_exp_f32 v83, v83
    v_mfma_f32_16x16x32_bf16 v[148:151], a[44:47], v[96:99], v[148:151]
    ds_read_b128 a[16:19], v4 offset:768
    v_mfma_f32_16x16x32_bf16 v[160:163], a[48:51], v[96:99], v[160:163]
    ds_read_b128 a[20:23], v4 offset:832
    v_cvt_pk_bf16_f32 v104, v80, v81
    v_mfma_f32_16x16x32_bf16 v[168:171], a[48:51], v[100:103], v[168:171]
    s_waitcnt lgkmcnt(6)
    buffer_load_dwordx4 v21, s[16:19], s78 offen offset:2112 lds
    v_mfma_f32_16x16x32_bf16 v[172:175], a[52:55], v[100:103], v[172:175]
    ds_read_b128 a[24:27], v4 offset:896
    ds_read_b128 a[28:31], v4 offset:960
    v_mfma_f32_16x16x32_bf16 v[164:167], a[52:55], v[96:99], v[164:167]
    ds_read_b64_tr_b16 a[32:33], v6 offset:17152
    v_cvt_pk_bf16_f32 v105, v82, v83
    v_mfma_f32_16x16x32_bf16 v[176:179], a[56:59], v[96:99], v[176:179]
    v_exp_f32 v88, v88
    v_mfma_f32_16x16x32_bf16 v[184:187], a[56:59], v[100:103], v[184:187]
    ds_read_b64_tr_b16 a[34:35], v6 offset:17664
    v_mfma_f32_16x16x32_bf16 v[188:191], a[60:63], v[100:103], v[188:191]
    buffer_load_dwordx4 v22, s[16:19], s78 offen offset:3168 lds
    v_mfma_f32_16x16x32_bf16 v[180:183], a[60:63], v[96:99], v[180:183]
    s_add_u32 s78, s76, 3584
    ds_read_b64_tr_b16 a[36:37], v6 offset:17184
    ds_read_b64_tr_b16 a[38:39], v6 offset:17696
    v_exp_f32 v89, v89
    v_mfma_f32_16x16x32_bf16 a[240:243], a[248:251], v[96:99], a[240:243]
    s_add_u32 m0, s72, 38016
    v_exp_f32 v90, v90
    v_mfma_f32_16x16x32_bf16 a[244:247], a[248:251], v[100:103], a[244:247]
    s_waitcnt lgkmcnt(6)
    ds_read_b64_tr_b16 a[40:41], v6 offset:17216
    v_mfma_f32_16x16x32_bf16 v[68:71], a[0:3], a[64:67], v[112:115]
    ds_read_b64_tr_b16 a[42:43], v6 offset:17728
    v_mfma_f32_16x16x32_bf16 v[68:71], a[4:7], a[72:75], v[68:71]
    ds_read_b64_tr_b16 a[44:45], v6 offset:17248
    v_mfma_f32_16x16x32_bf16 v[68:71], a[8:11], a[80:83], v[68:71]
    buffer_load_dwordx4 v23, s[20:23], s78 offen lds
    v_exp_f32 v91, v91
    v_mfma_f32_16x16x32_bf16 v[68:71], a[12:15], a[88:91], v[68:71]
    ds_read_b64_tr_b16 a[46:47], v6 offset:17760
    v_cvt_pk_bf16_f32 v108, v88, v89
    v_mfma_f32_16x16x32_bf16 v[76:79], a[12:15], a[92:95], v[116:119]
    ds_read_b64_tr_b16 a[48:49], v6 offset:17280
    v_cvt_pk_bf16_f32 v109, v90, v91
    v_mfma_f32_16x16x32_bf16 v[76:79], a[8:11], a[84:87], v[76:79]
    ds_read_b64_tr_b16 a[50:51], v6 offset:17792
    v_mfma_f32_16x16x32_bf16 v[76:79], a[4:7], a[76:79], v[76:79]
    ds_read_b64_tr_b16 a[52:53], v6 offset:17312
    v_mfma_f32_16x16x32_bf16 v[76:79], a[0:3], a[68:71], v[76:79]
    buffer_load_dwordx4 v24, s[20:23], s78 offen offset:1032 lds
    v_exp_f32 v84, v84
    v_mfma_f32_16x16x32_bf16 v[76:79], a[16:19], a[100:103], v[76:79]
    ds_read_b64_tr_b16 a[54:55], v6 offset:17824
    v_mfma_f32_16x16x32_bf16 v[76:79], a[20:23], a[108:111], v[76:79]
    s_waitcnt lgkmcnt(5)
    v_exp_f32 v85, v85
    v_mfma_f32_16x16x32_bf16 v[76:79], a[24:27], a[116:119], v[76:79]
    ds_read_b64_tr_b16 a[56:57], v6 offset:17344
    ds_read_b64_tr_b16 a[58:59], v6 offset:17856
    v_mfma_f32_16x16x32_bf16 v[76:79], a[28:31], a[124:127], v[76:79]
    ds_read_b64_tr_b16 a[60:61], v6 offset:17376
    v_mfma_f32_16x16x32_bf16 v[68:71], a[28:31], a[120:123], v[68:71]
    buffer_load_dwordx4 v25, s[20:23], s78 offen offset:2112 lds
    v_exp_f32 v86, v86
    v_mfma_f32_16x16x32_bf16 v[68:71], a[24:27], a[112:115], v[68:71]
    ds_read_b64_tr_b16 a[62:63], v6 offset:17888
    v_mfma_f32_16x16x32_bf16 v[68:71], a[20:23], a[104:107], v[68:71]
    v_exp_f32 v87, v87
    v_mfma_f32_16x16x32_bf16 v[68:71], a[16:19], a[96:99], v[68:71]
    v_cvt_pk_bf16_f32 v106, v84, v85
    v_mfma_f32_16x16x32_bf16 v[192:195], a[32:35], v[96:99], v[192:195]
    buffer_load_dwordx4 v26, s[20:23], s78 offen offset:3144 lds
    v_mfma_f32_16x16x32_bf16 v[200:203], a[32:35], v[100:103], v[200:203]
    v_cvt_pk_bf16_f32 v107, v86, v87
    v_mfma_f32_16x16x32_bf16 v[204:207], a[36:39], v[100:103], v[204:207]
    v_exp_f32 v92, v92
    v_mfma_f32_16x16x32_bf16 v[196:199], a[36:39], v[96:99], v[196:199]
    s_waitcnt vmcnt(16) lgkmcnt(0)
    s_barrier
    ds_read_b128 a[0:3], v5 offset:0
    v_mfma_f32_16x16x32_bf16 v[208:211], a[40:43], v[96:99], v[208:211]
    s_add_u32 s77, s75, 147456
    ds_read_b128 a[4:7], v5 offset:64
    v_mfma_f32_16x16x32_bf16 v[216:219], a[40:43], v[100:103], v[216:219]
    s_add_u32 m0, s73, 0
    v_exp_f32 v93, v93
    v_mfma_f32_16x16x32_bf16 v[220:223], a[44:47], v[100:103], v[220:223]
    ds_read_b128 a[8:11], v5 offset:128
    v_mfma_f32_16x16x32_bf16 v[212:215], a[44:47], v[96:99], v[212:215]
    ds_read_b128 a[12:15], v5 offset:192
    v_mfma_f32_16x16x32_bf16 v[224:227], a[48:51], v[96:99], v[224:227]
    v_exp_f32 v94, v94
    v_mfma_f32_16x16x32_bf16 v[232:235], a[48:51], v[100:103], v[232:235]
    ds_read_b128 a[16:19], v5 offset:256
    v_mfma_f32_16x16x32_bf16 v[236:239], a[52:55], v[100:103], v[236:239]
    buffer_load_dwordx4 v19, s[12:15], s77 offen lds
    v_mfma_f32_16x16x32_bf16 v[228:231], a[52:55], v[96:99], v[228:231]
    ds_read_b128 a[20:23], v5 offset:320
    ds_read_b128 a[24:27], v5 offset:384
    v_exp_f32 v95, v95
    v_mfma_f32_16x16x32_bf16 v[240:243], a[56:59], v[96:99], v[240:243]
    ds_read_b128 a[28:31], v5 offset:448
    v_cvt_pk_bf16_f32 v110, v92, v93
    v_mfma_f32_16x16x32_bf16 v[248:251], a[56:59], v[100:103], v[248:251]
    ds_read_b64_tr_b16 a[32:33], v7 offset:16896
    v_cvt_pk_bf16_f32 v111, v94, v95
    v_mfma_f32_16x16x32_bf16 v[252:255], a[60:63], v[100:103], v[252:255]
    ds_read_b64_tr_b16 a[34:35], v7 offset:17408
    v_mfma_f32_16x16x32_bf16 v[244:247], a[60:63], v[96:99], v[244:247]
    s_waitcnt lgkmcnt(6)
    ds_read_b64_tr_b16 a[36:37], v7 offset:16928
    v_mfma_f32_16x16x32_bf16 v[80:83], a[0:3], a[64:67], v[112:115]
    ds_read_b64_tr_b16 a[38:39], v7 offset:17440
    v_mfma_f32_16x16x32_bf16 v[80:83], a[4:7], a[72:75], v[80:83]
    buffer_load_dwordx4 v20, s[12:15], s77 offen offset:1056 lds
    v_mfma_f32_16x16x32_bf16 v[80:83], a[8:11], a[80:83], v[80:83]
    ds_read_b64_tr_b16 a[40:41], v7 offset:16960
    v_mfma_f32_16x16x32_bf16 v[80:83], a[12:15], a[88:91], v[80:83]
    ds_read_b64_tr_b16 a[42:43], v7 offset:17472
    v_mfma_f32_16x16x32_bf16 v[88:91], a[12:15], a[92:95], v[116:119]
    ds_read_b64_tr_b16 a[44:45], v7 offset:16992
    v_mfma_f32_16x16x32_bf16 v[88:91], a[8:11], a[84:87], v[88:91]
    ds_read_b64_tr_b16 a[46:47], v7 offset:17504
    v_mfma_f32_16x16x32_bf16 v[88:91], a[4:7], a[76:79], v[88:91]
    v_mfma_f32_16x16x32_bf16 v[88:91], a[0:3], a[68:71], v[88:91]
    s_waitcnt lgkmcnt(5)
    ds_read_b64_tr_b16 a[48:49], v7 offset:17024
    v_mfma_f32_16x16x32_bf16 v[88:91], a[16:19], a[100:103], v[88:91]
    ds_read_b64_tr_b16 a[50:51], v7 offset:17536
    v_mfma_f32_16x16x32_bf16 v[88:91], a[20:23], a[108:111], v[88:91]
    buffer_load_dwordx4 v21, s[12:15], s77 offen offset:2112 lds
    v_mfma_f32_16x16x32_bf16 v[88:91], a[24:27], a[116:119], v[88:91]
    ds_read_b64_tr_b16 a[52:53], v7 offset:17056
    v_mfma_f32_16x16x32_bf16 v[88:91], a[28:31], a[124:127], v[88:91]
    ds_read_b64_tr_b16 a[54:55], v7 offset:17568
    v_mfma_f32_16x16x32_bf16 v[80:83], a[28:31], a[120:123], v[80:83]
    ds_read_b64_tr_b16 a[56:57], v7 offset:17088
    v_mfma_f32_16x16x32_bf16 v[80:83], a[24:27], a[112:115], v[80:83]
    ds_read_b64_tr_b16 a[58:59], v7 offset:17600
    v_mfma_f32_16x16x32_bf16 v[80:83], a[20:23], a[104:107], v[80:83]
    ds_read_b64_tr_b16 a[60:61], v7 offset:17120
    v_mfma_f32_16x16x32_bf16 v[80:83], a[16:19], a[96:99], v[80:83]
    v_exp_f32 v64, v64
    v_mfma_f32_16x16x32_bf16 v[128:131], a[32:35], v[104:107], v[128:131]
    ds_read_b64_tr_b16 a[62:63], v7 offset:17632
    v_mfma_f32_16x16x32_bf16 v[136:139], a[32:35], v[108:111], v[136:139]
    s_waitcnt lgkmcnt(6)
    buffer_load_dwordx4 v22, s[12:15], s77 offen offset:3168 lds
    v_mfma_f32_16x16x32_bf16 v[140:143], a[36:39], v[108:111], v[140:143]
    v_exp_f32 v65, v65
    v_mfma_f32_16x16x32_bf16 v[132:135], a[36:39], v[104:107], v[132:135]
    ds_read_b128 a[0:3], v5 offset:512
    ds_read_b128 a[4:7], v5 offset:576
    v_mfma_f32_16x16x32_bf16 v[144:147], a[40:43], v[104:107], v[144:147]
    s_add_u32 s78, s75, 114688
    ds_read_b128 a[8:11], v5 offset:640
    v_mfma_f32_16x16x32_bf16 v[152:155], a[40:43], v[108:111], v[152:155]
    s_add_u32 m0, s73, 16896
    v_exp_f32 v66, v66
    v_mfma_f32_16x16x32_bf16 v[156:159], a[44:47], v[108:111], v[156:159]
    ds_read_b128 a[12:15], v5 offset:704
    v_mfma_f32_16x16x32_bf16 v[148:151], a[44:47], v[104:107], v[148:151]
    v_exp_f32 v67, v67
    v_mfma_f32_16x16x32_bf16 v[160:163], a[48:51], v[104:107], v[160:163]
    ds_read_b128 a[16:19], v5 offset:768
    ds_read_b128 a[20:23], v5 offset:832
    v_mfma_f32_16x16x32_bf16 v[168:171], a[48:51], v[108:111], v[168:171]
    s_waitcnt lgkmcnt(6)
    ds_read_b128 a[24:27], v5 offset:896
    v_cvt_pk_bf16_f32 v96, v64, v65
    v_mfma_f32_16x16x32_bf16 v[172:175], a[52:55], v[108:111], v[172:175]
    buffer_load_dwordx4 v19, s[16:19], s78 offen lds
    v_mfma_f32_16x16x32_bf16 v[164:167], a[52:55], v[104:107], v[164:167]
    ds_read_b128 a[28:31], v5 offset:960
    v_cvt_pk_bf16_f32 v97, v66, v67
    v_mfma_f32_16x16x32_bf16 v[176:179], a[56:59], v[104:107], v[176:179]
    v_exp_f32 v72, v72
    v_mfma_f32_16x16x32_bf16 v[184:187], a[56:59], v[108:111], v[184:187]
    ds_read_b64_tr_b16 a[32:33], v7 offset:17152
    ds_read_b64_tr_b16 a[34:35], v7 offset:17664
    v_mfma_f32_16x16x32_bf16 v[188:191], a[60:63], v[108:111], v[188:191]
    ds_read_b64_tr_b16 a[36:37], v7 offset:17184
    v_mfma_f32_16x16x32_bf16 v[180:183], a[60:63], v[104:107], v[180:183]
    v_exp_f32 v73, v73
    v_mfma_f32_16x16x32_bf16 a[240:243], a[248:251], v[104:107], a[240:243]
    ds_read_b64_tr_b16 a[38:39], v7 offset:17696
    v_mfma_f32_16x16x32_bf16 a[244:247], a[248:251], v[108:111], a[244:247]
    s_waitcnt lgkmcnt(5)
    v_exp_f32 v74, v74
    v_mfma_f32_16x16x32_bf16 v[84:87], a[0:3], a[64:67], v[112:115]
    ds_read_b64_tr_b16 a[40:41], v7 offset:17216
    ds_read_b64_tr_b16 a[42:43], v7 offset:17728
    v_mfma_f32_16x16x32_bf16 v[84:87], a[4:7], a[72:75], v[84:87]
    buffer_load_dwordx4 v20, s[16:19], s78 offen offset:1056 lds
    v_mfma_f32_16x16x32_bf16 v[84:87], a[8:11], a[80:83], v[84:87]
    ds_read_b64_tr_b16 a[44:45], v7 offset:17248
    ds_read_b64_tr_b16 a[46:47], v7 offset:17760
    v_exp_f32 v75, v75
    v_mfma_f32_16x16x32_bf16 v[84:87], a[12:15], a[88:91], v[84:87]
    ds_read_b64_tr_b16 a[48:49], v7 offset:17280
    v_cvt_pk_bf16_f32 v100, v72, v73
    v_mfma_f32_16x16x32_bf16 v[92:95], a[12:15], a[92:95], v[116:119]
    ds_read_b64_tr_b16 a[50:51], v7 offset:17792
    v_cvt_pk_bf16_f32 v101, v74, v75
    v_mfma_f32_16x16x32_bf16 v[92:95], a[8:11], a[84:87], v[92:95]
    ds_read_b64_tr_b16 a[52:53], v7 offset:17312
    v_mfma_f32_16x16x32_bf16 v[92:95], a[4:7], a[76:79], v[92:95]
    v_exp_f32 v68, v68
    v_mfma_f32_16x16x32_bf16 v[92:95], a[0:3], a[68:71], v[92:95]
    ds_read_b64_tr_b16 a[54:55], v7 offset:17824
    v_mfma_f32_16x16x32_bf16 v[92:95], a[16:19], a[100:103], v[92:95]
    buffer_load_dwordx4 v21, s[16:19], s78 offen offset:2112 lds
    v_mfma_f32_16x16x32_bf16 v[92:95], a[20:23], a[108:111], v[92:95]
    v_exp_f32 v69, v69
    v_mfma_f32_16x16x32_bf16 v[92:95], a[24:27], a[116:119], v[92:95]
    s_waitcnt lgkmcnt(4)
    ds_read_b64_tr_b16 a[56:57], v7 offset:17344
    ds_read_b64_tr_b16 a[58:59], v7 offset:17856
    v_mfma_f32_16x16x32_bf16 v[92:95], a[28:31], a[124:127], v[92:95]
    ds_read_b64_tr_b16 a[60:61], v7 offset:17376
    v_mfma_f32_16x16x32_bf16 v[84:87], a[28:31], a[120:123], v[84:87]
    v_exp_f32 v70, v70
    v_mfma_f32_16x16x32_bf16 v[84:87], a[24:27], a[112:115], v[84:87]
    ds_read_b64_tr_b16 a[62:63], v7 offset:17888
    v_mfma_f32_16x16x32_bf16 v[84:87], a[20:23], a[104:107], v[84:87]
    v_exp_f32 v71, v71
    v_mfma_f32_16x16x32_bf16 v[84:87], a[16:19], a[96:99], v[84:87]
    buffer_load_dwordx4 v22, s[16:19], s78 offen offset:3168 lds
    v_mfma_f32_16x16x32_bf16 v[192:195], a[32:35], v[104:107], v[192:195]
    v_cvt_pk_bf16_f32 v98, v68, v69
    v_cvt_pk_bf16_f32 v99, v70, v71
    v_mfma_f32_16x16x32_bf16 v[200:203], a[32:35], v[108:111], v[200:203]
    v_exp_f32 v76, v76
    v_mfma_f32_16x16x32_bf16 v[204:207], a[36:39], v[108:111], v[204:207]
    v_mfma_f32_16x16x32_bf16 v[196:199], a[36:39], v[104:107], v[196:199]
    s_waitcnt vmcnt(8) lgkmcnt(0)
    s_barrier
    ds_read_b128 a[0:3], v5 offset:33792
    v_mfma_f32_16x16x32_bf16 v[208:211], a[40:43], v[104:107], v[208:211]
    s_add_u32 s77, s75, 163840
    ds_read_b64_tr_b16 a[128:129], v12 offset:33792
    v_mfma_f32_16x16x32_bf16 v[216:219], a[40:43], v[108:111], v[216:219]
    s_add_u32 m0, s73, 67584
    ds_read_b128 a[4:7], v5 offset:33856
    v_mfma_f32_16x16x32_bf16 v[220:223], a[44:47], v[108:111], v[220:223]
    v_exp_f32 v77, v77
    v_mfma_f32_16x16x32_bf16 v[212:215], a[44:47], v[104:107], v[212:215]
    ds_read_b128 a[8:11], v5 offset:33920
    ds_read_b128 a[12:15], v5 offset:33984
    v_mfma_f32_16x16x32_bf16 v[224:227], a[48:51], v[104:107], v[224:227]
    ds_read_b64_tr_b16 a[130:131], v12 offset:34048
    v_exp_f32 v78, v78
    v_mfma_f32_16x16x32_bf16 v[232:235], a[48:51], v[108:111], v[232:235]
    ds_read_b128 a[16:19], v5 offset:34048
    v_mfma_f32_16x16x32_bf16 v[236:239], a[52:55], v[108:111], v[236:239]
    buffer_load_dwordx4 v19, s[12:15], s77 offen lds
    v_mfma_f32_16x16x32_bf16 v[228:231], a[52:55], v[104:107], v[228:231]
    ds_read_b128 a[20:23], v5 offset:34112
    ds_read_b128 a[24:27], v5 offset:34176
    v_exp_f32 v79, v79
    v_mfma_f32_16x16x32_bf16 v[240:243], a[56:59], v[104:107], v[240:243]
    ds_read_b64_tr_b16 a[132:133], v12 offset:34304
    ds_read_b128 a[28:31], v5 offset:34240
    v_mfma_f32_16x16x32_bf16 v[248:251], a[56:59], v[108:111], v[248:251]
    ds_read_b64_tr_b16 a[32:33], v7 offset:50688
    v_cvt_pk_bf16_f32 v102, v76, v77
    v_mfma_f32_16x16x32_bf16 v[252:255], a[60:63], v[108:111], v[252:255]
    ds_read_b64_tr_b16 a[34:35], v7 offset:51200
    v_cvt_pk_bf16_f32 v103, v78, v79
    v_mfma_f32_16x16x32_bf16 v[244:247], a[60:63], v[104:107], v[244:247]
    s_waitcnt lgkmcnt(8)
    ds_read_b64_tr_b16 a[134:135], v12 offset:34560
    v_mfma_f32_16x16x32_bf16 v[64:67], a[0:3], a[64:67], v[112:115]
    ds_read_b64_tr_b16 a[36:37], v7 offset:50720
    v_mfma_f32_16x16x32_bf16 v[64:67], a[4:7], a[72:75], v[64:67]
    ds_read_b64_tr_b16 a[38:39], v7 offset:51232
    v_mfma_f32_16x16x32_bf16 v[64:67], a[8:11], a[80:83], v[64:67]
    buffer_load_dwordx4 v20, s[12:15], s77 offen offset:1056 lds
    v_mfma_f32_16x16x32_bf16 v[64:67], a[12:15], a[88:91], v[64:67]
    ds_read_b64_tr_b16 a[40:41], v7 offset:50752
    ds_read_b64_tr_b16 a[136:137], v12 offset:33800
    v_mfma_f32_16x16x32_bf16 v[72:75], a[12:15], a[92:95], v[116:119]
    ds_read_b64_tr_b16 a[42:43], v7 offset:51264
    v_mfma_f32_16x16x32_bf16 v[72:75], a[8:11], a[84:87], v[72:75]
    ds_read_b64_tr_b16 a[44:45], v7 offset:50784
    v_mfma_f32_16x16x32_bf16 v[72:75], a[4:7], a[76:79], v[72:75]
    ds_read_b64_tr_b16 a[46:47], v7 offset:51296
    v_mfma_f32_16x16x32_bf16 v[72:75], a[0:3], a[68:71], v[72:75]
    s_waitcnt lgkmcnt(7)
    ds_read_b64_tr_b16 a[138:139], v12 offset:34056
    v_mfma_f32_16x16x32_bf16 v[72:75], a[16:19], a[100:103], v[72:75]
    ds_read_b64_tr_b16 a[48:49], v7 offset:50816
    v_mfma_f32_16x16x32_bf16 v[72:75], a[20:23], a[108:111], v[72:75]
    ds_read_b64_tr_b16 a[50:51], v7 offset:51328
    v_mfma_f32_16x16x32_bf16 v[72:75], a[24:27], a[116:119], v[72:75]
    buffer_load_dwordx4 v21, s[12:15], s77 offen offset:2112 lds
    v_mfma_f32_16x16x32_bf16 v[72:75], a[28:31], a[124:127], v[72:75]
    ds_read_b64_tr_b16 a[52:53], v7 offset:50848
    ds_read_b64_tr_b16 a[54:55], v7 offset:51360
    v_mfma_f32_16x16x32_bf16 v[64:67], a[28:31], a[120:123], v[64:67]
    ds_read_b64_tr_b16 a[140:141], v12 offset:34312
    v_mfma_f32_16x16x32_bf16 v[64:67], a[24:27], a[112:115], v[64:67]
    ds_read_b64_tr_b16 a[56:57], v7 offset:50880
    v_mfma_f32_16x16x32_bf16 v[64:67], a[20:23], a[104:107], v[64:67]
    ds_read_b64_tr_b16 a[58:59], v7 offset:51392
    v_mfma_f32_16x16x32_bf16 v[64:67], a[16:19], a[96:99], v[64:67]
    ds_read_b64_tr_b16 a[60:61], v7 offset:50912
    ds_read_b64_tr_b16 a[142:143], v12 offset:34568
    v_mfma_f32_16x16x32_bf16 v[128:131], a[32:35], v[96:99], v[128:131]
    v_exp_f32 v80, v80
    v_mfma_f32_16x16x32_bf16 v[136:139], a[32:35], v[100:103], v[136:139]
    s_waitcnt lgkmcnt(7)
    ds_read_b64_tr_b16 a[62:63], v7 offset:51424
    v_mfma_f32_16x16x32_bf16 v[140:143], a[36:39], v[100:103], v[140:143]
    buffer_load_dwordx4 v22, s[12:15], s77 offen offset:3168 lds
    v_exp_f32 v81, v81
    v_mfma_f32_16x16x32_bf16 v[132:135], a[36:39], v[96:99], v[132:135]
    ds_read_b128 a[0:3], v5 offset:34304
    ds_read_b128 a[4:7], v5 offset:34368
    v_mfma_f32_16x16x32_bf16 v[144:147], a[40:43], v[96:99], v[144:147]
    s_add_u32 s78, s75, 131072
    ds_read_b64_tr_b16 a[144:145], v8 offset:33792
    ds_read_b128 a[8:11], v5 offset:34432
    v_mfma_f32_16x16x32_bf16 v[152:155], a[40:43], v[100:103], v[152:155]
    s_add_u32 m0, s73, 84480
    v_exp_f32 v82, v82
    v_mfma_f32_16x16x32_bf16 v[156:159], a[44:47], v[100:103], v[156:159]
    ds_read_b128 a[12:15], v5 offset:34496
    v_mfma_f32_16x16x32_bf16 v[148:151], a[44:47], v[96:99], v[148:151]
    v_exp_f32 v83, v83
    v_mfma_f32_16x16x32_bf16 v[160:163], a[48:51], v[96:99], v[160:163]
    ds_read_b128 a[16:19], v5 offset:34560
    ds_read_b64_tr_b16 a[146:147], v8 offset:34048
    v_mfma_f32_16x16x32_bf16 v[168:171], a[48:51], v[100:103], v[168:171]
    s_waitcnt lgkmcnt(7)
    ds_read_b128 a[20:23], v5 offset:34624
    ds_read_b128 a[24:27], v5 offset:34688
    v_mfma_f32_16x16x32_bf16 v[172:175], a[52:55], v[100:103], v[172:175]
    buffer_load_dwordx4 v19, s[16:19], s78 offen lds
    v_cvt_pk_bf16_f32 v104, v80, v81
    v_mfma_f32_16x16x32_bf16 v[164:167], a[52:55], v[96:99], v[164:167]
    ds_read_b128 a[28:31], v5 offset:34752
    ds_read_b64_tr_b16 a[148:149], v8 offset:34304
    v_cvt_pk_bf16_f32 v105, v82, v83
    v_mfma_f32_16x16x32_bf16 v[176:179], a[56:59], v[96:99], v[176:179]
    v_exp_f32 v88, v88
    v_mfma_f32_16x16x32_bf16 v[184:187], a[56:59], v[100:103], v[184:187]
    ds_read_b64_tr_b16 a[32:33], v7 offset:50944
    ds_read_b64_tr_b16 a[34:35], v7 offset:51456
    v_mfma_f32_16x16x32_bf16 v[188:191], a[60:63], v[100:103], v[188:191]
    ds_read_b64_tr_b16 a[36:37], v7 offset:50976
    v_mfma_f32_16x16x32_bf16 v[180:183], a[60:63], v[96:99], v[180:183]
    v_exp_f32 v89, v89
    v_mfma_f32_16x16x32_bf16 a[240:243], a[248:251], v[96:99], a[240:243]
    ds_read_b64_tr_b16 a[38:39], v7 offset:51488
    ds_read_b64_tr_b16 a[150:151], v8 offset:34560
    v_mfma_f32_16x16x32_bf16 a[244:247], a[248:251], v[100:103], a[244:247]
    s_waitcnt lgkmcnt(7)
    v_exp_f32 v90, v90
    v_mfma_f32_16x16x32_bf16 v[68:71], a[0:3], a[64:67], v[112:115]
    ds_read_b64_tr_b16 a[40:41], v7 offset:51008
    ds_read_b64_tr_b16 a[42:43], v7 offset:51520
    v_mfma_f32_16x16x32_bf16 v[68:71], a[4:7], a[72:75], v[68:71]
    buffer_load_dwordx4 v20, s[16:19], s78 offen offset:1056 lds
    v_mfma_f32_16x16x32_bf16 v[68:71], a[8:11], a[80:83], v[68:71]
    ds_read_b64_tr_b16 a[44:45], v7 offset:51040
    ds_read_b64_tr_b16 a[152:153], v8 offset:33800
    v_exp_f32 v91, v91
    v_mfma_f32_16x16x32_bf16 v[68:71], a[12:15], a[88:91], v[68:71]
    ds_read_b64_tr_b16 a[46:47], v7 offset:51552
    v_cvt_pk_bf16_f32 v108, v88, v89
    v_mfma_f32_16x16x32_bf16 v[76:79], a[12:15], a[92:95], v[116:119]
    ds_read_b64_tr_b16 a[48:49], v7 offset:51072
    v_cvt_pk_bf16_f32 v109, v90, v91
    v_mfma_f32_16x16x32_bf16 v[76:79], a[8:11], a[84:87], v[76:79]
    ds_read_b64_tr_b16 a[50:51], v7 offset:51584
    ds_read_b64_tr_b16 a[154:155], v8 offset:34056
    v_mfma_f32_16x16x32_bf16 v[76:79], a[4:7], a[76:79], v[76:79]
    ds_read_b64_tr_b16 a[52:53], v7 offset:51104
    v_mfma_f32_16x16x32_bf16 v[76:79], a[0:3], a[68:71], v[76:79]
    v_exp_f32 v84, v84
    v_mfma_f32_16x16x32_bf16 v[76:79], a[16:19], a[100:103], v[76:79]
    ds_read_b64_tr_b16 a[54:55], v7 offset:51616
    v_mfma_f32_16x16x32_bf16 v[76:79], a[20:23], a[108:111], v[76:79]
    buffer_load_dwordx4 v21, s[16:19], s78 offen offset:2112 lds
    v_exp_f32 v85, v85
    v_mfma_f32_16x16x32_bf16 v[76:79], a[24:27], a[116:119], v[76:79]
    s_waitcnt lgkmcnt(6)
    ds_read_b64_tr_b16 a[56:57], v7 offset:51136
    ds_read_b64_tr_b16 a[156:157], v8 offset:34312
    v_mfma_f32_16x16x32_bf16 v[76:79], a[28:31], a[124:127], v[76:79]
    ds_read_b64_tr_b16 a[58:59], v7 offset:51648
    ds_read_b64_tr_b16 a[60:61], v7 offset:51168
    v_mfma_f32_16x16x32_bf16 v[68:71], a[28:31], a[120:123], v[68:71]
    v_exp_f32 v86, v86
    v_mfma_f32_16x16x32_bf16 v[68:71], a[24:27], a[112:115], v[68:71]
    ds_read_b64_tr_b16 a[62:63], v7 offset:51680
    ds_read_b64_tr_b16 a[158:159], v8 offset:34568
    v_mfma_f32_16x16x32_bf16 v[68:71], a[20:23], a[104:107], v[68:71]
    v_exp_f32 v87, v87
    v_mfma_f32_16x16x32_bf16 v[68:71], a[16:19], a[96:99], v[68:71]
    buffer_load_dwordx4 v22, s[16:19], s78 offen offset:3168 lds
    v_mfma_f32_16x16x32_bf16 v[192:195], a[32:35], v[96:99], v[192:195]
    ds_read_b64_tr_b16 a[160:161], v12 offset:42240
    v_cvt_pk_bf16_f32 v106, v84, v85
    v_mfma_f32_16x16x32_bf16 v[200:203], a[32:35], v[100:103], v[200:203]
    v_cvt_pk_bf16_f32 v107, v86, v87
    v_mfma_f32_16x16x32_bf16 v[204:207], a[36:39], v[100:103], v[204:207]
    v_exp_f32 v92, v92
    v_mfma_f32_16x16x32_bf16 v[196:199], a[36:39], v[96:99], v[196:199]
    s_waitcnt vmcnt(8) lgkmcnt(2)
    s_barrier
    ds_read_b128 a[0:3], v4 offset:0
    v_mfma_f32_16x16x32_bf16 v[208:211], a[40:43], v[96:99], v[208:211]
    s_add_u32 s77, s75, 180224
    ds_read_b64_tr_b16 a[162:163], v12 offset:42496
    v_mfma_f32_16x16x32_bf16 v[216:219], a[40:43], v[100:103], v[216:219]
    s_add_u32 m0, s73, 101376
    ds_read_b128 a[4:7], v4 offset:64
    v_mfma_f32_16x16x32_bf16 v[220:223], a[44:47], v[100:103], v[220:223]
    v_exp_f32 v93, v93
    v_mfma_f32_16x16x32_bf16 v[212:215], a[44:47], v[96:99], v[212:215]
    ds_read_b128 a[8:11], v4 offset:128
    ds_read_b128 a[12:15], v4 offset:192
    v_mfma_f32_16x16x32_bf16 v[224:227], a[48:51], v[96:99], v[224:227]
    v_exp_f32 v94, v94
    v_mfma_f32_16x16x32_bf16 v[232:235], a[48:51], v[100:103], v[232:235]
    ds_read_b64_tr_b16 a[164:165], v12 offset:42752
    ds_read_b128 a[16:19], v4 offset:256
    v_mfma_f32_16x16x32_bf16 v[236:239], a[52:55], v[100:103], v[236:239]
    buffer_load_dwordx4 v19, s[12:15], s77 offen lds
    v_mfma_f32_16x16x32_bf16 v[228:231], a[52:55], v[96:99], v[228:231]
    ds_read_b128 a[20:23], v4 offset:320
    ds_read_b128 a[24:27], v4 offset:384
    v_exp_f32 v95, v95
    v_mfma_f32_16x16x32_bf16 v[240:243], a[56:59], v[96:99], v[240:243]
    ds_read_b128 a[28:31], v4 offset:448
    ds_read_b64_tr_b16 a[166:167], v12 offset:43008
    v_mfma_f32_16x16x32_bf16 v[248:251], a[56:59], v[100:103], v[248:251]
    ds_read_b64_tr_b16 a[32:33], v6 offset:16896
    v_cvt_pk_bf16_f32 v110, v92, v93
    v_mfma_f32_16x16x32_bf16 v[252:255], a[60:63], v[100:103], v[252:255]
    ds_read_b64_tr_b16 a[34:35], v6 offset:17408
    v_cvt_pk_bf16_f32 v111, v94, v95
    v_mfma_f32_16x16x32_bf16 v[244:247], a[60:63], v[96:99], v[244:247]
    s_waitcnt lgkmcnt(8)
    ds_read_b64_tr_b16 a[36:37], v6 offset:16928
    v_mfma_f32_16x16x32_bf16 v[80:83], a[0:3], a[64:67], v[112:115]
    ds_read_b64_tr_b16 a[168:169], v12 offset:42248
    v_mfma_f32_16x16x32_bf16 v[80:83], a[4:7], a[72:75], v[80:83]
    ds_read_b64_tr_b16 a[38:39], v6 offset:17440
    v_mfma_f32_16x16x32_bf16 v[80:83], a[8:11], a[80:83], v[80:83]
    buffer_load_dwordx4 v20, s[12:15], s77 offen offset:1056 lds
    v_mfma_f32_16x16x32_bf16 v[80:83], a[12:15], a[88:91], v[80:83]
    ds_read_b64_tr_b16 a[40:41], v6 offset:16960
    v_mfma_f32_16x16x32_bf16 v[88:91], a[12:15], a[92:95], v[116:119]
    ds_read_b64_tr_b16 a[42:43], v6 offset:17472
    ds_read_b64_tr_b16 a[170:171], v12 offset:42504
    v_mfma_f32_16x16x32_bf16 v[88:91], a[8:11], a[84:87], v[88:91]
    ds_read_b64_tr_b16 a[44:45], v6 offset:16992
    v_mfma_f32_16x16x32_bf16 v[88:91], a[4:7], a[76:79], v[88:91]
    ds_read_b64_tr_b16 a[46:47], v6 offset:17504
    v_mfma_f32_16x16x32_bf16 v[88:91], a[0:3], a[68:71], v[88:91]
    s_waitcnt lgkmcnt(7)
    ds_read_b64_tr_b16 a[48:49], v6 offset:17024
    v_mfma_f32_16x16x32_bf16 v[88:91], a[16:19], a[100:103], v[88:91]
    ds_read_b64_tr_b16 a[172:173], v12 offset:42760
    v_mfma_f32_16x16x32_bf16 v[88:91], a[20:23], a[108:111], v[88:91]
    ds_read_b64_tr_b16 a[50:51], v6 offset:17536
    v_mfma_f32_16x16x32_bf16 v[88:91], a[24:27], a[116:119], v[88:91]
    buffer_load_dwordx4 v21, s[12:15], s77 offen offset:2112 lds
    v_mfma_f32_16x16x32_bf16 v[88:91], a[28:31], a[124:127], v[88:91]
    ds_read_b64_tr_b16 a[52:53], v6 offset:17056
    ds_read_b64_tr_b16 a[54:55], v6 offset:17568
    v_mfma_f32_16x16x32_bf16 v[80:83], a[28:31], a[120:123], v[80:83]
    ds_read_b64_tr_b16 a[174:175], v12 offset:43016
    v_mfma_f32_16x16x32_bf16 v[80:83], a[24:27], a[112:115], v[80:83]
    ds_read_b64_tr_b16 a[56:57], v6 offset:17088
    v_mfma_f32_16x16x32_bf16 v[80:83], a[20:23], a[104:107], v[80:83]
    ds_read_b64_tr_b16 a[58:59], v6 offset:17600
    v_mfma_f32_16x16x32_bf16 v[80:83], a[16:19], a[96:99], v[80:83]
    ds_read_b64_tr_b16 a[60:61], v6 offset:17120
    v_mfma_f32_16x16x32_bf16 v[128:131], a[32:35], v[104:107], v[128:131]
    v_exp_f32 v64, v64
    v_mfma_f32_16x16x32_bf16 v[136:139], a[32:35], v[108:111], v[136:139]
    s_waitcnt lgkmcnt(6)
    ds_read_b64_tr_b16 a[62:63], v6 offset:17632
    ds_read_b64_tr_b16 a[176:177], v8 offset:42240
    v_mfma_f32_16x16x32_bf16 v[140:143], a[36:39], v[108:111], v[140:143]
    buffer_load_dwordx4 v22, s[12:15], s77 offen offset:3168 lds
    v_exp_f32 v65, v65
    v_mfma_f32_16x16x32_bf16 v[132:135], a[36:39], v[104:107], v[132:135]
    ds_read_b128 a[0:3], v4 offset:512
    ds_read_b128 a[4:7], v4 offset:576
    v_mfma_f32_16x16x32_bf16 v[144:147], a[40:43], v[104:107], v[144:147]
    s_add_u32 s78, s75, 147456
    ds_read_b128 a[8:11], v4 offset:640
    ds_read_b64_tr_b16 a[178:179], v8 offset:42496
    v_mfma_f32_16x16x32_bf16 v[152:155], a[40:43], v[108:111], v[152:155]
    s_add_u32 m0, s73, 118272
    v_exp_f32 v66, v66
    v_mfma_f32_16x16x32_bf16 v[156:159], a[44:47], v[108:111], v[156:159]
    ds_read_b128 a[12:15], v4 offset:704
    v_mfma_f32_16x16x32_bf16 v[148:151], a[44:47], v[104:107], v[148:151]
    v_exp_f32 v67, v67
    v_mfma_f32_16x16x32_bf16 v[160:163], a[48:51], v[104:107], v[160:163]
    ds_read_b128 a[16:19], v4 offset:768
    ds_read_b128 a[20:23], v4 offset:832
    v_mfma_f32_16x16x32_bf16 v[168:171], a[48:51], v[108:111], v[168:171]
    s_waitcnt lgkmcnt(7)
    ds_read_b64_tr_b16 a[180:181], v8 offset:42752
    ds_read_b128 a[24:27], v4 offset:896
    v_mfma_f32_16x16x32_bf16 v[172:175], a[52:55], v[108:111], v[172:175]
    buffer_load_dwordx4 v19, s[16:19], s78 offen lds
    v_cvt_pk_bf16_f32 v96, v64, v65
    v_mfma_f32_16x16x32_bf16 v[164:167], a[52:55], v[104:107], v[164:167]
    ds_read_b128 a[28:31], v4 offset:960
    v_cvt_pk_bf16_f32 v97, v66, v67
    v_mfma_f32_16x16x32_bf16 v[176:179], a[56:59], v[104:107], v[176:179]
    v_exp_f32 v72, v72
    v_mfma_f32_16x16x32_bf16 v[184:187], a[56:59], v[108:111], v[184:187]
    ds_read_b64_tr_b16 a[32:33], v6 offset:17152
    ds_read_b64_tr_b16 a[182:183], v8 offset:43008
    v_mfma_f32_16x16x32_bf16 v[188:191], a[60:63], v[108:111], v[188:191]
    ds_read_b64_tr_b16 a[34:35], v6 offset:17664
    ds_read_b64_tr_b16 a[36:37], v6 offset:17184
    v_mfma_f32_16x16x32_bf16 v[180:183], a[60:63], v[104:107], v[180:183]
    v_exp_f32 v73, v73
    v_mfma_f32_16x16x32_bf16 a[240:243], a[248:251], v[104:107], a[240:243]
    ds_read_b64_tr_b16 a[38:39], v6 offset:17696
    ds_read_b64_tr_b16 a[184:185], v8 offset:42248
    v_mfma_f32_16x16x32_bf16 a[244:247], a[248:251], v[108:111], a[244:247]
    s_waitcnt lgkmcnt(7)
    v_exp_f32 v74, v74
    v_mfma_f32_16x16x32_bf16 v[84:87], a[0:3], a[64:67], v[112:115]
    ds_read_b64_tr_b16 a[40:41], v6 offset:17216
    ds_read_b64_tr_b16 a[42:43], v6 offset:17728
    v_mfma_f32_16x16x32_bf16 v[84:87], a[4:7], a[72:75], v[84:87]
    buffer_load_dwordx4 v20, s[16:19], s78 offen offset:1056 lds
    v_mfma_f32_16x16x32_bf16 v[84:87], a[8:11], a[80:83], v[84:87]
    ds_read_b64_tr_b16 a[44:45], v6 offset:17248
    ds_read_b64_tr_b16 a[46:47], v6 offset:17760
    v_exp_f32 v75, v75
    v_mfma_f32_16x16x32_bf16 v[84:87], a[12:15], a[88:91], v[84:87]
    ds_read_b64_tr_b16 a[186:187], v8 offset:42504
    v_cvt_pk_bf16_f32 v100, v72, v73
    v_mfma_f32_16x16x32_bf16 v[92:95], a[12:15], a[92:95], v[116:119]
    ds_read_b64_tr_b16 a[48:49], v6 offset:17280
    v_cvt_pk_bf16_f32 v101, v74, v75
    v_mfma_f32_16x16x32_bf16 v[92:95], a[8:11], a[84:87], v[92:95]
    ds_read_b64_tr_b16 a[50:51], v6 offset:17792
    v_mfma_f32_16x16x32_bf16 v[92:95], a[4:7], a[76:79], v[92:95]
    ds_read_b64_tr_b16 a[52:53], v6 offset:17312
    ds_read_b64_tr_b16 a[188:189], v8 offset:42760
    v_mfma_f32_16x16x32_bf16 v[92:95], a[0:3], a[68:71], v[92:95]
    v_exp_f32 v68, v68
    v_mfma_f32_16x16x32_bf16 v[92:95], a[16:19], a[100:103], v[92:95]
    ds_read_b64_tr_b16 a[54:55], v6 offset:17824
    v_mfma_f32_16x16x32_bf16 v[92:95], a[20:23], a[108:111], v[92:95]
    buffer_load_dwordx4 v21, s[16:19], s78 offen offset:2112 lds
    v_exp_f32 v69, v69
    v_mfma_f32_16x16x32_bf16 v[92:95], a[24:27], a[116:119], v[92:95]
    s_waitcnt lgkmcnt(6)
    ds_read_b64_tr_b16 a[56:57], v6 offset:17344
    ds_read_b64_tr_b16 a[58:59], v6 offset:17856
    v_mfma_f32_16x16x32_bf16 v[92:95], a[28:31], a[124:127], v[92:95]
    ds_read_b64_tr_b16 a[190:191], v8 offset:43016
    ds_read_b64_tr_b16 a[60:61], v6 offset:17376
    v_mfma_f32_16x16x32_bf16 v[84:87], a[28:31], a[120:123], v[84:87]
    v_exp_f32 v70, v70
    v_mfma_f32_16x16x32_bf16 v[84:87], a[24:27], a[112:115], v[84:87]
    ds_read_b64_tr_b16 a[62:63], v6 offset:17888
    v_mfma_f32_16x16x32_bf16 v[84:87], a[20:23], a[104:107], v[84:87]
    v_exp_f32 v71, v71
    v_mfma_f32_16x16x32_bf16 v[84:87], a[16:19], a[96:99], v[84:87]
    buffer_load_dwordx4 v22, s[16:19], s78 offen offset:3168 lds
    v_mfma_f32_16x16x32_bf16 v[192:195], a[32:35], v[104:107], v[192:195]
    v_cvt_pk_bf16_f32 v98, v68, v69
    v_cvt_pk_bf16_f32 v99, v70, v71
    v_mfma_f32_16x16x32_bf16 v[200:203], a[32:35], v[108:111], v[200:203]
    v_exp_f32 v76, v76
    v_mfma_f32_16x16x32_bf16 v[204:207], a[36:39], v[108:111], v[204:207]
    v_mfma_f32_16x16x32_bf16 v[196:199], a[36:39], v[104:107], v[196:199]
    s_waitcnt vmcnt(8) lgkmcnt(0)
    s_barrier
    ds_read_b128 a[0:3], v5 offset:0
    v_mfma_f32_16x16x32_bf16 v[208:211], a[40:43], v[104:107], v[208:211]
    s_add_u32 s77, s75, 196608
    ds_read_b128 a[4:7], v5 offset:64
    v_mfma_f32_16x16x32_bf16 v[216:219], a[40:43], v[108:111], v[216:219]
    s_add_u32 m0, s73, 0
    v_exp_f32 v77, v77
    v_mfma_f32_16x16x32_bf16 v[220:223], a[44:47], v[108:111], v[220:223]
    ds_read_b128 a[8:11], v5 offset:128
    v_mfma_f32_16x16x32_bf16 v[212:215], a[44:47], v[104:107], v[212:215]
    ds_read_b128 a[12:15], v5 offset:192
    v_mfma_f32_16x16x32_bf16 v[224:227], a[48:51], v[104:107], v[224:227]
    buffer_load_dwordx4 v19, s[12:15], s77 offen lds
    v_exp_f32 v78, v78
    v_mfma_f32_16x16x32_bf16 v[232:235], a[48:51], v[108:111], v[232:235]
    ds_read_b128 a[16:19], v5 offset:256
    v_mfma_f32_16x16x32_bf16 v[236:239], a[52:55], v[108:111], v[236:239]
    ds_read_b128 a[20:23], v5 offset:320
    v_mfma_f32_16x16x32_bf16 v[228:231], a[52:55], v[104:107], v[228:231]
    v_exp_f32 v79, v79
    v_mfma_f32_16x16x32_bf16 v[240:243], a[56:59], v[104:107], v[240:243]
    ds_read_b128 a[24:27], v5 offset:384
    ds_read_b128 a[28:31], v5 offset:448
    v_mfma_f32_16x16x32_bf16 v[248:251], a[56:59], v[108:111], v[248:251]
    buffer_load_dwordx4 v20, s[12:15], s77 offen offset:1056 lds
    v_cvt_pk_bf16_f32 v102, v76, v77
    v_mfma_f32_16x16x32_bf16 v[252:255], a[60:63], v[108:111], v[252:255]
    ds_read_b64_tr_b16 a[32:33], v7 offset:16896
    v_cvt_pk_bf16_f32 v103, v78, v79
    v_mfma_f32_16x16x32_bf16 v[244:247], a[60:63], v[104:107], v[244:247]
    s_waitcnt lgkmcnt(5)
    ds_read_b64_tr_b16 a[34:35], v7 offset:17408
    v_mfma_f32_16x16x32_bf16 v[64:67], a[0:3], a[64:67], v[112:115]
    buffer_load_dwordx4 v21, s[12:15], s77 offen offset:2112 lds
    v_mfma_f32_16x16x32_bf16 v[64:67], a[4:7], a[72:75], v[64:67]
    ds_read_b64_tr_b16 a[36:37], v7 offset:16928
    ds_read_b64_tr_b16 a[38:39], v7 offset:17440
    v_mfma_f32_16x16x32_bf16 v[64:67], a[8:11], a[80:83], v[64:67]
    ds_read_b64_tr_b16 a[40:41], v7 offset:16960
    v_mfma_f32_16x16x32_bf16 v[64:67], a[12:15], a[88:91], v[64:67]
    buffer_load_dwordx4 v22, s[12:15], s77 offen offset:3168 lds
    v_mfma_f32_16x16x32_bf16 v[72:75], a[12:15], a[92:95], v[116:119]
    s_add_u32 s78, s75, 163840
    ds_read_b64_tr_b16 a[42:43], v7 offset:17472
    v_mfma_f32_16x16x32_bf16 v[72:75], a[8:11], a[84:87], v[72:75]
    s_add_u32 m0, s73, 16896
    ds_read_b64_tr_b16 a[44:45], v7 offset:16992
    v_mfma_f32_16x16x32_bf16 v[72:75], a[4:7], a[76:79], v[72:75]
    ds_read_b64_tr_b16 a[46:47], v7 offset:17504
    v_mfma_f32_16x16x32_bf16 v[72:75], a[0:3], a[68:71], v[72:75]
    s_waitcnt lgkmcnt(6)
    buffer_load_dwordx4 v19, s[16:19], s78 offen lds
    v_mfma_f32_16x16x32_bf16 v[72:75], a[16:19], a[100:103], v[72:75]
    ds_read_b64_tr_b16 a[48:49], v7 offset:17024
    v_mfma_f32_16x16x32_bf16 v[72:75], a[20:23], a[108:111], v[72:75]
    ds_read_b64_tr_b16 a[50:51], v7 offset:17536
    v_mfma_f32_16x16x32_bf16 v[72:75], a[24:27], a[116:119], v[72:75]
    ds_read_b64_tr_b16 a[52:53], v7 offset:17056
    v_mfma_f32_16x16x32_bf16 v[72:75], a[28:31], a[124:127], v[72:75]
    ds_read_b64_tr_b16 a[54:55], v7 offset:17568
    v_mfma_f32_16x16x32_bf16 v[64:67], a[28:31], a[120:123], v[64:67]
    buffer_load_dwordx4 v20, s[16:19], s78 offen offset:1056 lds
    v_mfma_f32_16x16x32_bf16 v[64:67], a[24:27], a[112:115], v[64:67]
    ds_read_b64_tr_b16 a[56:57], v7 offset:17088
    v_mfma_f32_16x16x32_bf16 v[64:67], a[20:23], a[104:107], v[64:67]
    ds_read_b64_tr_b16 a[58:59], v7 offset:17600
    v_mfma_f32_16x16x32_bf16 v[64:67], a[16:19], a[96:99], v[64:67]
    ds_read_b64_tr_b16 a[60:61], v7 offset:17120
    v_mfma_f32_16x16x32_bf16 v[128:131], a[32:35], v[96:99], v[128:131]
    buffer_load_dwordx4 v21, s[16:19], s78 offen offset:2112 lds
    v_exp_f32 v80, v80
    v_mfma_f32_16x16x32_bf16 v[136:139], a[32:35], v[100:103], v[136:139]
    s_waitcnt lgkmcnt(5)
    ds_read_b64_tr_b16 a[62:63], v7 offset:17632
    v_mfma_f32_16x16x32_bf16 v[140:143], a[36:39], v[100:103], v[140:143]
    v_exp_f32 v81, v81
    v_mfma_f32_16x16x32_bf16 v[132:135], a[36:39], v[96:99], v[132:135]
    ds_read_b128 a[0:3], v5 offset:512
    ds_read_b128 a[4:7], v5 offset:576
    v_mfma_f32_16x16x32_bf16 v[144:147], a[40:43], v[96:99], v[144:147]
    buffer_load_dwordx4 v22, s[16:19], s78 offen offset:3168 lds
    v_mfma_f32_16x16x32_bf16 v[152:155], a[40:43], v[100:103], v[152:155]
    s_add_u32 s77, s76, 114688
    ds_read_b128 a[8:11], v5 offset:640
    ds_read_b128 a[12:15], v5 offset:704
    v_exp_f32 v82, v82
    v_mfma_f32_16x16x32_bf16 v[156:159], a[44:47], v[100:103], v[156:159]
    s_add_u32 m0, s72, 33792
    v_exp_f32 v83, v83
    v_mfma_f32_16x16x32_bf16 v[148:151], a[44:47], v[96:99], v[148:151]
    ds_read_b128 a[16:19], v5 offset:768
    v_mfma_f32_16x16x32_bf16 v[160:163], a[48:51], v[96:99], v[160:163]
    buffer_load_dwordx4 v23, s[20:23], s77 offen lds
    v_mfma_f32_16x16x32_bf16 v[168:171], a[48:51], v[100:103], v[168:171]
    s_waitcnt lgkmcnt(5)
    ds_read_b128 a[20:23], v5 offset:832
    ds_read_b128 a[24:27], v5 offset:896
    v_mfma_f32_16x16x32_bf16 v[172:175], a[52:55], v[100:103], v[172:175]
    ds_read_b128 a[28:31], v5 offset:960
    v_cvt_pk_bf16_f32 v104, v80, v81
    v_mfma_f32_16x16x32_bf16 v[164:167], a[52:55], v[96:99], v[164:167]
    buffer_load_dwordx4 v24, s[20:23], s77 offen offset:1032 lds
    v_cvt_pk_bf16_f32 v105, v82, v83
    v_mfma_f32_16x16x32_bf16 v[176:179], a[56:59], v[96:99], v[176:179]
    v_exp_f32 v88, v88
    v_mfma_f32_16x16x32_bf16 v[184:187], a[56:59], v[100:103], v[184:187]
    ds_read_b64_tr_b16 a[32:33], v7 offset:17152
    ds_read_b64_tr_b16 a[34:35], v7 offset:17664
    v_mfma_f32_16x16x32_bf16 v[188:191], a[60:63], v[100:103], v[188:191]
    ds_read_b64_tr_b16 a[36:37], v7 offset:17184
    v_mfma_f32_16x16x32_bf16 v[180:183], a[60:63], v[96:99], v[180:183]
    v_exp_f32 v89, v89
    v_mfma_f32_16x16x32_bf16 a[240:243], a[248:251], v[96:99], a[240:243]
    ds_read_b64_tr_b16 a[38:39], v7 offset:17696
    v_mfma_f32_16x16x32_bf16 a[244:247], a[248:251], v[100:103], a[244:247]
    s_waitcnt lgkmcnt(5)
    buffer_load_dwordx4 v25, s[20:23], s77 offen offset:2112 lds
    v_exp_f32 v90, v90
    v_mfma_f32_16x16x32_bf16 v[68:71], a[0:3], a[64:67], v[112:115]
    ds_read_b64_tr_b16 a[40:41], v7 offset:17216
    ds_read_b64_tr_b16 a[42:43], v7 offset:17728
    v_mfma_f32_16x16x32_bf16 v[68:71], a[4:7], a[72:75], v[68:71]
    ds_read_b64_tr_b16 a[44:45], v7 offset:17248
    v_mfma_f32_16x16x32_bf16 v[68:71], a[8:11], a[80:83], v[68:71]
    buffer_load_dwordx4 v26, s[20:23], s77 offen offset:3144 lds
    v_exp_f32 v91, v91
    v_mfma_f32_16x16x32_bf16 v[68:71], a[12:15], a[88:91], v[68:71]
    s_add_u32 s78, s76, 118272
    ds_read_b64_tr_b16 a[46:47], v7 offset:17760
    v_cvt_pk_bf16_f32 v108, v88, v89
    v_mfma_f32_16x16x32_bf16 v[76:79], a[12:15], a[92:95], v[116:119]
    s_add_u32 m0, s72, 38016
    ds_read_b64_tr_b16 a[48:49], v7 offset:17280
    v_cvt_pk_bf16_f32 v109, v90, v91
    v_mfma_f32_16x16x32_bf16 v[76:79], a[8:11], a[84:87], v[76:79]
    ds_read_b64_tr_b16 a[50:51], v7 offset:17792
    v_mfma_f32_16x16x32_bf16 v[76:79], a[4:7], a[76:79], v[76:79]
    buffer_load_dwordx4 v23, s[20:23], s78 offen lds
    v_mfma_f32_16x16x32_bf16 v[76:79], a[0:3], a[68:71], v[76:79]
    ds_read_b64_tr_b16 a[52:53], v7 offset:17312
    ds_read_b64_tr_b16 a[54:55], v7 offset:17824
    v_exp_f32 v84, v84
    v_mfma_f32_16x16x32_bf16 v[76:79], a[16:19], a[100:103], v[76:79]
    v_exp_f32 v85, v85
    v_mfma_f32_16x16x32_bf16 v[76:79], a[20:23], a[108:111], v[76:79]
    ds_read_b64_tr_b16 a[56:57], v7 offset:17344
    v_mfma_f32_16x16x32_bf16 v[76:79], a[24:27], a[116:119], v[76:79]
    s_waitcnt lgkmcnt(6)
    buffer_load_dwordx4 v24, s[20:23], s78 offen offset:1032 lds
    v_mfma_f32_16x16x32_bf16 v[76:79], a[28:31], a[124:127], v[76:79]
    ds_read_b64_tr_b16 a[58:59], v7 offset:17856
    ds_read_b64_tr_b16 a[60:61], v7 offset:17376
    v_mfma_f32_16x16x32_bf16 v[68:71], a[28:31], a[120:123], v[68:71]
    v_exp_f32 v86, v86
    v_mfma_f32_16x16x32_bf16 v[68:71], a[24:27], a[112:115], v[68:71]
    ds_read_b64_tr_b16 a[62:63], v7 offset:17888
    v_mfma_f32_16x16x32_bf16 v[68:71], a[20:23], a[104:107], v[68:71]
    buffer_load_dwordx4 v25, s[20:23], s78 offen offset:2112 lds
    v_exp_f32 v87, v87
    v_mfma_f32_16x16x32_bf16 v[68:71], a[16:19], a[96:99], v[68:71]
    v_cvt_pk_bf16_f32 v106, v84, v85
    v_mfma_f32_16x16x32_bf16 v[192:195], a[32:35], v[96:99], v[192:195]
    buffer_load_dwordx4 v26, s[20:23], s78 offen offset:3144 lds
    v_mfma_f32_16x16x32_bf16 v[200:203], a[32:35], v[100:103], v[200:203]
    v_cvt_pk_bf16_f32 v107, v86, v87
    v_mfma_f32_16x16x32_bf16 v[204:207], a[36:39], v[100:103], v[204:207]
    v_exp_f32 v92, v92
    v_mfma_f32_16x16x32_bf16 v[196:199], a[36:39], v[96:99], v[196:199]
    s_waitcnt vmcnt(16) lgkmcnt(0)
    s_barrier
    ds_read_b128 a[0:3], v5 offset:33792
    v_mfma_f32_16x16x32_bf16 v[208:211], a[40:43], v[96:99], v[208:211]
    s_add_u32 s77, s75, 212992
    ds_read_b128 a[4:7], v5 offset:33856
    v_mfma_f32_16x16x32_bf16 v[216:219], a[40:43], v[100:103], v[216:219]
    s_add_u32 m0, s73, 67584
    v_exp_f32 v93, v93
    v_mfma_f32_16x16x32_bf16 v[220:223], a[44:47], v[100:103], v[220:223]
    ds_read_b128 a[8:11], v5 offset:33920
    v_mfma_f32_16x16x32_bf16 v[212:215], a[44:47], v[96:99], v[212:215]
    ds_read_b128 a[12:15], v5 offset:33984
    v_mfma_f32_16x16x32_bf16 v[224:227], a[48:51], v[96:99], v[224:227]
    v_exp_f32 v94, v94
    v_mfma_f32_16x16x32_bf16 v[232:235], a[48:51], v[100:103], v[232:235]
    ds_read_b128 a[16:19], v5 offset:34048
    v_mfma_f32_16x16x32_bf16 v[236:239], a[52:55], v[100:103], v[236:239]
    buffer_load_dwordx4 v19, s[12:15], s77 offen lds
    v_mfma_f32_16x16x32_bf16 v[228:231], a[52:55], v[96:99], v[228:231]
    ds_read_b128 a[20:23], v5 offset:34112
    ds_read_b128 a[24:27], v5 offset:34176
    v_exp_f32 v95, v95
    v_mfma_f32_16x16x32_bf16 v[240:243], a[56:59], v[96:99], v[240:243]
    ds_read_b128 a[28:31], v5 offset:34240
    v_cvt_pk_bf16_f32 v110, v92, v93
    v_mfma_f32_16x16x32_bf16 v[248:251], a[56:59], v[100:103], v[248:251]
    ds_read_b64_tr_b16 a[32:33], v7 offset:50688
    v_cvt_pk_bf16_f32 v111, v94, v95
    v_mfma_f32_16x16x32_bf16 v[252:255], a[60:63], v[100:103], v[252:255]
    ds_read_b64_tr_b16 a[34:35], v7 offset:51200
    v_mfma_f32_16x16x32_bf16 v[244:247], a[60:63], v[96:99], v[244:247]
    s_waitcnt lgkmcnt(6)
    ds_read_b64_tr_b16 a[36:37], v7 offset:50720
    v_mfma_f32_16x16x32_bf16 v[80:83], a[0:3], a[64:67], v[112:115]
    ds_read_b64_tr_b16 a[38:39], v7 offset:51232
    v_mfma_f32_16x16x32_bf16 v[80:83], a[4:7], a[72:75], v[80:83]
    buffer_load_dwordx4 v20, s[12:15], s77 offen offset:1056 lds
    v_mfma_f32_16x16x32_bf16 v[80:83], a[8:11], a[80:83], v[80:83]
    ds_read_b64_tr_b16 a[40:41], v7 offset:50752
    v_mfma_f32_16x16x32_bf16 v[80:83], a[12:15], a[88:91], v[80:83]
    ds_read_b64_tr_b16 a[42:43], v7 offset:51264
    v_mfma_f32_16x16x32_bf16 v[88:91], a[12:15], a[92:95], v[116:119]
    ds_read_b64_tr_b16 a[44:45], v7 offset:50784
    v_mfma_f32_16x16x32_bf16 v[88:91], a[8:11], a[84:87], v[88:91]
    ds_read_b64_tr_b16 a[46:47], v7 offset:51296
    v_mfma_f32_16x16x32_bf16 v[88:91], a[4:7], a[76:79], v[88:91]
    v_mfma_f32_16x16x32_bf16 v[88:91], a[0:3], a[68:71], v[88:91]
    s_waitcnt lgkmcnt(5)
    ds_read_b64_tr_b16 a[48:49], v7 offset:50816
    v_mfma_f32_16x16x32_bf16 v[88:91], a[16:19], a[100:103], v[88:91]
    ds_read_b64_tr_b16 a[50:51], v7 offset:51328
    v_mfma_f32_16x16x32_bf16 v[88:91], a[20:23], a[108:111], v[88:91]
    buffer_load_dwordx4 v21, s[12:15], s77 offen offset:2112 lds
    v_mfma_f32_16x16x32_bf16 v[88:91], a[24:27], a[116:119], v[88:91]
    ds_read_b64_tr_b16 a[52:53], v7 offset:50848
    v_mfma_f32_16x16x32_bf16 v[88:91], a[28:31], a[124:127], v[88:91]
    ds_read_b64_tr_b16 a[54:55], v7 offset:51360
    v_mfma_f32_16x16x32_bf16 v[80:83], a[28:31], a[120:123], v[80:83]
    ds_read_b64_tr_b16 a[56:57], v7 offset:50880
    v_mfma_f32_16x16x32_bf16 v[80:83], a[24:27], a[112:115], v[80:83]
    ds_read_b64_tr_b16 a[58:59], v7 offset:51392
    v_mfma_f32_16x16x32_bf16 v[80:83], a[20:23], a[104:107], v[80:83]
    ds_read_b64_tr_b16 a[60:61], v7 offset:50912
    v_mfma_f32_16x16x32_bf16 v[80:83], a[16:19], a[96:99], v[80:83]
    v_exp_f32 v64, v64
    v_mfma_f32_16x16x32_bf16 v[128:131], a[32:35], v[104:107], v[128:131]
    ds_read_b64_tr_b16 a[62:63], v7 offset:51424
    v_mfma_f32_16x16x32_bf16 v[136:139], a[32:35], v[108:111], v[136:139]
    s_waitcnt lgkmcnt(6)
    buffer_load_dwordx4 v22, s[12:15], s77 offen offset:3168 lds
    v_mfma_f32_16x16x32_bf16 v[140:143], a[36:39], v[108:111], v[140:143]
    v_exp_f32 v65, v65
    v_mfma_f32_16x16x32_bf16 v[132:135], a[36:39], v[104:107], v[132:135]
    ds_read_b128 a[0:3], v5 offset:34304
    ds_read_b128 a[4:7], v5 offset:34368
    v_mfma_f32_16x16x32_bf16 v[144:147], a[40:43], v[104:107], v[144:147]
    s_add_u32 s78, s75, 180224
    ds_read_b128 a[8:11], v5 offset:34432
    v_mfma_f32_16x16x32_bf16 v[152:155], a[40:43], v[108:111], v[152:155]
    s_add_u32 m0, s73, 84480
    v_exp_f32 v66, v66
    v_mfma_f32_16x16x32_bf16 v[156:159], a[44:47], v[108:111], v[156:159]
    ds_read_b128 a[12:15], v5 offset:34496
    v_mfma_f32_16x16x32_bf16 v[148:151], a[44:47], v[104:107], v[148:151]
    v_exp_f32 v67, v67
    v_mfma_f32_16x16x32_bf16 v[160:163], a[48:51], v[104:107], v[160:163]
    ds_read_b128 a[16:19], v5 offset:34560
    ds_read_b128 a[20:23], v5 offset:34624
    v_mfma_f32_16x16x32_bf16 v[168:171], a[48:51], v[108:111], v[168:171]
    s_waitcnt lgkmcnt(6)
    ds_read_b128 a[24:27], v5 offset:34688
    v_cvt_pk_bf16_f32 v96, v64, v65
    v_mfma_f32_16x16x32_bf16 v[172:175], a[52:55], v[108:111], v[172:175]
    buffer_load_dwordx4 v19, s[16:19], s78 offen lds
    v_mfma_f32_16x16x32_bf16 v[164:167], a[52:55], v[104:107], v[164:167]
    ds_read_b128 a[28:31], v5 offset:34752
    v_cvt_pk_bf16_f32 v97, v66, v67
    v_mfma_f32_16x16x32_bf16 v[176:179], a[56:59], v[104:107], v[176:179]
    v_exp_f32 v72, v72
    v_mfma_f32_16x16x32_bf16 v[184:187], a[56:59], v[108:111], v[184:187]
    ds_read_b64_tr_b16 a[32:33], v7 offset:50944
    ds_read_b64_tr_b16 a[34:35], v7 offset:51456
    v_mfma_f32_16x16x32_bf16 v[188:191], a[60:63], v[108:111], v[188:191]
    ds_read_b64_tr_b16 a[36:37], v7 offset:50976
    v_mfma_f32_16x16x32_bf16 v[180:183], a[60:63], v[104:107], v[180:183]
    v_exp_f32 v73, v73
    v_mfma_f32_16x16x32_bf16 a[240:243], a[248:251], v[104:107], a[240:243]
    ds_read_b64_tr_b16 a[38:39], v7 offset:51488
    v_mfma_f32_16x16x32_bf16 a[244:247], a[248:251], v[108:111], a[244:247]
    s_waitcnt lgkmcnt(5)
    v_exp_f32 v74, v74
    v_mfma_f32_16x16x32_bf16 v[84:87], a[0:3], a[64:67], v[112:115]
    ds_read_b64_tr_b16 a[40:41], v7 offset:51008
    ds_read_b64_tr_b16 a[42:43], v7 offset:51520
    v_mfma_f32_16x16x32_bf16 v[84:87], a[4:7], a[72:75], v[84:87]
    buffer_load_dwordx4 v20, s[16:19], s78 offen offset:1056 lds
    v_mfma_f32_16x16x32_bf16 v[84:87], a[8:11], a[80:83], v[84:87]
    ds_read_b64_tr_b16 a[44:45], v7 offset:51040
    ds_read_b64_tr_b16 a[46:47], v7 offset:51552
    v_exp_f32 v75, v75
    v_mfma_f32_16x16x32_bf16 v[84:87], a[12:15], a[88:91], v[84:87]
    ds_read_b64_tr_b16 a[48:49], v7 offset:51072
    v_cvt_pk_bf16_f32 v100, v72, v73
    v_mfma_f32_16x16x32_bf16 v[92:95], a[12:15], a[92:95], v[116:119]
    ds_read_b64_tr_b16 a[50:51], v7 offset:51584
    v_cvt_pk_bf16_f32 v101, v74, v75
    v_mfma_f32_16x16x32_bf16 v[92:95], a[8:11], a[84:87], v[92:95]
    ds_read_b64_tr_b16 a[52:53], v7 offset:51104
    v_mfma_f32_16x16x32_bf16 v[92:95], a[4:7], a[76:79], v[92:95]
    v_exp_f32 v68, v68
    v_mfma_f32_16x16x32_bf16 v[92:95], a[0:3], a[68:71], v[92:95]
    ds_read_b64_tr_b16 a[54:55], v7 offset:51616
    v_mfma_f32_16x16x32_bf16 v[92:95], a[16:19], a[100:103], v[92:95]
    buffer_load_dwordx4 v21, s[16:19], s78 offen offset:2112 lds
    v_mfma_f32_16x16x32_bf16 v[92:95], a[20:23], a[108:111], v[92:95]
    v_exp_f32 v69, v69
    v_mfma_f32_16x16x32_bf16 v[92:95], a[24:27], a[116:119], v[92:95]
    s_waitcnt lgkmcnt(4)
    ds_read_b64_tr_b16 a[56:57], v7 offset:51136
    ds_read_b64_tr_b16 a[58:59], v7 offset:51648
    v_mfma_f32_16x16x32_bf16 v[92:95], a[28:31], a[124:127], v[92:95]
    ds_read_b64_tr_b16 a[60:61], v7 offset:51168
    v_mfma_f32_16x16x32_bf16 v[84:87], a[28:31], a[120:123], v[84:87]
    v_exp_f32 v70, v70
    v_mfma_f32_16x16x32_bf16 v[84:87], a[24:27], a[112:115], v[84:87]
    ds_read_b64_tr_b16 a[62:63], v7 offset:51680
    v_mfma_f32_16x16x32_bf16 v[84:87], a[20:23], a[104:107], v[84:87]
    v_exp_f32 v71, v71
    v_mfma_f32_16x16x32_bf16 v[84:87], a[16:19], a[96:99], v[84:87]
    buffer_load_dwordx4 v22, s[16:19], s78 offen offset:3168 lds
    v_mfma_f32_16x16x32_bf16 v[192:195], a[32:35], v[104:107], v[192:195]
    v_cvt_pk_bf16_f32 v98, v68, v69
    v_cvt_pk_bf16_f32 v99, v70, v71
    v_mfma_f32_16x16x32_bf16 v[200:203], a[32:35], v[108:111], v[200:203]
    v_exp_f32 v76, v76
    v_mfma_f32_16x16x32_bf16 v[204:207], a[36:39], v[108:111], v[204:207]
    v_mfma_f32_16x16x32_bf16 v[196:199], a[36:39], v[104:107], v[196:199]
    s_waitcnt vmcnt(8) lgkmcnt(0)
    s_barrier
    ds_read_b128 a[0:3], v4 offset:0
    v_mfma_f32_16x16x32_bf16 v[208:211], a[40:43], v[104:107], v[208:211]
    s_add_u32 s77, s75, 229376
    ds_read_b64_tr_b16 v[32:33], v12 offset:33792
    v_mfma_f32_16x16x32_bf16 v[216:219], a[40:43], v[108:111], v[216:219]
    s_add_u32 m0, s73, 101376
    ds_read_b128 a[4:7], v4 offset:64
    v_mfma_f32_16x16x32_bf16 v[220:223], a[44:47], v[108:111], v[220:223]
    v_exp_f32 v77, v77
    v_mfma_f32_16x16x32_bf16 v[212:215], a[44:47], v[104:107], v[212:215]
    ds_read_b128 a[8:11], v4 offset:128
    ds_read_b128 a[12:15], v4 offset:192
    v_mfma_f32_16x16x32_bf16 v[224:227], a[48:51], v[104:107], v[224:227]
    v_exp_f32 v78, v78
    v_mfma_f32_16x16x32_bf16 v[232:235], a[48:51], v[108:111], v[232:235]
    ds_read_b128 a[16:19], v4 offset:256
    v_mfma_f32_16x16x32_bf16 v[236:239], a[52:55], v[108:111], v[236:239]
    buffer_load_dwordx4 v19, s[12:15], s77 offen lds
    v_mfma_f32_16x16x32_bf16 v[228:231], a[52:55], v[104:107], v[228:231]
    ds_read_b128 a[20:23], v4 offset:320
    ds_read_b64_tr_b16 v[34:35], v12 offset:34048
    v_exp_f32 v79, v79
    v_mfma_f32_16x16x32_bf16 v[240:243], a[56:59], v[104:107], v[240:243]
    ds_read_b128 a[24:27], v4 offset:384
    ds_read_b128 a[28:31], v4 offset:448
    v_mfma_f32_16x16x32_bf16 v[248:251], a[56:59], v[108:111], v[248:251]
    ds_read_b64_tr_b16 a[32:33], v6 offset:16896
    v_cvt_pk_bf16_f32 v102, v76, v77
    v_mfma_f32_16x16x32_bf16 v[252:255], a[60:63], v[108:111], v[252:255]
    ds_read_b64_tr_b16 a[34:35], v6 offset:17408
    v_cvt_pk_bf16_f32 v103, v78, v79
    v_mfma_f32_16x16x32_bf16 v[244:247], a[60:63], v[104:107], v[244:247]
    s_waitcnt lgkmcnt(7)
    ds_read_b64_tr_b16 a[36:37], v6 offset:16928
    v_mfma_f32_16x16x32_bf16 v[64:67], a[0:3], a[64:67], v[112:115]
    ds_read_b64_tr_b16 v[36:37], v12 offset:34304
    v_mfma_f32_16x16x32_bf16 v[64:67], a[4:7], a[72:75], v[64:67]
    ds_read_b64_tr_b16 a[38:39], v6 offset:17440
    v_mfma_f32_16x16x32_bf16 v[64:67], a[8:11], a[80:83], v[64:67]
    buffer_load_dwordx4 v20, s[12:15], s77 offen offset:1056 lds
    v_mfma_f32_16x16x32_bf16 v[64:67], a[12:15], a[88:91], v[64:67]
    ds_read_b64_tr_b16 a[40:41], v6 offset:16960
    v_mfma_f32_16x16x32_bf16 v[72:75], a[12:15], a[92:95], v[116:119]
    ds_read_b64_tr_b16 a[42:43], v6 offset:17472
    v_mfma_f32_16x16x32_bf16 v[72:75], a[8:11], a[84:87], v[72:75]
    ds_read_b64_tr_b16 a[44:45], v6 offset:16992
    v_mfma_f32_16x16x32_bf16 v[72:75], a[4:7], a[76:79], v[72:75]
    ds_read_b64_tr_b16 a[46:47], v6 offset:17504
    ds_read_b64_tr_b16 v[38:39], v12 offset:34560
    v_mfma_f32_16x16x32_bf16 v[72:75], a[0:3], a[68:71], v[72:75]
    s_waitcnt lgkmcnt(7)
    ds_read_b64_tr_b16 a[48:49], v6 offset:17024
    v_mfma_f32_16x16x32_bf16 v[72:75], a[16:19], a[100:103], v[72:75]
    ds_read_b64_tr_b16 a[50:51], v6 offset:17536
    v_mfma_f32_16x16x32_bf16 v[72:75], a[20:23], a[108:111], v[72:75]
    buffer_load_dwordx4 v21, s[12:15], s77 offen offset:2112 lds
    v_mfma_f32_16x16x32_bf16 v[72:75], a[24:27], a[116:119], v[72:75]
    ds_read_b64_tr_b16 a[52:53], v6 offset:17056
    v_mfma_f32_16x16x32_bf16 v[72:75], a[28:31], a[124:127], v[72:75]
    ds_read_b64_tr_b16 a[54:55], v6 offset:17568
    v_mfma_f32_16x16x32_bf16 v[64:67], a[28:31], a[120:123], v[64:67]
    ds_read_b64_tr_b16 v[40:41], v12 offset:33800
    v_mfma_f32_16x16x32_bf16 v[64:67], a[24:27], a[112:115], v[64:67]
    ds_read_b64_tr_b16 a[56:57], v6 offset:17088
    v_mfma_f32_16x16x32_bf16 v[64:67], a[20:23], a[104:107], v[64:67]
    ds_read_b64_tr_b16 a[58:59], v6 offset:17600
    v_mfma_f32_16x16x32_bf16 v[64:67], a[16:19], a[96:99], v[64:67]
    ds_read_b64_tr_b16 a[60:61], v6 offset:17120
    v_mfma_f32_16x16x32_bf16 v[128:131], a[32:35], v[96:99], v[128:131]
    v_exp_f32 v80, v80
    v_mfma_f32_16x16x32_bf16 v[136:139], a[32:35], v[100:103], v[136:139]
    s_waitcnt lgkmcnt(6)
    ds_read_b64_tr_b16 a[62:63], v6 offset:17632
    v_mfma_f32_16x16x32_bf16 v[140:143], a[36:39], v[100:103], v[140:143]
    buffer_load_dwordx4 v22, s[12:15], s77 offen offset:3168 lds
    v_exp_f32 v81, v81
    v_mfma_f32_16x16x32_bf16 v[132:135], a[36:39], v[96:99], v[132:135]
    ds_read_b128 a[0:3], v4 offset:512
    ds_read_b64_tr_b16 v[42:43], v12 offset:34056
    v_mfma_f32_16x16x32_bf16 v[144:147], a[40:43], v[96:99], v[144:147]
    s_add_u32 s78, s75, 196608
    ds_read_b128 a[4:7], v4 offset:576
    ds_read_b128 a[8:11], v4 offset:640
    v_mfma_f32_16x16x32_bf16 v[152:155], a[40:43], v[100:103], v[152:155]
    s_add_u32 m0, s73, 118272
    v_exp_f32 v82, v82
    v_mfma_f32_16x16x32_bf16 v[156:159], a[44:47], v[100:103], v[156:159]
    ds_read_b128 a[12:15], v4 offset:704
    v_mfma_f32_16x16x32_bf16 v[148:151], a[44:47], v[96:99], v[148:151]
    v_exp_f32 v83, v83
    v_mfma_f32_16x16x32_bf16 v[160:163], a[48:51], v[96:99], v[160:163]
    ds_read_b128 a[16:19], v4 offset:768
    ds_read_b128 a[20:23], v4 offset:832
    v_mfma_f32_16x16x32_bf16 v[168:171], a[48:51], v[100:103], v[168:171]
    s_waitcnt lgkmcnt(7)
    ds_read_b64_tr_b16 v[44:45], v12 offset:34312
    ds_read_b128 a[24:27], v4 offset:896
    v_mfma_f32_16x16x32_bf16 v[172:175], a[52:55], v[100:103], v[172:175]
    buffer_load_dwordx4 v19, s[16:19], s78 offen lds
    v_cvt_pk_bf16_f32 v104, v80, v81
    v_mfma_f32_16x16x32_bf16 v[164:167], a[52:55], v[96:99], v[164:167]
    ds_read_b128 a[28:31], v4 offset:960
    v_cvt_pk_bf16_f32 v105, v82, v83
    v_mfma_f32_16x16x32_bf16 v[176:179], a[56:59], v[96:99], v[176:179]
    v_exp_f32 v88, v88
    v_mfma_f32_16x16x32_bf16 v[184:187], a[56:59], v[100:103], v[184:187]
    ds_read_b64_tr_b16 a[32:33], v6 offset:17152
    ds_read_b64_tr_b16 a[34:35], v6 offset:17664
    v_mfma_f32_16x16x32_bf16 v[188:191], a[60:63], v[100:103], v[188:191]
    ds_read_b64_tr_b16 a[36:37], v6 offset:17184
    ds_read_b64_tr_b16 v[46:47], v12 offset:34568
    v_mfma_f32_16x16x32_bf16 v[180:183], a[60:63], v[96:99], v[180:183]
    v_exp_f32 v89, v89
    v_mfma_f32_16x16x32_bf16 a[240:243], a[248:251], v[96:99], a[240:243]
    ds_read_b64_tr_b16 a[38:39], v6 offset:17696
    v_mfma_f32_16x16x32_bf16 a[244:247], a[248:251], v[100:103], a[244:247]
    s_waitcnt lgkmcnt(6)
    v_exp_f32 v90, v90
    v_mfma_f32_16x16x32_bf16 v[68:71], a[0:3], a[64:67], v[112:115]
    ds_read_b64_tr_b16 a[40:41], v6 offset:17216
    ds_read_b64_tr_b16 a[42:43], v6 offset:17728
    v_mfma_f32_16x16x32_bf16 v[68:71], a[4:7], a[72:75], v[68:71]
    buffer_load_dwordx4 v20, s[16:19], s78 offen offset:1056 lds
    v_mfma_f32_16x16x32_bf16 v[68:71], a[8:11], a[80:83], v[68:71]
    ds_read_b64_tr_b16 a[44:45], v6 offset:17248
    ds_read_b64_tr_b16 a[46:47], v6 offset:17760
    v_exp_f32 v91, v91
    v_mfma_f32_16x16x32_bf16 v[68:71], a[12:15], a[88:91], v[68:71]
    ds_read_b64_tr_b16 a[192:193], v8 offset:33792
    v_cvt_pk_bf16_f32 v108, v88, v89
    v_mfma_f32_16x16x32_bf16 v[76:79], a[12:15], a[92:95], v[116:119]
    ds_read_b64_tr_b16 a[48:49], v6 offset:17280
    v_cvt_pk_bf16_f32 v109, v90, v91
    v_mfma_f32_16x16x32_bf16 v[76:79], a[8:11], a[84:87], v[76:79]
    ds_read_b64_tr_b16 a[50:51], v6 offset:17792
    v_mfma_f32_16x16x32_bf16 v[76:79], a[4:7], a[76:79], v[76:79]
    ds_read_b64_tr_b16 a[52:53], v6 offset:17312
    v_mfma_f32_16x16x32_bf16 v[76:79], a[0:3], a[68:71], v[76:79]
    v_exp_f32 v84, v84
    v_mfma_f32_16x16x32_bf16 v[76:79], a[16:19], a[100:103], v[76:79]
    ds_read_b64_tr_b16 a[54:55], v6 offset:17824
    ds_read_b64_tr_b16 a[194:195], v8 offset:34048
    v_mfma_f32_16x16x32_bf16 v[76:79], a[20:23], a[108:111], v[76:79]
    buffer_load_dwordx4 v21, s[16:19], s78 offen offset:2112 lds
    v_exp_f32 v85, v85
    v_mfma_f32_16x16x32_bf16 v[76:79], a[24:27], a[116:119], v[76:79]
    s_waitcnt lgkmcnt(6)
    ds_read_b64_tr_b16 a[56:57], v6 offset:17344
    ds_read_b64_tr_b16 a[58:59], v6 offset:17856
    v_mfma_f32_16x16x32_bf16 v[76:79], a[28:31], a[124:127], v[76:79]
    ds_read_b64_tr_b16 a[60:61], v6 offset:17376
    v_mfma_f32_16x16x32_bf16 v[68:71], a[28:31], a[120:123], v[68:71]
    v_exp_f32 v86, v86
    v_mfma_f32_16x16x32_bf16 v[68:71], a[24:27], a[112:115], v[68:71]
    ds_read_b64_tr_b16 a[62:63], v6 offset:17888
    v_mfma_f32_16x16x32_bf16 v[68:71], a[20:23], a[104:107], v[68:71]
    v_exp_f32 v87, v87
    v_mfma_f32_16x16x32_bf16 v[68:71], a[16:19], a[96:99], v[68:71]
    ds_read_b64_tr_b16 a[196:197], v8 offset:34304
    v_cvt_pk_bf16_f32 v106, v84, v85
    v_mfma_f32_16x16x32_bf16 v[192:195], a[32:35], v[96:99], v[192:195]
    buffer_load_dwordx4 v22, s[16:19], s78 offen offset:3168 lds
    v_mfma_f32_16x16x32_bf16 v[200:203], a[32:35], v[100:103], v[200:203]
    v_cvt_pk_bf16_f32 v107, v86, v87
    v_mfma_f32_16x16x32_bf16 v[204:207], a[36:39], v[100:103], v[204:207]
    v_exp_f32 v92, v92
    v_mfma_f32_16x16x32_bf16 v[196:199], a[36:39], v[96:99], v[196:199]
    s_waitcnt vmcnt(8) lgkmcnt(1)
    s_barrier
    ds_read_b128 a[0:3], v5 offset:0
    v_mfma_f32_16x16x32_bf16 v[208:211], a[40:43], v[96:99], v[208:211]
    s_add_u32 s77, s75, 245760
    ds_read_b64_tr_b16 a[198:199], v8 offset:34560
    v_mfma_f32_16x16x32_bf16 v[216:219], a[40:43], v[100:103], v[216:219]
    s_add_u32 m0, s73, 0
    ds_read_b128 a[4:7], v5 offset:64
    v_mfma_f32_16x16x32_bf16 v[220:223], a[44:47], v[100:103], v[220:223]
    v_exp_f32 v93, v93
    v_mfma_f32_16x16x32_bf16 v[212:215], a[44:47], v[96:99], v[212:215]
    ds_read_b128 a[8:11], v5 offset:128
    ds_read_b128 a[12:15], v5 offset:192
    v_mfma_f32_16x16x32_bf16 v[224:227], a[48:51], v[96:99], v[224:227]
    v_exp_f32 v94, v94
    v_mfma_f32_16x16x32_bf16 v[232:235], a[48:51], v[100:103], v[232:235]
    ds_read_b128 a[16:19], v5 offset:256
    v_mfma_f32_16x16x32_bf16 v[236:239], a[52:55], v[100:103], v[236:239]
    buffer_load_dwordx4 v19, s[12:15], s77 offen lds
    v_mfma_f32_16x16x32_bf16 v[228:231], a[52:55], v[96:99], v[228:231]
    ds_read_b128 a[20:23], v5 offset:320
    ds_read_b64_tr_b16 a[200:201], v8 offset:33800
    v_exp_f32 v95, v95
    v_mfma_f32_16x16x32_bf16 v[240:243], a[56:59], v[96:99], v[240:243]
    ds_read_b128 a[24:27], v5 offset:384
    ds_read_b128 a[28:31], v5 offset:448
    v_mfma_f32_16x16x32_bf16 v[248:251], a[56:59], v[100:103], v[248:251]
    ds_read_b64_tr_b16 a[32:33], v7 offset:16896
    v_cvt_pk_bf16_f32 v110, v92, v93
    v_mfma_f32_16x16x32_bf16 v[252:255], a[60:63], v[100:103], v[252:255]
    ds_read_b64_tr_b16 a[34:35], v7 offset:17408
    v_cvt_pk_bf16_f32 v111, v94, v95
    v_mfma_f32_16x16x32_bf16 v[244:247], a[60:63], v[96:99], v[244:247]
    s_waitcnt lgkmcnt(7)
    ds_read_b64_tr_b16 a[36:37], v7 offset:16928
    v_mfma_f32_16x16x32_bf16 v[80:83], a[0:3], a[64:67], v[112:115]
    ds_read_b64_tr_b16 a[202:203], v8 offset:34056
    v_mfma_f32_16x16x32_bf16 v[80:83], a[4:7], a[72:75], v[80:83]
    ds_read_b64_tr_b16 a[38:39], v7 offset:17440
    v_mfma_f32_16x16x32_bf16 v[80:83], a[8:11], a[80:83], v[80:83]
    buffer_load_dwordx4 v20, s[12:15], s77 offen offset:1056 lds
    v_mfma_f32_16x16x32_bf16 v[80:83], a[12:15], a[88:91], v[80:83]
    ds_read_b64_tr_b16 a[40:41], v7 offset:16960
    v_mfma_f32_16x16x32_bf16 v[88:91], a[12:15], a[92:95], v[116:119]
    ds_read_b64_tr_b16 a[42:43], v7 offset:17472
    v_mfma_f32_16x16x32_bf16 v[88:91], a[8:11], a[84:87], v[88:91]
    ds_read_b64_tr_b16 a[44:45], v7 offset:16992
    v_mfma_f32_16x16x32_bf16 v[88:91], a[4:7], a[76:79], v[88:91]
    ds_read_b64_tr_b16 a[46:47], v7 offset:17504
    ds_read_b64_tr_b16 a[204:205], v8 offset:34312
    v_mfma_f32_16x16x32_bf16 v[88:91], a[0:3], a[68:71], v[88:91]
    s_waitcnt lgkmcnt(7)
    ds_read_b64_tr_b16 a[48:49], v7 offset:17024
    v_mfma_f32_16x16x32_bf16 v[88:91], a[16:19], a[100:103], v[88:91]
    ds_read_b64_tr_b16 a[50:51], v7 offset:17536
    v_mfma_f32_16x16x32_bf16 v[88:91], a[20:23], a[108:111], v[88:91]
    buffer_load_dwordx4 v21, s[12:15], s77 offen offset:2112 lds
    v_mfma_f32_16x16x32_bf16 v[88:91], a[24:27], a[116:119], v[88:91]
    ds_read_b64_tr_b16 a[52:53], v7 offset:17056
    v_mfma_f32_16x16x32_bf16 v[88:91], a[28:31], a[124:127], v[88:91]
    ds_read_b64_tr_b16 a[54:55], v7 offset:17568
    v_mfma_f32_16x16x32_bf16 v[80:83], a[28:31], a[120:123], v[80:83]
    ds_read_b64_tr_b16 a[206:207], v8 offset:34568
    v_mfma_f32_16x16x32_bf16 v[80:83], a[24:27], a[112:115], v[80:83]
    ds_read_b64_tr_b16 a[56:57], v7 offset:17088
    v_mfma_f32_16x16x32_bf16 v[80:83], a[20:23], a[104:107], v[80:83]
    ds_read_b64_tr_b16 a[58:59], v7 offset:17600
    v_mfma_f32_16x16x32_bf16 v[80:83], a[16:19], a[96:99], v[80:83]
    ds_read_b64_tr_b16 a[60:61], v7 offset:17120
    v_mfma_f32_16x16x32_bf16 v[128:131], a[32:35], v[104:107], v[128:131]
    v_exp_f32 v64, v64
    v_mfma_f32_16x16x32_bf16 v[136:139], a[32:35], v[108:111], v[136:139]
    s_waitcnt lgkmcnt(6)
    ds_read_b64_tr_b16 a[62:63], v7 offset:17632
    v_mfma_f32_16x16x32_bf16 v[140:143], a[36:39], v[108:111], v[140:143]
    buffer_load_dwordx4 v22, s[12:15], s77 offen offset:3168 lds
    v_exp_f32 v65, v65
    v_mfma_f32_16x16x32_bf16 v[132:135], a[36:39], v[104:107], v[132:135]
    ds_read_b128 a[0:3], v5 offset:512
    ds_read_b64_tr_b16 a[208:209], v12 offset:42240
    v_mfma_f32_16x16x32_bf16 v[144:147], a[40:43], v[104:107], v[144:147]
    s_add_u32 s78, s75, 212992
    ds_read_b128 a[4:7], v5 offset:576
    ds_read_b128 a[8:11], v5 offset:640
    v_mfma_f32_16x16x32_bf16 v[152:155], a[40:43], v[108:111], v[152:155]
    s_add_u32 m0, s73, 16896
    v_exp_f32 v66, v66
    v_mfma_f32_16x16x32_bf16 v[156:159], a[44:47], v[108:111], v[156:159]
    ds_read_b128 a[12:15], v5 offset:704
    v_mfma_f32_16x16x32_bf16 v[148:151], a[44:47], v[104:107], v[148:151]
    v_exp_f32 v67, v67
    v_mfma_f32_16x16x32_bf16 v[160:163], a[48:51], v[104:107], v[160:163]
    ds_read_b128 a[16:19], v5 offset:768
    ds_read_b128 a[20:23], v5 offset:832
    v_mfma_f32_16x16x32_bf16 v[168:171], a[48:51], v[108:111], v[168:171]
    s_waitcnt lgkmcnt(7)
    ds_read_b64_tr_b16 a[210:211], v12 offset:42496
    ds_read_b128 a[24:27], v5 offset:896
    v_mfma_f32_16x16x32_bf16 v[172:175], a[52:55], v[108:111], v[172:175]
    buffer_load_dwordx4 v19, s[16:19], s78 offen lds
    v_cvt_pk_bf16_f32 v96, v64, v65
    v_mfma_f32_16x16x32_bf16 v[164:167], a[52:55], v[104:107], v[164:167]
    ds_read_b128 a[28:31], v5 offset:960
    v_cvt_pk_bf16_f32 v97, v66, v67
    v_mfma_f32_16x16x32_bf16 v[176:179], a[56:59], v[104:107], v[176:179]
    v_exp_f32 v72, v72
    v_mfma_f32_16x16x32_bf16 v[184:187], a[56:59], v[108:111], v[184:187]
    ds_read_b64_tr_b16 a[32:33], v7 offset:17152
    ds_read_b64_tr_b16 a[34:35], v7 offset:17664
    v_mfma_f32_16x16x32_bf16 v[188:191], a[60:63], v[108:111], v[188:191]
    ds_read_b64_tr_b16 a[36:37], v7 offset:17184
    ds_read_b64_tr_b16 a[212:213], v12 offset:42752
    v_mfma_f32_16x16x32_bf16 v[180:183], a[60:63], v[104:107], v[180:183]
    v_exp_f32 v73, v73
    v_mfma_f32_16x16x32_bf16 a[240:243], a[248:251], v[104:107], a[240:243]
    ds_read_b64_tr_b16 a[38:39], v7 offset:17696
    v_mfma_f32_16x16x32_bf16 a[244:247], a[248:251], v[108:111], a[244:247]
    s_waitcnt lgkmcnt(6)
    v_exp_f32 v74, v74
    v_mfma_f32_16x16x32_bf16 v[84:87], a[0:3], a[64:67], v[112:115]
    ds_read_b64_tr_b16 a[40:41], v7 offset:17216
    ds_read_b64_tr_b16 a[42:43], v7 offset:17728
    v_mfma_f32_16x16x32_bf16 v[84:87], a[4:7], a[72:75], v[84:87]
    buffer_load_dwordx4 v20, s[16:19], s78 offen offset:1056 lds
    v_mfma_f32_16x16x32_bf16 v[84:87], a[8:11], a[80:83], v[84:87]
    ds_read_b64_tr_b16 a[44:45], v7 offset:17248
    ds_read_b64_tr_b16 a[46:47], v7 offset:17760
    v_exp_f32 v75, v75
    v_mfma_f32_16x16x32_bf16 v[84:87], a[12:15], a[88:91], v[84:87]
    ds_read_b64_tr_b16 a[214:215], v12 offset:43008
    v_cvt_pk_bf16_f32 v100, v72, v73
    v_mfma_f32_16x16x32_bf16 v[92:95], a[12:15], a[92:95], v[116:119]
    ds_read_b64_tr_b16 a[48:49], v7 offset:17280
    v_cvt_pk_bf16_f32 v101, v74, v75
    v_mfma_f32_16x16x32_bf16 v[92:95], a[8:11], a[84:87], v[92:95]
    ds_read_b64_tr_b16 a[50:51], v7 offset:17792
    v_mfma_f32_16x16x32_bf16 v[92:95], a[4:7], a[76:79], v[92:95]
    ds_read_b64_tr_b16 a[52:53], v7 offset:17312
    v_mfma_f32_16x16x32_bf16 v[92:95], a[0:3], a[68:71], v[92:95]
    v_exp_f32 v68, v68
    v_mfma_f32_16x16x32_bf16 v[92:95], a[16:19], a[100:103], v[92:95]
    ds_read_b64_tr_b16 a[54:55], v7 offset:17824
    ds_read_b64_tr_b16 a[216:217], v12 offset:42248
    v_mfma_f32_16x16x32_bf16 v[92:95], a[20:23], a[108:111], v[92:95]
    buffer_load_dwordx4 v21, s[16:19], s78 offen offset:2112 lds
    v_exp_f32 v69, v69
    v_mfma_f32_16x16x32_bf16 v[92:95], a[24:27], a[116:119], v[92:95]
    s_waitcnt lgkmcnt(6)
    ds_read_b64_tr_b16 a[56:57], v7 offset:17344
    ds_read_b64_tr_b16 a[58:59], v7 offset:17856
    v_mfma_f32_16x16x32_bf16 v[92:95], a[28:31], a[124:127], v[92:95]
    ds_read_b64_tr_b16 a[60:61], v7 offset:17376
    v_mfma_f32_16x16x32_bf16 v[84:87], a[28:31], a[120:123], v[84:87]
    v_exp_f32 v70, v70
    v_mfma_f32_16x16x32_bf16 v[84:87], a[24:27], a[112:115], v[84:87]
    ds_read_b64_tr_b16 a[62:63], v7 offset:17888
    v_mfma_f32_16x16x32_bf16 v[84:87], a[20:23], a[104:107], v[84:87]
    v_exp_f32 v71, v71
    v_mfma_f32_16x16x32_bf16 v[84:87], a[16:19], a[96:99], v[84:87]
    ds_read_b64_tr_b16 a[218:219], v12 offset:42504
    v_cvt_pk_bf16_f32 v98, v68, v69
    v_mfma_f32_16x16x32_bf16 v[192:195], a[32:35], v[104:107], v[192:195]
    buffer_load_dwordx4 v22, s[16:19], s78 offen offset:3168 lds
    v_mfma_f32_16x16x32_bf16 v[200:203], a[32:35], v[108:111], v[200:203]
    v_cvt_pk_bf16_f32 v99, v70, v71
    v_mfma_f32_16x16x32_bf16 v[204:207], a[36:39], v[108:111], v[204:207]
    v_exp_f32 v76, v76
    v_mfma_f32_16x16x32_bf16 v[196:199], a[36:39], v[104:107], v[196:199]
    s_waitcnt vmcnt(8) lgkmcnt(1)
    s_barrier
    ds_read_b128 a[0:3], v5 offset:33792
    v_mfma_f32_16x16x32_bf16 v[208:211], a[40:43], v[104:107], v[208:211]
    s_add_u32 s77, s75, 245760
    ds_read_b64_tr_b16 a[220:221], v12 offset:42760
    v_mfma_f32_16x16x32_bf16 v[216:219], a[40:43], v[108:111], v[216:219]
    s_add_u32 m0, s73, 67584
    ds_read_b128 a[4:7], v5 offset:33856
    v_mfma_f32_16x16x32_bf16 v[220:223], a[44:47], v[108:111], v[220:223]
    v_exp_f32 v77, v77
    v_mfma_f32_16x16x32_bf16 v[212:215], a[44:47], v[104:107], v[212:215]
    ds_read_b128 a[8:11], v5 offset:33920
    ds_read_b128 a[12:15], v5 offset:33984
    v_mfma_f32_16x16x32_bf16 v[224:227], a[48:51], v[104:107], v[224:227]
    v_exp_f32 v78, v78
    v_mfma_f32_16x16x32_bf16 v[232:235], a[48:51], v[108:111], v[232:235]
    ds_read_b128 a[16:19], v5 offset:34048
    v_mfma_f32_16x16x32_bf16 v[236:239], a[52:55], v[108:111], v[236:239]
    buffer_load_dwordx4 v19, s[16:19], s77 offen lds
    v_mfma_f32_16x16x32_bf16 v[228:231], a[52:55], v[104:107], v[228:231]
    ds_read_b128 a[20:23], v5 offset:34112
    ds_read_b64_tr_b16 a[222:223], v12 offset:43016
    v_exp_f32 v79, v79
    v_mfma_f32_16x16x32_bf16 v[240:243], a[56:59], v[104:107], v[240:243]
    ds_read_b128 a[24:27], v5 offset:34176
    ds_read_b128 a[28:31], v5 offset:34240
    v_mfma_f32_16x16x32_bf16 v[248:251], a[56:59], v[108:111], v[248:251]
    ds_read_b64_tr_b16 a[32:33], v7 offset:50688
    v_cvt_pk_bf16_f32 v102, v76, v77
    v_mfma_f32_16x16x32_bf16 v[252:255], a[60:63], v[108:111], v[252:255]
    ds_read_b64_tr_b16 a[34:35], v7 offset:51200
    v_cvt_pk_bf16_f32 v103, v78, v79
    v_mfma_f32_16x16x32_bf16 v[244:247], a[60:63], v[104:107], v[244:247]
    s_waitcnt lgkmcnt(7)
    ds_read_b64_tr_b16 a[36:37], v7 offset:50720
    v_mfma_f32_16x16x32_bf16 v[64:67], a[0:3], a[64:67], v[112:115]
    ds_read_b64_tr_b16 a[224:225], v8 offset:42240
    v_mfma_f32_16x16x32_bf16 v[64:67], a[4:7], a[72:75], v[64:67]
    ds_read_b64_tr_b16 a[38:39], v7 offset:51232
    v_mfma_f32_16x16x32_bf16 v[64:67], a[8:11], a[80:83], v[64:67]
    buffer_load_dwordx4 v20, s[16:19], s77 offen offset:1056 lds
    v_mfma_f32_16x16x32_bf16 v[64:67], a[12:15], a[88:91], v[64:67]
    ds_read_b64_tr_b16 a[40:41], v7 offset:50752
    v_mfma_f32_16x16x32_bf16 v[72:75], a[12:15], a[92:95], v[116:119]
    ds_read_b64_tr_b16 a[42:43], v7 offset:51264
    v_mfma_f32_16x16x32_bf16 v[72:75], a[8:11], a[84:87], v[72:75]
    ds_read_b64_tr_b16 a[44:45], v7 offset:50784
    v_mfma_f32_16x16x32_bf16 v[72:75], a[4:7], a[76:79], v[72:75]
    ds_read_b64_tr_b16 a[46:47], v7 offset:51296
    ds_read_b64_tr_b16 a[226:227], v8 offset:42496
    v_mfma_f32_16x16x32_bf16 v[72:75], a[0:3], a[68:71], v[72:75]
    s_waitcnt lgkmcnt(7)
    ds_read_b64_tr_b16 a[48:49], v7 offset:50816
    v_mfma_f32_16x16x32_bf16 v[72:75], a[16:19], a[100:103], v[72:75]
    ds_read_b64_tr_b16 a[50:51], v7 offset:51328
    v_mfma_f32_16x16x32_bf16 v[72:75], a[20:23], a[108:111], v[72:75]
    buffer_load_dwordx4 v21, s[16:19], s77 offen offset:2112 lds
    v_mfma_f32_16x16x32_bf16 v[72:75], a[24:27], a[116:119], v[72:75]
    ds_read_b64_tr_b16 a[52:53], v7 offset:50848
    v_mfma_f32_16x16x32_bf16 v[72:75], a[28:31], a[124:127], v[72:75]
    ds_read_b64_tr_b16 a[54:55], v7 offset:51360
    v_mfma_f32_16x16x32_bf16 v[64:67], a[28:31], a[120:123], v[64:67]
    ds_read_b64_tr_b16 a[228:229], v8 offset:42752
    v_mfma_f32_16x16x32_bf16 v[64:67], a[24:27], a[112:115], v[64:67]
    ds_read_b64_tr_b16 a[56:57], v7 offset:50880
    v_mfma_f32_16x16x32_bf16 v[64:67], a[20:23], a[104:107], v[64:67]
    ds_read_b64_tr_b16 a[58:59], v7 offset:51392
    v_mfma_f32_16x16x32_bf16 v[64:67], a[16:19], a[96:99], v[64:67]
    ds_read_b64_tr_b16 a[60:61], v7 offset:50912
    v_mfma_f32_16x16x32_bf16 v[128:131], a[32:35], v[96:99], v[128:131]
    v_exp_f32 v80, v80
    v_mfma_f32_16x16x32_bf16 v[136:139], a[32:35], v[100:103], v[136:139]
    s_waitcnt lgkmcnt(6)
    ds_read_b64_tr_b16 a[62:63], v7 offset:51424
    v_mfma_f32_16x16x32_bf16 v[140:143], a[36:39], v[100:103], v[140:143]
    buffer_load_dwordx4 v22, s[16:19], s77 offen offset:3168 lds
    v_exp_f32 v81, v81
    v_mfma_f32_16x16x32_bf16 v[132:135], a[36:39], v[96:99], v[132:135]
    ds_read_b128 a[0:3], v5 offset:34304
    ds_read_b64_tr_b16 a[230:231], v8 offset:43008
    v_mfma_f32_16x16x32_bf16 v[144:147], a[40:43], v[96:99], v[144:147]
    s_add_u32 s78, s75, 229376
    ds_read_b128 a[4:7], v5 offset:34368
    ds_read_b128 a[8:11], v5 offset:34432
    v_mfma_f32_16x16x32_bf16 v[152:155], a[40:43], v[100:103], v[152:155]
    s_add_u32 m0, s73, 84480
    v_exp_f32 v82, v82
    v_mfma_f32_16x16x32_bf16 v[156:159], a[44:47], v[100:103], v[156:159]
    ds_read_b128 a[12:15], v5 offset:34496
    v_mfma_f32_16x16x32_bf16 v[148:151], a[44:47], v[96:99], v[148:151]
    v_exp_f32 v83, v83
    v_mfma_f32_16x16x32_bf16 v[160:163], a[48:51], v[96:99], v[160:163]
    ds_read_b128 a[16:19], v5 offset:34560
    ds_read_b128 a[20:23], v5 offset:34624
    v_mfma_f32_16x16x32_bf16 v[168:171], a[48:51], v[100:103], v[168:171]
    s_waitcnt lgkmcnt(7)
    ds_read_b64_tr_b16 a[232:233], v8 offset:42248
    ds_read_b128 a[24:27], v5 offset:34688
    v_mfma_f32_16x16x32_bf16 v[172:175], a[52:55], v[100:103], v[172:175]
    buffer_load_dwordx4 v19, s[16:19], s78 offen lds
    v_cvt_pk_bf16_f32 v104, v80, v81
    v_mfma_f32_16x16x32_bf16 v[164:167], a[52:55], v[96:99], v[164:167]
    ds_read_b128 a[28:31], v5 offset:34752
    v_cvt_pk_bf16_f32 v105, v82, v83
    v_mfma_f32_16x16x32_bf16 v[176:179], a[56:59], v[96:99], v[176:179]
    v_exp_f32 v88, v88
    v_mfma_f32_16x16x32_bf16 v[184:187], a[56:59], v[100:103], v[184:187]
    ds_read_b64_tr_b16 a[32:33], v7 offset:50944
    ds_read_b64_tr_b16 a[34:35], v7 offset:51456
    v_mfma_f32_16x16x32_bf16 v[188:191], a[60:63], v[100:103], v[188:191]
    ds_read_b64_tr_b16 a[36:37], v7 offset:50976
    ds_read_b64_tr_b16 a[234:235], v8 offset:42504
    v_mfma_f32_16x16x32_bf16 v[180:183], a[60:63], v[96:99], v[180:183]
    v_exp_f32 v89, v89
    v_mfma_f32_16x16x32_bf16 a[240:243], a[248:251], v[96:99], a[240:243]
    ds_read_b64_tr_b16 a[38:39], v7 offset:51488
    v_mfma_f32_16x16x32_bf16 a[244:247], a[248:251], v[100:103], a[244:247]
    s_waitcnt lgkmcnt(6)
    v_exp_f32 v90, v90
    v_mfma_f32_16x16x32_bf16 v[68:71], a[0:3], a[64:67], v[112:115]
    ds_read_b64_tr_b16 a[40:41], v7 offset:51008
    ds_read_b64_tr_b16 a[42:43], v7 offset:51520
    v_mfma_f32_16x16x32_bf16 v[68:71], a[4:7], a[72:75], v[68:71]
    buffer_load_dwordx4 v20, s[16:19], s78 offen offset:1056 lds
    v_mfma_f32_16x16x32_bf16 v[68:71], a[8:11], a[80:83], v[68:71]
    ds_read_b64_tr_b16 a[44:45], v7 offset:51040
    ds_read_b64_tr_b16 a[46:47], v7 offset:51552
    v_exp_f32 v91, v91
    v_mfma_f32_16x16x32_bf16 v[68:71], a[12:15], a[88:91], v[68:71]
    ds_read_b64_tr_b16 a[236:237], v8 offset:42760
    v_cvt_pk_bf16_f32 v108, v88, v89
    v_mfma_f32_16x16x32_bf16 v[76:79], a[12:15], a[92:95], v[116:119]
    ds_read_b64_tr_b16 a[48:49], v7 offset:51072
    v_cvt_pk_bf16_f32 v109, v90, v91
    v_mfma_f32_16x16x32_bf16 v[76:79], a[8:11], a[84:87], v[76:79]
    ds_read_b64_tr_b16 a[50:51], v7 offset:51584
    v_mfma_f32_16x16x32_bf16 v[76:79], a[4:7], a[76:79], v[76:79]
    ds_read_b64_tr_b16 a[52:53], v7 offset:51104
    v_mfma_f32_16x16x32_bf16 v[76:79], a[0:3], a[68:71], v[76:79]
    v_exp_f32 v84, v84
    v_mfma_f32_16x16x32_bf16 v[76:79], a[16:19], a[100:103], v[76:79]
    ds_read_b64_tr_b16 a[54:55], v7 offset:51616
    ds_read_b64_tr_b16 a[238:239], v8 offset:43016
    v_mfma_f32_16x16x32_bf16 v[76:79], a[20:23], a[108:111], v[76:79]
    buffer_load_dwordx4 v21, s[16:19], s78 offen offset:2112 lds
    v_exp_f32 v85, v85
    v_mfma_f32_16x16x32_bf16 v[76:79], a[24:27], a[116:119], v[76:79]
    s_waitcnt lgkmcnt(6)
    ds_read_b64_tr_b16 a[56:57], v7 offset:51136
    ds_read_b64_tr_b16 a[58:59], v7 offset:51648
    v_mfma_f32_16x16x32_bf16 v[76:79], a[28:31], a[124:127], v[76:79]
    ds_read_b64_tr_b16 a[60:61], v7 offset:51168
    v_mfma_f32_16x16x32_bf16 v[68:71], a[28:31], a[120:123], v[68:71]
    v_exp_f32 v86, v86
    v_mfma_f32_16x16x32_bf16 v[68:71], a[24:27], a[112:115], v[68:71]
    ds_read_b64_tr_b16 a[62:63], v7 offset:51680
    v_mfma_f32_16x16x32_bf16 v[68:71], a[20:23], a[104:107], v[68:71]
    v_exp_f32 v87, v87
    v_mfma_f32_16x16x32_bf16 v[68:71], a[16:19], a[96:99], v[68:71]
    buffer_load_dwordx4 v22, s[16:19], s78 offen offset:3168 lds
    v_mfma_f32_16x16x32_bf16 v[192:195], a[32:35], v[96:99], v[192:195]
    v_cvt_pk_bf16_f32 v106, v84, v85
    v_cvt_pk_bf16_f32 v107, v86, v87
    v_mfma_f32_16x16x32_bf16 v[200:203], a[32:35], v[100:103], v[200:203]
    v_exp_f32 v92, v92
    v_mfma_f32_16x16x32_bf16 v[204:207], a[36:39], v[100:103], v[204:207]
    v_mfma_f32_16x16x32_bf16 v[196:199], a[36:39], v[96:99], v[196:199]
    s_waitcnt vmcnt(8) lgkmcnt(0)
    s_barrier
    ds_read_b128 a[0:3], v4 offset:0
    v_mfma_f32_16x16x32_bf16 v[208:211], a[40:43], v[96:99], v[208:211]
    s_add_u32 s77, s76, 128
    ds_read_b128 a[4:7], v4 offset:64
    v_mfma_f32_16x16x32_bf16 v[216:219], a[40:43], v[100:103], v[216:219]
    s_add_u32 m0, s72, 33792
    v_exp_f32 v93, v93
    v_mfma_f32_16x16x32_bf16 v[220:223], a[44:47], v[100:103], v[220:223]
    ds_read_b128 a[8:11], v4 offset:128
    v_mfma_f32_16x16x32_bf16 v[212:215], a[44:47], v[96:99], v[212:215]
    ds_read_b128 a[12:15], v4 offset:192
    v_mfma_f32_16x16x32_bf16 v[224:227], a[48:51], v[96:99], v[224:227]
    buffer_load_dwordx4 v23, s[20:23], s77 offen lds
    v_exp_f32 v94, v94
    v_mfma_f32_16x16x32_bf16 v[232:235], a[48:51], v[100:103], v[232:235]
    ds_read_b128 a[16:19], v4 offset:256
    v_mfma_f32_16x16x32_bf16 v[236:239], a[52:55], v[100:103], v[236:239]
    ds_read_b128 a[20:23], v4 offset:320
    v_mfma_f32_16x16x32_bf16 v[228:231], a[52:55], v[96:99], v[228:231]
    v_exp_f32 v95, v95
    v_mfma_f32_16x16x32_bf16 v[240:243], a[56:59], v[96:99], v[240:243]
    ds_read_b128 a[24:27], v4 offset:384
    ds_read_b128 a[28:31], v4 offset:448
    v_mfma_f32_16x16x32_bf16 v[248:251], a[56:59], v[100:103], v[248:251]
    buffer_load_dwordx4 v24, s[20:23], s77 offen offset:1032 lds
    v_cvt_pk_bf16_f32 v110, v92, v93
    v_mfma_f32_16x16x32_bf16 v[252:255], a[60:63], v[100:103], v[252:255]
    ds_read_b64_tr_b16 a[32:33], v6 offset:16896
    v_cvt_pk_bf16_f32 v111, v94, v95
    v_mfma_f32_16x16x32_bf16 v[244:247], a[60:63], v[96:99], v[244:247]
    s_waitcnt lgkmcnt(5)
    ds_read_b64_tr_b16 a[34:35], v6 offset:17408
    v_mfma_f32_16x16x32_bf16 v[80:83], a[0:3], a[64:67], v[112:115]
    buffer_load_dwordx4 v25, s[20:23], s77 offen offset:2112 lds
    v_mfma_f32_16x16x32_bf16 v[80:83], a[4:7], a[72:75], v[80:83]
    ds_read_b64_tr_b16 a[36:37], v6 offset:16928
    ds_read_b64_tr_b16 a[38:39], v6 offset:17440
    v_mfma_f32_16x16x32_bf16 v[80:83], a[8:11], a[80:83], v[80:83]
    ds_read_b64_tr_b16 a[40:41], v6 offset:16960
    v_mfma_f32_16x16x32_bf16 v[80:83], a[12:15], a[88:91], v[80:83]
    buffer_load_dwordx4 v26, s[20:23], s77 offen offset:3144 lds
    v_mfma_f32_16x16x32_bf16 v[88:91], a[12:15], a[92:95], v[116:119]
    s_add_u32 s78, s76, 3712
    ds_read_b64_tr_b16 a[42:43], v6 offset:17472
    v_mfma_f32_16x16x32_bf16 v[88:91], a[8:11], a[84:87], v[88:91]
    s_add_u32 m0, s72, 38016
    ds_read_b64_tr_b16 a[44:45], v6 offset:16992
    v_mfma_f32_16x16x32_bf16 v[88:91], a[4:7], a[76:79], v[88:91]
    ds_read_b64_tr_b16 a[46:47], v6 offset:17504
    v_mfma_f32_16x16x32_bf16 v[88:91], a[0:3], a[68:71], v[88:91]
    s_waitcnt lgkmcnt(6)
    buffer_load_dwordx4 v23, s[20:23], s78 offen lds
    v_mfma_f32_16x16x32_bf16 v[88:91], a[16:19], a[100:103], v[88:91]
    ds_read_b64_tr_b16 a[48:49], v6 offset:17024
    v_mfma_f32_16x16x32_bf16 v[88:91], a[20:23], a[108:111], v[88:91]
    ds_read_b64_tr_b16 a[50:51], v6 offset:17536
    v_mfma_f32_16x16x32_bf16 v[88:91], a[24:27], a[116:119], v[88:91]
    ds_read_b64_tr_b16 a[52:53], v6 offset:17056
    v_mfma_f32_16x16x32_bf16 v[88:91], a[28:31], a[124:127], v[88:91]
    ds_read_b64_tr_b16 a[54:55], v6 offset:17568
    v_mfma_f32_16x16x32_bf16 v[80:83], a[28:31], a[120:123], v[80:83]
    buffer_load_dwordx4 v24, s[20:23], s78 offen offset:1032 lds
    v_mfma_f32_16x16x32_bf16 v[80:83], a[24:27], a[112:115], v[80:83]
    ds_read_b64_tr_b16 a[56:57], v6 offset:17088
    v_mfma_f32_16x16x32_bf16 v[80:83], a[20:23], a[104:107], v[80:83]
    ds_read_b64_tr_b16 a[58:59], v6 offset:17600
    v_mfma_f32_16x16x32_bf16 v[80:83], a[16:19], a[96:99], v[80:83]
    ds_read_b64_tr_b16 a[60:61], v6 offset:17120
    v_mfma_f32_16x16x32_bf16 v[128:131], a[32:35], v[104:107], v[128:131]
    buffer_load_dwordx4 v25, s[20:23], s78 offen offset:2112 lds
    v_exp_f32 v64, v64
    v_mfma_f32_16x16x32_bf16 v[136:139], a[32:35], v[108:111], v[136:139]
    s_waitcnt lgkmcnt(5)
    ds_read_b64_tr_b16 a[62:63], v6 offset:17632
    v_mfma_f32_16x16x32_bf16 v[140:143], a[36:39], v[108:111], v[140:143]
    v_exp_f32 v65, v65
    v_mfma_f32_16x16x32_bf16 v[132:135], a[36:39], v[104:107], v[132:135]
    ds_read_b128 a[0:3], v4 offset:512
    ds_read_b128 a[4:7], v4 offset:576
    v_mfma_f32_16x16x32_bf16 v[144:147], a[40:43], v[104:107], v[144:147]
    buffer_load_dwordx4 v26, s[20:23], s78 offen offset:3144 lds
    v_mfma_f32_16x16x32_bf16 v[152:155], a[40:43], v[108:111], v[152:155]
    s_add_u32 s77, s76, 114816
    ds_read_b128 a[8:11], v4 offset:640
    ds_read_b128 a[12:15], v4 offset:704
    v_exp_f32 v66, v66
    v_mfma_f32_16x16x32_bf16 v[156:159], a[44:47], v[108:111], v[156:159]
    s_add_u32 m0, s72, 101376
    v_exp_f32 v67, v67
    v_mfma_f32_16x16x32_bf16 v[148:151], a[44:47], v[104:107], v[148:151]
    ds_read_b128 a[16:19], v4 offset:768
    v_mfma_f32_16x16x32_bf16 v[160:163], a[48:51], v[104:107], v[160:163]
    buffer_load_dwordx4 v23, s[20:23], s77 offen lds
    v_mfma_f32_16x16x32_bf16 v[168:171], a[48:51], v[108:111], v[168:171]
    s_waitcnt lgkmcnt(5)
    ds_read_b128 a[20:23], v4 offset:832
    ds_read_b128 a[24:27], v4 offset:896
    v_mfma_f32_16x16x32_bf16 v[172:175], a[52:55], v[108:111], v[172:175]
    ds_read_b128 a[28:31], v4 offset:960
    v_cvt_pk_bf16_f32 v96, v64, v65
    v_mfma_f32_16x16x32_bf16 v[164:167], a[52:55], v[104:107], v[164:167]
    buffer_load_dwordx4 v24, s[20:23], s77 offen offset:1032 lds
    v_cvt_pk_bf16_f32 v97, v66, v67
    v_mfma_f32_16x16x32_bf16 v[176:179], a[56:59], v[104:107], v[176:179]
    v_exp_f32 v72, v72
    v_mfma_f32_16x16x32_bf16 v[184:187], a[56:59], v[108:111], v[184:187]
    ds_read_b64_tr_b16 a[32:33], v6 offset:17152
    ds_read_b64_tr_b16 a[34:35], v6 offset:17664
    v_mfma_f32_16x16x32_bf16 v[188:191], a[60:63], v[108:111], v[188:191]
    ds_read_b64_tr_b16 a[36:37], v6 offset:17184
    v_mfma_f32_16x16x32_bf16 v[180:183], a[60:63], v[104:107], v[180:183]
    v_exp_f32 v73, v73
    v_mfma_f32_16x16x32_bf16 a[240:243], a[248:251], v[104:107], a[240:243]
    ds_read_b64_tr_b16 a[38:39], v6 offset:17696
    v_mfma_f32_16x16x32_bf16 a[244:247], a[248:251], v[108:111], a[244:247]
    s_waitcnt lgkmcnt(5)
    buffer_load_dwordx4 v25, s[20:23], s77 offen offset:2112 lds
    v_exp_f32 v74, v74
    v_mfma_f32_16x16x32_bf16 v[84:87], a[0:3], a[64:67], v[112:115]
    ds_read_b64_tr_b16 a[40:41], v6 offset:17216
    ds_read_b64_tr_b16 a[42:43], v6 offset:17728
    v_mfma_f32_16x16x32_bf16 v[84:87], a[4:7], a[72:75], v[84:87]
    ds_read_b64_tr_b16 a[44:45], v6 offset:17248
    v_mfma_f32_16x16x32_bf16 v[84:87], a[8:11], a[80:83], v[84:87]
    buffer_load_dwordx4 v26, s[20:23], s77 offen offset:3144 lds
    v_exp_f32 v75, v75
    v_mfma_f32_16x16x32_bf16 v[84:87], a[12:15], a[88:91], v[84:87]
    s_add_u32 s78, s76, 118400
    ds_read_b64_tr_b16 a[46:47], v6 offset:17760
    v_cvt_pk_bf16_f32 v100, v72, v73
    v_mfma_f32_16x16x32_bf16 v[92:95], a[12:15], a[92:95], v[116:119]
    s_add_u32 m0, s72, 105600
    ds_read_b64_tr_b16 a[48:49], v6 offset:17280
    v_cvt_pk_bf16_f32 v101, v74, v75
    v_mfma_f32_16x16x32_bf16 v[92:95], a[8:11], a[84:87], v[92:95]
    ds_read_b64_tr_b16 a[50:51], v6 offset:17792
    v_mfma_f32_16x16x32_bf16 v[92:95], a[4:7], a[76:79], v[92:95]
    buffer_load_dwordx4 v23, s[20:23], s78 offen lds
    v_mfma_f32_16x16x32_bf16 v[92:95], a[0:3], a[68:71], v[92:95]
    ds_read_b64_tr_b16 a[52:53], v6 offset:17312
    ds_read_b64_tr_b16 a[54:55], v6 offset:17824
    v_exp_f32 v68, v68
    v_mfma_f32_16x16x32_bf16 v[92:95], a[16:19], a[100:103], v[92:95]
    v_exp_f32 v69, v69
    v_mfma_f32_16x16x32_bf16 v[92:95], a[20:23], a[108:111], v[92:95]
    ds_read_b64_tr_b16 a[56:57], v6 offset:17344
    v_mfma_f32_16x16x32_bf16 v[92:95], a[24:27], a[116:119], v[92:95]
    s_waitcnt lgkmcnt(6)
    buffer_load_dwordx4 v24, s[20:23], s78 offen offset:1032 lds
    v_mfma_f32_16x16x32_bf16 v[92:95], a[28:31], a[124:127], v[92:95]
    ds_read_b64_tr_b16 a[58:59], v6 offset:17856
    ds_read_b64_tr_b16 a[60:61], v6 offset:17376
    v_mfma_f32_16x16x32_bf16 v[84:87], a[28:31], a[120:123], v[84:87]
    v_exp_f32 v70, v70
    v_mfma_f32_16x16x32_bf16 v[84:87], a[24:27], a[112:115], v[84:87]
    ds_read_b64_tr_b16 a[62:63], v6 offset:17888
    v_mfma_f32_16x16x32_bf16 v[84:87], a[20:23], a[104:107], v[84:87]
    buffer_load_dwordx4 v25, s[20:23], s78 offen offset:2112 lds
    v_exp_f32 v71, v71
    v_mfma_f32_16x16x32_bf16 v[84:87], a[16:19], a[96:99], v[84:87]
    v_cvt_pk_bf16_f32 v98, v68, v69
    v_mfma_f32_16x16x32_bf16 v[192:195], a[32:35], v[104:107], v[192:195]
    buffer_load_dwordx4 v26, s[20:23], s78 offen offset:3144 lds
    v_mfma_f32_16x16x32_bf16 v[200:203], a[32:35], v[108:111], v[200:203]
    v_cvt_pk_bf16_f32 v99, v70, v71
    v_mfma_f32_16x16x32_bf16 v[204:207], a[36:39], v[108:111], v[204:207]
    v_exp_f32 v76, v76
    v_mfma_f32_16x16x32_bf16 v[196:199], a[36:39], v[104:107], v[196:199]
    s_waitcnt vmcnt(16) lgkmcnt(0)
    s_barrier
    ds_read_b64_tr_b16 a[0:1], v7 offset:16896
    v_mfma_f32_16x16x32_bf16 v[208:211], a[40:43], v[104:107], v[208:211]
    s_add_u32 s77, s76, 256
    ds_read_b64_tr_b16 a[2:3], v7 offset:17408
    v_mfma_f32_16x16x32_bf16 v[216:219], a[40:43], v[108:111], v[216:219]
    s_add_u32 m0, s72, 0
    ds_read_b64_tr_b16 a[4:5], v7 offset:16928
    v_mfma_f32_16x16x32_bf16 v[220:223], a[44:47], v[108:111], v[220:223]
    v_exp_f32 v77, v77
    v_mfma_f32_16x16x32_bf16 v[212:215], a[44:47], v[104:107], v[212:215]
    ds_read_b64_tr_b16 a[6:7], v7 offset:17440
    ds_read_b64_tr_b16 a[8:9], v7 offset:16960
    v_mfma_f32_16x16x32_bf16 v[224:227], a[48:51], v[104:107], v[224:227]
    v_exp_f32 v78, v78
    v_mfma_f32_16x16x32_bf16 v[232:235], a[48:51], v[108:111], v[232:235]
    ds_read_b64_tr_b16 a[10:11], v7 offset:17472
    ds_read_b64_tr_b16 a[12:13], v7 offset:16992
    v_mfma_f32_16x16x32_bf16 v[236:239], a[52:55], v[108:111], v[236:239]
    buffer_load_dwordx4 v23, s[20:23], s77 offen lds
    v_mfma_f32_16x16x32_bf16 v[228:231], a[52:55], v[104:107], v[228:231]
    ds_read_b64_tr_b16 a[14:15], v7 offset:17504
    ds_read_b64_tr_b16 a[16:17], v7 offset:17024
    v_exp_f32 v79, v79
    v_mfma_f32_16x16x32_bf16 v[240:243], a[56:59], v[104:107], v[240:243]
    ds_read_b64_tr_b16 a[18:19], v7 offset:17536
    v_cvt_pk_bf16_f32 v102, v76, v77
    v_mfma_f32_16x16x32_bf16 v[248:251], a[56:59], v[108:111], v[248:251]
    ds_read_b64_tr_b16 a[20:21], v7 offset:17056
    v_cvt_pk_bf16_f32 v103, v78, v79
    v_mfma_f32_16x16x32_bf16 v[252:255], a[60:63], v[108:111], v[252:255]
    ds_read_b64_tr_b16 a[22:23], v7 offset:17568
    v_mfma_f32_16x16x32_bf16 v[244:247], a[60:63], v[104:107], v[244:247]
    s_waitcnt lgkmcnt(7)
    ds_read_b64_tr_b16 a[24:25], v7 offset:17088
    v_mfma_f32_16x16x32_bf16 v[128:131], a[0:3], v[96:99], v[128:131]
    v_exp_f32 v80, v80
    v_mfma_f32_16x16x32_bf16 v[136:139], a[0:3], v[100:103], v[136:139]
    ds_read_b64_tr_b16 a[26:27], v7 offset:17600
    ds_read_b64_tr_b16 a[28:29], v7 offset:17120
    v_exp_f32 v81, v81
    v_mfma_f32_16x16x32_bf16 v[140:143], a[4:7], v[100:103], v[140:143]
    buffer_load_dwordx4 v24, s[20:23], s77 offen offset:1032 lds
    v_mfma_f32_16x16x32_bf16 v[132:135], a[4:7], v[96:99], v[132:135]
    s_waitcnt lgkmcnt(6)
    ds_read_b64_tr_b16 a[30:31], v7 offset:17632
    ds_read_b64_tr_b16 a[32:33], v7 offset:17152
    v_exp_f32 v82, v82
    v_mfma_f32_16x16x32_bf16 v[144:147], a[8:11], v[96:99], v[144:147]
    ds_read_b64_tr_b16 a[34:35], v7 offset:17664
    v_mfma_f32_16x16x32_bf16 v[152:155], a[8:11], v[100:103], v[152:155]
    v_exp_f32 v83, v83
    v_mfma_f32_16x16x32_bf16 v[156:159], a[12:15], v[100:103], v[156:159]
    ds_read_b64_tr_b16 a[36:37], v7 offset:17184
    ds_read_b64_tr_b16 a[38:39], v7 offset:17696
    v_cvt_pk_bf16_f32 v104, v80, v81
    v_mfma_f32_16x16x32_bf16 v[148:151], a[12:15], v[96:99], v[148:151]
    s_waitcnt lgkmcnt(7)
    ds_read_b64_tr_b16 a[40:41], v7 offset:17216
    v_cvt_pk_bf16_f32 v105, v82, v83
    v_mfma_f32_16x16x32_bf16 v[160:163], a[16:19], v[96:99], v[160:163]
    v_exp_f32 v88, v88
    v_mfma_f32_16x16x32_bf16 v[168:171], a[16:19], v[100:103], v[168:171]
    ds_read_b64_tr_b16 a[42:43], v7 offset:17728
    ds_read_b64_tr_b16 a[44:45], v7 offset:17248
    v_mfma_f32_16x16x32_bf16 v[172:175], a[20:23], v[100:103], v[172:175]
    buffer_load_dwordx4 v25, s[20:23], s77 offen offset:2112 lds
    v_exp_f32 v89, v89
    v_mfma_f32_16x16x32_bf16 v[164:167], a[20:23], v[96:99], v[164:167]
    s_waitcnt lgkmcnt(6)
    ds_read_b64_tr_b16 a[46:47], v7 offset:17760
    ds_read_b64_tr_b16 a[48:49], v7 offset:17280
    v_exp_f32 v90, v90
    v_mfma_f32_16x16x32_bf16 v[176:179], a[24:27], v[96:99], v[176:179]
    ds_read_b64_tr_b16 a[50:51], v7 offset:17792
    v_mfma_f32_16x16x32_bf16 v[184:187], a[24:27], v[100:103], v[184:187]
    v_exp_f32 v91, v91
    v_mfma_f32_16x16x32_bf16 v[188:191], a[28:31], v[100:103], v[188:191]
    ds_read_b64_tr_b16 a[52:53], v7 offset:17312
    ds_read_b64_tr_b16 a[54:55], v7 offset:17824
    v_mfma_f32_16x16x32_bf16 v[180:183], a[28:31], v[96:99], v[180:183]
    ds_read_b64_tr_b16 a[56:57], v7 offset:17344
    v_cvt_pk_bf16_f32 v108, v88, v89
    v_mfma_f32_16x16x32_bf16 a[240:243], a[248:251], v[96:99], a[240:243]
    ds_read_b64_tr_b16 a[58:59], v7 offset:17856
    v_cvt_pk_bf16_f32 v109, v90, v91
    v_mfma_f32_16x16x32_bf16 a[244:247], a[248:251], v[100:103], a[244:247]
    s_waitcnt lgkmcnt(7)
    v_exp_f32 v84, v84
    v_mfma_f32_16x16x32_bf16 v[192:195], a[32:35], v[96:99], v[192:195]
    ds_read_b64_tr_b16 a[60:61], v7 offset:17376
    ds_read_b64_tr_b16 a[62:63], v7 offset:17888
    v_exp_f32 v85, v85
    v_mfma_f32_16x16x32_bf16 v[200:203], a[32:35], v[100:103], v[200:203]
    buffer_load_dwordx4 v26, s[20:23], s77 offen offset:3144 lds
    v_mfma_f32_16x16x32_bf16 v[204:207], a[36:39], v[100:103], v[204:207]
    ds_read_b64_tr_b16 a[0:1], v7 offset:0
    ds_read_b64_tr_b16 a[2:3], v7 offset:512
    v_exp_f32 v86, v86
    v_mfma_f32_16x16x32_bf16 v[196:199], a[36:39], v[96:99], v[196:199]
    s_add_u32 s78, s76, 3840
    ds_read_b64_tr_b16 a[4:5], v7 offset:32
    ds_read_b64_tr_b16 a[6:7], v7 offset:544
    v_mfma_f32_16x16x32_bf16 v[208:211], a[40:43], v[96:99], v[208:211]
    s_add_u32 m0, s72, 4224
    v_exp_f32 v87, v87
    v_mfma_f32_16x16x32_bf16 v[216:219], a[40:43], v[100:103], v[216:219]
    s_waitcnt lgkmcnt(7)
    ds_read_b64_tr_b16 a[8:9], v7 offset:64
    ds_read_b64_tr_b16 a[10:11], v7 offset:576
    v_cvt_pk_bf16_f32 v106, v84, v85
    v_mfma_f32_16x16x32_bf16 v[220:223], a[44:47], v[100:103], v[220:223]
    ds_read_b64_tr_b16 a[12:13], v7 offset:96
    v_cvt_pk_bf16_f32 v107, v86, v87
    v_mfma_f32_16x16x32_bf16 v[212:215], a[44:47], v[96:99], v[212:215]
    v_exp_f32 v92, v92
    v_mfma_f32_16x16x32_bf16 v[224:227], a[48:51], v[96:99], v[224:227]
    ds_read_b64_tr_b16 a[14:15], v7 offset:608
    ds_read_b64_tr_b16 a[16:17], v7 offset:128
    v_mfma_f32_16x16x32_bf16 v[232:235], a[48:51], v[100:103], v[232:235]
    buffer_load_dwordx4 v23, s[20:23], s78 offen lds
    v_exp_f32 v93, v93
    v_mfma_f32_16x16x32_bf16 v[236:239], a[52:55], v[100:103], v[236:239]
    ds_read_b64_tr_b16 a[18:19], v7 offset:640
    ds_read_b64_tr_b16 a[20:21], v7 offset:160
    v_exp_f32 v94, v94
    v_mfma_f32_16x16x32_bf16 v[228:231], a[52:55], v[96:99], v[228:231]
    s_waitcnt lgkmcnt(7)
    ds_read_b64_tr_b16 a[22:23], v7 offset:672
    v_mfma_f32_16x16x32_bf16 v[240:243], a[56:59], v[96:99], v[240:243]
    v_exp_f32 v95, v95
    v_mfma_f32_16x16x32_bf16 v[248:251], a[56:59], v[100:103], v[248:251]
    ds_read_b64_tr_b16 a[24:25], v7 offset:192
    ds_read_b64_tr_b16 a[26:27], v7 offset:704
    v_mfma_f32_16x16x32_bf16 v[252:255], a[60:63], v[100:103], v[252:255]
    ds_read_b64_tr_b16 a[28:29], v7 offset:224
    v_cvt_pk_bf16_f32 v110, v92, v93
    v_cvt_pk_bf16_f32 v111, v94, v95
    v_mfma_f32_16x16x32_bf16 v[244:247], a[60:63], v[96:99], v[244:247]
    ds_read_b64_tr_b16 a[30:31], v7 offset:736
    v_mfma_f32_16x16x32_bf16 v[128:131], a[0:3], v[104:107], v[128:131]
    ds_read_b64_tr_b16 a[32:33], v7 offset:256
    v_mfma_f32_16x16x32_bf16 v[136:139], a[0:3], v[108:111], v[136:139]
    ds_read_b64_tr_b16 a[34:35], v7 offset:768
    v_mfma_f32_16x16x32_bf16 a[240:243], a[248:251], v[104:107], a[240:243]
    buffer_load_dwordx4 v24, s[20:23], s78 offen offset:1032 lds
    v_mfma_f32_16x16x32_bf16 a[244:247], a[248:251], v[108:111], a[244:247]
    ds_read_b64_tr_b16 a[36:37], v7 offset:288
    ds_read_b64_tr_b16 a[38:39], v7 offset:800
    v_mfma_f32_16x16x32_bf16 v[140:143], a[4:7], v[108:111], v[140:143]
    ds_read_b64_tr_b16 a[40:41], v7 offset:320
    v_mfma_f32_16x16x32_bf16 v[132:135], a[4:7], v[104:107], v[132:135]
    s_waitcnt lgkmcnt(7)
    ds_read_b64_tr_b16 a[42:43], v7 offset:832
    v_mfma_f32_16x16x32_bf16 v[144:147], a[8:11], v[104:107], v[144:147]
    ds_read_b64_tr_b16 a[44:45], v7 offset:352
    v_accvgpr_read_b32 v48, a240
    v_mfma_f32_16x16x32_bf16 v[152:155], a[8:11], v[108:111], v[152:155]
    ds_read_b64_tr_b16 a[46:47], v7 offset:864
    v_mfma_f32_16x16x32_bf16 v[156:159], a[12:15], v[108:111], v[156:159]
    ds_read_b64_tr_b16 a[48:49], v7 offset:384
    v_cvt_pk_bf16_f32 v128, v128, v129
    v_mfma_f32_16x16x32_bf16 v[148:151], a[12:15], v[104:107], v[148:151]
    ds_read_b64_tr_b16 a[50:51], v7 offset:896
    v_cvt_pk_bf16_f32 v129, v130, v131
    v_mfma_f32_16x16x32_bf16 v[160:163], a[16:19], v[104:107], v[160:163]
    buffer_load_dwordx4 v25, s[20:23], s78 offen offset:2112 lds
    v_cvt_pk_bf16_f32 v130, v132, v133
    v_cvt_pk_bf16_f32 v131, v134, v135
    v_mfma_f32_16x16x32_bf16 v[168:171], a[16:19], v[108:111], v[168:171]
    ds_read_b64_tr_b16 a[52:53], v7 offset:416
    ds_read_b64_tr_b16 a[54:55], v7 offset:928
    v_cvt_pk_bf16_f32 v136, v136, v137
    v_cvt_pk_bf16_f32 v137, v138, v139
    v_mfma_f32_16x16x32_bf16 v[172:175], a[20:23], v[108:111], v[172:175]
    ds_read_b64_tr_b16 a[56:57], v7 offset:448
    v_cvt_pk_bf16_f32 v138, v140, v141
    v_cvt_pk_bf16_f32 v139, v142, v143
    v_accvgpr_read_b32 v49, a244
    v_mfma_f32_16x16x32_bf16 v[164:167], a[20:23], v[104:107], v[164:167]
    ds_read_b64_tr_b16 a[58:59], v7 offset:960
    v_cvt_pk_bf16_f32 v144, v144, v145
    v_mfma_f32_16x16x32_bf16 v[176:179], a[24:27], v[104:107], v[176:179]
    v_rcp_f32 v48, v48
    v_cvt_pk_bf16_f32 v145, v146, v147
    v_cvt_pk_bf16_f32 v146, v148, v149
    v_mfma_f32_16x16x32_bf16 v[184:187], a[24:27], v[108:111], v[184:187]
    s_waitcnt lgkmcnt(6)
    ds_read_b64_tr_b16 a[60:61], v7 offset:480
    ds_read_b64_tr_b16 a[62:63], v7 offset:992
    v_cvt_pk_bf16_f32 v147, v150, v151
    v_cvt_pk_bf16_f32 v152, v152, v153
    v_mfma_f32_16x16x32_bf16 v[188:191], a[28:31], v[108:111], v[188:191]
    v_cvt_pk_bf16_f32 v153, v154, v155
    v_cvt_pk_bf16_f32 v154, v156, v157
    v_cvt_pk_bf16_f32 v155, v158, v159
    v_mfma_f32_16x16x32_bf16 v[180:183], a[28:31], v[104:107], v[180:183]
    buffer_load_dwordx4 v26, s[20:23], s78 offen offset:3144 lds
    v_mfma_f32_16x16x32_bf16 v[192:195], a[32:35], v[104:107], v[192:195]
    v_cvt_pk_bf16_f32 v160, v160, v161
    v_cvt_pk_bf16_f32 v161, v162, v163
    v_cvt_pk_bf16_f32 v162, v164, v165
    v_cvt_pk_bf16_f32 v163, v166, v167
    v_mfma_f32_16x16x32_bf16 v[200:203], a[32:35], v[108:111], v[200:203]
    v_cvt_pk_bf16_f32 v168, v168, v169
    v_cvt_pk_bf16_f32 v169, v170, v171
    v_cvt_pk_bf16_f32 v170, v172, v173
    v_cvt_pk_bf16_f32 v171, v174, v175
    v_mfma_f32_16x16x32_bf16 v[204:207], a[36:39], v[108:111], v[204:207]
    v_rcp_f32 v49, v49
    v_mfma_f32_16x16x32_bf16 v[196:199], a[36:39], v[104:107], v[196:199]
    s_waitcnt vmcnt(16) lgkmcnt(0)
    s_barrier
    ds_read_b64_tr_b16 a[0:1], v12 offset:33792
    v_mfma_f32_16x16x32_bf16 v[208:211], a[40:43], v[104:107], v[208:211]
    s_add_u32 s77, s76, 114944
    ds_read_b64_tr_b16 a[2:3], v12 offset:34048
    v_cvt_pk_bf16_f32 v176, v176, v177
    v_cvt_pk_bf16_f32 v177, v178, v179
    v_cvt_pk_bf16_f32 v178, v180, v181
    v_mfma_f32_16x16x32_bf16 v[216:219], a[40:43], v[108:111], v[216:219]
    s_add_u32 m0, s72, 67584
    ds_read_b64_tr_b16 a[4:5], v12 offset:34304
    v_cvt_pk_bf16_f32 v179, v182, v183
    v_cvt_pk_bf16_f32 v184, v184, v185
    v_cvt_pk_bf16_f32 v185, v186, v187
    v_mfma_f32_16x16x32_bf16 v[220:223], a[44:47], v[108:111], v[220:223]
    s_lshl_b32 s3, s88, 12
    ds_read_b64_tr_b16 a[6:7], v12 offset:34560
    v_cvt_pk_bf16_f32 v186, v188, v189
    v_cvt_pk_bf16_f32 v187, v190, v191
    v_mfma_f32_16x16x32_bf16 v[212:215], a[44:47], v[104:107], v[212:215]
    ds_read_b64_tr_b16 a[8:9], v12 offset:42240
    v_cvt_pk_bf16_f32 v192, v192, v193
    v_mfma_f32_16x16x32_bf16 v[224:227], a[48:51], v[104:107], v[224:227]
    buffer_load_dwordx4 v23, s[20:23], s77 offen lds
    v_cvt_pk_bf16_f32 v193, v194, v195
    v_cvt_pk_bf16_f32 v194, v196, v197
    v_mfma_f32_16x16x32_bf16 v[232:235], a[48:51], v[108:111], v[232:235]
    s_add_u32 s4, s3, 135168
    ds_read_b64_tr_b16 a[10:11], v12 offset:42496
    ds_read_b64_tr_b16 a[12:13], v12 offset:42752
    v_cvt_pk_bf16_f32 v195, v198, v199
    v_cvt_pk_bf16_f32 v200, v200, v201
    v_mfma_f32_16x16x32_bf16 v[236:239], a[52:55], v[108:111], v[236:239]
    ds_read_b64_tr_b16 a[14:15], v12 offset:43008
    ds_read_b64_tr_b16 a[16:17], v12 offset:33800
    v_cvt_pk_bf16_f32 v201, v202, v203
    v_cvt_pk_bf16_f32 v202, v204, v205
    v_mfma_f32_16x16x32_bf16 v[228:231], a[52:55], v[104:107], v[228:231]
    ds_read_b64_tr_b16 a[18:19], v12 offset:34056
    v_cvt_pk_bf16_f32 v203, v206, v207
    v_mfma_f32_16x16x32_bf16 v[240:243], a[56:59], v[104:107], v[240:243]
    buffer_load_dwordx4 v24, s[20:23], s77 offen offset:1032 lds
    v_cvt_pk_bf16_f32 v208, v208, v209
    v_cvt_pk_bf16_f32 v209, v210, v211
    v_mfma_f32_16x16x32_bf16 v[248:251], a[56:59], v[108:111], v[248:251]
    ds_read_b64_tr_b16 a[20:21], v12 offset:34312
    ds_read_b64_tr_b16 a[22:23], v12 offset:34568
    v_cvt_pk_bf16_f32 v210, v212, v213
    v_cvt_pk_bf16_f32 v211, v214, v215
    v_mfma_f32_16x16x32_bf16 v[252:255], a[60:63], v[108:111], v[252:255]
    ds_read_b64_tr_b16 a[24:25], v12 offset:42248
    ds_read_b64_tr_b16 a[26:27], v12 offset:42504
    v_cvt_pk_bf16_f32 v216, v216, v217
    v_cvt_pk_bf16_f32 v217, v218, v219
    v_mfma_f32_16x16x32_bf16 v[244:247], a[60:63], v[104:107], v[244:247]
    ds_read_b64_tr_b16 a[28:29], v12 offset:42760
    v_cvt_pk_bf16_f32 v218, v220, v221
    v_cvt_pk_bf16_f32 v219, v222, v223
    v_mfma_f32_16x16x32_bf16 v[64:67], a[128:131], v[128:131], 0
    ds_read_b64_tr_b16 a[30:31], v12 offset:43016
    v_cvt_pk_bf16_f32 v224, v224, v225
    v_cvt_pk_bf16_f32 v225, v226, v227
    v_cvt_pk_bf16_f32 v226, v228, v229
    v_mfma_f32_16x16x32_bf16 v[64:67], a[132:135], v[144:147], v[64:67]
    buffer_load_dwordx4 v25, s[20:23], s77 offen offset:2112 lds
    v_cvt_pk_bf16_f32 v227, v230, v231
    v_cvt_pk_bf16_f32 v232, v232, v233
    v_mfma_f32_16x16x32_bf16 v[72:75], a[132:135], v[152:155], 0
    ds_read_b64_tr_b16 a[32:33], v8 offset:33792
    ds_read_b64_tr_b16 a[34:35], v8 offset:34048
    v_cvt_pk_bf16_f32 v233, v234, v235
    v_cvt_pk_bf16_f32 v234, v236, v237
    v_mfma_f32_16x16x32_bf16 v[72:75], a[128:131], v[136:139], v[72:75]
    ds_read_b64_tr_b16 a[36:37], v8 offset:34304
    v_cvt_pk_bf16_f32 v235, v238, v239
    v_add_u32 v50, s4, v27
    v_mfma_f32_16x16x32_bf16 v[68:71], a[136:139], v[128:131], 0
    s_xor_b32 s3, s3, 0x2000
    ds_read_b64_tr_b16 a[38:39], v8 offset:34560
    ds_read_b64_tr_b16 a[40:41], v8 offset:42240
    v_cvt_pk_bf16_f32 v240, v240, v241
    v_cvt_pk_bf16_f32 v241, v242, v243
    v_mfma_f32_16x16x32_bf16 v[68:71], a[140:143], v[144:147], v[68:71]
    s_add_u32 s4, s3, 135168
    buffer_load_dwordx4 v26, s[20:23], s77 offen offset:3144 lds
    v_cvt_pk_bf16_f32 v242, v244, v245
    v_cvt_pk_bf16_f32 v243, v246, v247
    v_mfma_f32_16x16x32_bf16 v[76:79], a[140:143], v[152:155], 0
    s_add_u32 s78, s76, 118528
    ds_read_b64_tr_b16 a[42:43], v8 offset:42496
    ds_read_b64_tr_b16 a[44:45], v8 offset:42752
    v_cvt_pk_bf16_f32 v248, v248, v249
    v_cvt_pk_bf16_f32 v249, v250, v251
    v_mfma_f32_16x16x32_bf16 v[76:79], a[136:139], v[136:139], v[76:79]
    s_add_u32 m0, s72, 71808
    ds_read_b64_tr_b16 a[46:47], v8 offset:43008
    v_cvt_pk_bf16_f32 v250, v252, v253
    v_cvt_pk_bf16_f32 v251, v254, v255
    v_mfma_f32_16x16x32_bf16 v[80:83], a[144:147], v[128:131], 0
    ds_read_b64_tr_b16 a[48:49], v8 offset:33800
    ds_read_b64_tr_b16 a[50:51], v8 offset:34056
    v_mfma_f32_16x16x32_bf16 v[80:83], a[148:151], v[144:147], v[80:83]
    ds_read_b64_tr_b16 a[52:53], v8 offset:34312
    ds_read_b64_tr_b16 a[54:55], v8 offset:34568
    v_mfma_f32_16x16x32_bf16 v[88:91], a[148:151], v[152:155], 0
    buffer_load_dwordx4 v23, s[20:23], s78 offen lds
    v_add_u32 v51, s4, v27
    v_mfma_f32_16x16x32_bf16 v[88:91], a[144:147], v[136:139], v[88:91]
    ds_read_b64_tr_b16 a[56:57], v8 offset:42248
    ds_read_b64_tr_b16 a[58:59], v8 offset:42504
    v_mfma_f32_16x16x32_bf16 v[84:87], a[152:155], v[128:131], 0
    ds_read_b64_tr_b16 a[60:61], v8 offset:42760
    v_mfma_f32_16x16x32_bf16 v[84:87], a[156:159], v[144:147], v[84:87]
    ds_read_b64_tr_b16 a[62:63], v8 offset:43016
    v_mfma_f32_16x16x32_bf16 v[92:95], a[156:159], v[152:155], 0
    buffer_load_dwordx4 v24, s[20:23], s78 offen offset:1032 lds
    v_mfma_f32_16x16x32_bf16 v[92:95], a[152:155], v[136:139], v[92:95]
    v_mfma_f32_16x16x32_bf16 v[64:67], a[160:163], v[160:163], v[64:67]
    v_mfma_f32_16x16x32_bf16 v[64:67], a[164:167], v[176:179], v[64:67]
    buffer_load_dwordx4 v25, s[20:23], s78 offen offset:2112 lds
    v_mfma_f32_16x16x32_bf16 v[72:75], a[164:167], v[184:187], v[72:75]
    v_mfma_f32_16x16x32_bf16 v[72:75], a[160:163], v[168:171], v[72:75]
    s_waitcnt vmcnt(15) lgkmcnt(0)
    s_barrier
    ds_read_b64_tr_b16 a[128:129], v13 offset:33792
    v_mfma_f32_16x16x32_bf16 v[68:71], a[168:171], v[160:163], v[68:71]
    ds_read_b64_tr_b16 a[130:131], v13 offset:34048
    v_mfma_f32_16x16x32_bf16 v[68:71], a[172:175], v[176:179], v[68:71]
    ds_read_b64_tr_b16 a[132:133], v13 offset:34304
    v_mfma_f32_16x16x32_bf16 v[76:79], a[172:175], v[184:187], v[76:79]
    ds_read_b64_tr_b16 a[134:135], v13 offset:34560
    v_mfma_f32_16x16x32_bf16 v[76:79], a[168:171], v[168:171], v[76:79]
    buffer_load_dwordx4 v26, s[20:23], s78 offen offset:3144 lds
    v_mfma_f32_16x16x32_bf16 v[80:83], a[176:179], v[160:163], v[80:83]
    s_add_u32 s77, s76, 384
    ds_read_b64_tr_b16 a[136:137], v13 offset:42240
    ds_read_b64_tr_b16 a[138:139], v13 offset:42496
    v_mfma_f32_16x16x32_bf16 v[80:83], a[180:183], v[176:179], v[80:83]
    s_add_u32 m0, s72, 33792
    ds_read_b64_tr_b16 a[140:141], v13 offset:42752
    ds_read_b64_tr_b16 a[142:143], v13 offset:43008
    v_mfma_f32_16x16x32_bf16 v[88:91], a[180:183], v[184:187], v[88:91]
    ds_read_b64_tr_b16 a[144:145], v13 offset:33800
    v_mfma_f32_16x16x32_bf16 v[88:91], a[176:179], v[168:171], v[88:91]
    ds_read_b64_tr_b16 a[146:147], v13 offset:34056
    v_mfma_f32_16x16x32_bf16 v[84:87], a[184:187], v[160:163], v[84:87]
    ds_read_b64_tr_b16 a[148:149], v13 offset:34312
    ds_read_b64_tr_b16 a[150:151], v13 offset:34568
    v_mfma_f32_16x16x32_bf16 v[84:87], a[188:191], v[176:179], v[84:87]
    buffer_load_dwordx4 v23, s[20:23], s77 offen lds
    v_mfma_f32_16x16x32_bf16 v[92:95], a[188:191], v[184:187], v[92:95]
    ds_read_b64_tr_b16 a[152:153], v13 offset:42248
    ds_read_b64_tr_b16 a[154:155], v13 offset:42504
    v_mfma_f32_16x16x32_bf16 v[92:95], a[184:187], v[168:171], v[92:95]
    ds_read_b64_tr_b16 a[156:157], v13 offset:42760
    v_mfma_f32_16x16x32_bf16 v[64:67], v[32:35], v[192:195], v[64:67]
    ds_read_b64_tr_b16 a[158:159], v13 offset:43016
    v_mfma_f32_16x16x32_bf16 v[64:67], v[36:39], v[208:211], v[64:67]
    buffer_load_dwordx4 v24, s[20:23], s77 offen offset:1032 lds
    v_mfma_f32_16x16x32_bf16 v[72:75], v[36:39], v[216:219], v[72:75]
    ds_read_b64_tr_b16 a[160:161], v9 offset:33792
    ds_read_b64_tr_b16 a[162:163], v9 offset:34048
    v_mfma_f32_16x16x32_bf16 v[72:75], v[32:35], v[200:203], v[72:75]
    ds_read_b64_tr_b16 a[164:165], v9 offset:34304
    ds_read_b64_tr_b16 a[166:167], v9 offset:34560
    v_mfma_f32_16x16x32_bf16 v[68:71], v[40:43], v[192:195], v[68:71]
    ds_read_b64_tr_b16 a[168:169], v9 offset:42240
    v_mfma_f32_16x16x32_bf16 v[68:71], v[44:47], v[208:211], v[68:71]
    ds_read_b64_tr_b16 a[170:171], v9 offset:42496
    ds_read_b64_tr_b16 a[172:173], v9 offset:42752
    v_mfma_f32_16x16x32_bf16 v[76:79], v[44:47], v[216:219], v[76:79]
    buffer_load_dwordx4 v25, s[20:23], s77 offen offset:2112 lds
    v_mfma_f32_16x16x32_bf16 v[76:79], v[40:43], v[200:203], v[76:79]
    ds_read_b64_tr_b16 a[174:175], v9 offset:43008
    ds_read_b64_tr_b16 a[176:177], v9 offset:33800
    v_mfma_f32_16x16x32_bf16 v[80:83], a[192:195], v[192:195], v[80:83]
    ds_read_b64_tr_b16 a[178:179], v9 offset:34056
    v_mfma_f32_16x16x32_bf16 v[80:83], a[196:199], v[208:211], v[80:83]
    ds_read_b64_tr_b16 a[180:181], v9 offset:34312
    ds_read_b64_tr_b16 a[182:183], v9 offset:34568
    v_mfma_f32_16x16x32_bf16 v[88:91], a[196:199], v[216:219], v[88:91]
    buffer_load_dwordx4 v26, s[20:23], s77 offen offset:3144 lds
    v_mfma_f32_16x16x32_bf16 v[88:91], a[192:195], v[200:203], v[88:91]
    s_add_u32 s78, s76, 3968
    ds_read_b64_tr_b16 a[184:185], v9 offset:42248
    ds_read_b64_tr_b16 a[186:187], v9 offset:42504
    v_mfma_f32_16x16x32_bf16 v[84:87], a[200:203], v[192:195], v[84:87]
    s_add_u32 m0, s72, 38016
    ds_read_b64_tr_b16 a[188:189], v9 offset:42760
    v_mfma_f32_16x16x32_bf16 v[84:87], a[204:207], v[208:211], v[84:87]
    ds_read_b64_tr_b16 a[190:191], v9 offset:43016
    v_mfma_f32_16x16x32_bf16 v[92:95], a[204:207], v[216:219], v[92:95]
    buffer_load_dwordx4 v23, s[20:23], s78 offen lds
    v_mfma_f32_16x16x32_bf16 v[92:95], a[200:203], v[200:203], v[92:95]
    v_mfma_f32_16x16x32_bf16 v[64:67], a[208:211], v[224:227], v[64:67]
    v_mfma_f32_16x16x32_bf16 v[132:135], a[212:215], v[240:243], v[64:67]
    buffer_load_dwordx4 v24, s[20:23], s78 offen offset:1032 lds
    v_mfma_f32_16x16x32_bf16 v[72:75], a[212:215], v[248:251], v[72:75]
    v_mfma_f32_16x16x32_bf16 v[148:151], a[208:211], v[232:235], v[72:75]
    s_waitcnt vmcnt(14) lgkmcnt(0)
    s_barrier
    ds_read_b64_tr_b16 a[64:65], v12 offset:0
    v_mfma_f32_16x16x32_bf16 v[68:71], a[216:219], v[224:227], v[68:71]
    ds_read_b64_tr_b16 a[66:67], v12 offset:256
    v_bfe_u32 v43, v0, 3, 1
    v_mfma_f32_16x16x32_bf16 v[140:143], a[220:223], v[240:243], v[68:71]
    s_lshl_b32 s3, s90, 2
    ds_read_b64_tr_b16 a[68:69], v12 offset:512
    v_mfma_f32_16x16x32_bf16 v[76:79], a[220:223], v[248:251], v[76:79]
    s_and_b32 s4, s86, 5
    ds_read_b64_tr_b16 a[70:71], v12 offset:768
    v_mfma_f32_16x16x32_bf16 v[156:159], a[216:219], v[232:235], v[76:79]
    s_sub_u32 s3, s4, s3
    ds_read_b64_tr_b16 a[72:73], v12 offset:8448
    v_mfma_f32_16x16x32_bf16 v[80:83], a[224:227], v[224:227], v[80:83]
    buffer_load_dwordx4 v25, s[20:23], s78 offen offset:2112 lds
    v_mfma_f32_16x16x32_bf16 v[164:167], a[228:231], v[240:243], v[80:83]
    ds_read_b64_tr_b16 a[74:75], v12 offset:8704
    ds_read_b64_tr_b16 a[76:77], v12 offset:8960
    v_mfma_f32_16x16x32_bf16 v[88:91], a[228:231], v[248:251], v[88:91]
    ds_read_b64_tr_b16 a[78:79], v12 offset:9216
    ds_read_b64_tr_b16 a[192:193], v12 offset:8
    v_mfma_f32_16x16x32_bf16 v[180:183], a[224:227], v[232:235], v[88:91]
    ds_read_b64_tr_b16 a[194:195], v12 offset:264
    v_mul_f32 v132, v48, v132
    v_mfma_f32_16x16x32_bf16 v[84:87], a[232:235], v[224:227], v[84:87]
    buffer_load_dwordx4 v26, s[20:23], s78 offen offset:3144 lds
    v_mul_f32 v133, v48, v133
    v_mfma_f32_16x16x32_bf16 v[172:175], a[236:239], v[240:243], v[84:87]
    s_add_u32 s77, s76, 115072
    ds_read_b64_tr_b16 a[196:197], v12 offset:520
    ds_read_b64_tr_b16 a[198:199], v12 offset:776
    v_cmp_eq_u32 s[16:17], s3, v43
    v_mul_f32 v134, v48, v134
    v_mfma_f32_16x16x32_bf16 v[92:95], a[236:239], v[248:251], v[92:95]
    s_add_u32 m0, s72, 101376
    ds_read_b64_tr_b16 a[200:201], v12 offset:8456
    ds_read_b64_tr_b16 a[202:203], v12 offset:8712
    v_mul_f32 v135, v48, v135
    v_mfma_f32_16x16x32_bf16 v[188:191], a[232:235], v[232:235], v[92:95]
    ds_read_b64_tr_b16 a[204:205], v12 offset:8968
    v_mov_b32 v63, 1073741824
    v_cvt_pk_bf16_f32 v132, v132, v133
    v_mfma_f32_16x16x32_bf16 v[64:67], a[0:3], v[128:131], 0
    ds_read_b64_tr_b16 a[206:207], v12 offset:9224
    v_cvt_pk_bf16_f32 v133, v134, v135
    v_mul_f32 v140, v48, v140
    v_mfma_f32_16x16x32_bf16 v[64:67], a[4:7], v[144:147], v[64:67]
    ds_read_b64_tr_b16 a[208:209], v8 offset:0
    ds_read_b64_tr_b16 a[210:211], v8 offset:256
    v_cndmask_b32 v1, v27, v63, s[16:17]
    v_mul_f32 v141, v48, v141
    v_mfma_f32_16x16x32_bf16 v[64:67], a[8:11], v[160:163], v[64:67]
    buffer_load_dwordx4 v23, s[20:23], s77 offen lds
    v_mul_f32 v142, v48, v142
    v_mfma_f32_16x16x32_bf16 v[64:67], a[12:15], v[176:179], v[64:67]
    ds_read_b64_tr_b16 a[212:213], v8 offset:512
    ds_read_b64_tr_b16 a[214:215], v8 offset:768
    v_lshrrev_b32 v43, 4, v0
    v_mul_f32 v143, v48, v143
    v_mfma_f32_16x16x32_bf16 v[72:75], a[12:15], v[184:187], 0
    ds_read_b64_tr_b16 a[216:217], v8 offset:8448
    v_cvt_pk_bf16_f32 v134, v140, v141
    v_cvt_pk_bf16_f32 v135, v142, v143
    v_mfma_f32_16x16x32_bf16 v[72:75], a[8:11], v[168:171], v[72:75]
    ds_write_b128 v50, v[132:135] offset:0
    v_mfma_f32_16x16x32_bf16 v[72:75], a[4:7], v[152:155], v[72:75]
    v_lshlrev_b32 v43, 7, v43
    v_mul_f32 v148, v49, v148
    v_mfma_f32_16x16x32_bf16 v[72:75], a[0:3], v[136:139], v[72:75]
    ds_read_b64_tr_b16 a[218:219], v8 offset:8704
    ds_read_b64_tr_b16 a[220:221], v8 offset:8960
    v_and_b32 v53, 7, v0
    v_mul_f32 v149, v49, v149
    v_mfma_f32_16x16x32_bf16 v[68:71], a[16:19], v[128:131], 0
    buffer_load_dwordx4 v24, s[20:23], s77 offen offset:1032 lds
    v_mul_f32 v150, v49, v150
    v_mul_f32 v151, v49, v151
    v_mfma_f32_16x16x32_bf16 v[68:71], a[20:23], v[144:147], v[68:71]
    ds_read_b64_tr_b16 a[222:223], v8 offset:9216
    ds_read_b64_tr_b16 a[224:225], v8 offset:8
    v_lshl_add_u32 v43, v53, 4, v43
    v_cvt_pk_bf16_f32 v148, v148, v149
    v_mfma_f32_16x16x32_bf16 v[68:71], a[24:27], v[160:163], v[68:71]
    s_lshl_b32 s3, s89, 9
    ds_read_b64_tr_b16 a[226:227], v8 offset:264
    ds_read_b64_tr_b16 a[228:229], v8 offset:520
    v_cvt_pk_bf16_f32 v149, v150, v151
    v_mfma_f32_16x16x32_bf16 v[68:71], a[28:31], v[176:179], v[68:71]
    s_add_u32 s3, s3, 151552
    ds_read_b64_tr_b16 a[230:231], v8 offset:776
    ds_read_b64_tr_b16 a[232:233], v8 offset:8456
    v_mul_f32 v156, v49, v156
    v_mfma_f32_16x16x32_bf16 v[76:79], a[28:31], v[184:187], 0
    buffer_load_dwordx4 v25, s[20:23], s77 offen offset:2112 lds
    v_mul_f32 v157, v49, v157
    v_mul_f32 v158, v49, v158
    v_mfma_f32_16x16x32_bf16 v[76:79], a[24:27], v[168:171], v[76:79]
    ds_read_b64_tr_b16 a[234:235], v8 offset:8712
    ds_read_b64_tr_b16 a[236:237], v8 offset:8968
    v_mul_f32 v159, v49, v159
    v_mfma_f32_16x16x32_bf16 v[76:79], a[20:23], v[152:155], v[76:79]
    ds_read_b64_tr_b16 a[238:239], v8 offset:9224
    v_cvt_pk_bf16_f32 v150, v156, v157
    v_mfma_f32_16x16x32_bf16 v[76:79], a[16:19], v[136:139], v[76:79]
    buffer_load_dwordx4 v26, s[20:23], s77 offen offset:3144 lds
    v_add_u32 v52, s3, v43
    v_cvt_pk_bf16_f32 v151, v158, v159
    v_mfma_f32_16x16x32_bf16 v[80:83], a[32:35], v[128:131], 0
    s_add_u32 s78, s76, 118656
    ds_write_b128 v50, v[148:151] offset:1024
    v_mfma_f32_16x16x32_bf16 v[80:83], a[36:39], v[144:147], v[80:83]
    s_add_u32 m0, s72, 105600
    v_mfma_f32_16x16x32_bf16 v[80:83], a[40:43], v[160:163], v[80:83]
    s_lshl_b32 s3, s86, 4
    buffer_load_dwordx4 v23, s[20:23], s78 offen lds
    v_mfma_f32_16x16x32_bf16 v[80:83], a[44:47], v[176:179], v[80:83]
    s_waitcnt vmcnt(13) lgkmcnt(0)
    s_barrier
    ds_read_b64_tr_b16 a[0:1], v13 offset:0
    v_mfma_f32_16x16x32_bf16 v[88:91], a[44:47], v[184:187], 0
    s_add_u32 s3, s3, s34
    ds_read_b64_tr_b16 a[2:3], v13 offset:256
    ds_read_b128 v[96:99], v51 offset:0
    v_mfma_f32_16x16x32_bf16 v[88:91], a[40:43], v[168:171], v[88:91]
    s_add_u32 s98, s3, 251904
    ds_read_b64_tr_b16 a[4:5], v13 offset:512
    ds_read_b128 v[100:103], v51 offset:1024
    v_mfma_f32_16x16x32_bf16 v[88:91], a[36:39], v[152:155], v[88:91]
    s_add_u32 s3, s86, 1
    ds_read_b64_tr_b16 a[6:7], v13 offset:768
    v_mfma_f32_16x16x32_bf16 v[88:91], a[32:35], v[136:139], v[88:91]
    ds_read_b64_tr_b16 a[8:9], v13 offset:8448
    v_mfma_f32_16x16x32_bf16 v[84:87], a[48:51], v[128:131], 0
    s_and_b32 s3, s3, 7
    buffer_load_dwordx4 v24, s[20:23], s78 offen offset:1032 lds
    v_mfma_f32_16x16x32_bf16 v[84:87], a[52:55], v[144:147], v[84:87]
    s_and_b32 s4, s3, 4
    ds_read_b64_tr_b16 a[10:11], v13 offset:8704
    ds_read_b64_tr_b16 a[12:13], v13 offset:8960
    v_mfma_f32_16x16x32_bf16 v[84:87], a[56:59], v[160:163], v[84:87]
    ds_read_b64_tr_b16 a[14:15], v13 offset:9216
    ds_read_b64_tr_b16 a[16:17], v13 offset:8
    v_mfma_f32_16x16x32_bf16 v[84:87], a[60:63], v[176:179], v[84:87]
    s_add_u32 s3, s3, s4
    ds_read_b64_tr_b16 a[18:19], v13 offset:264
    s_waitcnt lgkmcnt(9)
    v_lshlrev_b32 v196, 16, v96
    v_mfma_f32_16x16x32_bf16 v[92:95], a[60:63], v[184:187], 0
    ds_read_b64_tr_b16 a[20:21], v13 offset:520
    ds_read_b64_tr_b16 a[22:23], v13 offset:776
    v_and_b32 v197, s68, v96
    v_mfma_f32_16x16x32_bf16 v[92:95], a[56:59], v[168:171], v[92:95]
    s_lshl_b32 s8, s3, 11
    buffer_load_dwordx4 v25, s[20:23], s78 offen offset:2112 lds
    v_lshlrev_b32 v198, 16, v97
    v_and_b32 v199, s68, v97
    v_mfma_f32_16x16x32_bf16 v[92:95], a[52:55], v[152:155], v[92:95]
    ds_read_b64_tr_b16 a[24:25], v13 offset:8456
    ds_read_b64_tr_b16 a[26:27], v13 offset:8712
    v_fmac_f32 v196, v48, v164
    v_fmac_f32 v197, v48, v165
    v_mfma_f32_16x16x32_bf16 v[92:95], a[48:51], v[136:139], v[92:95]
    s_add_u32 s3, s86, 2
    ds_read_b64_tr_b16 a[28:29], v13 offset:8968
    v_fmac_f32 v198, v48, v166
    v_fmac_f32 v199, v48, v167
    v_mfma_f32_16x16x32_bf16 v[64:67], a[128:131], v[192:195], v[64:67]
    s_and_b32 s3, s3, 7
    ds_read_b64_tr_b16 a[30:31], v13 offset:9224
    v_cvt_pk_bf16_f32 v96, v196, v197
    v_cvt_pk_bf16_f32 v97, v198, v199
    v_mfma_f32_16x16x32_bf16 v[64:67], a[132:135], v[208:211], v[64:67]
    buffer_load_dwordx4 v26, s[20:23], s78 offen offset:3144 lds
    v_lshlrev_b32 v204, 16, v98
    v_and_b32 v205, s68, v98
    v_mfma_f32_16x16x32_bf16 v[64:67], a[136:139], v[224:227], v[64:67]
    s_add_u32 s77, s76, 512
    ds_read_b64_tr_b16 a[32:33], v9 offset:0
    ds_read_b64_tr_b16 a[34:35], v9 offset:256
    v_lshlrev_b32 v206, 16, v99
    v_and_b32 v207, s68, v99
    v_mfma_f32_16x16x32_bf16 v[132:135], a[140:143], v[240:243], v[64:67]
    s_add_u32 m0, s72, 0
    ds_read_b64_tr_b16 a[36:37], v9 offset:512
    ds_read_b64_tr_b16 a[38:39], v9 offset:768
    v_fmac_f32 v204, v48, v172
    v_fmac_f32 v205, v48, v173
    v_mfma_f32_16x16x32_bf16 v[72:75], a[140:143], v[248:251], v[72:75]
    s_and_b32 s4, s3, 4
    ds_read_b64_tr_b16 a[40:41], v9 offset:8448
    v_fmac_f32 v206, v48, v174
    v_fmac_f32 v207, v48, v175
    v_mfma_f32_16x16x32_bf16 v[72:75], a[136:139], v[232:235], v[72:75]
    s_add_u32 s3, s3, s4
    ds_read_b64_tr_b16 a[42:43], v9 offset:8704
    ds_read_b64_tr_b16 a[44:45], v9 offset:8960
    v_cvt_pk_bf16_f32 v98, v204, v205
    v_cvt_pk_bf16_f32 v99, v206, v207
    v_mfma_f32_16x16x32_bf16 v[72:75], a[132:135], v[216:219], v[72:75]
    s_lshl_b32 s9, s3, 11
    ds_read_b64_tr_b16 a[46:47], v9 offset:9216
    s_waitcnt lgkmcnt(10)
    v_lshlrev_b32 v212, 16, v100
    v_and_b32 v213, s68, v100
    v_mfma_f32_16x16x32_bf16 v[148:151], a[128:131], v[200:203], v[72:75]
    s_add_u32 s3, s86, 3
    buffer_load_dwordx4 v23, s[20:23], s77 offen lds
    v_lshlrev_b32 v214, 16, v101
    v_and_b32 v215, s68, v101
    v_mfma_f32_16x16x32_bf16 v[68:71], a[144:147], v[192:195], v[68:71]
    ds_read_b64_tr_b16 a[48:49], v9 offset:8
    ds_read_b64_tr_b16 a[50:51], v9 offset:264
    v_fmac_f32 v212, v49, v180
    v_fmac_f32 v213, v49, v181
    v_mfma_f32_16x16x32_bf16 v[68:71], a[148:151], v[208:211], v[68:71]
    s_and_b32 s3, s3, 7
    ds_read_b64_tr_b16 a[52:53], v9 offset:520
    ds_read_b64_tr_b16 a[54:55], v9 offset:776
    v_fmac_f32 v214, v49, v182
    v_fmac_f32 v215, v49, v183
    v_mfma_f32_16x16x32_bf16 v[68:71], a[152:155], v[224:227], v[68:71]
    ds_read_b64_tr_b16 a[56:57], v9 offset:8456
    v_cvt_pk_bf16_f32 v100, v212, v213
    v_cvt_pk_bf16_f32 v101, v214, v215
    v_mfma_f32_16x16x32_bf16 v[140:143], a[156:159], v[240:243], v[68:71]
    s_and_b32 s4, s3, 4
    buffer_load_dwordx4 v24, s[20:23], s77 offen offset:1032 lds
    v_lshlrev_b32 v220, 16, v102
    v_and_b32 v221, s68, v102
    v_mfma_f32_16x16x32_bf16 v[76:79], a[156:159], v[248:251], v[76:79]
    ds_read_b64_tr_b16 a[58:59], v9 offset:8712
    ds_read_b64_tr_b16 a[60:61], v9 offset:8968
    v_lshlrev_b32 v222, 16, v103
    v_and_b32 v223, s68, v103
    v_mfma_f32_16x16x32_bf16 v[76:79], a[152:155], v[232:235], v[76:79]
    s_add_u32 s3, s3, s4
    ds_read_b64_tr_b16 a[62:63], v9 offset:9224
    v_fmac_f32 v220, v49, v188
    v_fmac_f32 v221, v49, v189
    v_mfma_f32_16x16x32_bf16 v[76:79], a[148:151], v[216:219], v[76:79]
    buffer_load_dwordx4 v25, s[20:23], s77 offen offset:2112 lds
    v_fmac_f32 v222, v49, v190
    v_fmac_f32 v223, v49, v191
    v_mfma_f32_16x16x32_bf16 v[156:159], a[144:147], v[200:203], v[76:79]
    s_lshl_b32 s10, s3, 11
    v_cvt_pk_bf16_f32 v102, v220, v221
    v_cvt_pk_bf16_f32 v103, v222, v223
    v_mfma_f32_16x16x32_bf16 v[80:83], a[160:163], v[192:195], v[80:83]
    s_add_u32 s3, s86, 4
    v_mfma_f32_16x16x32_bf16 v[80:83], a[164:167], v[208:211], v[80:83]
    s_add_u32 s80, s79, 0
    buffer_store_dwordx4 v[96:99], v1, s[28:31], s80 offen sc1
    v_mfma_f32_16x16x32_bf16 v[80:83], a[168:171], v[224:227], v[80:83]
    s_and_b32 s3, s3, 7
    buffer_load_dwordx4 v26, s[20:23], s77 offen offset:3144 lds
    v_mfma_f32_16x16x32_bf16 v[164:167], a[172:175], v[240:243], v[80:83]
    s_waitcnt vmcnt(13) lgkmcnt(0)
    s_barrier
    ds_read_b64_tr_b16 a[128:129], v12 offset:33792
    v_mfma_f32_16x16x32_bf16 v[88:91], a[172:175], v[248:251], v[88:91]
    s_add_u32 s78, s76, 4096
    ds_read_b64_tr_b16 a[130:131], v12 offset:34048
    v_mfma_f32_16x16x32_bf16 v[88:91], a[168:171], v[232:235], v[88:91]
    s_add_u32 m0, s72, 4224
    ds_read_b64_tr_b16 a[132:133], v12 offset:34304
    v_mfma_f32_16x16x32_bf16 v[88:91], a[164:167], v[216:219], v[88:91]
    s_and_b32 s4, s3, 4
    s_add_u32 s80, s81, 0
    buffer_store_dwordx4 v[100:103], v27, s[28:31], s80 offen sc1
    v_mfma_f32_16x16x32_bf16 v[180:183], a[160:163], v[200:203], v[88:91]
    s_add_u32 s3, s3, s4
    ds_read_b64_tr_b16 a[134:135], v12 offset:34560
    ds_read_b64_tr_b16 a[136:137], v12 offset:42240
    v_mfma_f32_16x16x32_bf16 v[84:87], a[176:179], v[192:195], v[84:87]
    s_lshl_b32 s11, s3, 11
    s_mov_b64 exec, s[16:17]
    ds_write_b128 v52, v[96:99] offset:0
    s_mov_b64 exec, -1
    v_mfma_f32_16x16x32_bf16 v[84:87], a[180:183], v[208:211], v[84:87]
    s_add_u32 s3, s86, 5
    v_mul_f32 v132, v48, v132
    v_mul_f32 v133, v48, v133
    v_mfma_f32_16x16x32_bf16 v[84:87], a[184:187], v[224:227], v[84:87]
    ds_read_b64_tr_b16 a[138:139], v12 offset:42496
    ds_read_b64_tr_b16 a[140:141], v12 offset:42752
    v_mfma_f32_16x16x32_bf16 v[172:175], a[188:191], v[240:243], v[84:87]
    s_and_b32 s3, s3, 7
    buffer_load_dwordx4 v23, s[20:23], s78 offen lds
    v_mul_f32 v134, v48, v134
    v_mfma_f32_16x16x32_bf16 v[92:95], a[188:191], v[248:251], v[92:95]
    ds_read_b64_tr_b16 a[142:143], v12 offset:43008
    ds_read_b64_tr_b16 a[144:145], v12 offset:33800
    v_mul_f32 v135, v48, v135
    v_cvt_pk_bf16_f32 v132, v132, v133
    v_mfma_f32_16x16x32_bf16 v[92:95], a[184:187], v[232:235], v[92:95]
    s_and_b32 s4, s3, 4
    ds_read_b64_tr_b16 a[146:147], v12 offset:34056
    ds_read_b64_tr_b16 a[148:149], v12 offset:34312
    v_cvt_pk_bf16_f32 v133, v134, v135
    v_mfma_f32_16x16x32_bf16 v[92:95], a[180:183], v[216:219], v[92:95]
    s_add_u32 s3, s3, s4
    ds_read_b64_tr_b16 a[150:151], v12 offset:34568
    ds_read_b64_tr_b16 a[152:153], v12 offset:42248
    v_mul_f32 v140, v48, v140
    v_mfma_f32_16x16x32_bf16 v[188:191], a[176:179], v[200:203], v[92:95]
    buffer_load_dwordx4 v24, s[20:23], s78 offen offset:1032 lds
    v_mul_f32 v141, v48, v141
    v_mul_f32 v142, v48, v142
    v_mfma_f32_16x16x32_bf16 v[64:67], a[64:67], v[128:131], 0
    s_lshl_b32 s12, s3, 11
    ds_read_b64_tr_b16 a[154:155], v12 offset:42504
    ds_read_b64_tr_b16 a[156:157], v12 offset:42760
    v_mul_f32 v143, v48, v143
    v_mfma_f32_16x16x32_bf16 v[64:67], a[68:71], v[144:147], v[64:67]
    ds_read_b64_tr_b16 a[158:159], v12 offset:43016
    ds_read_b64_tr_b16 a[160:161], v8 offset:33792
    v_cvt_pk_bf16_f32 v134, v140, v141
    v_mfma_f32_16x16x32_bf16 v[64:67], a[72:75], v[160:163], v[64:67]
    s_add_u32 s3, s86, 6
    ds_read_b64_tr_b16 a[162:163], v8 offset:34048
    ds_read_b64_tr_b16 a[164:165], v8 offset:34304
    v_cvt_pk_bf16_f32 v135, v142, v143
    v_mfma_f32_16x16x32_bf16 v[64:67], a[76:79], v[176:179], v[64:67]
    buffer_load_dwordx4 v25, s[20:23], s78 offen offset:2112 lds
    v_mfma_f32_16x16x32_bf16 v[72:75], a[76:79], v[184:187], 0
    s_and_b32 s3, s3, 7
    ds_write_b128 v50, v[132:135] offset:0
    v_mfma_f32_16x16x32_bf16 v[72:75], a[72:75], v[168:171], v[72:75]
    s_and_b32 s4, s3, 4
    ds_read_b64_tr_b16 a[166:167], v8 offset:34560
    v_mul_f32 v148, v49, v148
    v_mul_f32 v149, v49, v149
    v_mul_f32 v150, v49, v150
    v_mfma_f32_16x16x32_bf16 v[72:75], a[68:71], v[152:155], v[72:75]
    ds_read_b64_tr_b16 a[168:169], v8 offset:42240
    ds_read_b64_tr_b16 a[170:171], v8 offset:42496
    v_mul_f32 v151, v49, v151
    v_cvt_pk_bf16_f32 v148, v148, v149
    v_mfma_f32_16x16x32_bf16 v[72:75], a[64:67], v[136:139], v[72:75]
    s_add_u32 s3, s3, s4
    ds_read_b64_tr_b16 a[172:173], v8 offset:42752
    ds_read_b64_tr_b16 a[174:175], v8 offset:43008
    v_cvt_pk_bf16_f32 v149, v150, v151
    v_mul_f32 v156, v49, v156
    v_mfma_f32_16x16x32_bf16 v[68:71], a[192:195], v[128:131], 0
    buffer_load_dwordx4 v26, s[20:23], s78 offen offset:3144 lds
    v_mul_f32 v157, v49, v157
    v_mfma_f32_16x16x32_bf16 v[68:71], a[196:199], v[144:147], v[68:71]
    s_add_u32 s77, s76, 115200
    ds_read_b64_tr_b16 a[176:177], v8 offset:33800
    ds_read_b64_tr_b16 a[178:179], v8 offset:34056
    v_mul_f32 v158, v49, v158
    v_mfma_f32_16x16x32_bf16 v[68:71], a[200:203], v[160:163], v[68:71]
    s_add_u32 m0, s72, 67584
    ds_read_b64_tr_b16 a[180:181], v8 offset:34312
    ds_read_b64_tr_b16 a[182:183], v8 offset:34568
    v_mul_f32 v159, v49, v159
    v_cvt_pk_bf16_f32 v150, v156, v157
    v_mfma_f32_16x16x32_bf16 v[68:71], a[204:207], v[176:179], v[68:71]
    s_lshl_b32 s13, s3, 11
    ds_read_b64_tr_b16 a[184:185], v8 offset:42248
    ds_read_b64_tr_b16 a[186:187], v8 offset:42504
    v_cvt_pk_bf16_f32 v151, v158, v159
    v_mfma_f32_16x16x32_bf16 v[76:79], a[204:207], v[184:187], 0
    s_add_u32 s3, s86, 7
    ds_write_b128 v50, v[148:151] offset:1024
    v_mfma_f32_16x16x32_bf16 v[76:79], a[200:203], v[168:171], v[76:79]
    s_and_b32 s3, s3, 7
    buffer_load_dwordx4 v23, s[20:23], s77 offen lds
    v_mfma_f32_16x16x32_bf16 v[76:79], a[196:199], v[152:155], v[76:79]
    s_and_b32 s4, s3, 4
    ds_read_b64_tr_b16 a[188:189], v8 offset:42760
    ds_read_b64_tr_b16 a[190:191], v8 offset:43016
    v_mfma_f32_16x16x32_bf16 v[76:79], a[192:195], v[136:139], v[76:79]
    buffer_load_dwordx4 v24, s[20:23], s77 offen offset:1032 lds
    v_mfma_f32_16x16x32_bf16 v[80:83], a[208:211], v[128:131], 0
    s_add_u32 s3, s3, s4
    v_mfma_f32_16x16x32_bf16 v[80:83], a[212:215], v[144:147], v[80:83]
    v_mfma_f32_16x16x32_bf16 v[80:83], a[216:219], v[160:163], v[80:83]
    s_lshl_b32 s14, s3, 11
    v_mfma_f32_16x16x32_bf16 v[80:83], a[220:223], v[176:179], v[80:83]
    s_waitcnt vmcnt(12) lgkmcnt(0)
    s_barrier
    ds_read_b64_tr_b16 a[64:65], v13 offset:33792
    v_mfma_f32_16x16x32_bf16 v[88:91], a[220:223], v[184:187], 0
    ds_read_b64_tr_b16 a[66:67], v13 offset:34048
    ds_read_b128 v[96:99], v51 offset:0
    v_mfma_f32_16x16x32_bf16 v[88:91], a[216:219], v[168:171], v[88:91]
    buffer_load_dwordx4 v25, s[20:23], s77 offen offset:2112 lds
    v_mfma_f32_16x16x32_bf16 v[88:91], a[212:215], v[152:155], v[88:91]
    ds_read_b64_tr_b16 a[68:69], v13 offset:34304
    ds_read_b128 v[100:103], v51 offset:1024
    v_mfma_f32_16x16x32_bf16 v[88:91], a[208:211], v[136:139], v[88:91]
    ds_read_b64_tr_b16 a[70:71], v13 offset:34560
    ds_read_b64_tr_b16 a[72:73], v13 offset:42240
    v_mfma_f32_16x16x32_bf16 v[84:87], a[224:227], v[128:131], 0
    ds_read_b64_tr_b16 a[74:75], v13 offset:42496
    ds_read_b64_tr_b16 a[76:77], v13 offset:42752
    v_min_u32 v36, 55, v0
    v_mfma_f32_16x16x32_bf16 v[84:87], a[228:231], v[144:147], v[84:87]
    s_mul_i32 s4, s88, 896
    buffer_load_dwordx4 v26, s[20:23], s77 offen offset:3144 lds
    v_mfma_f32_16x16x32_bf16 v[84:87], a[232:235], v[160:163], v[84:87]
    s_add_u32 s4, s4, 158720
    ds_read_b64_tr_b16 a[78:79], v13 offset:43008
    ds_read_b64_tr_b16 a[192:193], v13 offset:33800
    v_mfma_f32_16x16x32_bf16 v[84:87], a[236:239], v[176:179], v[84:87]
    s_add_u32 s78, s76, 118784
    ds_read_b64_tr_b16 a[194:195], v13 offset:34056
    s_waitcnt lgkmcnt(9)
    v_lshlrev_b32 v196, 16, v96
    v_mfma_f32_16x16x32_bf16 v[92:95], a[236:239], v[184:187], 0
    s_add_u32 m0, s72, 71808
    ds_read_b64_tr_b16 a[196:197], v13 offset:34312
    ds_read_b64_tr_b16 a[198:199], v13 offset:34568
    v_and_b32 v197, s68, v96
    v_mfma_f32_16x16x32_bf16 v[92:95], a[232:235], v[168:171], v[92:95]
    ds_read_b64_tr_b16 a[200:201], v13 offset:42248
    v_lshl_add_u32 v34, v36, 4, s4
    v_lshlrev_b32 v198, 16, v97
    v_and_b32 v199, s68, v97
    v_mfma_f32_16x16x32_bf16 v[92:95], a[228:231], v[152:155], v[92:95]
    buffer_load_dwordx4 v23, s[20:23], s78 offen lds
    v_fmac_f32 v196, v48, v164
    v_fmac_f32 v197, v48, v165
    v_mfma_f32_16x16x32_bf16 v[92:95], a[224:227], v[136:139], v[92:95]
    ds_read_b64_tr_b16 a[202:203], v13 offset:42504
    ds_read_b64_tr_b16 a[204:205], v13 offset:42760
    v_fmac_f32 v198, v48, v166
    v_fmac_f32 v199, v48, v167
    v_mfma_f32_16x16x32_bf16 v[64:67], a[0:3], v[192:195], v[64:67]
    ds_write_b64 v34, v[28:29]
    v_mfma_f32_16x16x32_bf16 v[64:67], a[4:7], v[208:211], v[64:67]
    ds_write_b64 v34, v[30:31] offset:8
    v_mfma_f32_16x16x32_bf16 v[64:67], a[8:11], v[224:227], v[64:67]
    ds_read_b64_tr_b16 a[206:207], v13 offset:43016
    ds_read_b64_tr_b16 a[208:209], v9 offset:33792
    v_cvt_pk_bf16_f32 v96, v196, v197
    v_cvt_pk_bf16_f32 v97, v198, v199
    v_mfma_f32_16x16x32_bf16 v[132:135], a[12:15], v[240:243], v[64:67]
    ds_read_b64_tr_b16 a[210:211], v9 offset:34048
    ds_read_b64_tr_b16 a[212:213], v9 offset:34304
    v_lshlrev_b32 v204, 16, v98
    v_and_b32 v205, s68, v98
    v_mfma_f32_16x16x32_bf16 v[72:75], a[12:15], v[248:251], v[72:75]
    buffer_load_dwordx4 v24, s[20:23], s78 offen offset:1032 lds
    v_lshrrev_b32 v116, 3, v0
    v_lshlrev_b32 v206, 16, v99
    v_mfma_f32_16x16x32_bf16 v[72:75], a[8:11], v[232:235], v[72:75]
    ds_read_b64_tr_b16 a[214:215], v9 offset:34560
    ds_read_b64_tr_b16 a[216:217], v9 offset:42240
    v_and_b32 v207, s68, v99
    v_fmac_f32 v204, v48, v172
    v_mfma_f32_16x16x32_bf16 v[72:75], a[4:7], v[216:219], v[72:75]
    ds_read_b64_tr_b16 a[218:219], v9 offset:42496
    ds_read_b64_tr_b16 a[220:221], v9 offset:42752
    v_fmac_f32 v205, v48, v173
    s_cmp_eq_u32 s88, 3
    s_cselect_b64 vcc, -1, 0
    s_cselect_b32 s15, 0, -1
    s_cselect_b32 s5, 3, 0
    v_mfma_f32_16x16x32_bf16 v[148:151], a[0:3], v[200:203], v[72:75]
    ds_read_b64_tr_b16 a[222:223], v9 offset:43008
    v_fmac_f32 v206, v48, v174
    v_fmac_f32 v207, v48, v175
    v_cvt_pk_bf16_f32 v98, v204, v205
    v_mfma_f32_16x16x32_bf16 v[68:71], a[16:19], v[192:195], v[68:71]
    buffer_load_dwordx4 v25, s[20:23], s78 offen offset:2112 lds
    v_cvt_pk_bf16_f32 v99, v206, v207
    s_waitcnt lgkmcnt(10)
    v_lshlrev_b32 v212, 16, v100
    v_mfma_f32_16x16x32_bf16 v[68:71], a[20:23], v[208:211], v[68:71]
    ds_read_b64_tr_b16 a[224:225], v9 offset:33800
    ds_read_b64_tr_b16 a[226:227], v9 offset:34056
    v_and_b32 v213, s68, v100
    v_lshlrev_b32 v214, 16, v101
    v_mfma_f32_16x16x32_bf16 v[68:71], a[24:27], v[224:227], v[68:71]
    ds_read_b64_tr_b16 a[228:229], v9 offset:34312
    ds_read_b64_tr_b16 a[230:231], v9 offset:34568
    v_and_b32 v215, s68, v101
    v_fmac_f32 v212, v49, v180
    v_mfma_f32_16x16x32_bf16 v[140:143], a[28:31], v[240:243], v[68:71]
    ds_read_b64_tr_b16 a[232:233], v9 offset:42248
    v_fmac_f32 v213, v49, v181
    v_fmac_f32 v214, v49, v182
    v_fmac_f32 v215, v49, v183
    v_mfma_f32_16x16x32_bf16 v[76:79], a[28:31], v[248:251], v[76:79]
    buffer_load_dwordx4 v26, s[20:23], s78 offen offset:3144 lds
    v_cvt_pk_bf16_f32 v100, v212, v213
    v_cvt_pk_bf16_f32 v101, v214, v215
    v_mfma_f32_16x16x32_bf16 v[76:79], a[24:27], v[232:235], v[76:79]
    s_add_u32 s77, s76, 640
    ds_read_b64_tr_b16 a[234:235], v9 offset:42504
    ds_read_b64_tr_b16 a[236:237], v9 offset:42760
    v_mul_u32_u24 v105, 896, v53
    v_lshlrev_b32 v220, 16, v102
    v_mfma_f32_16x16x32_bf16 v[76:79], a[20:23], v[216:219], v[76:79]
    s_add_u32 m0, s72, 33792
    ds_read_b64_tr_b16 a[238:239], v9 offset:43016
    v_and_b32 v221, s68, v102
    v_lshlrev_b32 v222, 16, v103
    v_and_b32 v223, s68, v103
    v_mfma_f32_16x16x32_bf16 v[156:159], a[16:19], v[200:203], v[76:79]
    v_lshl_add_u32 v105, v116, 4, v105
    s_lshl_b32 s4, s88, 7
    v_fmac_f32 v220, v49, v188
    v_fmac_f32 v221, v49, v189
    v_mfma_f32_16x16x32_bf16 v[80:83], a[32:35], v[192:195], v[80:83]
    v_fmac_f32 v222, v49, v190
    v_fmac_f32 v223, v49, v191
    v_cvt_pk_bf16_f32 v102, v220, v221
    v_cvt_pk_bf16_f32 v103, v222, v223
    v_add_u32 v105, s4, v105
    v_mfma_f32_16x16x32_bf16 v[80:83], a[36:39], v[208:211], v[80:83]
    buffer_load_dwordx4 v23, s[20:23], s77 offen lds
    v_mfma_f32_16x16x32_bf16 v[80:83], a[40:43], v[224:227], v[80:83]
    s_add_u32 s80, s79, 32768
    buffer_store_dwordx4 v[96:99], v1, s[28:31], s80 offen sc1
    v_cndmask_b32 v104, v105, v63, vcc
    v_mfma_f32_16x16x32_bf16 v[164:167], a[44:47], v[240:243], v[80:83]
    s_waitcnt vmcnt(10) lgkmcnt(0)
    s_barrier
    ds_read_b64_tr_b16 a[0:1], v12 offset:0
    v_mfma_f32_16x16x32_bf16 v[88:91], a[44:47], v[248:251], v[88:91]
    buffer_load_dwordx4 v24, s[20:23], s77 offen offset:1032 lds
    v_cndmask_b32 v118, v14, v63, vcc
    v_mfma_f32_16x16x32_bf16 v[88:91], a[40:43], v[232:235], v[88:91]
    ds_read_b64_tr_b16 a[2:3], v12 offset:256
    v_lshlrev_b32 v119, 4, v53
    v_mfma_f32_16x16x32_bf16 v[88:91], a[36:39], v[216:219], v[88:91]
    s_add_u32 s80, s81, 32768
    buffer_store_dwordx4 v[100:103], v27, s[28:31], s80 offen sc1
    v_mfma_f32_16x16x32_bf16 v[180:183], a[32:35], v[200:203], v[88:91]
    ds_read_b64_tr_b16 a[4:5], v12 offset:512
    v_and_b32 v43, 15, v0
    v_mfma_f32_16x16x32_bf16 v[84:87], a[48:51], v[192:195], v[84:87]
    s_mov_b64 exec, s[16:17]
    ds_write_b128 v52, v[96:99] offset:1024
    s_mov_b64 exec, -1
    v_mfma_f32_16x16x32_bf16 v[84:87], a[52:55], v[208:211], v[84:87]
    v_lshlrev_b32 v43, 3, v43
    v_mul_f32 v132, v48, v132
    v_mfma_f32_16x16x32_bf16 v[84:87], a[56:59], v[224:227], v[84:87]
    ds_read_b64_tr_b16 a[6:7], v12 offset:768
    v_mul_f32 v133, v48, v133
    v_mfma_f32_16x16x32_bf16 v[172:175], a[60:63], v[240:243], v[84:87]
    buffer_load_dwordx4 v25, s[20:23], s77 offen offset:2112 lds
    v_add_u32 v43, 1024, v43
    v_mul_f32 v134, v48, v134
    v_mfma_f32_16x16x32_bf16 v[92:95], a[60:63], v[248:251], v[92:95]
    ds_read_b64_tr_b16 a[8:9], v12 offset:8448
    v_mul_f32 v135, v48, v135
    v_cvt_pk_bf16_f32 v132, v132, v133
    v_mfma_f32_16x16x32_bf16 v[92:95], a[56:59], v[232:235], v[92:95]
    s_cmp_gt_u32 s88, 1
    s_cselect_b64 vcc, -1, 0
    ds_read_b64_tr_b16 a[10:11], v12 offset:8704
    v_cvt_pk_bf16_f32 v133, v134, v135
    v_mfma_f32_16x16x32_bf16 v[92:95], a[52:55], v[216:219], v[92:95]
    buffer_load_dwordx4 v26, s[20:23], s77 offen offset:3144 lds
    v_mul_f32 v140, v48, v140
    v_mfma_f32_16x16x32_bf16 v[188:191], a[48:51], v[200:203], v[92:95]
    s_add_u32 s78, s76, 4224
    ds_read_b64_tr_b16 a[12:13], v12 offset:8960
    v_mul_f32 v141, v48, v141
    v_mul_f32 v142, v48, v142
    v_mfma_f32_16x16x32_bf16 v[64:67], a[128:131], v[128:131], 0
    s_add_u32 m0, s72, 38016
    ds_read_b64_tr_b16 a[14:15], v12 offset:9216
    v_cndmask_b32 v125, v119, v43, vcc
    v_mul_f32 v143, v48, v143
    v_mfma_f32_16x16x32_bf16 v[64:67], a[132:135], v[144:147], v[64:67]
    s_add_u32 s64, s94, s88
    ds_read_b64_tr_b16 a[16:17], v12 offset:8
    v_cvt_pk_bf16_f32 v134, v140, v141
    v_mfma_f32_16x16x32_bf16 v[64:67], a[136:139], v[160:163], v[64:67]
    s_add_u32 s65, s64, 4
    buffer_load_dwordx4 v23, s[20:23], s78 offen lds
    v_cvt_pk_bf16_f32 v135, v142, v143
    v_mfma_f32_16x16x32_bf16 v[64:67], a[140:143], v[176:179], v[64:67]
    s_add_u32 s64, s64, 1
    ds_write_b128 v50, v[132:135] offset:0
    v_mfma_f32_16x16x32_bf16 v[72:75], a[140:143], v[184:187], 0
    s_sub_u32 s64, s64, s5
    v_mul_f32 v148, v49, v148
    v_mul_f32 v149, v49, v149
    v_mul_f32 v150, v49, v150
    v_mfma_f32_16x16x32_bf16 v[72:75], a[136:139], v[168:171], v[72:75]
    s_lshl_b32 s60, s87, 3
    ds_read_b64_tr_b16 a[18:19], v12 offset:264
    v_mul_f32 v151, v49, v151
    v_mfma_f32_16x16x32_bf16 v[72:75], a[132:135], v[152:155], v[72:75]
    ds_read_b64_tr_b16 a[20:21], v12 offset:520
    v_cvt_pk_bf16_f32 v148, v148, v149
    v_mfma_f32_16x16x32_bf16 v[72:75], a[128:131], v[136:139], v[72:75]
    s_add_u32 s60, s60, s86
    buffer_load_dwordx4 v24, s[20:23], s78 offen offset:1032 lds
    v_cvt_pk_bf16_f32 v149, v150, v151
    v_mul_f32 v156, v49, v156
    v_mfma_f32_16x16x32_bf16 v[68:71], a[144:147], v[128:131], 0
    ds_read_b64_tr_b16 a[22:23], v12 offset:776
    v_mul_f32 v157, v49, v157
    v_mfma_f32_16x16x32_bf16 v[68:71], a[148:151], v[144:147], v[68:71]
    s_mul_i32 s96, s60, 7168
    ds_read_b64_tr_b16 a[24:25], v12 offset:8456
    v_mul_f32 v158, v49, v158
    v_mfma_f32_16x16x32_bf16 v[68:71], a[152:155], v[160:163], v[68:71]
    s_lshl_b32 s61, s86, 7
    ds_read_b64_tr_b16 a[26:27], v12 offset:8712
    v_mul_f32 v159, v49, v159
    v_cvt_pk_bf16_f32 v150, v156, v157
    v_mfma_f32_16x16x32_bf16 v[68:71], a[156:159], v[176:179], v[68:71]
    buffer_load_dwordx4 v25, s[20:23], s78 offen offset:2112 lds
    v_cvt_pk_bf16_f32 v151, v158, v159
    v_mfma_f32_16x16x32_bf16 v[76:79], a[156:159], v[184:187], 0
    s_add_u32 s61, s61, 251904
    ds_write_b128 v50, v[148:151] offset:1024
    v_mfma_f32_16x16x32_bf16 v[76:79], a[152:155], v[168:171], v[76:79]
    v_mfma_f32_16x16x32_bf16 v[76:79], a[148:151], v[152:155], v[76:79]
    s_add_u32 s61, s61, s34
    ds_read_b64_tr_b16 a[28:29], v12 offset:8968
    v_mfma_f32_16x16x32_bf16 v[76:79], a[144:147], v[136:139], v[76:79]
    ds_read_b64_tr_b16 a[30:31], v12 offset:9224
    v_mfma_f32_16x16x32_bf16 v[80:83], a[160:163], v[128:131], 0
    s_lshr_b32 s3, s86, 1
    buffer_load_dwordx4 v26, s[20:23], s78 offen offset:3144 lds
    v_mfma_f32_16x16x32_bf16 v[80:83], a[164:167], v[144:147], v[80:83]
    s_add_u32 s77, s76, 115328
    ds_read_b64_tr_b16 a[32:33], v8 offset:0
    v_mfma_f32_16x16x32_bf16 v[80:83], a[168:171], v[160:163], v[80:83]
    s_add_u32 m0, s72, 101376
    ds_read_b64_tr_b16 a[34:35], v8 offset:256
    v_mfma_f32_16x16x32_bf16 v[80:83], a[172:175], v[176:179], v[80:83]
    s_waitcnt lgkmcnt(4)
    s_barrier
    ds_read_b64_tr_b16 a[36:37], v8 offset:512
    v_mfma_f32_16x16x32_bf16 v[88:91], a[172:175], v[184:187], 0
    s_lshl_b32 s62, s3, 18
    ds_read_b128 v[96:99], v51 offset:0
    v_mfma_f32_16x16x32_bf16 v[88:91], a[168:171], v[168:171], v[88:91]
    s_lshl_b32 s3, s88, 15
    buffer_load_dwordx4 v23, s[20:23], s77 offen lds
    v_mfma_f32_16x16x32_bf16 v[88:91], a[164:167], v[152:155], v[88:91]
    s_add_u32 s62, s62, s3
    ds_read_b128 v[100:103], v51 offset:1024
    ds_read_b64_tr_b16 a[38:39], v8 offset:768
    v_mfma_f32_16x16x32_bf16 v[88:91], a[160:163], v[136:139], v[88:91]
    s_and_b32 s3, s86, 1
    ds_read_b64_tr_b16 a[40:41], v8 offset:8448
    v_mfma_f32_16x16x32_bf16 v[84:87], a[176:179], v[128:131], 0
    buffer_load_dwordx4 v24, s[20:23], s77 offen offset:1032 lds
    v_mfma_f32_16x16x32_bf16 v[84:87], a[180:183], v[144:147], v[84:87]
    s_lshl_b32 s3, s3, 7
    ds_read_b64_tr_b16 a[42:43], v8 offset:8704
    v_mfma_f32_16x16x32_bf16 v[84:87], a[184:187], v[160:163], v[84:87]
    s_add_u32 s62, s62, s3
    ds_read_b64_tr_b16 a[44:45], v8 offset:8960
    s_waitcnt lgkmcnt(5)
    v_lshlrev_b32 v196, 16, v96
    v_mfma_f32_16x16x32_bf16 v[84:87], a[188:191], v[176:179], v[84:87]
    ds_read_b64_tr_b16 a[46:47], v8 offset:9216
    v_and_b32 v197, s68, v96
    v_mfma_f32_16x16x32_bf16 v[92:95], a[188:191], v[184:187], 0
    s_xor_b32 s62, s62, s34
    v_lshlrev_b32 v198, 16, v97
    v_and_b32 v199, s68, v97
    v_mfma_f32_16x16x32_bf16 v[92:95], a[184:187], v[168:171], v[92:95]
    buffer_load_dwordx4 v25, s[20:23], s77 offen offset:2112 lds
    v_mfma_f32_16x16x32_bf16 v[92:95], a[180:183], v[152:155], v[92:95]
    s_mov_b32 s6, s62
    ds_read_b64_tr_b16 a[48:49], v8 offset:8
    v_fmac_f32 v196, v48, v164
    v_fmac_f32 v197, v48, v165
    v_mfma_f32_16x16x32_bf16 v[92:95], a[176:179], v[136:139], v[92:95]
    ds_read_b64_tr_b16 a[50:51], v8 offset:264
    v_fmac_f32 v198, v48, v166
    v_fmac_f32 v199, v48, v167
    v_mfma_f32_16x16x32_bf16 v[64:67], a[64:67], v[192:195], v[64:67]
    v_cvt_pk_bf16_f32 v96, v196, v197
    v_cvt_pk_bf16_f32 v97, v198, v199
    v_mfma_f32_16x16x32_bf16 v[64:67], a[68:71], v[208:211], v[64:67]
    buffer_load_dwordx4 v26, s[20:23], s77 offen offset:3144 lds
    v_lshlrev_b32 v204, 16, v98
    v_and_b32 v205, s68, v98
    v_mfma_f32_16x16x32_bf16 v[64:67], a[72:75], v[224:227], v[64:67]
    s_add_u32 s78, s76, 118912
    ds_read_b64_tr_b16 a[52:53], v8 offset:520
    v_lshlrev_b32 v206, 16, v99
    v_and_b32 v207, s68, v99
    v_mfma_f32_16x16x32_bf16 v[132:135], a[76:79], v[240:243], v[64:67]
    s_add_u32 m0, s72, 105600
    ds_read_b64_tr_b16 a[54:55], v8 offset:776
    v_fmac_f32 v204, v48, v172
    v_fmac_f32 v205, v48, v173
    v_mfma_f32_16x16x32_bf16 v[72:75], a[76:79], v[248:251], v[72:75]
    ds_read_b64_tr_b16 a[56:57], v8 offset:8456
    v_add_u32 v40, 114240, v27
    v_fmac_f32 v206, v48, v174
    v_fmac_f32 v207, v48, v175
    v_mfma_f32_16x16x32_bf16 v[72:75], a[72:75], v[232:235], v[72:75]
    v_cmp_gt_u32 vcc, 28, v0
    v_cvt_pk_bf16_f32 v98, v204, v205
    v_cvt_pk_bf16_f32 v99, v206, v207
    v_mfma_f32_16x16x32_bf16 v[72:75], a[68:71], v[216:219], v[72:75]
    buffer_load_dwordx4 v23, s[20:23], s78 offen lds
    s_waitcnt lgkmcnt(4)
    v_lshlrev_b32 v212, 16, v100
    v_mfma_f32_16x16x32_bf16 v[148:151], a[64:67], v[200:203], v[72:75]
    ds_read_b64_tr_b16 a[58:59], v8 offset:8712
    v_and_b32 v213, s68, v100
    v_cndmask_b32 v40, v40, v27, vcc
    v_lshlrev_b32 v214, 16, v101
    v_mfma_f32_16x16x32_bf16 v[68:71], a[192:195], v[192:195], v[68:71]
    ds_read_b64_tr_b16 a[60:61], v8 offset:8968
    v_and_b32 v215, s68, v101
    v_fmac_f32 v212, v49, v180
    v_fmac_f32 v213, v49, v181
    v_mfma_f32_16x16x32_bf16 v[68:71], a[196:199], v[208:211], v[68:71]
    v_cmp_gt_u32 vcc, 56, v0
    v_fmac_f32 v214, v49, v182
    v_fmac_f32 v215, v49, v183
    v_mfma_f32_16x16x32_bf16 v[68:71], a[200:203], v[224:227], v[68:71]
    buffer_load_dwordx4 v24, s[20:23], s78 offen offset:1032 lds
    v_cvt_pk_bf16_f32 v100, v212, v213
    v_cvt_pk_bf16_f32 v101, v214, v215
    v_mfma_f32_16x16x32_bf16 v[140:143], a[204:207], v[240:243], v[68:71]
    ds_read_b64_tr_b16 a[62:63], v8 offset:9224
    v_cndmask_b32 v40, v63, v40, vcc
    v_lshlrev_b32 v220, 16, v102
    v_and_b32 v221, s68, v102
    v_mfma_f32_16x16x32_bf16 v[76:79], a[204:207], v[248:251], v[76:79]
    v_add_u32 v15, 0, v40
    v_lshlrev_b32 v222, 16, v103
    v_and_b32 v223, s68, v103
    v_mfma_f32_16x16x32_bf16 v[76:79], a[200:203], v[232:235], v[76:79]
    v_fmac_f32 v220, v49, v188
    v_fmac_f32 v221, v49, v189
    v_mfma_f32_16x16x32_bf16 v[76:79], a[196:199], v[216:219], v[76:79]
    v_add_u32 v16, 2528, v40
    v_fmac_f32 v222, v49, v190
    v_fmac_f32 v223, v49, v191
    v_mfma_f32_16x16x32_bf16 v[156:159], a[192:195], v[200:203], v[76:79]
    buffer_load_dwordx4 v25, s[20:23], s78 offen offset:2112 lds
    v_cvt_pk_bf16_f32 v102, v220, v221
    v_cvt_pk_bf16_f32 v103, v222, v223
    v_mfma_f32_16x16x32_bf16 v[80:83], a[208:211], v[192:195], v[80:83]
    v_add_u32 v122, 2, v122
    v_add_u32 v17, 5056, v40
    v_mfma_f32_16x16x32_bf16 v[80:83], a[212:215], v[208:211], v[80:83]
    s_add_u32 s80, s79, 65536
    buffer_store_dwordx4 v[96:99], v1, s[28:31], s80 offen sc1
    v_mfma_f32_16x16x32_bf16 v[80:83], a[216:219], v[224:227], v[80:83]
    v_add_u32 v18, 7584, v40
    v_mfma_f32_16x16x32_bf16 v[164:167], a[220:223], v[240:243], v[80:83]
    s_waitcnt vmcnt(14) lgkmcnt(0)
    s_barrier
    s_lshl_b32 s3, s90, 2
    v_mfma_f32_16x16x32_bf16 v[88:91], a[220:223], v[248:251], v[88:91]
    s_lshl_b32 s4, s89, 4
    ds_read_b64_tr_b16 a[128:129], v13 offset:0
    ds_read_b64_tr_b16 a[130:131], v13 offset:256
    v_mfma_f32_16x16x32_bf16 v[88:91], a[216:219], v[232:235], v[88:91]
    s_add_u32 s3, s3, s4
    buffer_load_dwordx4 v26, s[20:23], s78 offen offset:3144 lds
    v_mfma_f32_16x16x32_bf16 v[88:91], a[212:215], v[216:219], v[88:91]
    s_add_u32 s77, s76, 768
    s_add_u32 s80, s81, 65536
    buffer_store_dwordx4 v[100:103], v27, s[28:31], s80 offen sc1
    buffer_store_dwordx2 v[122:123], v55, s[28:31], s98 offen sc1
    v_mfma_f32_16x16x32_bf16 v[180:183], a[208:211], v[200:203], v[88:91]
    s_mul_i32 s74, s3, 3584
    ds_read_b64_tr_b16 a[132:133], v13 offset:512
    ds_read_b64_tr_b16 a[134:135], v13 offset:768
    v_mfma_f32_16x16x32_bf16 v[84:87], a[224:227], v[192:195], v[84:87]
    s_add_u32 m0, s72, 0
    s_mov_b64 exec, s[16:17]
    ds_write_b128 v52, v[96:99] offset:2048
    s_mov_b64 exec, -1
    v_mfma_f32_16x16x32_bf16 v[84:87], a[228:231], v[208:211], v[84:87]
    s_mul_i32 s4, s86, 448
    ds_read_b64_tr_b16 a[136:137], v13 offset:8448
    v_mul_f32 v132, v48, v132
    v_mfma_f32_16x16x32_bf16 v[84:87], a[232:235], v[224:227], v[84:87]
    s_add_u32 s74, s74, s4
    ds_read_b64_tr_b16 a[138:139], v13 offset:8704
    ds_read_b64_tr_b16 a[140:141], v13 offset:8960
    v_mul_f32 v133, v48, v133
    v_mfma_f32_16x16x32_bf16 v[172:175], a[236:239], v[240:243], v[84:87]
    s_mul_i32 s3, s86, 200704
    ds_read_b64_tr_b16 a[142:143], v13 offset:9216
    ds_read_b64_tr_b16 a[144:145], v13 offset:8
    v_mul_f32 v134, v48, v134
    v_mfma_f32_16x16x32_bf16 v[92:95], a[236:239], v[248:251], v[92:95]
    buffer_load_dwordx4 v23, s[20:23], s77 offen lds
    v_mul_f32 v135, v48, v135
    v_cvt_pk_bf16_f32 v132, v132, v133
    v_mfma_f32_16x16x32_bf16 v[92:95], a[232:235], v[232:235], v[92:95]
    ds_read_b64_tr_b16 a[146:147], v13 offset:264
    ds_read_b64_tr_b16 a[148:149], v13 offset:520
    v_cvt_pk_bf16_f32 v133, v134, v135
    v_mfma_f32_16x16x32_bf16 v[92:95], a[228:231], v[216:219], v[92:95]
    ds_read_b64_tr_b16 a[150:151], v13 offset:776
    ds_read_b64_tr_b16 a[152:153], v13 offset:8456
    v_mul_f32 v140, v48, v140
    v_mfma_f32_16x16x32_bf16 v[188:191], a[224:227], v[200:203], v[92:95]
    ds_read_b64_tr_b16 a[154:155], v13 offset:8712
    ds_read_b64_tr_b16 a[156:157], v13 offset:8968
    v_mul_f32 v141, v48, v141
    v_mul_f32 v142, v48, v142
    v_mfma_f32_16x16x32_bf16 v[64:67], a[0:3], v[128:131], 0
    buffer_load_dwordx4 v24, s[20:23], s77 offen offset:1032 lds
    s_add_u32 s52, s38, s3
    s_addc_u32 s53, s39, 0
    v_mfma_f32_16x16x32_bf16 v[64:67], a[4:7], v[144:147], v[64:67]
    ds_read_b64_tr_b16 a[158:159], v13 offset:9224
    ds_read_b64_tr_b16 a[160:161], v9 offset:0
    v_mul_f32 v143, v48, v143
    v_cvt_pk_bf16_f32 v134, v140, v141
    v_mfma_f32_16x16x32_bf16 v[64:67], a[8:11], v[160:163], v[64:67]
    ds_read_b64_tr_b16 a[162:163], v9 offset:256
    ds_read_b64_tr_b16 a[164:165], v9 offset:512
    v_cvt_pk_bf16_f32 v135, v142, v143
    v_mfma_f32_16x16x32_bf16 v[64:67], a[12:15], v[176:179], v[64:67]
    ds_write_b128 v50, v[132:135] offset:0
    v_mfma_f32_16x16x32_bf16 v[72:75], a[12:15], v[184:187], 0
    s_sub_u32 s52, s52, 512
    s_subb_u32 s53, s53, 0
    v_mul_f32 v148, v49, v148
    v_mul_f32 v149, v49, v149
    v_mul_f32 v150, v49, v150
    v_mfma_f32_16x16x32_bf16 v[72:75], a[8:11], v[168:171], v[72:75]
    s_mov_b32 s54, 201216
    ds_read_b64_tr_b16 a[166:167], v9 offset:768
    ds_read_b64_tr_b16 a[168:169], v9 offset:8448
    v_mul_f32 v151, v49, v151
    v_mfma_f32_16x16x32_bf16 v[72:75], a[4:7], v[152:155], v[72:75]
    s_mov_b32 s55, 0x20000
    buffer_load_dwordx4 v25, s[20:23], s77 offen offset:2112 lds
    v_cvt_pk_bf16_f32 v148, v148, v149
    v_mfma_f32_16x16x32_bf16 v[72:75], a[0:3], v[136:139], v[72:75]
    s_mov_b32 s56, s50
    ds_read_b64_tr_b16 a[170:171], v9 offset:8704
    ds_read_b64_tr_b16 a[172:173], v9 offset:8960
    v_cvt_pk_bf16_f32 v149, v150, v151
    v_mul_f32 v156, v49, v156
    v_mfma_f32_16x16x32_bf16 v[68:71], a[16:19], v[128:131], 0
    s_mov_b32 s57, s51
    ds_read_b64_tr_b16 a[174:175], v9 offset:9216
    ds_read_b64_tr_b16 a[176:177], v9 offset:8
    v_mul_f32 v157, v49, v157
    v_mfma_f32_16x16x32_bf16 v[68:71], a[20:23], v[144:147], v[68:71]
    buffer_load_dwordx4 v26, s[20:23], s77 offen offset:3144 lds
    v_mul_f32 v158, v49, v158
    v_mfma_f32_16x16x32_bf16 v[68:71], a[24:27], v[160:163], v[68:71]
    s_add_u32 s78, s76, 4352
    ds_read_b64_tr_b16 a[178:179], v9 offset:264
    ds_read_b64_tr_b16 a[180:181], v9 offset:520
    v_mul_f32 v159, v49, v159
    v_cvt_pk_bf16_f32 v150, v156, v157
    v_mfma_f32_16x16x32_bf16 v[68:71], a[28:31], v[176:179], v[68:71]
    s_add_u32 m0, s72, 4224
    ds_read_b64_tr_b16 a[182:183], v9 offset:776
    ds_read_b64_tr_b16 a[184:185], v9 offset:8456
    v_cvt_pk_bf16_f32 v151, v158, v159
    v_mfma_f32_16x16x32_bf16 v[76:79], a[28:31], v[184:187], 0
    s_mov_b32 s58, 1835008
    ds_write_b128 v50, v[148:151] offset:1024
    v_mfma_f32_16x16x32_bf16 v[76:79], a[24:27], v[168:171], v[76:79]
    s_mov_b32 s59, 0x20000
    ds_read_b64_tr_b16 a[186:187], v9 offset:8712
    v_mfma_f32_16x16x32_bf16 v[76:79], a[20:23], v[152:155], v[76:79]
    ds_read_b64_tr_b16 a[188:189], v9 offset:8968
    ds_read_b64_tr_b16 a[190:191], v9 offset:9224
    v_mfma_f32_16x16x32_bf16 v[76:79], a[16:19], v[136:139], v[76:79]
    buffer_load_dwordx4 v23, s[20:23], s78 offen lds
    v_mfma_f32_16x16x32_bf16 v[80:83], a[32:35], v[128:131], 0
    buffer_load_dwordx4 v24, s[20:23], s78 offen offset:1032 lds
    v_mfma_f32_16x16x32_bf16 v[80:83], a[36:39], v[144:147], v[80:83]
    v_mfma_f32_16x16x32_bf16 v[80:83], a[40:43], v[160:163], v[80:83]
    v_mfma_f32_16x16x32_bf16 v[80:83], a[44:47], v[176:179], v[80:83]
    s_waitcnt vmcnt(17) lgkmcnt(0)
    s_barrier
    ds_read_b64_tr_b16 a[64:65], v12 offset:33792
    v_mfma_f32_16x16x32_bf16 v[88:91], a[44:47], v[184:187], 0
    ds_read_b64_tr_b16 a[66:67], v12 offset:34048
    ds_read_b128 v[96:99], v51 offset:0
    v_mfma_f32_16x16x32_bf16 v[88:91], a[40:43], v[168:171], v[88:91]
    ds_read_b64_tr_b16 a[68:69], v12 offset:34304
    ds_read_b128 v[100:103], v51 offset:1024
    v_mfma_f32_16x16x32_bf16 v[88:91], a[36:39], v[152:155], v[88:91]
    buffer_load_dwordx4 v25, s[20:23], s78 offen offset:2112 lds
    v_mfma_f32_16x16x32_bf16 v[88:91], a[32:35], v[136:139], v[88:91]
    ds_read_b64_tr_b16 a[70:71], v12 offset:34560
    ds_read_b64_tr_b16 a[72:73], v12 offset:42240
    v_mfma_f32_16x16x32_bf16 v[84:87], a[48:51], v[128:131], 0
    ds_read_b64_tr_b16 a[74:75], v12 offset:42496
    ds_read_b64_tr_b16 a[76:77], v12 offset:42752
    v_mfma_f32_16x16x32_bf16 v[84:87], a[52:55], v[144:147], v[84:87]
    ds_read_b64_tr_b16 a[78:79], v12 offset:43008
    v_mfma_f32_16x16x32_bf16 v[84:87], a[56:59], v[160:163], v[84:87]
    buffer_load_dwordx4 v26, s[20:23], s78 offen offset:3144 lds
    v_mfma_f32_16x16x32_bf16 v[84:87], a[60:63], v[176:179], v[84:87]
    s_add_u32 s77, s76, 115456
    ds_read_b64_tr_b16 a[192:193], v12 offset:33800
    ds_read_b64_tr_b16 a[194:195], v12 offset:34056
    v_mfma_f32_16x16x32_bf16 v[92:95], a[60:63], v[184:187], 0
    s_add_u32 m0, s72, 67584
    ds_read_b64_tr_b16 a[196:197], v12 offset:34312
    ds_read_b64_tr_b16 a[198:199], v12 offset:34568
    s_waitcnt lgkmcnt(11)
    v_lshlrev_b32 v196, 16, v96
    v_mfma_f32_16x16x32_bf16 v[92:95], a[56:59], v[168:171], v[92:95]
    ds_read_b64_tr_b16 a[200:201], v12 offset:42248
    v_and_b32 v197, s68, v96
    v_lshlrev_b32 v198, 16, v97
    v_and_b32 v199, s68, v97
    v_mfma_f32_16x16x32_bf16 v[92:95], a[52:55], v[152:155], v[92:95]
    ds_read_b64_tr_b16 a[202:203], v12 offset:42504
    v_fmac_f32 v196, v48, v164
    v_fmac_f32 v197, v48, v165
    v_mfma_f32_16x16x32_bf16 v[92:95], a[48:51], v[136:139], v[92:95]
    ds_read_b64_tr_b16 a[204:205], v12 offset:42760
    v_fmac_f32 v198, v48, v166
    v_fmac_f32 v199, v48, v167
    v_mfma_f32_16x16x32_bf16 v[64:67], a[128:131], v[192:195], v[64:67]
    buffer_load_dwordx4 v23, s[20:23], s77 offen lds
    v_cvt_pk_bf16_f32 v96, v196, v197
    v_cvt_pk_bf16_f32 v97, v198, v199
    v_mfma_f32_16x16x32_bf16 v[64:67], a[132:135], v[208:211], v[64:67]
    ds_read_b64_tr_b16 a[206:207], v12 offset:43016
    ds_read_b64_tr_b16 a[208:209], v8 offset:33792
    v_lshlrev_b32 v204, 16, v98
    v_and_b32 v205, s68, v98
    v_mfma_f32_16x16x32_bf16 v[64:67], a[136:139], v[224:227], v[64:67]
    ds_read_b64_tr_b16 a[210:211], v8 offset:34048
    ds_read_b64_tr_b16 a[212:213], v8 offset:34304
    v_lshlrev_b32 v206, 16, v99
    v_and_b32 v207, s68, v99
    v_mfma_f32_16x16x32_bf16 v[132:135], a[140:143], v[240:243], v[64:67]
    ds_read_b64_tr_b16 a[214:215], v8 offset:34560
    v_fmac_f32 v204, v48, v172
    v_fmac_f32 v205, v48, v173
    v_mfma_f32_16x16x32_bf16 v[72:75], a[140:143], v[248:251], v[72:75]
    buffer_load_dwordx4 v24, s[20:23], s77 offen offset:1032 lds
    v_fmac_f32 v206, v48, v174
    v_fmac_f32 v207, v48, v175
    v_mfma_f32_16x16x32_bf16 v[72:75], a[136:139], v[232:235], v[72:75]
    ds_read_b64_tr_b16 a[216:217], v8 offset:42240
    ds_read_b64_tr_b16 a[218:219], v8 offset:42496
    v_cvt_pk_bf16_f32 v98, v204, v205
    v_cvt_pk_bf16_f32 v99, v206, v207
    v_mfma_f32_16x16x32_bf16 v[72:75], a[132:135], v[216:219], v[72:75]
    ds_read_b64_tr_b16 a[220:221], v8 offset:42752
    ds_read_b64_tr_b16 a[222:223], v8 offset:43008
    s_waitcnt lgkmcnt(10)
    v_lshlrev_b32 v212, 16, v100
    v_mfma_f32_16x16x32_bf16 v[148:151], a[128:131], v[200:203], v[72:75]
    ds_read_b64_tr_b16 a[224:225], v8 offset:33800
    v_and_b32 v213, s68, v100
    v_lshlrev_b32 v214, 16, v101
    v_and_b32 v215, s68, v101
    v_mfma_f32_16x16x32_bf16 v[68:71], a[144:147], v[192:195], v[68:71]
    ds_read_b64_tr_b16 a[226:227], v8 offset:34056
    v_fmac_f32 v212, v49, v180
    v_fmac_f32 v213, v49, v181
    v_mfma_f32_16x16x32_bf16 v[68:71], a[148:151], v[208:211], v[68:71]
    buffer_load_dwordx4 v25, s[20:23], s77 offen offset:2112 lds
    v_fmac_f32 v214, v49, v182
    v_fmac_f32 v215, v49, v183
    v_mfma_f32_16x16x32_bf16 v[68:71], a[152:155], v[224:227], v[68:71]
    ds_read_b64_tr_b16 a[228:229], v8 offset:34312
    ds_read_b64_tr_b16 a[230:231], v8 offset:34568
    v_cvt_pk_bf16_f32 v100, v212, v213
    v_cvt_pk_bf16_f32 v101, v214, v215
    v_mfma_f32_16x16x32_bf16 v[140:143], a[156:159], v[240:243], v[68:71]
    ds_read_b64_tr_b16 a[232:233], v8 offset:42248
    ds_read_b64_tr_b16 a[234:235], v8 offset:42504
    v_lshlrev_b32 v220, 16, v102
    v_and_b32 v221, s68, v102
    v_mfma_f32_16x16x32_bf16 v[76:79], a[156:159], v[248:251], v[76:79]
    ds_read_b64_tr_b16 a[236:237], v8 offset:42760
    v_lshlrev_b32 v222, 16, v103
    v_and_b32 v223, s68, v103
    v_mfma_f32_16x16x32_bf16 v[76:79], a[152:155], v[232:235], v[76:79]
    buffer_load_dwordx4 v26, s[20:23], s77 offen offset:3144 lds
    v_fmac_f32 v220, v49, v188
    v_fmac_f32 v221, v49, v189
    v_mfma_f32_16x16x32_bf16 v[76:79], a[148:151], v[216:219], v[76:79]
    s_add_u32 s78, s76, 119040
    ds_read_b64_tr_b16 a[238:239], v8 offset:43016
    v_fmac_f32 v222, v49, v190
    v_fmac_f32 v223, v49, v191
    v_mfma_f32_16x16x32_bf16 v[156:159], a[144:147], v[200:203], v[76:79]
    s_add_u32 m0, s72, 71808
    buffer_load_dwordx4 v[108:111], v104, s[24:27], s96 offen
    v_cvt_pk_bf16_f32 v102, v220, v221
    v_cvt_pk_bf16_f32 v103, v222, v223
    v_mfma_f32_16x16x32_bf16 v[80:83], a[160:163], v[192:195], v[80:83]
    buffer_load_dwordx4 v23, s[20:23], s78 offen lds
    v_add_u32 v122, 1, v122
    v_mfma_f32_16x16x32_bf16 v[80:83], a[164:167], v[208:211], v[80:83]
    buffer_load_dwordx4 v[112:115], v105, s[24:27], s96 offen offset:384
    v_mfma_f32_16x16x32_bf16 v[80:83], a[168:171], v[224:227], v[80:83]
    s_add_u32 s80, s79, 98304
    buffer_store_dwordx4 v[96:99], v1, s[28:31], s80 offen sc1
    v_mfma_f32_16x16x32_bf16 v[164:167], a[172:175], v[240:243], v[80:83]
    s_waitcnt vmcnt(17) lgkmcnt(0)
    s_barrier
    ds_read_b64_tr_b16 a[0:1], v13 offset:33792
    v_mfma_f32_16x16x32_bf16 v[88:91], a[172:175], v[248:251], v[88:91]
    ds_read_b64_tr_b16 a[2:3], v13 offset:34048
    v_mfma_f32_16x16x32_bf16 v[88:91], a[168:171], v[232:235], v[88:91]
    ds_read_b64_tr_b16 a[4:5], v13 offset:34304
    v_mfma_f32_16x16x32_bf16 v[88:91], a[164:167], v[216:219], v[88:91]
    s_add_u32 s80, s81, 98304
    buffer_store_dwordx4 v[100:103], v27, s[28:31], s80 offen sc1
    buffer_store_dwordx2 v[122:123], v55, s[28:31], s98 offen sc1
    v_mfma_f32_16x16x32_bf16 v[180:183], a[160:163], v[200:203], v[88:91]
    buffer_load_dwordx4 v24, s[20:23], s78 offen offset:1032 lds
    v_mfma_f32_16x16x32_bf16 v[84:87], a[176:179], v[192:195], v[84:87]
    s_mov_b64 exec, s[16:17]
    ds_write_b128 v52, v[96:99] offset:3072
    s_mov_b64 exec, -1
    v_mfma_f32_16x16x32_bf16 v[84:87], a[180:183], v[208:211], v[84:87]
    ds_read_b64_tr_b16 a[6:7], v13 offset:34560
    ds_read_b64_tr_b16 a[8:9], v13 offset:42240
    v_mfma_f32_16x16x32_bf16 v[84:87], a[184:187], v[224:227], v[84:87]
    ds_read_b64_tr_b16 a[10:11], v13 offset:42496
    ds_read_b64_tr_b16 a[12:13], v13 offset:42752
    v_mul_f32 v132, v48, v132
    v_mul_f32 v133, v48, v133
    v_mfma_f32_16x16x32_bf16 v[172:175], a[188:191], v[240:243], v[84:87]
    ds_read_b64_tr_b16 a[14:15], v13 offset:43008
    ds_read_b64_tr_b16 a[16:17], v13 offset:33800
    v_mul_f32 v134, v48, v134
    v_mfma_f32_16x16x32_bf16 v[92:95], a[188:191], v[248:251], v[92:95]
    buffer_load_dwordx4 v25, s[20:23], s78 offen offset:2112 lds
    v_mul_f32 v135, v48, v135
    v_cvt_pk_bf16_f32 v132, v132, v133
    v_mfma_f32_16x16x32_bf16 v[92:95], a[184:187], v[232:235], v[92:95]
    ds_read_b64_tr_b16 a[18:19], v13 offset:34056
    ds_read_b64_tr_b16 a[20:21], v13 offset:34312
    v_cvt_pk_bf16_f32 v133, v134, v135
    v_mfma_f32_16x16x32_bf16 v[92:95], a[180:183], v[216:219], v[92:95]
    ds_read_b64_tr_b16 a[22:23], v13 offset:34568
    ds_read_b64_tr_b16 a[24:25], v13 offset:42248
    v_mul_f32 v140, v48, v140
    v_mfma_f32_16x16x32_bf16 v[188:191], a[176:179], v[200:203], v[92:95]
    ds_read_b64_tr_b16 a[26:27], v13 offset:42504
    ds_read_b64_tr_b16 a[28:29], v13 offset:42760
    v_mul_f32 v141, v48, v141
    v_mul_f32 v142, v48, v142
    v_mfma_f32_16x16x32_bf16 v[64:67], a[64:67], v[128:131], 0
    buffer_load_dwordx4 v26, s[20:23], s78 offen offset:3144 lds
    v_mul_f32 v143, v48, v143
    v_mfma_f32_16x16x32_bf16 v[64:67], a[68:71], v[144:147], v[64:67]
    s_add_u32 s77, s74, 0
    ds_read_b64_tr_b16 a[30:31], v13 offset:43016
    ds_read_b64_tr_b16 a[32:33], v9 offset:33792
    v_cvt_pk_bf16_f32 v134, v140, v141
    v_mfma_f32_16x16x32_bf16 v[64:67], a[72:75], v[160:163], v[64:67]
    s_add_u32 m0, s72, 33792
    ds_read_b64_tr_b16 a[34:35], v9 offset:34048
    ds_read_b64_tr_b16 a[36:37], v9 offset:34304
    v_cvt_pk_bf16_f32 v135, v142, v143
    v_mfma_f32_16x16x32_bf16 v[64:67], a[76:79], v[176:179], v[64:67]
    ds_write_b128 v50, v[132:135] offset:0
    v_mfma_f32_16x16x32_bf16 v[72:75], a[76:79], v[184:187], 0
    v_mul_f32 v148, v49, v148
    v_mul_f32 v149, v49, v149
    v_mul_f32 v150, v49, v150
    v_mfma_f32_16x16x32_bf16 v[72:75], a[72:75], v[168:171], v[72:75]
    ds_read_b64_tr_b16 a[38:39], v9 offset:34560
    ds_read_b64_tr_b16 a[40:41], v9 offset:42240
    v_mul_f32 v151, v49, v151
    v_mfma_f32_16x16x32_bf16 v[72:75], a[68:71], v[152:155], v[72:75]
    buffer_load_dwordx4 v15, s[40:43], s77 offen lds
    v_cvt_pk_bf16_f32 v148, v148, v149
    v_mfma_f32_16x16x32_bf16 v[72:75], a[64:67], v[136:139], v[72:75]
    ds_read_b64_tr_b16 a[42:43], v9 offset:42496
    ds_read_b64_tr_b16 a[44:45], v9 offset:42752
    v_cvt_pk_bf16_f32 v149, v150, v151
    v_mul_f32 v156, v49, v156
    v_mfma_f32_16x16x32_bf16 v[68:71], a[192:195], v[128:131], 0
    ds_read_b64_tr_b16 a[46:47], v9 offset:43008
    ds_read_b64_tr_b16 a[48:49], v9 offset:33800
    v_mul_f32 v157, v49, v157
    v_mfma_f32_16x16x32_bf16 v[68:71], a[196:199], v[144:147], v[68:71]
    ds_read_b64_tr_b16 a[50:51], v9 offset:34056
    ds_read_b64_tr_b16 a[52:53], v9 offset:34312
    v_mul_f32 v158, v49, v158
    v_mfma_f32_16x16x32_bf16 v[68:71], a[200:203], v[160:163], v[68:71]
    buffer_load_dwordx4 v16, s[40:43], s77 offen offset:1056 lds
    v_mul_f32 v159, v49, v159
    v_cvt_pk_bf16_f32 v150, v156, v157
    v_mfma_f32_16x16x32_bf16 v[68:71], a[204:207], v[176:179], v[68:71]
    ds_read_b64_tr_b16 a[54:55], v9 offset:34568
    ds_read_b64_tr_b16 a[56:57], v9 offset:42248
    v_cvt_pk_bf16_f32 v151, v158, v159
    v_mfma_f32_16x16x32_bf16 v[76:79], a[204:207], v[184:187], 0
    ds_write_b128 v50, v[148:151] offset:1024
    v_mfma_f32_16x16x32_bf16 v[76:79], a[200:203], v[168:171], v[76:79]
    ds_read_b64_tr_b16 a[58:59], v9 offset:42504
    v_mfma_f32_16x16x32_bf16 v[76:79], a[196:199], v[152:155], v[76:79]
    ds_read_b64_tr_b16 a[60:61], v9 offset:42760
    ds_read_b64_tr_b16 a[62:63], v9 offset:43016
    v_mfma_f32_16x16x32_bf16 v[76:79], a[192:195], v[136:139], v[76:79]
    buffer_load_dwordx4 v17, s[40:43], s77 offen offset:2112 lds
    v_mfma_f32_16x16x32_bf16 v[80:83], a[208:211], v[128:131], 0
    buffer_load_dwordx4 v18, s[40:43], s77 offen offset:3168 lds
    v_mfma_f32_16x16x32_bf16 v[80:83], a[212:215], v[144:147], v[80:83]
    s_add_u32 s78, s74, 28672
    v_mfma_f32_16x16x32_bf16 v[80:83], a[216:219], v[160:163], v[80:83]
    s_add_u32 m0, s72, 38016
    v_mfma_f32_16x16x32_bf16 v[80:83], a[220:223], v[176:179], v[80:83]
    s_waitcnt vmcnt(17) lgkmcnt(0)
    s_barrier
    ds_read_b64_tr_b16 a[128:129], v12 offset:0
    v_mfma_f32_16x16x32_bf16 v[88:91], a[220:223], v[184:187], 0
    ds_read_b128 v[96:99], v51 offset:0
    v_mfma_f32_16x16x32_bf16 v[88:91], a[216:219], v[168:171], v[88:91]
    ds_read_b64_tr_b16 a[130:131], v12 offset:256
    ds_read_b128 v[100:103], v51 offset:1024
    v_mfma_f32_16x16x32_bf16 v[88:91], a[212:215], v[152:155], v[88:91]
    buffer_load_dwordx4 v15, s[40:43], s78 offen lds
    v_mfma_f32_16x16x32_bf16 v[88:91], a[208:211], v[136:139], v[88:91]
    ds_read_b64_tr_b16 a[132:133], v12 offset:512
    v_mfma_f32_16x16x32_bf16 v[84:87], a[224:227], v[128:131], 0
    ds_read_b64_tr_b16 a[134:135], v12 offset:768
    v_mfma_f32_16x16x32_bf16 v[84:87], a[228:231], v[144:147], v[84:87]
    buffer_load_dwordx4 v16, s[40:43], s78 offen offset:1056 lds
    v_mfma_f32_16x16x32_bf16 v[84:87], a[232:235], v[160:163], v[84:87]
    buffer_load_dwordx2 v[120:121], v119, s[28:31], s61 offen sc1
    v_mfma_f32_16x16x32_bf16 v[84:87], a[236:239], v[176:179], v[84:87]
    ds_read_b64_tr_b16 a[136:137], v12 offset:8448
    s_waitcnt lgkmcnt(5)
    v_lshlrev_b32 v196, 16, v96
    v_mfma_f32_16x16x32_bf16 v[92:95], a[236:239], v[184:187], 0
    ds_read_b64_tr_b16 a[138:139], v12 offset:8704
    v_and_b32 v197, s68, v96
    v_mfma_f32_16x16x32_bf16 v[92:95], a[232:235], v[168:171], v[92:95]
    ds_read_b64_tr_b16 a[140:141], v12 offset:8960
    v_lshlrev_b32 v198, 16, v97
    v_and_b32 v199, s68, v97
    v_mfma_f32_16x16x32_bf16 v[92:95], a[228:231], v[152:155], v[92:95]
    buffer_load_dwordx4 v17, s[40:43], s78 offen offset:2112 lds
    v_fmac_f32 v196, v48, v164
    v_fmac_f32 v197, v48, v165
    v_mfma_f32_16x16x32_bf16 v[92:95], a[224:227], v[136:139], v[92:95]
    ds_read_b64_tr_b16 a[142:143], v12 offset:9216
    v_fmac_f32 v198, v48, v166
    v_fmac_f32 v199, v48, v167
    v_mfma_f32_16x16x32_bf16 v[64:67], a[0:3], v[192:195], v[64:67]
    ds_read_b64_tr_b16 a[144:145], v12 offset:8
    v_cvt_pk_bf16_f32 v96, v196, v197
    v_cvt_pk_bf16_f32 v97, v198, v199
    v_mfma_f32_16x16x32_bf16 v[64:67], a[4:7], v[208:211], v[64:67]
    v_lshlrev_b32 v204, 16, v98
    v_and_b32 v205, s68, v98
    v_mfma_f32_16x16x32_bf16 v[64:67], a[8:11], v[224:227], v[64:67]
    buffer_load_dwordx4 v18, s[40:43], s78 offen offset:3168 lds
    v_lshlrev_b32 v206, 16, v99
    v_and_b32 v207, s68, v99
    v_mfma_f32_16x16x32_bf16 v[132:135], a[12:15], v[240:243], v[64:67]
    ds_read_b64_tr_b16 a[146:147], v12 offset:264
    v_fmac_f32 v204, v48, v172
    v_fmac_f32 v205, v48, v173
    v_mfma_f32_16x16x32_bf16 v[72:75], a[12:15], v[248:251], v[72:75]
    ds_read_b64_tr_b16 a[148:149], v12 offset:520
    v_fmac_f32 v206, v48, v174
    v_fmac_f32 v207, v48, v175
    v_mfma_f32_16x16x32_bf16 v[72:75], a[8:11], v[232:235], v[72:75]
    s_add_u32 s77, s74, 229376
    ds_read_b64_tr_b16 a[150:151], v12 offset:776
    v_cvt_pk_bf16_f32 v98, v204, v205
    v_cvt_pk_bf16_f32 v99, v206, v207
    v_mfma_f32_16x16x32_bf16 v[72:75], a[4:7], v[216:219], v[72:75]
    s_add_u32 m0, s72, 101376
    s_waitcnt lgkmcnt(5)
    v_lshlrev_b32 v212, 16, v100
    v_and_b32 v213, s68, v100
    v_mfma_f32_16x16x32_bf16 v[148:151], a[0:3], v[200:203], v[72:75]
    ds_read_b64_tr_b16 a[152:153], v12 offset:8456
    v_lshlrev_b32 v214, 16, v101
    v_and_b32 v215, s68, v101
    v_mfma_f32_16x16x32_bf16 v[68:71], a[16:19], v[192:195], v[68:71]
    buffer_load_dwordx4 v15, s[40:43], s77 offen lds
    v_fmac_f32 v212, v49, v180
    v_fmac_f32 v213, v49, v181
    v_mfma_f32_16x16x32_bf16 v[68:71], a[20:23], v[208:211], v[68:71]
    ds_read_b64_tr_b16 a[154:155], v12 offset:8712
    v_fmac_f32 v214, v49, v182
    v_fmac_f32 v215, v49, v183
    v_mfma_f32_16x16x32_bf16 v[68:71], a[24:27], v[224:227], v[68:71]
    v_cvt_pk_bf16_f32 v100, v212, v213
    v_cvt_pk_bf16_f32 v101, v214, v215
    v_mfma_f32_16x16x32_bf16 v[140:143], a[28:31], v[240:243], v[68:71]
    ds_read_b64_tr_b16 a[156:157], v12 offset:8968
    v_lshlrev_b32 v220, 16, v102
    v_and_b32 v221, s68, v102
    v_mfma_f32_16x16x32_bf16 v[76:79], a[28:31], v[248:251], v[76:79]
    buffer_load_dwordx4 v16, s[40:43], s77 offen offset:1056 lds
    v_lshlrev_b32 v222, 16, v103
    v_and_b32 v223, s68, v103
    v_mfma_f32_16x16x32_bf16 v[76:79], a[24:27], v[232:235], v[76:79]
    ds_read_b64_tr_b16 a[158:159], v12 offset:9224
    v_fmac_f32 v220, v49, v188
    v_fmac_f32 v221, v49, v189
    v_mfma_f32_16x16x32_bf16 v[76:79], a[20:23], v[216:219], v[76:79]
    v_fmac_f32 v222, v49, v190
    v_fmac_f32 v223, v49, v191
    v_mfma_f32_16x16x32_bf16 v[156:159], a[16:19], v[200:203], v[76:79]
    ds_read_b64_tr_b16 a[160:161], v8 offset:0
    v_cvt_pk_bf16_f32 v102, v220, v221
    v_cvt_pk_bf16_f32 v103, v222, v223
    v_add_u32 v122, 1, v122
    v_mfma_f32_16x16x32_bf16 v[80:83], a[32:35], v[192:195], v[80:83]
    v_mfma_f32_16x16x32_bf16 v[80:83], a[36:39], v[208:211], v[80:83]
    ds_read_b64_tr_b16 a[162:163], v8 offset:256
    v_mfma_f32_16x16x32_bf16 v[80:83], a[40:43], v[224:227], v[80:83]
    buffer_load_dwordx4 v17, s[40:43], s77 offen offset:2112 lds
    v_mfma_f32_16x16x32_bf16 v[164:167], a[44:47], v[240:243], v[80:83]
    s_waitcnt vmcnt(16)
    s_barrier
    s_add_u32 s80, s79, 131072
    buffer_store_dwordx4 v[96:99], v1, s[28:31], s80 offen sc1
    v_mfma_f32_16x16x32_bf16 v[88:91], a[44:47], v[248:251], v[88:91]
    ds_read_b64_tr_b16 a[164:165], v8 offset:512
    v_mfma_f32_16x16x32_bf16 v[88:91], a[40:43], v[232:235], v[88:91]
    s_waitcnt vmcnt(6)
    v_subrev_u32 v56, s64, v120
    v_cmp_ne_u32 s[4:5], s95, v121
    v_cmp_lt_u32 vcc, 7, v56
    v_mfma_f32_16x16x32_bf16 v[88:91], a[36:39], v[216:219], v[88:91]
    s_add_u32 s80, s81, 131072
    buffer_store_dwordx4 v[100:103], v27, s[28:31], s80 offen sc1
    buffer_store_dwordx2 v[122:123], v55, s[28:31], s98 offen sc1
    v_mfma_f32_16x16x32_bf16 v[180:183], a[32:35], v[200:203], v[88:91]
    s_or_b64 vcc, vcc, s[4:5]
    s_cselect_b32 s67, 0, 1
    s_cselect_b64 vcc, -1, 0
    v_mfma_f32_16x16x32_bf16 v[84:87], a[48:51], v[192:195], v[84:87]
    s_mov_b64 exec, s[16:17]
    ds_write_b128 v52, v[96:99] offset:4096
    s_mov_b64 exec, -1
    v_cndmask_b32 v57, v118, v63, vcc
    v_mfma_f32_16x16x32_bf16 v[84:87], a[52:55], v[208:211], v[84:87]
    ds_read_b64_tr_b16 a[166:167], v8 offset:768
    v_mul_f32 v132, v48, v132
    v_mfma_f32_16x16x32_bf16 v[84:87], a[56:59], v[224:227], v[84:87]
    buffer_load_dwordx4 v18, s[40:43], s77 offen offset:3168 lds
    s_add_u32 s78, s74, 258048
    v_mul_f32 v133, v48, v133
    v_mfma_f32_16x16x32_bf16 v[172:175], a[60:63], v[240:243], v[84:87]
    s_add_u32 m0, s72, 105600
    ds_read_b64_tr_b16 a[168:169], v8 offset:8448
    ds_read_b64_tr_b16 a[170:171], v8 offset:8704
    v_mul_f32 v134, v48, v134
    v_mfma_f32_16x16x32_bf16 v[92:95], a[60:63], v[248:251], v[92:95]
    s_add_u32 s7, s6, s8
    buffer_load_dwordx4 v[236:239], v57, s[28:31], s7 offen sc1
    v_mul_f32 v135, v48, v135
    v_cvt_pk_bf16_f32 v132, v132, v133
    v_mfma_f32_16x16x32_bf16 v[92:95], a[56:59], v[232:235], v[92:95]
    ds_read_b64_tr_b16 a[172:173], v8 offset:8960
    ds_read_b64_tr_b16 a[174:175], v8 offset:9216
    v_cvt_pk_bf16_f32 v133, v134, v135
    v_mfma_f32_16x16x32_bf16 v[92:95], a[52:55], v[216:219], v[92:95]
    buffer_load_dwordx4 v15, s[40:43], s78 offen lds
    v_mul_f32 v140, v48, v140
    v_mfma_f32_16x16x32_bf16 v[188:191], a[48:51], v[200:203], v[92:95]
    ds_read_b64_tr_b16 a[176:177], v8 offset:8
    v_mul_f32 v141, v48, v141
    v_mul_f32 v142, v48, v142
    v_mfma_f32_16x16x32_bf16 v[64:67], a[128:131], v[128:131], 0
    buffer_load_dwordx4 v16, s[40:43], s78 offen offset:1056 lds
    v_mul_f32 v143, v48, v143
    v_mfma_f32_16x16x32_bf16 v[64:67], a[132:135], v[144:147], v[64:67]
    s_add_u32 s7, s6, s9
    buffer_load_dwordx4 v[244:247], v57, s[28:31], s7 offen sc1
    v_cvt_pk_bf16_f32 v134, v140, v141
    v_mfma_f32_16x16x32_bf16 v[64:67], a[136:139], v[160:163], v[64:67]
    s_waitcnt lgkmcnt(5)
    ds_read_b64_tr_b16 a[178:179], v8 offset:264
    v_cvt_pk_bf16_f32 v135, v142, v143
    v_mfma_f32_16x16x32_bf16 v[64:67], a[140:143], v[176:179], v[64:67]
    ds_write_b128 v50, v[132:135] offset:0
    v_mfma_f32_16x16x32_bf16 v[72:75], a[140:143], v[184:187], 0
    v_mul_f32 v148, v49, v148
    v_mul_f32 v149, v49, v149
    v_mul_f32 v150, v49, v150
    v_mfma_f32_16x16x32_bf16 v[72:75], a[136:139], v[168:171], v[72:75]
    ds_read_b64_tr_b16 a[180:181], v8 offset:520
    ds_read_b64_tr_b16 a[182:183], v8 offset:776
    v_mul_f32 v151, v49, v151
    v_mfma_f32_16x16x32_bf16 v[72:75], a[132:135], v[152:155], v[72:75]
    s_add_u32 s7, s6, s10
    buffer_load_dwordx4 v[252:255], v57, s[28:31], s7 offen sc1
    v_cvt_pk_bf16_f32 v148, v148, v149
    v_mfma_f32_16x16x32_bf16 v[72:75], a[128:131], v[136:139], v[72:75]
    buffer_load_dwordx4 v17, s[40:43], s78 offen offset:2112 lds
    v_cvt_pk_bf16_f32 v149, v150, v151
    v_mul_f32 v156, v49, v156
    v_mfma_f32_16x16x32_bf16 v[68:71], a[144:147], v[128:131], 0
    ds_read_b64_tr_b16 a[184:185], v8 offset:8456
    ds_read_b64_tr_b16 a[186:187], v8 offset:8712
    v_mul_f32 v157, v49, v157
    v_mfma_f32_16x16x32_bf16 v[68:71], a[148:151], v[144:147], v[68:71]
    buffer_load_dwordx4 v18, s[40:43], s78 offen offset:3168 lds
    v_mul_f32 v158, v49, v158
    v_mfma_f32_16x16x32_bf16 v[68:71], a[152:155], v[160:163], v[68:71]
    s_add_u32 s7, s6, s11
    buffer_load_dwordx4 v[32:35], v57, s[28:31], s7 offen sc1
    v_mul_f32 v159, v49, v159
    v_cvt_pk_bf16_f32 v150, v156, v157
    v_mfma_f32_16x16x32_bf16 v[68:71], a[156:159], v[176:179], v[68:71]
    ds_read_b64_tr_b16 a[188:189], v8 offset:8968
    v_cvt_pk_bf16_f32 v151, v158, v159
    v_mfma_f32_16x16x32_bf16 v[76:79], a[156:159], v[184:187], 0
    ds_write_b128 v50, v[148:151] offset:1024
    v_mfma_f32_16x16x32_bf16 v[76:79], a[152:155], v[168:171], v[76:79]
    v_mfma_f32_16x16x32_bf16 v[76:79], a[148:151], v[152:155], v[76:79]
    ds_read_b64_tr_b16 a[190:191], v8 offset:9224
    v_mfma_f32_16x16x32_bf16 v[76:79], a[144:147], v[136:139], v[76:79]
    s_add_u32 s7, s6, s12
    buffer_load_dwordx4 v[36:39], v57, s[28:31], s7 offen sc1
    v_mfma_f32_16x16x32_bf16 v[80:83], a[160:163], v[128:131], 0
    v_mfma_f32_16x16x32_bf16 v[80:83], a[164:167], v[144:147], v[80:83]
    s_waitcnt lgkmcnt(3)
    v_mfma_f32_16x16x32_bf16 v[80:83], a[168:171], v[160:163], v[80:83]
    s_add_u32 s7, s6, s13
    buffer_load_dwordx4 v[40:43], v57, s[28:31], s7 offen sc1
    v_mfma_f32_16x16x32_bf16 v[80:83], a[172:175], v[176:179], v[80:83]
    s_waitcnt lgkmcnt(0)
    s_barrier
    ds_read_b64_tr_b16 a[64:65], v13 offset:0
    v_mfma_f32_16x16x32_bf16 v[88:91], a[172:175], v[184:187], 0
    ds_read_b128 v[96:99], v51 offset:0
    v_mfma_f32_16x16x32_bf16 v[88:91], a[168:171], v[168:171], v[88:91]
    ds_read_b64_tr_b16 a[66:67], v13 offset:256
    ds_read_b128 v[100:103], v51 offset:1024
    v_mfma_f32_16x16x32_bf16 v[88:91], a[164:167], v[152:155], v[88:91]
    ds_read_b64_tr_b16 a[68:69], v13 offset:512
    v_mfma_f32_16x16x32_bf16 v[88:91], a[160:163], v[136:139], v[88:91]
    ds_read_b64_tr_b16 a[70:71], v13 offset:768
    v_mfma_f32_16x16x32_bf16 v[84:87], a[176:179], v[128:131], 0
    ds_read_b64_tr_b16 a[72:73], v13 offset:8448
    v_mfma_f32_16x16x32_bf16 v[84:87], a[180:183], v[144:147], v[84:87]
    s_add_u32 s7, s6, s14
    buffer_load_dwordx4 v[44:47], v57, s[28:31], s7 offen sc1
    v_mfma_f32_16x16x32_bf16 v[84:87], a[184:187], v[160:163], v[84:87]
    ds_read_b64_tr_b16 a[74:75], v13 offset:8704
    ds_read_b64_tr_b16 a[76:77], v13 offset:8960
    v_mfma_f32_16x16x32_bf16 v[84:87], a[188:191], v[176:179], v[84:87]
    ds_read_b64_tr_b16 a[78:79], v13 offset:9216
    s_waitcnt lgkmcnt(8)
    v_lshlrev_b32 v196, 16, v96
    v_mfma_f32_16x16x32_bf16 v[92:95], a[188:191], v[184:187], 0
    ds_read_b64_tr_b16 a[192:193], v13 offset:8
    v_and_b32 v197, s68, v96
    v_lshlrev_b32 v198, 16, v97
    v_mfma_f32_16x16x32_bf16 v[92:95], a[184:187], v[168:171], v[92:95]
    ds_read_b64_tr_b16 a[194:195], v13 offset:264
    v_and_b32 v199, s68, v97
    v_fmac_f32 v196, v48, v164
    v_fmac_f32 v197, v48, v165
    v_mfma_f32_16x16x32_bf16 v[92:95], a[180:183], v[152:155], v[92:95]
    ds_read_b64_tr_b16 a[196:197], v13 offset:520
    v_fmac_f32 v198, v48, v166
    v_fmac_f32 v199, v48, v167
    v_cvt_pk_bf16_f32 v96, v196, v197
    v_mfma_f32_16x16x32_bf16 v[92:95], a[176:179], v[136:139], v[92:95]
    s_waitcnt lgkmcnt(7)
    ds_read_b64_tr_b16 a[198:199], v13 offset:776
    v_cvt_pk_bf16_f32 v97, v198, v199
    v_lshlrev_b32 v204, 16, v98
    v_and_b32 v205, s68, v98
    v_mfma_f32_16x16x32_bf16 v[64:67], a[64:67], v[192:195], v[64:67]
    ds_read_b64_tr_b16 a[200:201], v13 offset:8456
    v_lshlrev_b32 v206, 16, v99
    v_and_b32 v207, s68, v99
    v_fmac_f32 v204, v48, v172
    v_mfma_f32_16x16x32_bf16 v[64:67], a[68:71], v[208:211], v[64:67]
    s_waitcnt lgkmcnt(7)
    ds_read_b64_tr_b16 a[202:203], v13 offset:8712
    v_fmac_f32 v205, v48, v173
    v_fmac_f32 v206, v48, v174
    v_fmac_f32 v207, v48, v175
    v_mfma_f32_16x16x32_bf16 v[64:67], a[72:75], v[224:227], v[64:67]
    s_waitcnt lgkmcnt(6)
    ds_read_b64_tr_b16 a[204:205], v13 offset:8968
    v_cvt_pk_bf16_f32 v98, v204, v205
    v_cvt_pk_bf16_f32 v99, v206, v207
    v_mfma_f32_16x16x32_bf16 v[132:135], a[76:79], v[240:243], v[64:67]
    ds_read_b64_tr_b16 a[206:207], v13 offset:9224
    v_lshlrev_b32 v212, 16, v100
    v_and_b32 v213, s68, v100
    v_lshlrev_b32 v214, 16, v101
    v_mfma_f32_16x16x32_bf16 v[72:75], a[76:79], v[248:251], v[72:75]
    ds_read_b64_tr_b16 a[208:209], v9 offset:0
    v_and_b32 v215, s68, v101
    v_fmac_f32 v212, v49, v180
    v_fmac_f32 v213, v49, v181
    v_mfma_f32_16x16x32_bf16 v[72:75], a[72:75], v[232:235], v[72:75]
    ds_read_b64_tr_b16 a[210:211], v9 offset:256
    v_fmac_f32 v214, v49, v182
    v_fmac_f32 v215, v49, v183
    v_cvt_pk_bf16_f32 v100, v212, v213
    v_mfma_f32_16x16x32_bf16 v[72:75], a[68:71], v[216:219], v[72:75]
    ds_read_b64_tr_b16 a[212:213], v9 offset:512
    v_cvt_pk_bf16_f32 v101, v214, v215
    v_lshlrev_b32 v220, 16, v102
    v_and_b32 v221, s68, v102
    v_mfma_f32_16x16x32_bf16 v[148:151], a[64:67], v[200:203], v[72:75]
    s_waitcnt lgkmcnt(7)
    ds_read_b64_tr_b16 a[214:215], v9 offset:768
    v_lshlrev_b32 v222, 16, v103
    v_and_b32 v223, s68, v103
    v_fmac_f32 v220, v49, v188
    v_mfma_f32_16x16x32_bf16 v[68:71], a[192:195], v[192:195], v[68:71]
    ds_read_b64_tr_b16 a[216:217], v9 offset:8448
    v_fmac_f32 v221, v49, v189
    v_fmac_f32 v222, v49, v190
    v_fmac_f32 v223, v49, v191
    v_mfma_f32_16x16x32_bf16 v[68:71], a[196:199], v[208:211], v[68:71]
    s_waitcnt lgkmcnt(7)
    ds_read_b64_tr_b16 a[218:219], v9 offset:8704
    v_cvt_pk_bf16_f32 v102, v220, v221
    v_cvt_pk_bf16_f32 v103, v222, v223
    v_mfma_f32_16x16x32_bf16 v[68:71], a[200:203], v[224:227], v[68:71]
    s_waitcnt lgkmcnt(6)
    ds_read_b64_tr_b16 a[220:221], v9 offset:8960
    v_mfma_f32_16x16x32_bf16 v[140:143], a[204:207], v[240:243], v[68:71]
    ds_read_b64_tr_b16 a[222:223], v9 offset:9216
    v_mfma_f32_16x16x32_bf16 v[76:79], a[204:207], v[248:251], v[76:79]
    ds_read_b64_tr_b16 a[224:225], v9 offset:8
    v_mfma_f32_16x16x32_bf16 v[76:79], a[200:203], v[232:235], v[76:79]
    s_add_u32 s80, s79, 163840
    buffer_store_dwordx4 v[96:99], v1, s[28:31], s80 offen sc1
    v_mfma_f32_16x16x32_bf16 v[76:79], a[196:199], v[216:219], v[76:79]
    ds_read_b64_tr_b16 a[226:227], v9 offset:264
    ds_read_b64_tr_b16 a[228:229], v9 offset:520
    v_mfma_f32_16x16x32_bf16 v[156:159], a[192:195], v[200:203], v[76:79]
    s_waitcnt lgkmcnt(7)
    ds_read_b64_tr_b16 a[230:231], v9 offset:776
    v_mfma_f32_16x16x32_bf16 v[80:83], a[208:211], v[192:195], v[80:83]
    s_add_u32 s80, s81, 163840
    buffer_store_dwordx4 v[100:103], v27, s[28:31], s80 offen sc1
    v_mfma_f32_16x16x32_bf16 v[80:83], a[212:215], v[208:211], v[80:83]
    s_waitcnt lgkmcnt(6)
    ds_read_b64_tr_b16 a[232:233], v9 offset:8456
    ds_read_b64_tr_b16 a[234:235], v9 offset:8712
    v_mfma_f32_16x16x32_bf16 v[80:83], a[216:219], v[224:227], v[80:83]
    s_waitcnt lgkmcnt(6)
    s_mov_b64 exec, s[16:17]
    ds_write_b128 v52, v[96:99] offset:5120
    s_mov_b64 exec, -1
    v_mfma_f32_16x16x32_bf16 v[164:167], a[220:223], v[240:243], v[80:83]
    v_subrev_u32 v50, 135168, v50
    v_subrev_u32 v51, 135168, v51
    v_mfma_f32_16x16x32_bf16 v[88:91], a[220:223], v[248:251], v[88:91]
    ds_read_b64_tr_b16 a[236:237], v9 offset:8968
    ds_read_b64_tr_b16 a[238:239], v9 offset:9224
    v_mul_f32 v132, v48, v132
    v_mfma_f32_16x16x32_bf16 v[88:91], a[216:219], v[232:235], v[88:91]
    v_mul_f32 v133, v48, v133
    v_mul_f32 v134, v48, v134
    v_mfma_f32_16x16x32_bf16 v[88:91], a[212:215], v[216:219], v[88:91]
    v_mul_f32 v135, v48, v135
    v_cvt_pk_bf16_f32 v132, v132, v133
    v_mfma_f32_16x16x32_bf16 v[180:183], a[208:211], v[200:203], v[88:91]
    s_waitcnt lgkmcnt(4)
    v_cvt_pk_bf16_f32 v133, v134, v135
    v_mul_f32 v140, v48, v140
    v_mul_f32 v141, v48, v141
    v_mfma_f32_16x16x32_bf16 v[84:87], a[224:227], v[192:195], v[84:87]
    v_mul_f32 v142, v48, v142
    v_mul_f32 v143, v48, v143
    v_mfma_f32_16x16x32_bf16 v[84:87], a[228:231], v[208:211], v[84:87]
    s_waitcnt lgkmcnt(2)
    v_cvt_pk_bf16_f32 v134, v140, v141
    v_cvt_pk_bf16_f32 v135, v142, v143
    v_mfma_f32_16x16x32_bf16 v[84:87], a[232:235], v[224:227], v[84:87]
    s_waitcnt lgkmcnt(0)
    ds_write_b128 v50, v[132:135] offset:0
    v_mfma_f32_16x16x32_bf16 v[172:175], a[236:239], v[240:243], v[84:87]
    v_mul_f32 v148, v49, v148
    v_mul_f32 v149, v49, v149
    v_mul_f32 v150, v49, v150
    v_mul_f32 v151, v49, v151
    v_mfma_f32_16x16x32_bf16 v[92:95], a[236:239], v[248:251], v[92:95]
    v_cvt_pk_bf16_f32 v148, v148, v149
    v_cvt_pk_bf16_f32 v149, v150, v151
    v_mfma_f32_16x16x32_bf16 v[92:95], a[232:235], v[232:235], v[92:95]
    v_mul_f32 v156, v49, v156
    v_mul_f32 v157, v49, v157
    v_mul_f32 v158, v49, v158
    v_mfma_f32_16x16x32_bf16 v[92:95], a[228:231], v[216:219], v[92:95]
    v_mul_f32 v159, v49, v159
    v_cvt_pk_bf16_f32 v150, v156, v157
    v_mfma_f32_16x16x32_bf16 v[188:191], a[224:227], v[200:203], v[92:95]
    v_cvt_pk_bf16_f32 v151, v158, v159
    ds_write_b128 v50, v[148:151] offset:1024
    v_add_u32 v122, 1, v122
    s_waitcnt vmcnt(6) lgkmcnt(0)
    s_barrier
    ds_read_b128 v[96:99], v51 offset:0
    ds_read_b128 v[100:103], v51 offset:1024
    buffer_store_dwordx2 v[122:123], v55, s[28:31], s98 offen sc1
    buffer_load_dwordx2 v[120:121], v125, s[28:31], s61 offen sc1
    s_waitcnt lgkmcnt(1)
    v_lshlrev_b32 v196, 16, v96
    v_and_b32 v197, s68, v96
    v_lshlrev_b32 v198, 16, v97
    v_and_b32 v199, s68, v97
    v_fmac_f32 v196, v48, v164
    v_fmac_f32 v197, v48, v165
    v_fmac_f32 v198, v48, v166
    v_fmac_f32 v199, v48, v167
    v_cvt_pk_bf16_f32 v96, v196, v197
    v_cvt_pk_bf16_f32 v97, v198, v199
    v_lshlrev_b32 v204, 16, v98
    v_and_b32 v205, s68, v98
    v_lshlrev_b32 v206, 16, v99
    v_and_b32 v207, s68, v99
    v_fmac_f32 v204, v48, v172
    v_fmac_f32 v205, v48, v173
    v_fmac_f32 v206, v48, v174
    v_fmac_f32 v207, v48, v175
    v_cvt_pk_bf16_f32 v98, v204, v205
    v_cvt_pk_bf16_f32 v99, v206, v207
    s_add_u32 s80, s79, 196608
    buffer_store_dwordx4 v[96:99], v1, s[28:31], s80 offen sc1
    s_waitcnt lgkmcnt(0)
    v_lshlrev_b32 v212, 16, v100
    v_and_b32 v213, s68, v100
    v_lshlrev_b32 v214, 16, v101
    v_and_b32 v215, s68, v101
    v_fmac_f32 v212, v49, v180
    v_fmac_f32 v213, v49, v181
    v_fmac_f32 v214, v49, v182
    v_fmac_f32 v215, v49, v183
    v_cvt_pk_bf16_f32 v100, v212, v213
    v_cvt_pk_bf16_f32 v101, v214, v215
    v_lshlrev_b32 v220, 16, v102
    v_and_b32 v221, s68, v102
    v_lshlrev_b32 v222, 16, v103
    v_and_b32 v223, s68, v103
    v_fmac_f32 v220, v49, v188
    v_fmac_f32 v221, v49, v189
    v_fmac_f32 v222, v49, v190
    v_fmac_f32 v223, v49, v191
    v_cvt_pk_bf16_f32 v102, v220, v221
    v_cvt_pk_bf16_f32 v103, v222, v223
    s_add_u32 s80, s81, 196608
    buffer_store_dwordx4 v[100:103], v27, s[28:31], s80 offen sc1
    s_mov_b64 exec, s[16:17]
    ds_write_b128 v52, v[96:99] offset:6144
    s_mov_b64 exec, -1
    s_branch L_tail
.section .rodata,"a"
.p2align 6
.amdhsa_kernel adaLN_cond__sliding_block_cached__dense_activation_relu__prompt_kernel
  .amdhsa_next_free_vgpr 512
  .amdhsa_next_free_sgpr 102
  .amdhsa_accum_offset 256
  .amdhsa_group_segment_fixed_size 0
  .amdhsa_kernarg_size 104
  .amdhsa_user_sgpr_count 2
  .amdhsa_user_sgpr_kernarg_segment_ptr 1
  .amdhsa_system_sgpr_workgroup_id_x 1
.end_amdhsa_kernel
```
